```python
import torch

def _softmax(x, axis=-1):
    return torch.softmax(x, dim=axis)
def _gelu(x):
    return torch.nn.functional.gelu(x, approximate="tanh")
def _silu(x):
    return torch.nn.functional.silu(x)
def _sigmoid(x):
    return torch.sigmoid(x)
def _layernorm(x, axis=-1, eps=1e-5):
    m = x.mean(dim=axis, keepdim=True)
    v = x.var(dim=axis, keepdim=True, unbiased=False)
    return (x - m) / torch.sqrt(v + eps)
def _scatter_add(tgt, idx, src, axis=0):
    return tgt.clone().index_add_(axis, idx, src)
def _segment_sum(src, seg, n):
    out = torch.zeros((n,) + src.shape[1:], dtype=src.dtype)
    return out.index_add_(0, seg, src)
def _pad(x, pw):
    flat = tuple(v for pair in reversed(pw) for v in pair)
    return torch.nn.functional.pad(x, flat)

kernel_name = 'sequential_preLN__softmax_full_mha__glu_gated_swiglu__prompt'

def setup_inputs():

    _w = (lambda a: (lambda t: t.to(torch.bfloat16) if t.is_floating_point() else t)(torch.as_tensor(a)))
    def _A_setup():
        B, S, D = 1, 2048, 1024
        return {
            "x": _w((lambda *s: torch.randn(*s, dtype=torch.bfloat16) * 0.05)(B, S, D)),
            "wqkv": _w((lambda *s: torch.randn(*s, dtype=torch.bfloat16) * 0.05)(D, 3 * D)),
            "wo": _w((lambda *s: torch.randn(*s, dtype=torch.bfloat16) * 0.05)(D, D)),
        }
    _A_in = _A_setup()

    def _B_setup():
        B, S, D, F = 1, 2048, 1024, 3584
        return {
            "x": _w((lambda *s: torch.randn(*s, dtype=torch.bfloat16) * 0.05)(B, S, D)),
            "w1": _w((lambda *s: torch.randn(*s, dtype=torch.bfloat16) * 0.8)(D, F) * (2.0 / D) ** 0.5),
            "w3": _w((lambda *s: torch.randn(*s, dtype=torch.bfloat16) * 0.8)(D, F) * (2.0 / D) ** 0.5),
            "w2": _w((lambda *s: torch.randn(*s, dtype=torch.bfloat16) * 0.8)(F, D) * (2.0 / F) ** 0.5),
        }
    _B_in = _B_setup()

    return {
        "A_x": _A_in["x"],
        "A_wqkv": _A_in["wqkv"],
        "A_wo": _A_in["wo"],
        "B_x": _B_in["x"],
        "B_w1": _B_in["w1"],
        "B_w3": _B_in["w3"],
        "B_w2": _B_in["w2"],
    }

def reference(A_x, A_wqkv, A_wo, B_x, B_w1, B_w3, B_w2):
    def _A_ref(x, wqkv, wo):
        B, S, D = x.shape
        H = 32; Dh = D // H
        qkv = (lambda x, *d: x.permute(*d))((x @ wqkv).reshape(B, S, 3, H, Dh), 2, 0, 3, 1, 4)
        q, k, v = qkv[0], qkv[1], qkv[2]
        scale = Dh ** -0.5
        scores = torch.einsum("bhqd,bhkd->bhqk", q, k) * scale
        p = _softmax(scores, axis=-1)
        o = torch.einsum("bhqk,bhkd->bhqd", p, v)
        return (lambda x, *d: x.permute(*d))(o, 0, 2, 1, 3).reshape(B, S, D) @ wo

    def _B_ref(x, w1, w3, w2):
        gate = torch.einsum("bsd,df->bsf", x, w1)
        up = torch.einsum("bsd,df->bsf", x, w3)
        h = _silu(gate) * up
        out = torch.einsum("bsf,fd->bsd", h, w2)
        return out

    x = A_x
    h = x + _A_ref(_layernorm(x, axis=-1), A_wqkv, A_wo)
    h2 = h + _B_ref(_layernorm(h, axis=-1), B_w1, B_w3, B_w2)
    return h2
```

```asm
; @launch grid=(256,1,1) block=(256,1,1) lds=163840
.amdgcn_target "amdgcn-amd-amdhsa--gfx950"
.text
.globl sequential_preLN__softmax_full_mha__glu_gated_swiglu__prompt_kernel
.p2align 12
.p2align 8
.type sequential_preLN__softmax_full_mha__glu_gated_swiglu__prompt_kernel,@function
sequential_preLN__softmax_full_mha__glu_gated_swiglu__prompt_kernel:
    s_cmp_ge_u32 s2, 256
    s_cbranch_scc1 L_sequential_preLN__softmax_full_mha__glu_gated_swiglu__prompt_kernel_end
    s_load_dwordx16 s[4:19], s[0:1], 0
    s_load_dwordx4 s[20:23], s[0:1], 64
    v_lshrrev_b32 v1, 6, v0
    v_and_b32 v0, 63, v0
    v_readfirstlane_b32 s3, v1
    s_and_b32 s44, s2, 7
    s_lshr_b32 s45, s2, 3
    v_mov_b32 v122, v0
    s_and_b32 s46, s45, 7
    s_and_b32 s47, s44, 1
    s_lshl_b32 s46, s46, 1
    s_add_u32 s46, s46, s47
    s_lshr_b32 s47, s44, 1
    s_lshl_b32 s47, s47, 2
    s_lshr_b32 s48, s45, 3
    s_add_u32 s47, s47, s48
    s_lshr_b32 s48, s3, 1
    s_and_b32 s49, s3, 1
    v_lshrrev_b32 v124, 3, v122
    v_and_b32 v125, 7, v122
    v_lshrrev_b32 v126, 1, v124
    v_xor_b32 v127, v125, v126
    s_lshl_b32 s50, s46, 7
    s_lshl_b32 s51, s3, 5
    s_add_u32 s50, s50, s51
    s_lshl_b32 s50, s50, 11
    v_lshlrev_b32 v128, 11, v124
    v_add_u32 v128, s50, v128
    v_lshl_add_u32 v96, v127, 4, v128
    v_xor_b32 v127, 4, v127
    v_lshl_add_u32 v97, v127, 4, v128
    v_add_u32 v98, 30720, v96
    v_add_u32 v99, 46080, v97
    v_add_u32 v97, 15360, v97
    v_and_b32 v126, 1, v126
    v_lshlrev_b32 v126, 1, v126
    v_xor_b32 v127, v125, v126
    v_mul_u32_u24 v128, 6144, v124
    s_mul_i32 s50, s3, 98304
    s_lshl_b32 s51, s47, 7
    s_add_u32 s50, s50, s51
    v_add_u32 v128, s50, v128
    v_lshl_add_u32 v100, v127, 4, v128
    v_xor_b32 v127, 4, v127
    v_lshl_add_u32 v101, v127, 4, v128
    v_add_u32 v101, 48128, v101
    v_add_u32 v102, 2048, v100
    v_add_u32 v103, 2048, v101
    v_add_u32 v104, 4096, v100
    v_add_u32 v105, 4096, v101
    s_lshl_b32 s53, s3, 12
    s_lshl_b32 s54, s3, 11
    s_add_u32 s54, s54, 16384
    s_mov_b32 s59, 1073741824
    s_mov_b32 s63, s46
    s_mul_i32 s56, s63, 393216
    s_lshl_b32 s57, s63, 7
    v_lshlrev_b32 v135, 4, v122
    s_lshl_b32 s64, s46, 4
    s_add_u32 s64, s64, s47
    s_lshl_b32 s64, s64, 2
    s_add_u32 s64, s64, s3
    s_lshl_b32 s65, s64, 12
    s_lshl_b32 s66, s64, 8
    s_lshl_b32 s67, s47, 1
    s_add_u32 s67, s67, s49
    s_getpc_b64 s[76:77]
L_sequential_preLN__softmax_full_mha__glu_gated_swiglu__prompt_kernel_pc_1:
    s_add_u32 s76, s76, sequential_preLN__softmax_full_mha__glu_gated_swiglu__prompt_kernel-L_sequential_preLN__softmax_full_mha__glu_gated_swiglu__prompt_kernel_pc_1
    s_addc_u32 s77, s77, (sequential_preLN__softmax_full_mha__glu_gated_swiglu__prompt_kernel-L_sequential_preLN__softmax_full_mha__glu_gated_swiglu__prompt_kernel_pc_1)>>32
    s_lshl_b32 s78, s45, 2
    s_add_u32 s78, s78, s3
    s_lshl_b32 s78, s78, 9
    v_and_b32 v132, 3, v122
    v_lshl_add_u32 v132, v132, 7, s78
    v_min_u32 v132, L_sequential_preLN__softmax_full_mha__glu_gated_swiglu__prompt_kernel_end-sequential_preLN__softmax_full_mha__glu_gated_swiglu__prompt_kernel, v132
    v_mov_b32 v133, s77
    v_add_co_u32 v132, vcc, s76, v132
    s_nop 1
    v_addc_co_u32 v133, vcc, 0, v133, vcc
    v_min_u32 v134, 23, v122
    v_lshlrev_b32 v134, 11, v134
    s_lshl_b32 s58, s45, 2
    s_add_u32 s58, s58, s3
    s_mul_i32 s58, s58, 49152
    s_or_b32 s51, s47, 3
    s_lshl_b32 s51, s51, 7
    s_add_u32 s58, s58, s51
    s_bitcmp1_b32 s47, 2
    s_cselect_b32 s58, s59, s58
    s_waitcnt lgkmcnt(0)
    s_mov_b32 s24, s6
    s_mov_b32 s25, s7
    s_mov_b32 s26, 0x600000
    s_mov_b32 s27, 0x20000
    s_mov_b32 s28, s4
    s_mov_b32 s29, s5
    s_mov_b32 s30, 0x400000
    s_mov_b32 s31, 0x20000
    global_load_dword v123, v[132:133], off
    s_add_u32 m0, s53, 0
    s_nop 0
    buffer_load_dwordx4 v96, s[28:31], s57 offen offset:0  lds
    buffer_load_dwordx4 v97, s[28:31], s57 offen offset:1024  lds
    buffer_load_dwordx4 v98, s[28:31], s57 offen offset:2048  lds
    buffer_load_dwordx4 v99, s[28:31], s57 offen offset:3072  lds
    s_add_u32 m0, s54, 0
    s_nop 0
    buffer_load_dwordx4 v100, s[24:27], s56 offen offset:0  lds
    buffer_load_dwordx4 v101, s[24:27], s56 offen offset:1024  lds
    s_add_u32 m0, s54, 8192
    s_nop 0
    buffer_load_dwordx4 v102, s[24:27], s56 offen offset:0  lds
    s_add_u32 s36, s22, 0x1400000
    s_addc_u32 s37, s23, 0
    s_mov_b32 s38, 0x40000
    s_mov_b32 s39, 0x20000
    s_add_u32 s40, s22, 0x1600000
    s_addc_u32 s41, s23, 0
    s_mov_b32 s42, 0x44000
    s_mov_b32 s43, 0x20000
    s_mov_b32 s32, s20
    s_mov_b32 s33, s21
    s_mov_b32 s34, 0x100
    s_mov_b32 s35, 0x20000
    v_and_b32 v124, 15, v122
    v_lshrrev_b32 v125, 4, v122
    v_lshrrev_b32 v126, 1, v124
    v_xor_b32 v126, v125, v126
    s_lshl_b32 s50, s48, 13
    v_lshlrev_b32 v127, 7, v124
    v_add_u32 v127, s50, v127
    v_lshl_add_u32 v106, v126, 4, v127
    v_xor_b32 v107, 64, v106
    v_lshrrev_b32 v126, 2, v124
    v_lshl_add_u32 v127, v125, 3, v126
    v_lshrrev_b32 v126, 1, v126
    v_and_b32 v128, 1, v125
    v_lshl_add_u32 v126, v128, 1, v126
    s_lshl_b32 s50, s49, 1
    v_xor_b32 v126, s50, v126
    v_lshlrev_b32 v126, 5, v126
    v_lshl_add_u32 v126, v127, 7, v126
    v_and_b32 v128, 3, v122
    v_lshl_add_u32 v126, v128, 3, v126
    v_add_u32 v114, 16384, v126
    v_xor_b32 v115, 32, v114
    v_mov_b32 v129, 0x3f803f80
    v_add_u32 v108, 40960, v106
    v_add_u32 v116, 40960, v114
    v_add_u32 v109, 40960, v107
    v_add_u32 v117, 40960, v115
    v_add_u32 v110, 81920, v106
    v_add_u32 v118, 81920, v114
    v_add_u32 v111, 81920, v107
    v_add_u32 v119, 81920, v115
    v_add_u32 v112, 122880, v106
    v_add_u32 v120, 122880, v114
    v_add_u32 v113, 122880, v107
    v_add_u32 v121, 122880, v115
    v_cmp_eq_u32 vcc, 0, v124
    s_nop 1
    v_cndmask_b32 v192, 0, v129, vcc
    v_mov_b32 v193, v192
    v_mov_b32 v194, v192
    v_mov_b32 v195, v192
    v_cmp_eq_u32 vcc, 1, v124
    s_nop 1
    v_cndmask_b32 v196, 0, v129, vcc
    v_mov_b32 v197, v196
    v_mov_b32 v198, v196
    v_mov_b32 v199, v196
    v_cmp_eq_u32 vcc, 2, v124
    s_nop 1
    v_cndmask_b32 v200, 0, v129, vcc
    v_mov_b32 v201, v200
    v_mov_b32 v202, v200
    v_mov_b32 v203, v200
    v_cmp_eq_u32 vcc, 3, v124
    s_nop 1
    v_cndmask_b32 v204, 0, v129, vcc
    v_mov_b32 v205, v204
    v_mov_b32 v206, v204
    v_mov_b32 v207, v204
    s_getpc_b64 s[76:77]
L_sequential_preLN__softmax_full_mha__glu_gated_swiglu__prompt_kernel_b_pc_1:
    s_add_u32 s76, s76, L_att_code-L_sequential_preLN__softmax_full_mha__glu_gated_swiglu__prompt_kernel_b_pc_1
    s_addc_u32 s77, s77, (L_att_code-L_sequential_preLN__softmax_full_mha__glu_gated_swiglu__prompt_kernel_b_pc_1)>>32
    s_lshl_b32 s78, s45, 2
    s_add_u32 s78, s78, s3
    s_lshl_b32 s78, s78, 9
    v_and_b32 v252, 3, v122
    v_lshl_add_u32 v252, v252, 7, s78
    v_min_u32 v252, L_sequential_preLN__softmax_full_mha__glu_gated_swiglu__prompt_kernel_end-L_att_code, v252
    v_mov_b32 v253, s77
    v_add_co_u32 v252, vcc, s76, v252
    s_nop 1
    v_addc_co_u32 v253, vcc, 0, v253, vcc
    v_mov_b32 v232, v122
    v_mov_b32 v233, v135
    v_mov_b32 v176, 0
    v_mov_b32 v177, 0
    v_mov_b32 v178, 0
    v_mov_b32 v179, 0
    v_mov_b32 v180, 0
    v_mov_b32 v181, 0
    v_mov_b32 v182, 0
    v_mov_b32 v183, 0
    v_mov_b32 v184, 0
    v_mov_b32 v185, 0
    v_mov_b32 v186, 0
    v_mov_b32 v187, 0
    v_mov_b32 v188, 0
    v_mov_b32 v189, 0
    v_mov_b32 v190, 0
    v_mov_b32 v191, 0
    v_add_u32 v224, 0, v122
    v_mul_u32_u24 v225, 74899, v224
    v_lshrrev_b32 v225, 20, v225
    v_mul_u32_u24 v225, 6944, v225
    v_lshl_add_u32 v168, v224, 4, v225
    v_add_u32 v224, 64, v122
    v_mul_u32_u24 v225, 74899, v224
    v_lshrrev_b32 v225, 20, v225
    v_mul_u32_u24 v225, 6944, v225
    v_lshl_add_u32 v169, v224, 4, v225
    v_subrev_u32 v169, 1024, v169
    v_add_u32 v224, 128, v122
    v_mul_u32_u24 v225, 74899, v224
    v_lshrrev_b32 v225, 20, v225
    v_mul_u32_u24 v225, 6944, v225
    v_lshl_add_u32 v170, v224, 4, v225
    v_subrev_u32 v170, 2048, v170
    v_add_u32 v224, 192, v122
    v_mul_u32_u24 v225, 74899, v224
    v_lshrrev_b32 v225, 20, v225
    v_mul_u32_u24 v225, 6944, v225
    v_lshl_add_u32 v171, v224, 4, v225
    v_subrev_u32 v171, 3072, v171
    v_add_u32 v224, 256, v122
    v_mul_u32_u24 v225, 74899, v224
    v_lshrrev_b32 v225, 20, v225
    v_mul_u32_u24 v225, 6944, v225
    v_lshl_add_u32 v172, v224, 4, v225
    v_add_u32 v224, 320, v122
    v_mul_u32_u24 v225, 74899, v224
    v_lshrrev_b32 v225, 20, v225
    v_mul_u32_u24 v225, 6944, v225
    v_lshl_add_u32 v173, v224, 4, v225
    v_subrev_u32 v173, 1024, v173
    v_add_u32 v224, 384, v122
    v_mul_u32_u24 v225, 74899, v224
    v_lshrrev_b32 v225, 20, v225
    v_mul_u32_u24 v225, 6944, v225
    v_lshl_add_u32 v174, v224, 4, v225
    v_subrev_u32 v174, 2048, v174
    v_and_b32 v224, 6, v124
    v_cmp_eq_u32 vcc, 0, v224
    v_mov_b32 v225, 0x3f803f80
    v_mov_b32 v226, 0x44444444
    v_cndmask_b32 v152, 0, v225, vcc
    v_cmp_eq_u32 vcc, 4, v224
    v_mov_b32 v153, v152
    v_and_b32 v224, 1, v124
    v_cndmask_b32 v154, 0, v225, vcc
    v_cmp_eq_u32 vcc, 0, v224
    v_mov_b32 v155, v154
    v_mov_b32 v227, 0xeeeeeeee
    v_cndmask_b32 v156, v227, v226, vcc
    s_lshl_b32 s51, s3, 13
    v_add_u32 v157, s51, v135
    s_lshl_b32 s51, s3, 12
    s_add_u32 s51, s51, 0x8000
    v_add_u32 v158, s51, v135
    v_xor_b32 v160, 0x2000, v158
    v_lshrrev_b32 v224, 3, v122
    v_and_b32 v225, 7, v122
    v_and_b32 v226, 6, v224
    v_xor_b32 v225, v225, v226
    v_lshlrev_b32 v224, 11, v224
    v_lshl_add_u32 v161, v225, 4, v224
    v_mov_b32 v163, v135
    s_lshl_b32 s51, s3, 13
    s_add_u32 s51, s51, 0x20000
    v_and_b32 v226, 3, v122
    v_lshl_add_u32 v226, v226, 3, s51
    v_lshrrev_b32 v224, 2, v122
    v_mul_u32_u24 v224, 224, v224
    v_add_u32 v159, v224, v226
    s_mul_i32 s51, s3, 24576
    s_add_u32 s51, s51, -114688
    v_add_u32 v162, s51, v159
    v_lshlrev_b32 v234, 7, v124
    v_and_b32 v224, 31, v122
    v_lshrrev_b32 v224, 2, v224
    v_lshrrev_b32 v225, 5, v122
    v_lshl_add_u32 v225, v225, 4, v224
    v_lshrrev_b32 v224, 1, v224
    v_lshlrev_b32 v224, 5, v224
    v_lshl_add_u32 v224, v225, 7, v224
    v_add_u32 v248, v224, v226
    v_xor_b32 v249, 32, v248
    v_xor_b32 v250, 64, v248
    v_xor_b32 v251, 96, v248
    v_and_b32 v224, 1, v125
    v_lshrrev_b32 v225, 1, v125
    v_lshlrev_b32 v224, 5, v224
    v_lshl_add_u32 v224, v225, 4, v224
    v_lshl_add_u32 v236, v124, 11, v224
    v_lshrrev_b32 v224, 2, v122
    v_lshlrev_b32 v237, 7, v122
    v_lshl_add_u32 v237, v224, 20, v237
    v_bfe_u32 v224, v163, 7, 2
    v_add_u32 v224, 1, v224
    v_lshrrev_b32 v224, 2, v224
    v_mul_u32_u24 v224, 16776832, v224
    v_add_u32 v163, v163, v224
    v_add_u32 v239, 15360, v161
    v_and_b32 v224, 1, v125
    v_lshrrev_b32 v225, 1, v125
    v_lshlrev_b32 v235, 4, v124
    v_lshl_add_u32 v235, v224, 15, v235
    v_lshl_add_u32 v235, v225, 8, v235
    v_bfe_u32 v224, v235, 7, 2
    v_add_u32 v224, 1, v224
    v_lshrrev_b32 v224, 2, v224
    v_mul_u32_u24 v224, 16776832, v224
    v_add_u32 v235, v235, v224
    v_accvgpr_write_b32 a248, -1
    v_accvgpr_write_b32 a249, -1
    v_accvgpr_write_b32 a250, -1
    v_accvgpr_write_b32 a251, -1
    s_lshl_b32 s50, s67, 6
    s_lshl_b32 s51, s46, 2
    s_add_u32 s50, s50, s51
    s_lshl_b32 s51, s48, 1
    s_add_u32 s50, s50, s51
    s_lshl_b32 s60, s50, 11
    s_lshl_b32 s61, s50, 12
    s_add_u32 s62, s61, 4096
    v_lshlrev_b32 v242, 9, v125
    v_lshl_add_u32 v243, v124, 4, v242
    v_lshrrev_b32 v244, 3, v124
    v_and_b32 v245, 7, v124
    v_lshl_add_u32 v244, v244, 4, v245
    v_and_b32 v245, 1, v125
    v_lshlrev_b32 v245, 10, v245
    v_lshrrev_b32 v242, 1, v125
    v_lshl_add_u32 v245, v242, 9, v245
    v_lshl_add_u32 v244, v244, 4, v245
    s_lshl_b32 s55, s3, 13
    v_add_u32 v246, s55, v243
    v_add_u32 v247, s55, v244
    v_lshrrev_b32 v240, 2, v124
    v_and_b32 v241, 3, v124
    v_lshl_add_u32 v241, v125, 2, v241
    v_lshl_add_u32 v241, v240, 4, v241
    v_lshlrev_b32 v241, 3, v241
    v_lshlrev_b32 v240, 3, v122
    v_mov_b32 v216, 0x3f803f80
    buffer_load_dwordx4 v103, s[24:27], s56 offen offset:1024  lds
    s_add_u32 m0, s54, 16384
    s_nop 0
    buffer_load_dwordx4 v104, s[24:27], s56 offen offset:0  lds
    buffer_load_dwordx4 v105, s[24:27], s56 offen offset:1024  lds
    buffer_load_dword v123, v134, s[24:27], s58 offen
    buffer_load_dwordx4 v[136:139], v135, s[28:31], s65 offen offset:0
    buffer_load_dwordx4 v[140:143], v135, s[28:31], s65 offen offset:1024
    buffer_load_dwordx4 v[144:147], v135, s[28:31], s65 offen offset:2048
    buffer_load_dwordx4 v[148:151], v135, s[28:31], s65 offen offset:3072
    s_add_u32 s63, s63, 1
    s_and_b32 s63, s63, 15
    s_mul_i32 s56, s63, 393216
    s_lshl_b32 s57, s63, 7
    v_mov_b32 v134, 0
    v_lshlrev_b32 v130, 2, v122
    buffer_store_dword v134, v130, s[36:39], s66 offen sc1
    s_branch L_page1
.p2align 12
L_page1:
    s_nop 0
    s_mov_b64 exec, 0
    s_cmp_eq_u32 s3, 0
    s_cbranch_scc1 L_stub_0
    s_cmp_eq_u32 s3, 1
    s_cbranch_scc1 L_stub_1
    s_cmp_eq_u32 s3, 2
    s_cbranch_scc1 L_stub_2
    s_branch L_stub_3
L_warm_start_ret:
    s_mov_b64 exec, -1
    s_add_u32 m0, s53, 40960
    s_nop 0
    buffer_load_dwordx4 v96, s[28:31], s57 offen offset:0  lds
    buffer_load_dwordx4 v97, s[28:31], s57 offen offset:1024  lds
    buffer_load_dwordx4 v98, s[28:31], s57 offen offset:2048  lds
    buffer_load_dwordx4 v99, s[28:31], s57 offen offset:3072  lds
    s_add_u32 m0, s54, 40960
    s_nop 0
    buffer_load_dwordx4 v100, s[24:27], s56 offen offset:0  lds
    buffer_load_dwordx4 v101, s[24:27], s56 offen offset:1024  lds
    s_add_u32 m0, s54, 49152
    s_nop 0
    buffer_load_dwordx4 v102, s[24:27], s56 offen offset:0  lds
    buffer_load_dwordx4 v103, s[24:27], s56 offen offset:1024  lds
    s_add_u32 m0, s54, 57344
    s_nop 0
    buffer_load_dwordx4 v104, s[24:27], s56 offen offset:0  lds
    buffer_load_dwordx4 v105, s[24:27], s56 offen offset:1024  lds
    s_add_u32 s63, s63, 1
    s_and_b32 s63, s63, 15
    s_mul_i32 s56, s63, 393216
    s_lshl_b32 s57, s63, 7
    s_waitcnt vmcnt(16)
    s_barrier
    ds_read_b128 a[0:3], v106 offset:0
    ds_read_b128 a[4:7], v107 offset:0
    ds_read_b64_tr_b16 a[64:65], v114 offset:8192
    ds_read_b64_tr_b16 a[66:67], v114 offset:8704
    ds_read_b64_tr_b16 a[68:69], v114 offset:12288
    ds_read_b64_tr_b16 a[70:71], v114 offset:12800
    ds_read_b128 a[8:11], v106 offset:2048
    ds_read_b128 a[12:15], v107 offset:2048
    ds_read_b128 a[16:19], v106 offset:4096
    ds_read_b128 a[20:23], v107 offset:4096
    ds_read_b128 a[24:27], v106 offset:6144
    ds_read_b128 a[28:31], v107 offset:6144
    ds_read_b64_tr_b16 a[72:73], v115 offset:8192
    ds_read_b64_tr_b16 a[74:75], v115 offset:8704
    ds_read_b64_tr_b16 a[76:77], v115 offset:12288
    ds_read_b64_tr_b16 a[78:79], v115 offset:12800
    ds_read_b64_tr_b16 a[80:81], v114 offset:16384
    ds_read_b64_tr_b16 a[82:83], v114 offset:16896
    s_add_u32 m0, s53, 81920
    s_nop 0
    buffer_load_dwordx4 v96, s[28:31], s57 offen offset:0  lds
    buffer_load_dwordx4 v97, s[28:31], s57 offen offset:1024  lds
    buffer_load_dwordx4 v98, s[28:31], s57 offen offset:2048  lds
    buffer_load_dwordx4 v99, s[28:31], s57 offen offset:3072  lds
    s_add_u32 m0, s54, 81920
    s_nop 0
    buffer_load_dwordx4 v100, s[24:27], s56 offen offset:0  lds
    buffer_load_dwordx4 v101, s[24:27], s56 offen offset:1024  lds
    s_waitcnt lgkmcnt(10)
    v_mfma_f32_16x16x32_bf16 v[32:35], a[64:67], a[0:3], 0
    v_mfma_f32_16x16x32_bf16 v[32:35], a[68:71], a[4:7], v[32:35]
    ds_read_b64_tr_b16 a[84:85], v114 offset:20480
    v_mfma_f32_16x16x32_bf16 v[36:39], a[64:67], a[8:11], 0
    s_add_u32 m0, s54, 90112
    ds_read_b64_tr_b16 a[86:87], v114 offset:20992
    v_mfma_f32_16x16x32_bf16 v[36:39], a[68:71], a[12:15], v[36:39]
    s_waitcnt lgkmcnt(8)
    buffer_load_dwordx4 v102, s[24:27], s56 offen offset:0  lds
    v_mfma_f32_16x16x32_bf16 v[40:43], a[64:67], a[16:19], 0
    ds_read_b64_tr_b16 a[88:89], v115 offset:16384
    v_mfma_f32_16x16x32_bf16 v[40:43], a[68:71], a[20:23], v[40:43]
    ds_read_b64_tr_b16 a[90:91], v115 offset:16896
    v_mfma_f32_16x16x32_bf16 v[44:47], a[64:67], a[24:27], 0
    buffer_load_dwordx4 v103, s[24:27], s56 offen offset:1024  lds
    v_mfma_f32_16x16x32_bf16 v[44:47], a[68:71], a[28:31], v[44:47]
    ds_read_b64_tr_b16 a[92:93], v115 offset:20480
    v_mfma_f32_16x16x32_bf16 v[208:211], a[64:67], v[200:203], 0
    v_mfma_f32_16x16x32_bf16 v[208:211], a[68:71], v[200:203], v[208:211]
    s_waitcnt lgkmcnt(7)
    v_mfma_f32_16x16x32_bf16 v[48:51], a[72:75], a[0:3], 0
    ds_read_b64_tr_b16 a[94:95], v115 offset:20992
    v_mfma_f32_16x16x32_bf16 v[48:51], a[76:79], a[4:7], v[48:51]
    v_mfma_f32_16x16x32_bf16 v[52:55], a[72:75], a[8:11], 0
    ds_read_b64_tr_b16 a[96:97], v114 offset:0
    v_mfma_f32_16x16x32_bf16 v[52:55], a[76:79], a[12:15], v[52:55]
    s_add_u32 m0, s54, 98304
    ds_read_b64_tr_b16 a[98:99], v114 offset:512
    v_mfma_f32_16x16x32_bf16 v[56:59], a[72:75], a[16:19], 0
    buffer_load_dwordx4 v104, s[24:27], s56 offen offset:0  lds
    v_mfma_f32_16x16x32_bf16 v[56:59], a[76:79], a[20:23], v[56:59]
    ds_read_b64_tr_b16 a[100:101], v114 offset:4096
    v_mfma_f32_16x16x32_bf16 v[60:63], a[72:75], a[24:27], 0
    ds_read_b64_tr_b16 a[102:103], v114 offset:4608
    v_mfma_f32_16x16x32_bf16 v[60:63], a[76:79], a[28:31], v[60:63]
    v_mfma_f32_16x16x32_bf16 v[208:211], a[72:75], v[204:207], v[208:211]
    v_mfma_f32_16x16x32_bf16 v[208:211], a[76:79], v[204:207], v[208:211]
    s_waitcnt lgkmcnt(8)
    buffer_load_dwordx4 v105, s[24:27], s56 offen offset:1024  lds
    v_mfma_f32_16x16x32_bf16 v[64:67], a[0:3], a[80:83], 0
    ds_read_b64_tr_b16 a[104:105], v115 offset:0
    v_mfma_f32_16x16x32_bf16 v[64:67], a[4:7], a[84:87], v[64:67]
    s_add_u32 s63, s63, 1
    ds_read_b64_tr_b16 a[106:107], v115 offset:512
    v_mfma_f32_16x16x32_bf16 v[68:71], a[8:11], a[80:83], 0
    s_and_b32 s63, s63, 15
    v_mfma_f32_16x16x32_bf16 v[68:71], a[12:15], a[84:87], v[68:71]
    s_mul_i32 s56, s63, 393216
    ds_read_b64_tr_b16 a[108:109], v115 offset:4096
    v_mfma_f32_16x16x32_bf16 v[72:75], a[16:19], a[80:83], 0
    s_lshl_b32 s57, s63, 7
    ds_read_b64_tr_b16 a[110:111], v115 offset:4608
    v_mfma_f32_16x16x32_bf16 v[72:75], a[20:23], a[84:87], v[72:75]
    s_waitcnt vmcnt(21)
    v_dot2_f32_bf16 v220, v136, v216, 0
    v_dot2_f32_bf16 v221, v136, v136, 0
    v_dot2_f32_bf16 v222, v144, v216, 0
    v_dot2_f32_bf16 v223, v144, v144, 0
    v_dot2_f32_bf16 v220, v137, v216, v220
    v_dot2_f32_bf16 v221, v137, v137, v221
    v_dot2_f32_bf16 v222, v145, v216, v222
    v_dot2_f32_bf16 v223, v145, v145, v223
    v_dot2_f32_bf16 v220, v138, v216, v220
    v_dot2_f32_bf16 v221, v138, v138, v221
    v_dot2_f32_bf16 v222, v146, v216, v222
    v_dot2_f32_bf16 v223, v146, v146, v223
    v_dot2_f32_bf16 v220, v139, v216, v220
    v_dot2_f32_bf16 v221, v139, v139, v221
    v_dot2_f32_bf16 v222, v147, v216, v222
    v_dot2_f32_bf16 v223, v147, v147, v223
    v_dot2_f32_bf16 v220, v140, v216, v220
    v_dot2_f32_bf16 v221, v140, v140, v221
    v_dot2_f32_bf16 v222, v148, v216, v222
    v_dot2_f32_bf16 v223, v148, v148, v223
    v_dot2_f32_bf16 v220, v141, v216, v220
    v_dot2_f32_bf16 v221, v141, v141, v221
    v_dot2_f32_bf16 v222, v149, v216, v222
    v_dot2_f32_bf16 v223, v149, v149, v223
    v_dot2_f32_bf16 v220, v142, v216, v220
    v_dot2_f32_bf16 v221, v142, v142, v221
    v_dot2_f32_bf16 v222, v150, v216, v222
    v_dot2_f32_bf16 v223, v150, v150, v223
    v_dot2_f32_bf16 v220, v143, v216, v220
    v_dot2_f32_bf16 v221, v143, v143, v221
    v_dot2_f32_bf16 v222, v151, v216, v222
    v_dot2_f32_bf16 v223, v151, v151, v223
    s_nop 0
    s_nop 1
    v_add_f32_dpp v220, v220, v220 row_ror:8 row_mask:0xf bank_mask:0xf
    v_add_f32_dpp v221, v221, v221 row_ror:8 row_mask:0xf bank_mask:0xf
    v_add_f32_dpp v222, v222, v222 row_ror:8 row_mask:0xf bank_mask:0xf
    v_add_f32_dpp v223, v223, v223 row_ror:8 row_mask:0xf bank_mask:0xf
    s_nop 1
    v_add_f32_dpp v220, v220, v220 row_ror:4 row_mask:0xf bank_mask:0xf
    v_add_f32_dpp v221, v221, v221 row_ror:4 row_mask:0xf bank_mask:0xf
    v_add_f32_dpp v222, v222, v222 row_ror:4 row_mask:0xf bank_mask:0xf
    v_add_f32_dpp v223, v223, v223 row_ror:4 row_mask:0xf bank_mask:0xf
    s_nop 1
    v_add_f32_dpp v220, v220, v220 row_ror:2 row_mask:0xf bank_mask:0xf
    v_add_f32_dpp v221, v221, v221 row_ror:2 row_mask:0xf bank_mask:0xf
    v_add_f32_dpp v222, v222, v222 row_ror:2 row_mask:0xf bank_mask:0xf
    v_add_f32_dpp v223, v223, v223 row_ror:2 row_mask:0xf bank_mask:0xf
    s_nop 1
    v_add_f32_dpp v220, v220, v220 row_ror:1 row_mask:0xf bank_mask:0xf
    v_add_f32_dpp v221, v221, v221 row_ror:1 row_mask:0xf bank_mask:0xf
    v_add_f32_dpp v222, v222, v222 row_ror:1 row_mask:0xf bank_mask:0xf
    v_add_f32_dpp v223, v223, v223 row_ror:1 row_mask:0xf bank_mask:0xf
    v_mov_b32 v224, v220
    v_mov_b32 v225, v221
    v_mov_b32 v226, v222
    v_mov_b32 v227, v223
    s_nop 1
    v_permlane16_swap_b32 v220, v224
    v_permlane16_swap_b32 v221, v225
    v_permlane16_swap_b32 v222, v226
    v_permlane16_swap_b32 v223, v227
    s_nop 1
    v_add_f32 v220, v220, v224
    v_add_f32 v221, v221, v225
    v_add_f32 v222, v222, v226
    v_add_f32 v223, v223, v227
    v_mov_b32 v224, v220
    v_mov_b32 v225, v221
    v_mov_b32 v226, v222
    v_mov_b32 v227, v223
    s_nop 1
    v_permlane32_swap_b32 v220, v224
    v_permlane32_swap_b32 v221, v225
    v_permlane32_swap_b32 v222, v226
    v_permlane32_swap_b32 v223, v227
    s_nop 1
    v_add_f32 v220, v220, v224
    v_add_f32 v221, v221, v225
    v_add_f32 v222, v222, v226
    v_add_f32 v223, v223, v227
    v_mul_f32 v220, 0xba800000, v220
    v_mul_f32 v221, 0x3a800000, v221
    v_fma_f32 v221, -v220, v220, v221
    v_max_f32 v221, 0, v221
    v_add_f32 v221, 0x3727c5ac, v221
    v_rsq_f32 v221, v221
    v_mul_f32 v222, 0xba800000, v222
    v_mul_f32 v223, 0x3a800000, v223
    v_fma_f32 v223, -v222, v222, v223
    v_max_f32 v223, 0, v223
    v_add_f32 v223, 0x3727c5ac, v223
    v_rsq_f32 v223, v223
    v_lshlrev_b32 v224, 20, v122
    s_lshl_b32 s68, s64, 4
    s_add_u32 s68, s68, 262144
    buffer_store_dwordx4 v[220:223], v224, s[40:43], s68 offen sc1
    s_waitcnt vmcnt(11)
    s_barrier
    v_mfma_f32_16x16x32_bf16 v[76:79], a[24:27], a[80:83], 0
    ds_read_b128 a[32:35], v108 offset:0
    v_mfma_f32_16x16x32_bf16 v[76:79], a[28:31], a[84:87], v[76:79]
    s_add_u32 m0, s53, 122880
    ds_read_b128 a[36:39], v109 offset:0
    v_mfma_f32_16x16x32_bf16 v[212:215], v[192:195], a[80:83], 0
    v_mfma_f32_16x16x32_bf16 v[212:215], v[192:195], a[84:87], v[212:215]
    s_waitcnt lgkmcnt(10)
    v_mfma_f32_16x16x32_bf16 v[80:83], a[0:3], a[88:91], 0
    buffer_load_dwordx4 v96, s[28:31], s57 offen offset:0  lds
    v_mfma_f32_16x16x32_bf16 v[80:83], a[4:7], a[92:95], v[80:83]
    ds_read_b64_tr_b16 a[64:65], v116 offset:8192
    v_mfma_f32_16x16x32_bf16 v[84:87], a[8:11], a[88:91], 0
    ds_read_b64_tr_b16 a[66:67], v116 offset:8704
    v_mfma_f32_16x16x32_bf16 v[84:87], a[12:15], a[92:95], v[84:87]
    buffer_load_dwordx4 v97, s[28:31], s57 offen offset:1024  lds
    v_mfma_f32_16x16x32_bf16 v[88:91], a[16:19], a[88:91], 0
    ds_read_b64_tr_b16 a[68:69], v116 offset:12288
    v_mfma_f32_16x16x32_bf16 v[88:91], a[20:23], a[92:95], v[88:91]
    ds_read_b64_tr_b16 a[70:71], v116 offset:12800
    v_mfma_f32_16x16x32_bf16 v[92:95], a[24:27], a[88:91], 0
    v_mfma_f32_16x16x32_bf16 v[92:95], a[28:31], a[92:95], v[92:95]
    ds_read_b128 a[40:43], v108 offset:2048
    v_mfma_f32_16x16x32_bf16 v[212:215], v[196:199], a[88:91], v[212:215]
    v_mfma_f32_16x16x32_bf16 v[212:215], v[196:199], a[92:95], v[212:215]
    s_waitcnt lgkmcnt(11)
    v_mfma_f32_16x16x32_bf16 v[0:3], a[96:99], a[0:3], 0
    ds_read_b128 a[44:47], v109 offset:2048
    v_mfma_f32_16x16x32_bf16 v[0:3], a[100:103], a[4:7], v[0:3]
    buffer_load_dwordx4 v98, s[28:31], s57 offen offset:2048  lds
    v_mfma_f32_16x16x32_bf16 v[4:7], a[96:99], a[8:11], 0
    ds_read_b128 a[48:51], v108 offset:4096
    v_mfma_f32_16x16x32_bf16 v[4:7], a[100:103], a[12:15], v[4:7]
    ds_read_b128 a[52:55], v109 offset:4096
    v_mfma_f32_16x16x32_bf16 v[8:11], a[96:99], a[16:19], 0
    buffer_load_dwordx4 v99, s[28:31], s57 offen offset:3072  lds
    v_mfma_f32_16x16x32_bf16 v[8:11], a[100:103], a[20:23], v[8:11]
    ds_read_b128 a[56:59], v108 offset:6144
    v_mfma_f32_16x16x32_bf16 v[12:15], a[96:99], a[24:27], 0
    ds_read_b128 a[60:63], v109 offset:6144
    v_mfma_f32_16x16x32_bf16 v[12:15], a[100:103], a[28:31], v[12:15]
    v_mfma_f32_16x16x32_bf16 v[208:211], a[96:99], v[192:195], v[208:211]
    v_mfma_f32_16x16x32_bf16 v[208:211], a[100:103], v[192:195], v[208:211]
    s_waitcnt lgkmcnt(12)
    v_mfma_f32_16x16x32_bf16 v[16:19], a[104:107], a[0:3], 0
    ds_read_b64_tr_b16 a[72:73], v117 offset:8192
    v_mfma_f32_16x16x32_bf16 v[16:19], a[108:111], a[4:7], v[16:19]
    s_add_u32 m0, s54, 122880
    ds_read_b64_tr_b16 a[74:75], v117 offset:8704
    v_mfma_f32_16x16x32_bf16 v[20:23], a[104:107], a[8:11], 0
    buffer_load_dwordx4 v100, s[24:27], s56 offen offset:0  lds
    v_mfma_f32_16x16x32_bf16 v[20:23], a[108:111], a[12:15], v[20:23]
    ds_read_b64_tr_b16 a[76:77], v117 offset:12288
    v_mfma_f32_16x16x32_bf16 v[24:27], a[104:107], a[16:19], 0
    ds_read_b64_tr_b16 a[78:79], v117 offset:12800
    v_mfma_f32_16x16x32_bf16 v[24:27], a[108:111], a[20:23], v[24:27]
    buffer_load_dwordx4 v101, s[24:27], s56 offen offset:1024  lds
    v_mfma_f32_16x16x32_bf16 v[28:31], a[104:107], a[24:27], 0
    ds_read_b64_tr_b16 a[80:81], v116 offset:16384
    v_mfma_f32_16x16x32_bf16 v[28:31], a[108:111], a[28:31], v[28:31]
    ds_read_b64_tr_b16 a[82:83], v116 offset:16896
    v_mfma_f32_16x16x32_bf16 v[208:211], a[104:107], v[196:199], v[208:211]
    v_mfma_f32_16x16x32_bf16 v[208:211], a[108:111], v[196:199], v[208:211]
    s_waitcnt lgkmcnt(10)
    v_mfma_f32_16x16x32_bf16 v[32:35], a[64:67], a[32:35], v[32:35]
    v_mfma_f32_16x16x32_bf16 v[32:35], a[68:71], a[36:39], v[32:35]
    ds_read_b64_tr_b16 a[84:85], v116 offset:20480
    v_mfma_f32_16x16x32_bf16 v[36:39], a[64:67], a[40:43], v[36:39]
    s_add_u32 m0, s54, 131072
    ds_read_b64_tr_b16 a[86:87], v116 offset:20992
    v_mfma_f32_16x16x32_bf16 v[36:39], a[68:71], a[44:47], v[36:39]
    s_waitcnt lgkmcnt(8)
    buffer_load_dwordx4 v102, s[24:27], s56 offen offset:0  lds
    v_mfma_f32_16x16x32_bf16 v[40:43], a[64:67], a[48:51], v[40:43]
    ds_read_b64_tr_b16 a[88:89], v117 offset:16384
    v_mfma_f32_16x16x32_bf16 v[40:43], a[68:71], a[52:55], v[40:43]
    ds_read_b64_tr_b16 a[90:91], v117 offset:16896
    v_mfma_f32_16x16x32_bf16 v[44:47], a[64:67], a[56:59], v[44:47]
    buffer_load_dwordx4 v103, s[24:27], s56 offen offset:1024  lds
    v_lshlrev_b32 v130, 10, v124
    v_mfma_f32_16x16x32_bf16 v[44:47], a[68:71], a[60:63], v[44:47]
    s_waitcnt lgkmcnt(6)
    ds_read_b64_tr_b16 a[92:93], v117 offset:20480
    v_mfma_f32_16x16x32_bf16 v[48:51], a[72:75], a[32:35], v[48:51]
    ds_read_b64_tr_b16 a[94:95], v117 offset:20992
    v_lshl_add_u32 v130, v125, 8, v130
    v_mfma_f32_16x16x32_bf16 v[48:51], a[76:79], a[36:39], v[48:51]
    v_cmp_gt_u32 vcc, 4, v124
    v_mfma_f32_16x16x32_bf16 v[52:55], a[72:75], a[40:43], v[52:55]
    ds_read_b64_tr_b16 a[96:97], v116 offset:0
    v_mov_b32 v131, 1073741824
    v_mfma_f32_16x16x32_bf16 v[52:55], a[76:79], a[44:47], v[52:55]
    s_add_u32 m0, s54, 139264
    ds_read_b64_tr_b16 a[98:99], v116 offset:512
    v_mfma_f32_16x16x32_bf16 v[56:59], a[72:75], a[48:51], v[56:59]
    s_mul_i32 s69, s67, 6144
    buffer_load_dwordx4 v104, s[24:27], s56 offen offset:0  lds
    v_mfma_f32_16x16x32_bf16 v[56:59], a[76:79], a[52:55], v[56:59]
    ds_read_b64_tr_b16 a[100:101], v116 offset:4096
    v_cndmask_b32 v130, v131, v130, vcc
    v_mfma_f32_16x16x32_bf16 v[60:63], a[72:75], a[56:59], v[60:63]
    ds_read_b64_tr_b16 a[102:103], v116 offset:4608
    v_mfma_f32_16x16x32_bf16 v[60:63], a[76:79], a[60:63], v[60:63]
    s_waitcnt lgkmcnt(8)
    s_lshl_b32 s70, s48, 29
    buffer_load_dwordx4 v105, s[24:27], s56 offen offset:1024  lds
    v_mfma_f32_16x16x32_bf16 v[64:67], a[32:35], a[80:83], v[64:67]
    s_add_u32 s69, s69, s70
    ds_read_b64_tr_b16 a[104:105], v117 offset:0
    v_mfma_f32_16x16x32_bf16 v[64:67], a[36:39], a[84:87], v[64:67]
    s_add_u32 s63, s63, 1
    ds_read_b64_tr_b16 a[106:107], v117 offset:512
    v_mfma_f32_16x16x32_bf16 v[68:71], a[40:43], a[80:83], v[68:71]
    s_and_b32 s63, s63, 15
    s_lshl_b32 s70, s46, 4
    v_mfma_f32_16x16x32_bf16 v[68:71], a[44:47], a[84:87], v[68:71]
    s_mul_i32 s56, s63, 393216
    ds_read_b64_tr_b16 a[108:109], v117 offset:4096
    s_add_u32 s70, s70, s69
    v_mfma_f32_16x16x32_bf16 v[72:75], a[48:51], a[80:83], v[72:75]
    s_lshl_b32 s57, s63, 7
    ds_read_b64_tr_b16 a[110:111], v117 offset:4608
    buffer_store_dwordx4 v[208:211], v130, s[40:43], s70 offen sc1
    v_mfma_f32_16x16x32_bf16 v[72:75], a[52:55], a[84:87], v[72:75]
    s_waitcnt vmcnt(12)
    s_barrier
    v_mfma_f32_16x16x32_bf16 v[76:79], a[56:59], a[80:83], v[76:79]
    ds_read_b128 a[0:3], v110 offset:0
    v_lshlrev_b32 v131, 4, v124
    v_mfma_f32_16x16x32_bf16 v[76:79], a[60:63], a[84:87], v[76:79]
    s_waitcnt lgkmcnt(9)
    s_add_u32 m0, s53, 0
    ds_read_b128 a[4:7], v111 offset:0
    v_lshl_add_u32 v131, v125, 27, v131
    v_mfma_f32_16x16x32_bf16 v[80:83], a[32:35], a[88:91], v[80:83]
    buffer_load_dwordx4 v96, s[28:31], s57 offen offset:0  lds
    v_mfma_f32_16x16x32_bf16 v[80:83], a[36:39], a[92:95], v[80:83]
    s_lshr_b32 s70, s46, 2
    ds_read_b64_tr_b16 a[64:65], v118 offset:8192
    v_mfma_f32_16x16x32_bf16 v[84:87], a[40:43], a[88:91], v[84:87]
    s_lshl_b32 s70, s70, 8
    ds_read_b64_tr_b16 a[66:67], v118 offset:8704
    v_mfma_f32_16x16x32_bf16 v[84:87], a[44:47], a[92:95], v[84:87]
    buffer_load_dwordx4 v97, s[28:31], s57 offen offset:1024  lds
    v_mfma_f32_16x16x32_bf16 v[88:91], a[48:51], a[88:91], v[88:91]
    s_add_u32 s69, s69, s70
    ds_read_b64_tr_b16 a[68:69], v118 offset:12288
    v_mfma_f32_16x16x32_bf16 v[88:91], a[52:55], a[92:95], v[88:91]
    ds_read_b64_tr_b16 a[70:71], v118 offset:12800
    v_mfma_f32_16x16x32_bf16 v[92:95], a[56:59], a[88:91], v[92:95]
    s_bfe_u32 s70, s46, 0x10001
    s_lshl_b32 s70, s70, 10
    v_mfma_f32_16x16x32_bf16 v[92:95], a[60:63], a[92:95], v[92:95]
    s_waitcnt lgkmcnt(10)
    ds_read_b128 a[8:11], v110 offset:2048
    v_mfma_f32_16x16x32_bf16 v[0:3], a[96:99], a[32:35], v[0:3]
    s_add_u32 s69, s69, s70
    ds_read_b128 a[12:15], v111 offset:2048
    v_mfma_f32_16x16x32_bf16 v[0:3], a[100:103], a[36:39], v[0:3]
    s_and_b32 s70, s46, 1
    buffer_load_dwordx4 v98, s[28:31], s57 offen offset:2048  lds
    v_mfma_f32_16x16x32_bf16 v[4:7], a[96:99], a[40:43], v[4:7]
    ds_read_b128 a[16:19], v110 offset:4096
    v_mfma_f32_16x16x32_bf16 v[4:7], a[100:103], a[44:47], v[4:7]
    s_lshl_b32 s70, s70, 3
    ds_read_b128 a[20:23], v111 offset:4096
    v_mfma_f32_16x16x32_bf16 v[8:11], a[96:99], a[48:51], v[8:11]
    buffer_load_dwordx4 v99, s[28:31], s57 offen offset:3072  lds
    v_mfma_f32_16x16x32_bf16 v[8:11], a[100:103], a[52:55], v[8:11]
    s_add_u32 s69, s69, s70
    ds_read_b128 a[24:27], v110 offset:6144
    v_mfma_f32_16x16x32_bf16 v[12:15], a[96:99], a[56:59], v[12:15]
    s_add_u32 s69, s69, 4096
    ds_read_b128 a[28:31], v111 offset:6144
    v_mfma_f32_16x16x32_bf16 v[12:15], a[100:103], a[60:63], v[12:15]
    s_waitcnt lgkmcnt(12)
    buffer_store_dwordx2 v[212:213], v131, s[40:43], s69 offen sc1
    v_mfma_f32_16x16x32_bf16 v[16:19], a[104:107], a[32:35], v[16:19]
    ds_read_b64_tr_b16 a[72:73], v119 offset:8192
    v_mfma_f32_16x16x32_bf16 v[16:19], a[108:111], a[36:39], v[16:19]
    s_add_u32 m0, s54, 0
    ds_read_b64_tr_b16 a[74:75], v119 offset:8704
    v_mfma_f32_16x16x32_bf16 v[20:23], a[104:107], a[40:43], v[20:23]
    buffer_load_dwordx4 v100, s[24:27], s56 offen offset:0  lds
    v_mfma_f32_16x16x32_bf16 v[20:23], a[108:111], a[44:47], v[20:23]
    ds_read_b64_tr_b16 a[76:77], v119 offset:12288
    v_mfma_f32_16x16x32_bf16 v[24:27], a[104:107], a[48:51], v[24:27]
    ds_read_b64_tr_b16 a[78:79], v119 offset:12800
    v_mfma_f32_16x16x32_bf16 v[24:27], a[108:111], a[52:55], v[24:27]
    buffer_load_dwordx4 v101, s[24:27], s56 offen offset:1024  lds
    v_mfma_f32_16x16x32_bf16 v[28:31], a[104:107], a[56:59], v[28:31]
    ds_read_b64_tr_b16 a[80:81], v118 offset:16384
    v_mfma_f32_16x16x32_bf16 v[28:31], a[108:111], a[60:63], v[28:31]
    s_waitcnt lgkmcnt(9)
    ds_read_b64_tr_b16 a[82:83], v118 offset:16896
    v_mfma_f32_16x16x32_bf16 v[32:35], a[64:67], a[0:3], v[32:35]
    v_mfma_f32_16x16x32_bf16 v[32:35], a[68:71], a[4:7], v[32:35]
    ds_read_b64_tr_b16 a[84:85], v118 offset:20480
    v_mfma_f32_16x16x32_bf16 v[36:39], a[64:67], a[8:11], v[36:39]
    s_add_u32 m0, s54, 8192
    ds_read_b64_tr_b16 a[86:87], v118 offset:20992
    v_mfma_f32_16x16x32_bf16 v[36:39], a[68:71], a[12:15], v[36:39]
    s_waitcnt lgkmcnt(8)
    buffer_load_dwordx4 v102, s[24:27], s56 offen offset:0  lds
    v_mfma_f32_16x16x32_bf16 v[40:43], a[64:67], a[16:19], v[40:43]
    ds_read_b64_tr_b16 a[88:89], v119 offset:16384
    v_mfma_f32_16x16x32_bf16 v[40:43], a[68:71], a[20:23], v[40:43]
    ds_read_b64_tr_b16 a[90:91], v119 offset:16896
    v_mfma_f32_16x16x32_bf16 v[44:47], a[64:67], a[24:27], v[44:47]
    buffer_load_dwordx4 v103, s[24:27], s56 offen offset:1024  lds
    v_mfma_f32_16x16x32_bf16 v[44:47], a[68:71], a[28:31], v[44:47]
    s_waitcnt lgkmcnt(6)
    ds_read_b64_tr_b16 a[92:93], v119 offset:20480
    v_mfma_f32_16x16x32_bf16 v[48:51], a[72:75], a[0:3], v[48:51]
    ds_read_b64_tr_b16 a[94:95], v119 offset:20992
    v_mfma_f32_16x16x32_bf16 v[48:51], a[76:79], a[4:7], v[48:51]
    v_mfma_f32_16x16x32_bf16 v[52:55], a[72:75], a[8:11], v[52:55]
    ds_read_b64_tr_b16 a[96:97], v118 offset:0
    v_mfma_f32_16x16x32_bf16 v[52:55], a[76:79], a[12:15], v[52:55]
    s_add_u32 m0, s54, 16384
    ds_read_b64_tr_b16 a[98:99], v118 offset:512
    v_mfma_f32_16x16x32_bf16 v[56:59], a[72:75], a[16:19], v[56:59]
    buffer_load_dwordx4 v104, s[24:27], s56 offen offset:0  lds
    v_mfma_f32_16x16x32_bf16 v[56:59], a[76:79], a[20:23], v[56:59]
    ds_read_b64_tr_b16 a[100:101], v118 offset:4096
    v_mfma_f32_16x16x32_bf16 v[60:63], a[72:75], a[24:27], v[60:63]
    ds_read_b64_tr_b16 a[102:103], v118 offset:4608
    v_mfma_f32_16x16x32_bf16 v[60:63], a[76:79], a[28:31], v[60:63]
    s_waitcnt lgkmcnt(8)
    buffer_load_dwordx4 v105, s[24:27], s56 offen offset:1024  lds
    v_mfma_f32_16x16x32_bf16 v[64:67], a[0:3], a[80:83], v[64:67]
    ds_read_b64_tr_b16 a[104:105], v119 offset:0
    v_mfma_f32_16x16x32_bf16 v[64:67], a[4:7], a[84:87], v[64:67]
    s_add_u32 s63, s63, 1
    ds_read_b64_tr_b16 a[106:107], v119 offset:512
    v_mfma_f32_16x16x32_bf16 v[68:71], a[8:11], a[80:83], v[68:71]
    s_and_b32 s63, s63, 15
    v_mfma_f32_16x16x32_bf16 v[68:71], a[12:15], a[84:87], v[68:71]
    s_mul_i32 s56, s63, 393216
    ds_read_b64_tr_b16 a[108:109], v119 offset:4096
    v_mfma_f32_16x16x32_bf16 v[72:75], a[16:19], a[80:83], v[72:75]
    s_lshl_b32 s57, s63, 7
    ds_read_b64_tr_b16 a[110:111], v119 offset:4608
    v_mfma_f32_16x16x32_bf16 v[72:75], a[20:23], a[84:87], v[72:75]
    s_waitcnt vmcnt(12)
    s_barrier
    v_mfma_f32_16x16x32_bf16 v[76:79], a[24:27], a[80:83], v[76:79]
    ds_read_b128 a[32:35], v112 offset:0
    v_mfma_f32_16x16x32_bf16 v[76:79], a[28:31], a[84:87], v[76:79]
    s_waitcnt lgkmcnt(9)
    s_add_u32 m0, s53, 40960
    ds_read_b128 a[36:39], v113 offset:0
    v_mfma_f32_16x16x32_bf16 v[80:83], a[0:3], a[88:91], v[80:83]
    buffer_load_dwordx4 v96, s[28:31], s57 offen offset:0  lds
    v_mfma_f32_16x16x32_bf16 v[80:83], a[4:7], a[92:95], v[80:83]
    ds_read_b64_tr_b16 a[64:65], v120 offset:8192
    v_mfma_f32_16x16x32_bf16 v[84:87], a[8:11], a[88:91], v[84:87]
    ds_read_b64_tr_b16 a[66:67], v120 offset:8704
    v_mfma_f32_16x16x32_bf16 v[84:87], a[12:15], a[92:95], v[84:87]
    buffer_load_dwordx4 v97, s[28:31], s57 offen offset:1024  lds
    v_mfma_f32_16x16x32_bf16 v[88:91], a[16:19], a[88:91], v[88:91]
    ds_read_b64_tr_b16 a[68:69], v120 offset:12288
    v_mfma_f32_16x16x32_bf16 v[88:91], a[20:23], a[92:95], v[88:91]
    ds_read_b64_tr_b16 a[70:71], v120 offset:12800
    v_mfma_f32_16x16x32_bf16 v[92:95], a[24:27], a[88:91], v[92:95]
    v_mfma_f32_16x16x32_bf16 v[92:95], a[28:31], a[92:95], v[92:95]
    s_waitcnt lgkmcnt(10)
    ds_read_b128 a[40:43], v112 offset:2048
    v_mfma_f32_16x16x32_bf16 v[0:3], a[96:99], a[0:3], v[0:3]
    ds_read_b128 a[44:47], v113 offset:2048
    v_mfma_f32_16x16x32_bf16 v[0:3], a[100:103], a[4:7], v[0:3]
    buffer_load_dwordx4 v98, s[28:31], s57 offen offset:2048  lds
    v_mfma_f32_16x16x32_bf16 v[4:7], a[96:99], a[8:11], v[4:7]
    ds_read_b128 a[48:51], v112 offset:4096
    v_mfma_f32_16x16x32_bf16 v[4:7], a[100:103], a[12:15], v[4:7]
    ds_read_b128 a[52:55], v113 offset:4096
    v_mfma_f32_16x16x32_bf16 v[8:11], a[96:99], a[16:19], v[8:11]
    buffer_load_dwordx4 v99, s[28:31], s57 offen offset:3072  lds
    v_mfma_f32_16x16x32_bf16 v[8:11], a[100:103], a[20:23], v[8:11]
    ds_read_b128 a[56:59], v112 offset:6144
    v_mfma_f32_16x16x32_bf16 v[12:15], a[96:99], a[24:27], v[12:15]
    ds_read_b128 a[60:63], v113 offset:6144
    v_mfma_f32_16x16x32_bf16 v[12:15], a[100:103], a[28:31], v[12:15]
    s_waitcnt lgkmcnt(12)
    v_mfma_f32_16x16x32_bf16 v[16:19], a[104:107], a[0:3], v[16:19]
    ds_read_b64_tr_b16 a[72:73], v121 offset:8192
    v_mfma_f32_16x16x32_bf16 v[16:19], a[108:111], a[4:7], v[16:19]
    s_add_u32 m0, s54, 40960
    ds_read_b64_tr_b16 a[74:75], v121 offset:8704
    v_mfma_f32_16x16x32_bf16 v[20:23], a[104:107], a[8:11], v[20:23]
    buffer_load_dwordx4 v100, s[24:27], s56 offen offset:0  lds
    v_mfma_f32_16x16x32_bf16 v[20:23], a[108:111], a[12:15], v[20:23]
    ds_read_b64_tr_b16 a[76:77], v121 offset:12288
    v_mfma_f32_16x16x32_bf16 v[24:27], a[104:107], a[16:19], v[24:27]
    ds_read_b64_tr_b16 a[78:79], v121 offset:12800
    v_mfma_f32_16x16x32_bf16 v[24:27], a[108:111], a[20:23], v[24:27]
    buffer_load_dwordx4 v101, s[24:27], s56 offen offset:1024  lds
    v_mfma_f32_16x16x32_bf16 v[28:31], a[104:107], a[24:27], v[28:31]
    ds_read_b64_tr_b16 a[80:81], v120 offset:16384
    v_mfma_f32_16x16x32_bf16 v[28:31], a[108:111], a[28:31], v[28:31]
    s_waitcnt lgkmcnt(9)
    ds_read_b64_tr_b16 a[82:83], v120 offset:16896
    v_mfma_f32_16x16x32_bf16 v[32:35], a[64:67], a[32:35], v[32:35]
    v_mov_b32 v130, 1
    v_mfma_f32_16x16x32_bf16 v[32:35], a[68:71], a[36:39], v[32:35]
    ds_read_b64_tr_b16 a[84:85], v120 offset:20480
    v_mfma_f32_16x16x32_bf16 v[36:39], a[64:67], a[40:43], v[36:39]
    s_add_u32 m0, s54, 49152
    ds_read_b64_tr_b16 a[86:87], v120 offset:20992
    v_mfma_f32_16x16x32_bf16 v[36:39], a[68:71], a[44:47], v[36:39]
    s_waitcnt lgkmcnt(8)
    buffer_load_dwordx4 v102, s[24:27], s56 offen offset:0  lds
    v_lshlrev_b32 v131, 8, v122
    v_mfma_f32_16x16x32_bf16 v[40:43], a[64:67], a[48:51], v[40:43]
    ds_read_b64_tr_b16 a[88:89], v121 offset:16384
    v_mfma_f32_16x16x32_bf16 v[40:43], a[68:71], a[52:55], v[40:43]
    ds_read_b64_tr_b16 a[90:91], v121 offset:16896
    v_mfma_f32_16x16x32_bf16 v[44:47], a[64:67], a[56:59], v[44:47]
    s_lshl_b32 s70, s3, 8
    buffer_load_dwordx4 v103, s[24:27], s56 offen offset:1024  lds
    v_mfma_f32_16x16x32_bf16 v[44:47], a[68:71], a[60:63], v[44:47]
    s_waitcnt lgkmcnt(6)
    ds_read_b64_tr_b16 a[92:93], v121 offset:20480
    v_mfma_f32_16x16x32_bf16 v[48:51], a[72:75], a[32:35], v[48:51]
    ds_read_b64_tr_b16 a[94:95], v121 offset:20992
    v_mfma_f32_16x16x32_bf16 v[48:51], a[76:79], a[36:39], v[48:51]
    s_and_b32 s71, s45, 3
    v_mfma_f32_16x16x32_bf16 v[52:55], a[72:75], a[40:43], v[52:55]
    ds_read_b64_tr_b16 a[96:97], v120 offset:0
    v_mfma_f32_16x16x32_bf16 v[52:55], a[76:79], a[44:47], v[52:55]
    s_add_u32 m0, s54, 57344
    ds_read_b64_tr_b16 a[98:99], v120 offset:512
    s_mul_i32 s71, s71, 64
    v_mfma_f32_16x16x32_bf16 v[56:59], a[72:75], a[48:51], v[56:59]
    buffer_load_dwordx4 v104, s[24:27], s56 offen offset:0  lds
    v_mfma_f32_16x16x32_bf16 v[56:59], a[76:79], a[52:55], v[56:59]
    ds_read_b64_tr_b16 a[100:101], v120 offset:4096
    v_mfma_f32_16x16x32_bf16 v[60:63], a[72:75], a[56:59], v[60:63]
    s_add_u32 s70, s70, s71
    ds_read_b64_tr_b16 a[102:103], v120 offset:4608
    v_mfma_f32_16x16x32_bf16 v[60:63], a[76:79], a[60:63], v[60:63]
    s_waitcnt lgkmcnt(8)
    buffer_load_dwordx4 v105, s[24:27], s56 offen offset:1024  lds
    v_mfma_f32_16x16x32_bf16 v[64:67], a[32:35], a[80:83], v[64:67]
    ds_read_b64_tr_b16 a[104:105], v121 offset:0
    v_mfma_f32_16x16x32_bf16 v[64:67], a[36:39], a[84:87], v[64:67]
    s_add_u32 s63, s63, 1
    ds_read_b64_tr_b16 a[106:107], v121 offset:512
    v_mfma_f32_16x16x32_bf16 v[68:71], a[40:43], a[80:83], v[68:71]
    s_and_b32 s63, s63, 15
    v_mfma_f32_16x16x32_bf16 v[68:71], a[44:47], a[84:87], v[68:71]
    s_mul_i32 s56, s63, 393216
    ds_read_b64_tr_b16 a[108:109], v121 offset:4096
    v_mfma_f32_16x16x32_bf16 v[72:75], a[48:51], a[80:83], v[72:75]
    s_lshl_b32 s57, s63, 7
    ds_read_b64_tr_b16 a[110:111], v121 offset:4608
    v_mfma_f32_16x16x32_bf16 v[72:75], a[52:55], a[84:87], v[72:75]
    s_waitcnt vmcnt(10)
    s_barrier
    v_mfma_f32_16x16x32_bf16 v[76:79], a[56:59], a[80:83], v[76:79]
    ds_read_b128 a[0:3], v106 offset:0
    buffer_atomic_add v130, v131, s[32:35], s70 offen sc1
L_stub_0:
    s_cbranch_execz L_warm_start_ret
    v_mfma_f32_16x16x32_bf16 v[76:79], a[60:63], a[84:87], v[76:79]
    s_waitcnt lgkmcnt(9)
    s_add_u32 m0, s53, 81920
    ds_read_b128 a[4:7], v107 offset:0
    v_mfma_f32_16x16x32_bf16 v[80:83], a[32:35], a[88:91], v[80:83]
    buffer_load_dwordx4 v96, s[28:31], s57 offen offset:0  lds
    v_mfma_f32_16x16x32_bf16 v[80:83], a[36:39], a[92:95], v[80:83]
    ds_read_b64_tr_b16 a[64:65], v114 offset:8192
    v_mfma_f32_16x16x32_bf16 v[84:87], a[40:43], a[88:91], v[84:87]
    ds_read_b64_tr_b16 a[66:67], v114 offset:8704
    v_mfma_f32_16x16x32_bf16 v[84:87], a[44:47], a[92:95], v[84:87]
    buffer_load_dwordx4 v97, s[28:31], s57 offen offset:1024  lds
    v_mfma_f32_16x16x32_bf16 v[88:91], a[48:51], a[88:91], v[88:91]
    ds_read_b64_tr_b16 a[68:69], v114 offset:12288
    v_mfma_f32_16x16x32_bf16 v[88:91], a[52:55], a[92:95], v[88:91]
    ds_read_b64_tr_b16 a[70:71], v114 offset:12800
    v_mfma_f32_16x16x32_bf16 v[92:95], a[56:59], a[88:91], v[92:95]
    v_mfma_f32_16x16x32_bf16 v[92:95], a[60:63], a[92:95], v[92:95]
    s_waitcnt lgkmcnt(10)
    ds_read_b128 a[8:11], v106 offset:2048
    v_mfma_f32_16x16x32_bf16 v[0:3], a[96:99], a[32:35], v[0:3]
    ds_read_b128 a[12:15], v107 offset:2048
    v_mfma_f32_16x16x32_bf16 v[0:3], a[100:103], a[36:39], v[0:3]
    buffer_load_dwordx4 v98, s[28:31], s57 offen offset:2048  lds
    v_mfma_f32_16x16x32_bf16 v[4:7], a[96:99], a[40:43], v[4:7]
    ds_read_b128 a[16:19], v106 offset:4096
    v_mfma_f32_16x16x32_bf16 v[4:7], a[100:103], a[44:47], v[4:7]
    ds_read_b128 a[20:23], v107 offset:4096
    v_mfma_f32_16x16x32_bf16 v[8:11], a[96:99], a[48:51], v[8:11]
    buffer_load_dwordx4 v99, s[28:31], s57 offen offset:3072  lds
    v_mfma_f32_16x16x32_bf16 v[8:11], a[100:103], a[52:55], v[8:11]
    ds_read_b128 a[24:27], v106 offset:6144
    v_mfma_f32_16x16x32_bf16 v[12:15], a[96:99], a[56:59], v[12:15]
    ds_read_b128 a[28:31], v107 offset:6144
    v_mfma_f32_16x16x32_bf16 v[12:15], a[100:103], a[60:63], v[12:15]
    s_waitcnt lgkmcnt(12)
    v_mfma_f32_16x16x32_bf16 v[16:19], a[104:107], a[32:35], v[16:19]
    ds_read_b64_tr_b16 a[72:73], v115 offset:8192
    v_mfma_f32_16x16x32_bf16 v[16:19], a[108:111], a[36:39], v[16:19]
    s_add_u32 m0, s54, 81920
    ds_read_b64_tr_b16 a[74:75], v115 offset:8704
    v_mfma_f32_16x16x32_bf16 v[20:23], a[104:107], a[40:43], v[20:23]
    buffer_load_dwordx4 v100, s[24:27], s56 offen offset:0  lds
    v_mfma_f32_16x16x32_bf16 v[20:23], a[108:111], a[44:47], v[20:23]
    ds_read_b64_tr_b16 a[76:77], v115 offset:12288
    v_mfma_f32_16x16x32_bf16 v[24:27], a[104:107], a[48:51], v[24:27]
    ds_read_b64_tr_b16 a[78:79], v115 offset:12800
    v_mfma_f32_16x16x32_bf16 v[24:27], a[108:111], a[52:55], v[24:27]
    buffer_load_dwordx4 v101, s[24:27], s56 offen offset:1024  lds
    v_mfma_f32_16x16x32_bf16 v[28:31], a[104:107], a[56:59], v[28:31]
    ds_read_b64_tr_b16 a[80:81], v114 offset:16384
    v_mfma_f32_16x16x32_bf16 v[28:31], a[108:111], a[60:63], v[28:31]
    s_waitcnt lgkmcnt(9)
    ds_read_b64_tr_b16 a[82:83], v114 offset:16896
    v_mfma_f32_16x16x32_bf16 v[32:35], a[64:67], a[0:3], v[32:35]
    v_mfma_f32_16x16x32_bf16 v[32:35], a[68:71], a[4:7], v[32:35]
    ds_read_b64_tr_b16 a[84:85], v114 offset:20480
    v_mfma_f32_16x16x32_bf16 v[36:39], a[64:67], a[8:11], v[36:39]
    s_add_u32 m0, s54, 90112
    ds_read_b64_tr_b16 a[86:87], v114 offset:20992
    v_mfma_f32_16x16x32_bf16 v[36:39], a[68:71], a[12:15], v[36:39]
    s_waitcnt lgkmcnt(8)
    buffer_load_dwordx4 v102, s[24:27], s56 offen offset:0  lds
    v_mfma_f32_16x16x32_bf16 v[40:43], a[64:67], a[16:19], v[40:43]
    ds_read_b64_tr_b16 a[88:89], v115 offset:16384
    v_mfma_f32_16x16x32_bf16 v[40:43], a[68:71], a[20:23], v[40:43]
    ds_read_b64_tr_b16 a[90:91], v115 offset:16896
    v_mfma_f32_16x16x32_bf16 v[44:47], a[64:67], a[24:27], v[44:47]
    buffer_load_dwordx4 v103, s[24:27], s56 offen offset:1024  lds
    v_mfma_f32_16x16x32_bf16 v[44:47], a[68:71], a[28:31], v[44:47]
    s_waitcnt lgkmcnt(6)
    s_cmp_eq_u32 s3, 0
    s_cselect_b32 s73, 64, 0
    ds_read_b64_tr_b16 a[92:93], v115 offset:20480
    v_mfma_f32_16x16x32_bf16 v[48:51], a[72:75], a[0:3], v[48:51]
    ds_read_b64_tr_b16 a[94:95], v115 offset:20992
    v_mfma_f32_16x16x32_bf16 v[48:51], a[76:79], a[4:7], v[48:51]
    v_mfma_f32_16x16x32_bf16 v[52:55], a[72:75], a[8:11], v[52:55]
    ds_read_b64_tr_b16 a[96:97], v114 offset:0
    v_mfma_f32_16x16x32_bf16 v[52:55], a[76:79], a[12:15], v[52:55]
    s_add_u32 m0, s54, 98304
    ds_read_b64_tr_b16 a[98:99], v114 offset:512
    v_mfma_f32_16x16x32_bf16 v[56:59], a[72:75], a[16:19], v[56:59]
    buffer_load_dwordx4 v104, s[24:27], s56 offen offset:0  lds
    v_mfma_f32_16x16x32_bf16 v[56:59], a[76:79], a[20:23], v[56:59]
    ds_read_b64_tr_b16 a[100:101], v114 offset:4096
    v_mfma_f32_16x16x32_bf16 v[60:63], a[72:75], a[24:27], v[60:63]
    ds_read_b64_tr_b16 a[102:103], v114 offset:4608
    v_mfma_f32_16x16x32_bf16 v[60:63], a[76:79], a[28:31], v[60:63]
    s_waitcnt lgkmcnt(8)
    buffer_load_dwordx4 v105, s[24:27], s56 offen offset:1024  lds
    v_mfma_f32_16x16x32_bf16 v[64:67], a[0:3], a[80:83], v[64:67]
    ds_read_b64_tr_b16 a[104:105], v115 offset:0
    v_mfma_f32_16x16x32_bf16 v[64:67], a[4:7], a[84:87], v[64:67]
    s_add_u32 s63, s63, 1
    ds_read_b64_tr_b16 a[106:107], v115 offset:512
    v_mfma_f32_16x16x32_bf16 v[68:71], a[8:11], a[80:83], v[68:71]
    s_and_b32 s63, s63, 15
    v_mfma_f32_16x16x32_bf16 v[68:71], a[12:15], a[84:87], v[68:71]
    s_mul_i32 s56, s63, 393216
    ds_read_b64_tr_b16 a[108:109], v115 offset:4096
    v_mov_b32 v129, s73
    v_mfma_f32_16x16x32_bf16 v[72:75], a[16:19], a[80:83], v[72:75]
    s_lshl_b32 s57, s63, 7
    ds_read_b64_tr_b16 a[110:111], v115 offset:4608
    v_mfma_f32_16x16x32_bf16 v[72:75], a[20:23], a[84:87], v[72:75]
    s_waitcnt vmcnt(11)
    s_barrier
    v_mfma_f32_16x16x32_bf16 v[76:79], a[24:27], a[80:83], v[76:79]
    ds_read_b128 a[32:35], v108 offset:0
    v_mfma_f32_16x16x32_bf16 v[76:79], a[28:31], a[84:87], v[76:79]
    s_waitcnt lgkmcnt(9)
    s_add_u32 m0, s53, 122880
    ds_read_b128 a[36:39], v109 offset:0
    v_mfma_f32_16x16x32_bf16 v[80:83], a[0:3], a[88:91], v[80:83]
    buffer_load_dwordx4 v96, s[28:31], s57 offen offset:0  lds
    v_mfma_f32_16x16x32_bf16 v[80:83], a[4:7], a[92:95], v[80:83]
    ds_read_b64_tr_b16 a[64:65], v116 offset:8192
    v_mfma_f32_16x16x32_bf16 v[84:87], a[8:11], a[88:91], v[84:87]
    ds_read_b64_tr_b16 a[66:67], v116 offset:8704
    v_mfma_f32_16x16x32_bf16 v[84:87], a[12:15], a[92:95], v[84:87]
    buffer_load_dwordx4 v97, s[28:31], s57 offen offset:1024  lds
    v_and_b32 v131, 3, v122
    v_mfma_f32_16x16x32_bf16 v[88:91], a[16:19], a[88:91], v[88:91]
    ds_read_b64_tr_b16 a[68:69], v116 offset:12288
    v_mfma_f32_16x16x32_bf16 v[88:91], a[20:23], a[92:95], v[88:91]
    ds_read_b64_tr_b16 a[70:71], v116 offset:12800
    v_mfma_f32_16x16x32_bf16 v[92:95], a[24:27], a[88:91], v[92:95]
    v_mfma_f32_16x16x32_bf16 v[92:95], a[28:31], a[92:95], v[92:95]
    s_waitcnt lgkmcnt(10)
    ds_read_b128 a[40:43], v108 offset:2048
    v_mfma_f32_16x16x32_bf16 v[0:3], a[96:99], a[0:3], v[0:3]
    ds_read_b128 a[44:47], v109 offset:2048
    v_mfma_f32_16x16x32_bf16 v[0:3], a[100:103], a[4:7], v[0:3]
    buffer_load_dwordx4 v98, s[28:31], s57 offen offset:2048  lds
    v_mfma_f32_16x16x32_bf16 v[4:7], a[96:99], a[8:11], v[4:7]
    ds_read_b128 a[48:51], v108 offset:4096
    v_mfma_f32_16x16x32_bf16 v[4:7], a[100:103], a[12:15], v[4:7]
    ds_read_b128 a[52:55], v109 offset:4096
    v_mul_u32_u24 v131, 64, v131
    v_mfma_f32_16x16x32_bf16 v[8:11], a[96:99], a[16:19], v[8:11]
    buffer_load_dwordx4 v99, s[28:31], s57 offen offset:3072  lds
    v_mfma_f32_16x16x32_bf16 v[8:11], a[100:103], a[20:23], v[8:11]
    ds_read_b128 a[56:59], v108 offset:6144
    v_mfma_f32_16x16x32_bf16 v[12:15], a[96:99], a[24:27], v[12:15]
    ds_read_b128 a[60:63], v109 offset:6144
    v_mfma_f32_16x16x32_bf16 v[12:15], a[100:103], a[28:31], v[12:15]
    s_waitcnt lgkmcnt(12)
    v_mfma_f32_16x16x32_bf16 v[16:19], a[104:107], a[0:3], v[16:19]
    ds_read_b64_tr_b16 a[72:73], v117 offset:8192
    v_mfma_f32_16x16x32_bf16 v[16:19], a[108:111], a[4:7], v[16:19]
    s_add_u32 m0, s54, 122880
    ds_read_b64_tr_b16 a[74:75], v117 offset:8704
    v_mfma_f32_16x16x32_bf16 v[20:23], a[104:107], a[8:11], v[20:23]
    buffer_load_dwordx4 v100, s[24:27], s56 offen offset:0  lds
    v_mfma_f32_16x16x32_bf16 v[20:23], a[108:111], a[12:15], v[20:23]
    s_lshl_b32 s73, s3, 8
    ds_read_b64_tr_b16 a[76:77], v117 offset:12288
    v_mfma_f32_16x16x32_bf16 v[24:27], a[104:107], a[16:19], v[24:27]
    ds_read_b64_tr_b16 a[78:79], v117 offset:12800
    v_mfma_f32_16x16x32_bf16 v[24:27], a[108:111], a[20:23], v[24:27]
    buffer_load_dwordx4 v101, s[24:27], s56 offen offset:1024  lds
    v_mfma_f32_16x16x32_bf16 v[28:31], a[104:107], a[24:27], v[28:31]
    ds_read_b64_tr_b16 a[80:81], v116 offset:16384
    v_mfma_f32_16x16x32_bf16 v[28:31], a[108:111], a[28:31], v[28:31]
    s_waitcnt lgkmcnt(9)
    ds_read_b64_tr_b16 a[82:83], v116 offset:16896
    v_mfma_f32_16x16x32_bf16 v[32:35], a[64:67], a[32:35], v[32:35]
    v_mfma_f32_16x16x32_bf16 v[32:35], a[68:71], a[36:39], v[32:35]
    ds_read_b64_tr_b16 a[84:85], v116 offset:20480
    v_mfma_f32_16x16x32_bf16 v[36:39], a[64:67], a[40:43], v[36:39]
    s_add_u32 m0, s54, 131072
    ds_read_b64_tr_b16 a[86:87], v116 offset:20992
    v_mfma_f32_16x16x32_bf16 v[36:39], a[68:71], a[44:47], v[36:39]
    s_waitcnt lgkmcnt(8)
    s_mul_i32 s69, s67, 6144
    buffer_load_dwordx4 v102, s[24:27], s56 offen offset:0  lds
    v_mfma_f32_16x16x32_bf16 v[40:43], a[64:67], a[48:51], v[40:43]
    ds_read_b64_tr_b16 a[88:89], v117 offset:16384
    v_mfma_f32_16x16x32_bf16 v[40:43], a[68:71], a[52:55], v[40:43]
    ds_read_b64_tr_b16 a[90:91], v117 offset:16896
    v_mfma_f32_16x16x32_bf16 v[44:47], a[64:67], a[56:59], v[44:47]
    buffer_load_dwordx4 v103, s[24:27], s56 offen offset:1024  lds
    v_mfma_f32_16x16x32_bf16 v[44:47], a[68:71], a[60:63], v[44:47]
    s_waitcnt lgkmcnt(6)
    ds_read_b64_tr_b16 a[92:93], v117 offset:20480
    v_mfma_f32_16x16x32_bf16 v[48:51], a[72:75], a[32:35], v[48:51]
    ds_read_b64_tr_b16 a[94:95], v117 offset:20992
    v_mfma_f32_16x16x32_bf16 v[48:51], a[76:79], a[36:39], v[48:51]
    v_mfma_f32_16x16x32_bf16 v[52:55], a[72:75], a[40:43], v[52:55]
    ds_read_b64_tr_b16 a[96:97], v116 offset:0
    v_mfma_f32_16x16x32_bf16 v[52:55], a[76:79], a[44:47], v[52:55]
    s_add_u32 m0, s54, 139264
    ds_read_b64_tr_b16 a[98:99], v116 offset:512
    s_add_u32 s72, s69, 4096
    v_mfma_f32_16x16x32_bf16 v[56:59], a[72:75], a[48:51], v[56:59]
    buffer_load_dwordx4 v104, s[24:27], s56 offen offset:0  lds
    v_mfma_f32_16x16x32_bf16 v[56:59], a[76:79], a[52:55], v[56:59]
    ds_read_b64_tr_b16 a[100:101], v116 offset:4096
    v_mfma_f32_16x16x32_bf16 v[60:63], a[72:75], a[56:59], v[60:63]
    ds_read_b64_tr_b16 a[102:103], v116 offset:4608
    v_mfma_f32_16x16x32_bf16 v[60:63], a[76:79], a[60:63], v[60:63]
    s_waitcnt lgkmcnt(8)
    buffer_load_dwordx4 v105, s[24:27], s56 offen offset:1024  lds
    v_mfma_f32_16x16x32_bf16 v[64:67], a[32:35], a[80:83], v[64:67]
    ds_read_b64_tr_b16 a[104:105], v117 offset:0
    v_mfma_f32_16x16x32_bf16 v[64:67], a[36:39], a[84:87], v[64:67]
    s_add_u32 s63, s63, 1
    ds_read_b64_tr_b16 a[106:107], v117 offset:512
    v_mfma_f32_16x16x32_bf16 v[68:71], a[40:43], a[80:83], v[68:71]
    s_and_b32 s63, s63, 15
    v_mfma_f32_16x16x32_bf16 v[68:71], a[44:47], a[84:87], v[68:71]
    s_mul_i32 s56, s63, 393216
    ds_read_b64_tr_b16 a[108:109], v117 offset:4096
    s_lshl_b32 s70, s46, 10
    v_mfma_f32_16x16x32_bf16 v[72:75], a[48:51], a[80:83], v[72:75]
    s_lshl_b32 s57, s63, 7
    ds_read_b64_tr_b16 a[110:111], v117 offset:4608
    v_mfma_f32_16x16x32_bf16 v[72:75], a[52:55], a[84:87], v[72:75]
    s_waitcnt vmcnt(10)
    s_barrier
    v_mfma_f32_16x16x32_bf16 v[76:79], a[56:59], a[80:83], v[76:79]
    ds_read_b128 a[0:3], v110 offset:0
    v_mfma_f32_16x16x32_bf16 v[76:79], a[60:63], a[84:87], v[76:79]
    s_waitcnt lgkmcnt(9)
    s_add_u32 m0, s53, 0
    ds_read_b128 a[4:7], v111 offset:0
    v_mfma_f32_16x16x32_bf16 v[80:83], a[32:35], a[88:91], v[80:83]
    buffer_load_dwordx4 v96, s[28:31], s57 offen offset:0  lds
    v_mfma_f32_16x16x32_bf16 v[80:83], a[36:39], a[92:95], v[80:83]
    ds_read_b64_tr_b16 a[64:65], v118 offset:8192
    v_mfma_f32_16x16x32_bf16 v[84:87], a[40:43], a[88:91], v[84:87]
    ds_read_b64_tr_b16 a[66:67], v118 offset:8704
    v_mfma_f32_16x16x32_bf16 v[84:87], a[44:47], a[92:95], v[84:87]
    s_lshl_b32 s71, s48, 9
    buffer_load_dwordx4 v97, s[28:31], s57 offen offset:1024  lds
    v_mfma_f32_16x16x32_bf16 v[88:91], a[48:51], a[88:91], v[88:91]
    ds_read_b64_tr_b16 a[68:69], v118 offset:12288
    v_mfma_f32_16x16x32_bf16 v[88:91], a[52:55], a[92:95], v[88:91]
    ds_read_b64_tr_b16 a[70:71], v118 offset:12800
    v_mfma_f32_16x16x32_bf16 v[92:95], a[56:59], a[88:91], v[92:95]
    v_mfma_f32_16x16x32_bf16 v[92:95], a[60:63], a[92:95], v[92:95]
    s_waitcnt lgkmcnt(10)
    ds_read_b128 a[8:11], v110 offset:2048
    v_mfma_f32_16x16x32_bf16 v[0:3], a[96:99], a[32:35], v[0:3]
    ds_read_b128 a[12:15], v111 offset:2048
    v_mfma_f32_16x16x32_bf16 v[0:3], a[100:103], a[36:39], v[0:3]
    buffer_load_dwordx4 v98, s[28:31], s57 offen offset:2048  lds
    v_mfma_f32_16x16x32_bf16 v[4:7], a[96:99], a[40:43], v[4:7]
    ds_read_b128 a[16:19], v110 offset:4096
    v_mfma_f32_16x16x32_bf16 v[4:7], a[100:103], a[44:47], v[4:7]
    s_add_u32 s70, s70, s71
    ds_read_b128 a[20:23], v111 offset:4096
    v_mfma_f32_16x16x32_bf16 v[8:11], a[96:99], a[48:51], v[8:11]
    buffer_load_dwordx4 v99, s[28:31], s57 offen offset:3072  lds
    v_mfma_f32_16x16x32_bf16 v[8:11], a[100:103], a[52:55], v[8:11]
    ds_read_b128 a[24:27], v110 offset:6144
    v_mfma_f32_16x16x32_bf16 v[12:15], a[96:99], a[56:59], v[12:15]
    ds_read_b128 a[28:31], v111 offset:6144
    v_mfma_f32_16x16x32_bf16 v[12:15], a[100:103], a[60:63], v[12:15]
    s_waitcnt lgkmcnt(12)
    v_mfma_f32_16x16x32_bf16 v[16:19], a[104:107], a[32:35], v[16:19]
    ds_read_b64_tr_b16 a[72:73], v119 offset:8192
    v_mfma_f32_16x16x32_bf16 v[16:19], a[108:111], a[36:39], v[16:19]
    s_add_u32 m0, s54, 0
    ds_read_b64_tr_b16 a[74:75], v119 offset:8704
    v_mfma_f32_16x16x32_bf16 v[20:23], a[104:107], a[40:43], v[20:23]
    buffer_load_dwordx4 v100, s[24:27], s56 offen offset:0  lds
    v_mfma_f32_16x16x32_bf16 v[20:23], a[108:111], a[44:47], v[20:23]
    s_add_u32 s70, s70, 262144
    ds_read_b64_tr_b16 a[76:77], v119 offset:12288
    v_mfma_f32_16x16x32_bf16 v[24:27], a[104:107], a[48:51], v[24:27]
    ds_read_b64_tr_b16 a[78:79], v119 offset:12800
    v_mfma_f32_16x16x32_bf16 v[24:27], a[108:111], a[52:55], v[24:27]
    buffer_load_dwordx4 v101, s[24:27], s56 offen offset:1024  lds
    v_mfma_f32_16x16x32_bf16 v[28:31], a[104:107], a[56:59], v[28:31]
    ds_read_b64_tr_b16 a[80:81], v118 offset:16384
    v_mfma_f32_16x16x32_bf16 v[28:31], a[108:111], a[60:63], v[28:31]
    s_waitcnt lgkmcnt(9)
    ds_read_b64_tr_b16 a[82:83], v118 offset:16896
    v_mfma_f32_16x16x32_bf16 v[32:35], a[64:67], a[0:3], v[32:35]
    s_and_b32 s92, s44, 7
    v_mfma_f32_16x16x32_bf16 v[32:35], a[68:71], a[4:7], v[32:35]
    ds_read_b64_tr_b16 a[84:85], v118 offset:20480
    v_mfma_f32_16x16x32_bf16 v[36:39], a[64:67], a[8:11], v[36:39]
    s_add_u32 m0, s54, 8192
    ds_read_b64_tr_b16 a[86:87], v118 offset:20992
    v_mfma_f32_16x16x32_bf16 v[36:39], a[68:71], a[12:15], v[36:39]
    s_waitcnt lgkmcnt(8)
    buffer_load_dwordx4 v102, s[24:27], s56 offen offset:0  lds
    v_mfma_f32_16x16x32_bf16 v[40:43], a[64:67], a[16:19], v[40:43]
    s_lshl_b32 s92, s92, 1
    ds_read_b64_tr_b16 a[88:89], v119 offset:16384
    v_mfma_f32_16x16x32_bf16 v[40:43], a[68:71], a[20:23], v[40:43]
    ds_read_b64_tr_b16 a[90:91], v119 offset:16896
    v_mfma_f32_16x16x32_bf16 v[44:47], a[64:67], a[24:27], v[44:47]
    buffer_load_dwordx4 v103, s[24:27], s56 offen offset:1024  lds
    v_mfma_f32_16x16x32_bf16 v[44:47], a[68:71], a[28:31], v[44:47]
    s_waitcnt lgkmcnt(6)
    s_and_b32 s93, s45, 1
    ds_read_b64_tr_b16 a[92:93], v119 offset:20480
    v_mfma_f32_16x16x32_bf16 v[48:51], a[72:75], a[0:3], v[48:51]
    ds_read_b64_tr_b16 a[94:95], v119 offset:20992
    v_mfma_f32_16x16x32_bf16 v[48:51], a[76:79], a[4:7], v[48:51]
    s_add_u32 s92, s92, s93
    v_mfma_f32_16x16x32_bf16 v[52:55], a[72:75], a[8:11], v[52:55]
    ds_read_b64_tr_b16 a[96:97], v118 offset:0
    v_mfma_f32_16x16x32_bf16 v[52:55], a[76:79], a[12:15], v[52:55]
    s_add_u32 m0, s54, 16384
    ds_read_b64_tr_b16 a[98:99], v118 offset:512
    v_mfma_f32_16x16x32_bf16 v[56:59], a[72:75], a[16:19], v[56:59]
    buffer_load_dwordx4 v104, s[24:27], s56 offen offset:0  lds
    v_mfma_f32_16x16x32_bf16 v[56:59], a[76:79], a[20:23], v[56:59]
    s_lshr_b32 s93, s44, 3
    ds_read_b64_tr_b16 a[100:101], v118 offset:4096
    v_mfma_f32_16x16x32_bf16 v[60:63], a[72:75], a[24:27], v[60:63]
    ds_read_b64_tr_b16 a[102:103], v118 offset:4608
    v_mfma_f32_16x16x32_bf16 v[60:63], a[76:79], a[28:31], v[60:63]
    s_waitcnt lgkmcnt(8)
    buffer_load_dwordx4 v105, s[24:27], s56 offen offset:1024  lds
    v_mfma_f32_16x16x32_bf16 v[64:67], a[0:3], a[80:83], v[64:67]
    s_lshl_b32 s93, s93, 4
    ds_read_b64_tr_b16 a[104:105], v119 offset:0
    v_mfma_f32_16x16x32_bf16 v[64:67], a[4:7], a[84:87], v[64:67]
    s_add_u32 s63, s63, 1
    ds_read_b64_tr_b16 a[106:107], v119 offset:512
    v_mfma_f32_16x16x32_bf16 v[68:71], a[8:11], a[80:83], v[68:71]
    s_and_b32 s63, s63, 15
    s_lshr_b32 s79, s45, 1
    v_mfma_f32_16x16x32_bf16 v[68:71], a[12:15], a[84:87], v[68:71]
    s_mul_i32 s56, s63, 393216
    ds_read_b64_tr_b16 a[108:109], v119 offset:4096
    v_mfma_f32_16x16x32_bf16 v[72:75], a[16:19], a[80:83], v[72:75]
    s_lshl_b32 s57, s63, 7
    ds_read_b64_tr_b16 a[110:111], v119 offset:4608
    v_mfma_f32_16x16x32_bf16 v[72:75], a[20:23], a[84:87], v[72:75]
    s_waitcnt vmcnt(10)
    s_barrier
    v_mfma_f32_16x16x32_bf16 v[76:79], a[24:27], a[80:83], v[76:79]
    s_add_u32 s93, s93, s79
    ds_read_b128 a[32:35], v112 offset:0
    v_mfma_f32_16x16x32_bf16 v[76:79], a[28:31], a[84:87], v[76:79]
    s_waitcnt lgkmcnt(9)
    s_add_u32 m0, s53, 40960
    ds_read_b128 a[36:39], v113 offset:0
    v_mfma_f32_16x16x32_bf16 v[80:83], a[0:3], a[88:91], v[80:83]
    buffer_load_dwordx4 v96, s[28:31], s57 offen offset:0  lds
    v_mfma_f32_16x16x32_bf16 v[80:83], a[4:7], a[92:95], v[80:83]
    s_mov_b32 s80, s8
    ds_read_b64_tr_b16 a[64:65], v120 offset:8192
    v_mfma_f32_16x16x32_bf16 v[84:87], a[8:11], a[88:91], v[84:87]
    ds_read_b64_tr_b16 a[66:67], v120 offset:8704
    v_mfma_f32_16x16x32_bf16 v[84:87], a[12:15], a[92:95], v[84:87]
    buffer_load_dwordx4 v97, s[28:31], s57 offen offset:1024  lds
    v_mfma_f32_16x16x32_bf16 v[88:91], a[16:19], a[88:91], v[88:91]
    s_mov_b32 s81, s9
    ds_read_b64_tr_b16 a[68:69], v120 offset:12288
    v_mfma_f32_16x16x32_bf16 v[88:91], a[20:23], a[92:95], v[88:91]
    ds_read_b64_tr_b16 a[70:71], v120 offset:12800
    v_mfma_f32_16x16x32_bf16 v[92:95], a[24:27], a[88:91], v[92:95]
    v_mfma_f32_16x16x32_bf16 v[92:95], a[28:31], a[92:95], v[92:95]
    s_waitcnt lgkmcnt(10)
    s_mov_b32 s82, 2097152
    ds_read_b128 a[40:43], v112 offset:2048
    v_mfma_f32_16x16x32_bf16 v[0:3], a[96:99], a[0:3], v[0:3]
    ds_read_b128 a[44:47], v113 offset:2048
    v_mfma_f32_16x16x32_bf16 v[0:3], a[100:103], a[4:7], v[0:3]
    buffer_load_dwordx4 v98, s[28:31], s57 offen offset:2048  lds
    v_mfma_f32_16x16x32_bf16 v[4:7], a[96:99], a[8:11], v[4:7]
    s_mov_b32 s83, 0x20000
    ds_read_b128 a[48:51], v112 offset:4096
    v_mfma_f32_16x16x32_bf16 v[4:7], a[100:103], a[12:15], v[4:7]
    ds_read_b128 a[52:55], v113 offset:4096
    v_mfma_f32_16x16x32_bf16 v[8:11], a[96:99], a[16:19], v[8:11]
    buffer_load_dwordx4 v99, s[28:31], s57 offen offset:3072  lds
    v_mfma_f32_16x16x32_bf16 v[8:11], a[100:103], a[20:23], v[8:11]
    ds_read_b128 a[56:59], v112 offset:6144
    v_mfma_f32_16x16x32_bf16 v[12:15], a[96:99], a[24:27], v[12:15]
    ds_read_b128 a[60:63], v113 offset:6144
    v_mfma_f32_16x16x32_bf16 v[12:15], a[100:103], a[28:31], v[12:15]
    s_waitcnt lgkmcnt(12)
    s_add_u32 s88, s22, 21037056
    s_addc_u32 s89, s23, 0
    v_mfma_f32_16x16x32_bf16 v[16:19], a[104:107], a[0:3], v[16:19]
    ds_read_b64_tr_b16 a[72:73], v121 offset:8192
    v_mfma_f32_16x16x32_bf16 v[16:19], a[108:111], a[4:7], v[16:19]
    s_add_u32 m0, s54, 40960
    ds_read_b64_tr_b16 a[74:75], v121 offset:8704
    v_mfma_f32_16x16x32_bf16 v[20:23], a[104:107], a[8:11], v[20:23]
    buffer_load_dwordx4 v100, s[24:27], s56 offen offset:0  lds
    v_mfma_f32_16x16x32_bf16 v[20:23], a[108:111], a[12:15], v[20:23]
    s_mov_b32 s90, 0x18000
    ds_read_b64_tr_b16 a[76:77], v121 offset:12288
    v_mfma_f32_16x16x32_bf16 v[24:27], a[104:107], a[16:19], v[24:27]
    ds_read_b64_tr_b16 a[78:79], v121 offset:12800
    v_mfma_f32_16x16x32_bf16 v[24:27], a[108:111], a[20:23], v[24:27]
    buffer_load_dwordx4 v101, s[24:27], s56 offen offset:1024  lds
    v_mfma_f32_16x16x32_bf16 v[28:31], a[104:107], a[24:27], v[28:31]
    ds_read_b64_tr_b16 a[80:81], v120 offset:16384
    v_mfma_f32_16x16x32_bf16 v[28:31], a[108:111], a[28:31], v[28:31]
    s_waitcnt lgkmcnt(9)
    s_mov_b32 s91, 0x20000
    ds_read_b64_tr_b16 a[82:83], v120 offset:16896
    v_mfma_f32_16x16x32_bf16 v[32:35], a[64:67], a[32:35], v[32:35]
    v_mfma_f32_16x16x32_bf16 v[32:35], a[68:71], a[36:39], v[32:35]
    ds_read_b64_tr_b16 a[84:85], v120 offset:20480
    v_mfma_f32_16x16x32_bf16 v[36:39], a[64:67], a[40:43], v[36:39]
    s_add_u32 m0, s54, 49152
    ds_read_b64_tr_b16 a[86:87], v120 offset:20992
    v_mfma_f32_16x16x32_bf16 v[36:39], a[68:71], a[44:47], v[36:39]
    s_waitcnt lgkmcnt(8)
    buffer_load_dwordx4 v102, s[24:27], s56 offen offset:0  lds
    v_mfma_f32_16x16x32_bf16 v[40:43], a[64:67], a[48:51], v[40:43]
    s_cmp_eq_u32 s49, 0
    s_cselect_b32 s36, s12, s14
    s_cselect_b32 s37, s13, s15
    ds_read_b64_tr_b16 a[88:89], v121 offset:16384
    v_mfma_f32_16x16x32_bf16 v[40:43], a[68:71], a[52:55], v[40:43]
    ds_read_b64_tr_b16 a[90:91], v121 offset:16896
    v_mfma_f32_16x16x32_bf16 v[44:47], a[64:67], a[56:59], v[44:47]
    buffer_load_dwordx4 v103, s[24:27], s56 offen offset:1024  lds
    v_mfma_f32_16x16x32_bf16 v[44:47], a[68:71], a[60:63], v[44:47]
    s_waitcnt lgkmcnt(6)
    ds_read_b64_tr_b16 a[92:93], v121 offset:20480
    v_mfma_f32_16x16x32_bf16 v[48:51], a[72:75], a[32:35], v[48:51]
    ds_read_b64_tr_b16 a[94:95], v121 offset:20992
    v_mfma_f32_16x16x32_bf16 v[48:51], a[76:79], a[36:39], v[48:51]
    v_mfma_f32_16x16x32_bf16 v[52:55], a[72:75], a[40:43], v[52:55]
    s_and_b32 s68, s2, 15
    ds_read_b64_tr_b16 a[96:97], v120 offset:0
    v_mfma_f32_16x16x32_bf16 v[52:55], a[76:79], a[44:47], v[52:55]
    s_add_u32 m0, s54, 57344
    ds_read_b64_tr_b16 a[98:99], v120 offset:512
    v_mfma_f32_16x16x32_bf16 v[56:59], a[72:75], a[48:51], v[56:59]
    buffer_load_dwordx4 v104, s[24:27], s56 offen offset:0  lds
    v_mfma_f32_16x16x32_bf16 v[56:59], a[76:79], a[52:55], v[56:59]
    s_lshl_b32 s68, s68, 1
    ds_read_b64_tr_b16 a[100:101], v120 offset:4096
    v_mfma_f32_16x16x32_bf16 v[60:63], a[72:75], a[56:59], v[60:63]
    ds_read_b64_tr_b16 a[102:103], v120 offset:4608
    v_mfma_f32_16x16x32_bf16 v[60:63], a[76:79], a[60:63], v[60:63]
    s_waitcnt lgkmcnt(8)
    buffer_load_dwordx4 v105, s[24:27], s56 offen offset:1024  lds
    v_mfma_f32_16x16x32_bf16 v[64:67], a[32:35], a[80:83], v[64:67]
    ds_read_b64_tr_b16 a[104:105], v121 offset:0
    v_mfma_f32_16x16x32_bf16 v[64:67], a[36:39], a[84:87], v[64:67]
    s_add_u32 s63, s63, 1
    ds_read_b64_tr_b16 a[106:107], v121 offset:512
    s_add_u32 s68, s68, s48
    v_mfma_f32_16x16x32_bf16 v[68:71], a[40:43], a[80:83], v[68:71]
    s_and_b32 s63, s63, 15
    buffer_load_dword v130, v131, s[32:35], s73 offen sc1
    v_mfma_f32_16x16x32_bf16 v[68:71], a[44:47], a[84:87], v[68:71]
    s_mul_i32 s56, s63, 393216
    ds_read_b64_tr_b16 a[108:109], v121 offset:4096
    s_lshr_b32 s65, s2, 4
    v_mfma_f32_16x16x32_bf16 v[72:75], a[48:51], a[80:83], v[72:75]
    s_lshl_b32 s57, s63, 7
    ds_read_b64_tr_b16 a[110:111], v121 offset:4608
    v_mfma_f32_16x16x32_bf16 v[72:75], a[52:55], a[84:87], v[72:75]
    s_waitcnt vmcnt(11)
    s_barrier
    v_mfma_f32_16x16x32_bf16 v[76:79], a[56:59], a[80:83], v[76:79]
    ds_read_b128 a[0:3], v106 offset:0
    v_mfma_f32_16x16x32_bf16 v[76:79], a[60:63], a[84:87], v[76:79]
    s_waitcnt lgkmcnt(9)
    s_add_u32 m0, s53, 81920
    ds_read_b128 a[4:7], v107 offset:0
    s_mul_i32 s101, s65, 458752
    v_mfma_f32_16x16x32_bf16 v[80:83], a[32:35], a[88:91], v[80:83]
    buffer_load_dwordx4 v96, s[28:31], s57 offen offset:0  lds
    v_mfma_f32_16x16x32_bf16 v[80:83], a[36:39], a[92:95], v[80:83]
    ds_read_b64_tr_b16 a[64:65], v114 offset:8192
    v_mfma_f32_16x16x32_bf16 v[84:87], a[40:43], a[88:91], v[84:87]
    s_mul_i32 s75, s68, 224
    ds_read_b64_tr_b16 a[66:67], v114 offset:8704
    v_mfma_f32_16x16x32_bf16 v[84:87], a[44:47], a[92:95], v[84:87]
    buffer_load_dwordx4 v97, s[28:31], s57 offen offset:1024  lds
    v_mfma_f32_16x16x32_bf16 v[88:91], a[48:51], a[88:91], v[88:91]
    ds_read_b64_tr_b16 a[68:69], v114 offset:12288
    v_mfma_f32_16x16x32_bf16 v[88:91], a[52:55], a[92:95], v[88:91]
    s_add_u32 s101, s101, s75
    ds_read_b64_tr_b16 a[70:71], v114 offset:12800
    v_mfma_f32_16x16x32_bf16 v[92:95], a[56:59], a[88:91], v[92:95]
    v_mfma_f32_16x16x32_bf16 v[92:95], a[60:63], a[92:95], v[92:95]
    s_waitcnt lgkmcnt(10)
    ds_read_b128 a[8:11], v106 offset:2048
    v_mfma_f32_16x16x32_bf16 v[0:3], a[96:99], a[32:35], v[0:3]
    s_mul_i32 s95, s49, 14336
    ds_read_b128 a[12:15], v107 offset:2048
    v_mfma_f32_16x16x32_bf16 v[0:3], a[100:103], a[36:39], v[0:3]
    buffer_load_dwordx4 v98, s[28:31], s57 offen offset:2048  lds
    v_mfma_f32_16x16x32_bf16 v[4:7], a[96:99], a[40:43], v[4:7]
    ds_read_b128 a[16:19], v106 offset:4096
    v_mfma_f32_16x16x32_bf16 v[4:7], a[100:103], a[44:47], v[4:7]
    s_lshl_b32 s75, s75, 1
    ds_read_b128 a[20:23], v107 offset:4096
    v_mfma_f32_16x16x32_bf16 v[8:11], a[96:99], a[48:51], v[8:11]
    buffer_load_dwordx4 v99, s[28:31], s57 offen offset:3072  lds
    v_mfma_f32_16x16x32_bf16 v[8:11], a[100:103], a[52:55], v[8:11]
    ds_read_b128 a[24:27], v106 offset:6144
    v_mfma_f32_16x16x32_bf16 v[12:15], a[96:99], a[56:59], v[12:15]
    s_add_u32 s95, s95, s75
    ds_read_b128 a[28:31], v107 offset:6144
    v_mfma_f32_16x16x32_bf16 v[12:15], a[100:103], a[60:63], v[12:15]
    s_waitcnt lgkmcnt(12)
    v_mfma_f32_16x16x32_bf16 v[16:19], a[104:107], a[32:35], v[16:19]
    ds_read_b64_tr_b16 a[72:73], v115 offset:8192
    v_mfma_f32_16x16x32_bf16 v[16:19], a[108:111], a[36:39], v[16:19]
    s_add_u32 m0, s54, 81920
    ds_read_b64_tr_b16 a[74:75], v115 offset:8704
    s_mul_i32 s100, s68, 458752
    v_mfma_f32_16x16x32_bf16 v[20:23], a[104:107], a[40:43], v[20:23]
    buffer_load_dwordx4 v100, s[24:27], s56 offen offset:0  lds
    v_mfma_f32_16x16x32_bf16 v[20:23], a[108:111], a[44:47], v[20:23]
    ds_read_b64_tr_b16 a[76:77], v115 offset:12288
    v_mfma_f32_16x16x32_bf16 v[24:27], a[104:107], a[48:51], v[24:27]
    s_mul_i32 s75, s65, 28672
    ds_read_b64_tr_b16 a[78:79], v115 offset:12800
    v_mfma_f32_16x16x32_bf16 v[24:27], a[108:111], a[52:55], v[24:27]
    buffer_load_dwordx4 v101, s[24:27], s56 offen offset:1024  lds
    v_mfma_f32_16x16x32_bf16 v[28:31], a[104:107], a[56:59], v[28:31]
    ds_read_b64_tr_b16 a[80:81], v114 offset:16384
    v_mfma_f32_16x16x32_bf16 v[28:31], a[108:111], a[60:63], v[28:31]
    s_waitcnt lgkmcnt(9)
    ds_read_b64_tr_b16 a[82:83], v114 offset:16896
    v_mfma_f32_16x16x32_bf16 v[32:35], a[64:67], a[0:3], v[32:35]
    s_add_u32 s100, s100, s75
    v_mfma_f32_16x16x32_bf16 v[32:35], a[68:71], a[4:7], v[32:35]
    ds_read_b64_tr_b16 a[84:85], v114 offset:20480
    v_mfma_f32_16x16x32_bf16 v[36:39], a[64:67], a[8:11], v[36:39]
    s_add_u32 m0, s54, 90112
    ds_read_b64_tr_b16 a[86:87], v114 offset:20992
    s_mul_i32 s75, s49, 14336
    v_mfma_f32_16x16x32_bf16 v[36:39], a[68:71], a[12:15], v[36:39]
    s_waitcnt lgkmcnt(8)
    buffer_load_dwordx4 v102, s[24:27], s56 offen offset:0  lds
    v_mfma_f32_16x16x32_bf16 v[40:43], a[64:67], a[16:19], v[40:43]
    ds_read_b64_tr_b16 a[88:89], v115 offset:16384
    v_mfma_f32_16x16x32_bf16 v[40:43], a[68:71], a[20:23], v[40:43]
    s_add_u32 s100, s100, s75
    ds_read_b64_tr_b16 a[90:91], v115 offset:16896
    v_mfma_f32_16x16x32_bf16 v[44:47], a[64:67], a[24:27], v[44:47]
    buffer_load_dwordx4 v103, s[24:27], s56 offen offset:1024  lds
    v_mfma_f32_16x16x32_bf16 v[44:47], a[68:71], a[28:31], v[44:47]
    s_waitcnt lgkmcnt(6)
    ds_read_b64_tr_b16 a[92:93], v115 offset:20480
    v_mfma_f32_16x16x32_bf16 v[48:51], a[72:75], a[0:3], v[48:51]
    ds_read_b64_tr_b16 a[94:95], v115 offset:20992
    v_mfma_f32_16x16x32_bf16 v[48:51], a[76:79], a[4:7], v[48:51]
    s_add_u32 s100, s100, 94371840
    v_mfma_f32_16x16x32_bf16 v[52:55], a[72:75], a[8:11], v[52:55]
    ds_read_b64_tr_b16 a[96:97], v114 offset:0
    v_mfma_f32_16x16x32_bf16 v[52:55], a[76:79], a[12:15], v[52:55]
    s_add_u32 m0, s54, 98304
L_stub_1:
    s_cbranch_execz L_warm_start_ret
    ds_read_b64_tr_b16 a[98:99], v114 offset:512
    s_mov_b32 s38, 7340032
    v_mfma_f32_16x16x32_bf16 v[56:59], a[72:75], a[16:19], v[56:59]
    buffer_load_dwordx4 v104, s[24:27], s56 offen offset:0  lds
    v_mfma_f32_16x16x32_bf16 v[56:59], a[76:79], a[20:23], v[56:59]
    ds_read_b64_tr_b16 a[100:101], v114 offset:4096
    v_mfma_f32_16x16x32_bf16 v[60:63], a[72:75], a[24:27], v[60:63]
    s_mov_b32 s39, 0x20000
    ds_read_b64_tr_b16 a[102:103], v114 offset:4608
    s_waitcnt vmcnt(9)
    v_cmp_gt_u32 vcc, v129, v130
    v_mfma_f32_16x16x32_bf16 v[60:63], a[76:79], a[28:31], v[60:63]
    s_waitcnt lgkmcnt(8)
    buffer_load_dwordx4 v105, s[24:27], s56 offen offset:1024  lds
    v_mfma_f32_16x16x32_bf16 v[64:67], a[0:3], a[80:83], v[64:67]
    ds_read_b64_tr_b16 a[104:105], v115 offset:0
    v_mfma_f32_16x16x32_bf16 v[64:67], a[4:7], a[84:87], v[64:67]
    s_add_u32 s63, s63, 1
    ds_read_b64_tr_b16 a[106:107], v115 offset:512
    v_mfma_f32_16x16x32_bf16 v[68:71], a[8:11], a[80:83], v[68:71]
    s_and_b32 s63, s63, 15
    s_mov_b32 s84, s16
    s_cbranch_vccnz L_sequential_preLN__softmax_full_mha__glu_gated_swiglu__prompt_kernel_spin_2
L_sequential_preLN__softmax_full_mha__glu_gated_swiglu__prompt_kernel_ok_3:
    v_mfma_f32_16x16x32_bf16 v[68:71], a[12:15], a[84:87], v[68:71]
    s_mul_i32 s56, s63, 393216
    ds_read_b64_tr_b16 a[108:109], v115 offset:4096
    v_mfma_f32_16x16x32_bf16 v[72:75], a[16:19], a[80:83], v[72:75]
    s_lshl_b32 s57, s63, 7
    ds_read_b64_tr_b16 a[110:111], v115 offset:4608
    s_mov_b32 s85, s17
    v_mfma_f32_16x16x32_bf16 v[72:75], a[20:23], a[84:87], v[72:75]
    s_barrier
    v_mfma_f32_16x16x32_bf16 v[76:79], a[24:27], a[80:83], v[76:79]
    ds_read_b128 a[32:35], v108 offset:0
    v_mfma_f32_16x16x32_bf16 v[76:79], a[28:31], a[84:87], v[76:79]
    s_waitcnt lgkmcnt(9)
    s_add_u32 m0, s53, 122880
    ds_read_b128 a[36:39], v109 offset:0
    s_mov_b32 s86, 7340032
    v_mfma_f32_16x16x32_bf16 v[80:83], a[0:3], a[88:91], v[80:83]
    buffer_load_dwordx4 v96, s[28:31], s57 offen offset:0  lds
    buffer_load_dwordx2 v[136:137], v240, s[40:43], s70 offen sc1
    v_mfma_f32_16x16x32_bf16 v[80:83], a[4:7], a[92:95], v[80:83]
    ds_read_b64_tr_b16 a[64:65], v116 offset:8192
    v_mfma_f32_16x16x32_bf16 v[84:87], a[8:11], a[88:91], v[84:87]
    ds_read_b64_tr_b16 a[66:67], v116 offset:8704
    v_mfma_f32_16x16x32_bf16 v[84:87], a[12:15], a[92:95], v[84:87]
    s_mov_b32 s87, 0x20000
    buffer_load_dwordx4 v97, s[28:31], s57 offen offset:1024  lds
    v_mfma_f32_16x16x32_bf16 v[88:91], a[16:19], a[88:91], v[88:91]
    ds_read_b64_tr_b16 a[68:69], v116 offset:12288
    v_mfma_f32_16x16x32_bf16 v[88:91], a[20:23], a[92:95], v[88:91]
    ds_read_b64_tr_b16 a[70:71], v116 offset:12800
    v_mfma_f32_16x16x32_bf16 v[92:95], a[24:27], a[88:91], v[92:95]
    s_lshl_b32 s64, s2, 2
    v_mfma_f32_16x16x32_bf16 v[92:95], a[28:31], a[92:95], v[92:95]
    s_waitcnt lgkmcnt(10)
    ds_read_b128 a[40:43], v108 offset:2048
    v_mfma_f32_16x16x32_bf16 v[0:3], a[96:99], a[0:3], v[0:3]
    ds_read_b128 a[44:47], v109 offset:2048
    v_mfma_f32_16x16x32_bf16 v[0:3], a[100:103], a[4:7], v[0:3]
    s_add_u32 s64, s64, s3
    buffer_load_dwordx4 v98, s[28:31], s57 offen offset:2048  lds
    buffer_load_dwordx2 v[224:225], v241, s[40:43], s70 offen sc1
    v_mfma_f32_16x16x32_bf16 v[4:7], a[96:99], a[8:11], v[4:7]
    ds_read_b128 a[48:51], v108 offset:4096
    v_mfma_f32_16x16x32_bf16 v[4:7], a[100:103], a[12:15], v[4:7]
    ds_read_b128 a[52:55], v109 offset:4096
    v_mfma_f32_16x16x32_bf16 v[8:11], a[96:99], a[16:19], v[8:11]
    s_and_b32 s68, s64, 15
    buffer_load_dwordx4 v99, s[28:31], s57 offen offset:3072  lds
    v_mfma_f32_16x16x32_bf16 v[8:11], a[100:103], a[20:23], v[8:11]
    ds_read_b128 a[56:59], v108 offset:6144
    v_mfma_f32_16x16x32_bf16 v[12:15], a[96:99], a[24:27], v[12:15]
    ds_read_b128 a[60:63], v109 offset:6144
    v_mfma_f32_16x16x32_bf16 v[12:15], a[100:103], a[28:31], v[12:15]
    s_waitcnt lgkmcnt(12)
    s_lshr_b32 s65, s64, 4
    v_mfma_f32_16x16x32_bf16 v[16:19], a[104:107], a[0:3], v[16:19]
    ds_read_b64_tr_b16 a[72:73], v117 offset:8192
    v_mfma_f32_16x16x32_bf16 v[16:19], a[108:111], a[4:7], v[16:19]
    s_add_u32 m0, s54, 122880
    ds_read_b64_tr_b16 a[74:75], v117 offset:8704
    v_mfma_f32_16x16x32_bf16 v[20:23], a[104:107], a[8:11], v[20:23]
    s_lshl_b32 s74, s65, 17
    buffer_load_dwordx4 v100, s[24:27], s56 offen offset:0  lds
    buffer_load_dwordx4 v[192:195], v135, s[40:43], s69 offen offset:0 sc1
    v_mfma_f32_16x16x32_bf16 v[20:23], a[108:111], a[12:15], v[20:23]
    ds_read_b64_tr_b16 a[76:77], v117 offset:12288
    v_mfma_f32_16x16x32_bf16 v[24:27], a[104:107], a[16:19], v[24:27]
    ds_read_b64_tr_b16 a[78:79], v117 offset:12800
    v_mfma_f32_16x16x32_bf16 v[24:27], a[108:111], a[20:23], v[24:27]
    s_lshl_b32 s75, s68, 7
    buffer_load_dwordx4 v101, s[24:27], s56 offen offset:1024  lds
    v_mfma_f32_16x16x32_bf16 v[28:31], a[104:107], a[24:27], v[28:31]
    ds_read_b64_tr_b16 a[80:81], v116 offset:16384
    v_mfma_f32_16x16x32_bf16 v[28:31], a[108:111], a[28:31], v[28:31]
    s_waitcnt lgkmcnt(9)
    ds_read_b64_tr_b16 a[82:83], v116 offset:16896
    v_mfma_f32_16x16x32_bf16 v[32:35], a[64:67], a[32:35], v[32:35]
    s_add_u32 s74, s74, s75
    v_mfma_f32_16x16x32_bf16 v[32:35], a[68:71], a[36:39], v[32:35]
    ds_read_b64_tr_b16 a[84:85], v116 offset:20480
    v_mfma_f32_16x16x32_bf16 v[36:39], a[64:67], a[40:43], v[36:39]
    s_add_u32 m0, s54, 131072
    ds_read_b64_tr_b16 a[86:87], v116 offset:20992
    v_mfma_f32_16x16x32_bf16 v[36:39], a[68:71], a[44:47], v[36:39]
    s_waitcnt lgkmcnt(8)
    s_mul_i32 s68, s68, 458752
    buffer_load_dwordx4 v102, s[24:27], s56 offen offset:0  lds
    buffer_load_dwordx4 v[196:199], v135, s[40:43], s69 offen offset:1024 sc1
    v_mfma_f32_16x16x32_bf16 v[40:43], a[64:67], a[48:51], v[40:43]
    ds_read_b64_tr_b16 a[88:89], v117 offset:16384
    v_mfma_f32_16x16x32_bf16 v[40:43], a[68:71], a[52:55], v[40:43]
    ds_read_b64_tr_b16 a[90:91], v117 offset:16896
    v_mfma_f32_16x16x32_bf16 v[44:47], a[64:67], a[56:59], v[44:47]
    s_lshl_b32 s79, s65, 13
    buffer_load_dwordx4 v103, s[24:27], s56 offen offset:1024  lds
    v_mfma_f32_16x16x32_bf16 v[44:47], a[68:71], a[60:63], v[44:47]
    s_waitcnt lgkmcnt(6)
    ds_read_b64_tr_b16 a[92:93], v117 offset:20480
    v_mfma_f32_16x16x32_bf16 v[48:51], a[72:75], a[32:35], v[48:51]
    ds_read_b64_tr_b16 a[94:95], v117 offset:20992
    v_mfma_f32_16x16x32_bf16 v[48:51], a[76:79], a[36:39], v[48:51]
    s_add_u32 s79, s79, s68
    v_mfma_f32_16x16x32_bf16 v[52:55], a[72:75], a[40:43], v[52:55]
    ds_read_b64_tr_b16 a[96:97], v116 offset:0
    v_mfma_f32_16x16x32_bf16 v[52:55], a[76:79], a[44:47], v[52:55]
    s_add_u32 m0, s54, 139264
    ds_read_b64_tr_b16 a[98:99], v116 offset:512
    v_mfma_f32_16x16x32_bf16 v[56:59], a[72:75], a[48:51], v[56:59]
    buffer_load_dwordx4 v104, s[24:27], s56 offen offset:0  lds
    buffer_load_dwordx4 v[200:203], v135, s[40:43], s69 offen offset:2048 sc1
    v_mfma_f32_16x16x32_bf16 v[56:59], a[76:79], a[52:55], v[56:59]
    s_cmp_lt_u32 s64, 896
    s_cselect_b32 s79, s79, s59
    ds_read_b64_tr_b16 a[100:101], v116 offset:4096
    v_mfma_f32_16x16x32_bf16 v[60:63], a[72:75], a[56:59], v[60:63]
    ds_read_b64_tr_b16 a[102:103], v116 offset:4608
    v_mfma_f32_16x16x32_bf16 v[60:63], a[76:79], a[60:63], v[60:63]
    s_waitcnt lgkmcnt(8)
    buffer_load_dwordx4 v105, s[24:27], s56 offen offset:1024  lds
    v_mfma_f32_16x16x32_bf16 v[64:67], a[32:35], a[80:83], v[64:67]
    ds_read_b64_tr_b16 a[104:105], v117 offset:0
    v_mfma_f32_16x16x32_bf16 v[64:67], a[36:39], a[84:87], v[64:67]
    s_add_u32 s63, s63, 1
    ds_read_b64_tr_b16 a[106:107], v117 offset:512
    v_mfma_f32_16x16x32_bf16 v[68:71], a[40:43], a[80:83], v[68:71]
    s_and_b32 s63, s63, 15
    s_lshl_b32 s76, s92, 3
    v_mfma_f32_16x16x32_bf16 v[68:71], a[44:47], a[84:87], v[68:71]
    s_mul_i32 s56, s63, 393216
    ds_read_b64_tr_b16 a[108:109], v117 offset:4096
    v_mfma_f32_16x16x32_bf16 v[72:75], a[48:51], a[80:83], v[72:75]
    s_lshl_b32 s57, s63, 7
    ds_read_b64_tr_b16 a[110:111], v117 offset:4608
    v_mfma_f32_16x16x32_bf16 v[72:75], a[52:55], a[84:87], v[72:75]
    s_waitcnt vmcnt(15)
    s_barrier
    s_lshl_b32 s77, s3, 1
    v_mfma_f32_16x16x32_bf16 v[76:79], a[56:59], a[80:83], v[76:79]
    ds_read_b128 a[0:3], v110 offset:0
    buffer_load_dwordx4 v[204:207], v135, s[40:43], s69 offen offset:3072 sc1
    v_mfma_f32_16x16x32_bf16 v[76:79], a[60:63], a[84:87], v[76:79]
    s_waitcnt lgkmcnt(9)
    s_add_u32 m0, s53, 0
    ds_read_b128 a[4:7], v111 offset:0
    v_mfma_f32_16x16x32_bf16 v[80:83], a[32:35], a[88:91], v[80:83]
    s_add_u32 s76, s76, s77
    buffer_load_dwordx4 v96, s[28:31], s57 offen offset:0  lds
    v_mfma_f32_16x16x32_bf16 v[80:83], a[36:39], a[92:95], v[80:83]
    ds_read_b64_tr_b16 a[64:65], v118 offset:8192
    v_mfma_f32_16x16x32_bf16 v[84:87], a[40:43], a[88:91], v[84:87]
    ds_read_b64_tr_b16 a[66:67], v118 offset:8704
    v_mfma_f32_16x16x32_bf16 v[84:87], a[44:47], a[92:95], v[84:87]
    buffer_load_dwordx4 v97, s[28:31], s57 offen offset:1024  lds
    v_mfma_f32_16x16x32_bf16 v[88:91], a[48:51], a[88:91], v[88:91]
    s_lshl_b32 s64, s76, 15
    ds_read_b64_tr_b16 a[68:69], v118 offset:12288
    v_mfma_f32_16x16x32_bf16 v[88:91], a[52:55], a[92:95], v[88:91]
    ds_read_b64_tr_b16 a[70:71], v118 offset:12800
    v_mfma_f32_16x16x32_bf16 v[92:95], a[56:59], a[88:91], v[92:95]
    s_lshl_b32 s77, s93, 7
    v_mfma_f32_16x16x32_bf16 v[92:95], a[60:63], a[92:95], v[92:95]
    s_waitcnt lgkmcnt(10)
    ds_read_b128 a[8:11], v110 offset:2048
    buffer_load_dwordx4 v[208:211], v135, s[40:43], s72 offen offset:0 sc1
    v_mfma_f32_16x16x32_bf16 v[0:3], a[96:99], a[32:35], v[0:3]
    ds_read_b128 a[12:15], v111 offset:2048
    v_mfma_f32_16x16x32_bf16 v[0:3], a[100:103], a[36:39], v[0:3]
    s_add_u32 s77, s77, s64
    buffer_load_dwordx4 v98, s[28:31], s57 offen offset:2048  lds
    v_mfma_f32_16x16x32_bf16 v[4:7], a[96:99], a[40:43], v[4:7]
    ds_read_b128 a[16:19], v110 offset:4096
    v_mfma_f32_16x16x32_bf16 v[4:7], a[100:103], a[44:47], v[4:7]
    ds_read_b128 a[20:23], v111 offset:4096
    v_mfma_f32_16x16x32_bf16 v[8:11], a[96:99], a[48:51], v[8:11]
    buffer_load_dwordx4 v99, s[28:31], s57 offen offset:3072  lds
    v_mfma_f32_16x16x32_bf16 v[8:11], a[100:103], a[52:55], v[8:11]
    s_add_u32 s78, s77, 32768
    ds_read_b128 a[24:27], v110 offset:6144
    v_mfma_f32_16x16x32_bf16 v[12:15], a[96:99], a[56:59], v[12:15]
    ds_read_b128 a[28:31], v111 offset:6144
    v_mfma_f32_16x16x32_bf16 v[12:15], a[100:103], a[60:63], v[12:15]
    s_waitcnt lgkmcnt(12)
    s_lshl_b32 s52, s67, 18
    v_mfma_f32_16x16x32_bf16 v[16:19], a[104:107], a[32:35], v[16:19]
    ds_read_b64_tr_b16 a[72:73], v119 offset:8192
    buffer_load_dwordx4 v[212:215], v135, s[40:43], s72 offen offset:1024 sc1
    v_mfma_f32_16x16x32_bf16 v[16:19], a[108:111], a[36:39], v[16:19]
    s_add_u32 m0, s54, 0
    ds_read_b64_tr_b16 a[74:75], v119 offset:8704
    v_mfma_f32_16x16x32_bf16 v[20:23], a[104:107], a[40:43], v[20:23]
    s_lshl_b32 s75, s48, 13
    buffer_load_dwordx4 v100, s[24:27], s56 offen offset:0  lds
    v_mfma_f32_16x16x32_bf16 v[20:23], a[108:111], a[44:47], v[20:23]
    ds_read_b64_tr_b16 a[76:77], v119 offset:12288
    v_mfma_f32_16x16x32_bf16 v[24:27], a[104:107], a[48:51], v[24:27]
    ds_read_b64_tr_b16 a[78:79], v119 offset:12800
    v_mfma_f32_16x16x32_bf16 v[24:27], a[108:111], a[52:55], v[24:27]
    buffer_load_dwordx4 v101, s[24:27], s56 offen offset:1024  lds
    v_mfma_f32_16x16x32_bf16 v[28:31], a[104:107], a[56:59], v[28:31]
    s_add_u32 s52, s52, s75
    ds_read_b64_tr_b16 a[80:81], v118 offset:16384
    v_mfma_f32_16x16x32_bf16 v[28:31], a[108:111], a[60:63], v[28:31]
    s_waitcnt lgkmcnt(9)
    ds_read_b64_tr_b16 a[82:83], v118 offset:16896
    v_mfma_f32_16x16x32_bf16 v[32:35], a[64:67], a[0:3], v[32:35]
    v_mfma_f32_16x16x32_bf16 v[32:35], a[68:71], a[4:7], v[32:35]
    ds_read_b64_tr_b16 a[84:85], v118 offset:20480
    v_mfma_f32_16x16x32_bf16 v[36:39], a[64:67], a[8:11], v[36:39]
    s_add_u32 m0, s54, 8192
    ds_read_b64_tr_b16 a[86:87], v118 offset:20992
    v_mfma_f32_16x16x32_bf16 v[36:39], a[68:71], a[12:15], v[36:39]
    s_waitcnt lgkmcnt(8)
    buffer_load_dwordx4 v102, s[24:27], s56 offen offset:0  lds
    v_mfma_f32_16x16x32_bf16 v[40:43], a[64:67], a[16:19], v[40:43]
    ds_read_b64_tr_b16 a[88:89], v119 offset:16384
    v_mfma_f32_16x16x32_bf16 v[40:43], a[68:71], a[20:23], v[40:43]
    ds_read_b64_tr_b16 a[90:91], v119 offset:16896
    v_mfma_f32_16x16x32_bf16 v[44:47], a[64:67], a[24:27], v[44:47]
    buffer_load_dwordx4 v103, s[24:27], s56 offen offset:1024  lds
    v_mfma_f32_16x16x32_bf16 v[44:47], a[68:71], a[28:31], v[44:47]
    s_waitcnt lgkmcnt(6)
    ds_read_b64_tr_b16 a[92:93], v119 offset:20480
    v_mfma_f32_16x16x32_bf16 v[48:51], a[72:75], a[0:3], v[48:51]
    ds_read_b64_tr_b16 a[94:95], v119 offset:20992
    v_mfma_f32_16x16x32_bf16 v[48:51], a[76:79], a[4:7], v[48:51]
    v_mfma_f32_16x16x32_bf16 v[52:55], a[72:75], a[8:11], v[52:55]
    ds_read_b64_tr_b16 a[96:97], v118 offset:0
    v_mfma_f32_16x16x32_bf16 v[52:55], a[76:79], a[12:15], v[52:55]
    s_add_u32 m0, s54, 16384
    ds_read_b64_tr_b16 a[98:99], v118 offset:512
    v_mfma_f32_16x16x32_bf16 v[56:59], a[72:75], a[16:19], v[56:59]
    buffer_load_dwordx4 v104, s[24:27], s56 offen offset:0  lds
    v_mfma_f32_16x16x32_bf16 v[56:59], a[76:79], a[20:23], v[56:59]
    ds_read_b64_tr_b16 a[100:101], v118 offset:4096
    v_mfma_f32_16x16x32_bf16 v[60:63], a[72:75], a[24:27], v[60:63]
    ds_read_b64_tr_b16 a[102:103], v118 offset:4608
    v_mfma_f32_16x16x32_bf16 v[60:63], a[76:79], a[28:31], v[60:63]
    s_waitcnt lgkmcnt(8)
    buffer_load_dwordx4 v105, s[24:27], s56 offen offset:1024  lds
    v_mfma_f32_16x16x32_bf16 v[64:67], a[0:3], a[80:83], v[64:67]
    ds_read_b64_tr_b16 a[104:105], v119 offset:0
    v_mfma_f32_16x16x32_bf16 v[64:67], a[4:7], a[84:87], v[64:67]
    s_add_u32 s63, s63, 1
    ds_read_b64_tr_b16 a[106:107], v119 offset:512
    v_mfma_f32_16x16x32_bf16 v[68:71], a[8:11], a[80:83], v[68:71]
    s_and_b32 s63, s63, 15
    v_mfma_f32_16x16x32_bf16 v[68:71], a[12:15], a[84:87], v[68:71]
    s_mul_i32 s56, s63, 393216
    ds_read_b64_tr_b16 a[108:109], v119 offset:4096
    v_mfma_f32_16x16x32_bf16 v[72:75], a[16:19], a[80:83], v[72:75]
    s_lshl_b32 s57, s63, 7
    ds_read_b64_tr_b16 a[110:111], v119 offset:4608
    v_mfma_f32_16x16x32_bf16 v[72:75], a[20:23], a[84:87], v[72:75]
    s_waitcnt vmcnt(13)
    s_barrier
    v_mfma_f32_16x16x32_bf16 v[76:79], a[24:27], a[80:83], v[76:79]
    ds_read_b128 a[32:35], v112 offset:0
    v_mfma_f32_16x16x32_bf16 v[76:79], a[28:31], a[84:87], v[76:79]
    s_waitcnt lgkmcnt(9)
    s_add_u32 m0, s53, 40960
    ds_read_b128 a[36:39], v113 offset:0
    v_mfma_f32_16x16x32_bf16 v[80:83], a[0:3], a[88:91], v[80:83]
    buffer_load_dwordx4 v96, s[28:31], s57 offen offset:0  lds
    v_mfma_f32_16x16x32_bf16 v[80:83], a[4:7], a[92:95], v[80:83]
    ds_read_b64_tr_b16 a[64:65], v120 offset:8192
    v_mfma_f32_16x16x32_bf16 v[84:87], a[8:11], a[88:91], v[84:87]
    ds_read_b64_tr_b16 a[66:67], v120 offset:8704
    v_mfma_f32_16x16x32_bf16 v[84:87], a[12:15], a[92:95], v[84:87]
    buffer_load_dwordx4 v97, s[28:31], s57 offen offset:1024  lds
    v_mfma_f32_16x16x32_bf16 v[88:91], a[16:19], a[88:91], v[88:91]
    ds_read_b64_tr_b16 a[68:69], v120 offset:12288
    v_mfma_f32_16x16x32_bf16 v[88:91], a[20:23], a[92:95], v[88:91]
    ds_read_b64_tr_b16 a[70:71], v120 offset:12800
    v_mfma_f32_16x16x32_bf16 v[92:95], a[24:27], a[88:91], v[92:95]
    v_mfma_f32_16x16x32_bf16 v[92:95], a[28:31], a[92:95], v[92:95]
    s_waitcnt lgkmcnt(10)
    ds_read_b128 a[40:43], v112 offset:2048
    v_mfma_f32_16x16x32_bf16 v[0:3], a[96:99], a[0:3], v[0:3]
    ds_read_b128 a[44:47], v113 offset:2048
    v_mfma_f32_16x16x32_bf16 v[0:3], a[100:103], a[4:7], v[0:3]
    buffer_load_dwordx4 v98, s[28:31], s57 offen offset:2048  lds
    v_mfma_f32_16x16x32_bf16 v[4:7], a[96:99], a[8:11], v[4:7]
    ds_read_b128 a[48:51], v112 offset:4096
    v_mfma_f32_16x16x32_bf16 v[4:7], a[100:103], a[12:15], v[4:7]
    ds_read_b128 a[52:55], v113 offset:4096
    v_mfma_f32_16x16x32_bf16 v[8:11], a[96:99], a[16:19], v[8:11]
    buffer_load_dwordx4 v99, s[28:31], s57 offen offset:3072  lds
    v_mfma_f32_16x16x32_bf16 v[8:11], a[100:103], a[20:23], v[8:11]
    ds_read_b128 a[56:59], v112 offset:6144
    v_mfma_f32_16x16x32_bf16 v[12:15], a[96:99], a[24:27], v[12:15]
    ds_read_b128 a[60:63], v113 offset:6144
    v_mfma_f32_16x16x32_bf16 v[12:15], a[100:103], a[28:31], v[12:15]
    s_waitcnt lgkmcnt(12)
    v_mfma_f32_16x16x32_bf16 v[16:19], a[104:107], a[0:3], v[16:19]
    s_waitcnt vmcnt(10)
    ds_read_b64_tr_b16 a[72:73], v121 offset:8192
    v_mfma_f32_16x16x32_bf16 v[16:19], a[108:111], a[4:7], v[16:19]
    s_add_u32 m0, s54, 40960
    ds_read_b64_tr_b16 a[74:75], v121 offset:8704
    v_mov_b32 v216, v136
    v_mfma_f32_16x16x32_bf16 v[20:23], a[104:107], a[8:11], v[20:23]
    buffer_load_dwordx4 v100, s[24:27], s56 offen offset:0  lds
    v_mov_b32 v218, v136
    v_mfma_f32_16x16x32_bf16 v[20:23], a[108:111], a[12:15], v[20:23]
    ds_read_b64_tr_b16 a[76:77], v121 offset:12288
    v_mov_b32 v220, v137
    v_mfma_f32_16x16x32_bf16 v[24:27], a[104:107], a[16:19], v[24:27]
    ds_read_b64_tr_b16 a[78:79], v121 offset:12800
    v_mov_b32 v222, v137
    v_mfma_f32_16x16x32_bf16 v[24:27], a[108:111], a[20:23], v[24:27]
    buffer_load_dwordx4 v101, s[24:27], s56 offen offset:1024  lds
    v_mfma_f32_16x16x32_bf16 v[28:31], a[104:107], a[24:27], v[28:31]
    s_nop 0
    ds_read_b64_tr_b16 a[80:81], v120 offset:16384
    v_mfma_f32_16x16x32_bf16 v[28:31], a[108:111], a[28:31], v[28:31]
    s_waitcnt lgkmcnt(9)
    ds_read_b64_tr_b16 a[82:83], v120 offset:16896
    v_permlane32_swap_b32 v216, v218
    v_mfma_f32_16x16x32_bf16 v[32:35], a[64:67], a[32:35], v[32:35]
    v_permlane32_swap_b32 v220, v222
    v_mov_b32 v217, v216
    v_mfma_f32_16x16x32_bf16 v[32:35], a[68:71], a[36:39], v[32:35]
    ds_read_b64_tr_b16 a[84:85], v120 offset:20480
    v_mov_b32 v219, v218
    v_mfma_f32_16x16x32_bf16 v[36:39], a[64:67], a[40:43], v[36:39]
    s_add_u32 m0, s54, 49152
    ds_read_b64_tr_b16 a[86:87], v120 offset:20992
    v_mov_b32 v221, v220
    v_mfma_f32_16x16x32_bf16 v[36:39], a[68:71], a[44:47], v[36:39]
    s_waitcnt lgkmcnt(8)
    buffer_load_dwordx4 v102, s[24:27], s56 offen offset:0  lds
    v_mov_b32 v223, v222
    v_mfma_f32_16x16x32_bf16 v[40:43], a[64:67], a[48:51], v[40:43]
    ds_read_b64_tr_b16 a[88:89], v121 offset:16384
    v_permlane16_swap_b32 v216, v217
    v_mfma_f32_16x16x32_bf16 v[40:43], a[68:71], a[52:55], v[40:43]
    ds_read_b64_tr_b16 a[90:91], v121 offset:16896
    v_permlane16_swap_b32 v218, v219
    v_mfma_f32_16x16x32_bf16 v[44:47], a[64:67], a[56:59], v[44:47]
    buffer_load_dwordx4 v103, s[24:27], s56 offen offset:1024  lds
    v_mfma_f32_16x16x32_bf16 v[44:47], a[68:71], a[60:63], v[44:47]
    s_waitcnt lgkmcnt(6)
    ds_read_b64_tr_b16 a[92:93], v121 offset:20480
    v_permlane16_swap_b32 v220, v221
    v_mfma_f32_16x16x32_bf16 v[48:51], a[72:75], a[32:35], v[48:51]
    ds_read_b64_tr_b16 a[94:95], v121 offset:20992
    v_permlane16_swap_b32 v222, v223
    v_mfma_f32_16x16x32_bf16 v[48:51], a[76:79], a[36:39], v[48:51]
    v_add_f32 v208, v208, v210
    v_add_f32 v212, v212, v214
    v_mfma_f32_16x16x32_bf16 v[52:55], a[72:75], a[40:43], v[52:55]
    ds_read_b64_tr_b16 a[96:97], v120 offset:0
    v_add_f32 v208, v208, v212
    v_mfma_f32_16x16x32_bf16 v[52:55], a[76:79], a[44:47], v[52:55]
    s_add_u32 m0, s54, 57344
    ds_read_b64_tr_b16 a[98:99], v120 offset:512
    v_add_f32 v209, v209, v211
    v_mfma_f32_16x16x32_bf16 v[56:59], a[72:75], a[48:51], v[56:59]
    buffer_load_dwordx4 v104, s[24:27], s56 offen offset:0  lds
    v_add_f32 v213, v213, v215
    v_mfma_f32_16x16x32_bf16 v[56:59], a[76:79], a[52:55], v[56:59]
    ds_read_b64_tr_b16 a[100:101], v120 offset:4096
    v_add_f32 v209, v209, v213
    v_mfma_f32_16x16x32_bf16 v[60:63], a[72:75], a[56:59], v[60:63]
    ds_read_b64_tr_b16 a[102:103], v120 offset:4608
    v_mov_b32 v210, v208
    v_mfma_f32_16x16x32_bf16 v[60:63], a[76:79], a[60:63], v[60:63]
    s_waitcnt lgkmcnt(8)
    buffer_load_dwordx4 v105, s[24:27], s56 offen offset:1024  lds
    v_mfma_f32_16x16x32_bf16 v[64:67], a[32:35], a[80:83], v[64:67]
    ds_read_b64_tr_b16 a[104:105], v121 offset:0
    v_mov_b32 v211, v209
    v_mfma_f32_16x16x32_bf16 v[64:67], a[36:39], a[84:87], v[64:67]
    s_add_u32 s63, s63, 1
    ds_read_b64_tr_b16 a[106:107], v121 offset:512
    v_mfma_f32_16x16x32_bf16 v[68:71], a[40:43], a[80:83], v[68:71]
    s_and_b32 s63, s63, 15
    s_nop 1
    v_mfma_f32_16x16x32_bf16 v[68:71], a[44:47], a[84:87], v[68:71]
    s_mul_i32 s56, s63, 393216
    ds_read_b64_tr_b16 a[108:109], v121 offset:4096
    v_permlane16_swap_b32 v208, v210
    v_mfma_f32_16x16x32_bf16 v[72:75], a[48:51], a[80:83], v[72:75]
    s_lshl_b32 s57, s63, 7
    ds_read_b64_tr_b16 a[110:111], v121 offset:4608
    v_permlane16_swap_b32 v209, v211
    v_mfma_f32_16x16x32_bf16 v[72:75], a[52:55], a[84:87], v[72:75]
    s_waitcnt vmcnt(10)
    s_barrier
    v_add_f32 v208, v208, v210
    v_mfma_f32_16x16x32_bf16 v[76:79], a[56:59], a[80:83], v[76:79]
    ds_read_b128 a[0:3], v106 offset:0
    v_add_f32 v209, v209, v211
    v_mfma_f32_16x16x32_bf16 v[76:79], a[60:63], a[84:87], v[76:79]
    s_waitcnt lgkmcnt(9)
    s_add_u32 m0, s53, 81920
    ds_read_b128 a[4:7], v107 offset:0
    v_mov_b32 v210, v208
    v_mfma_f32_16x16x32_bf16 v[80:83], a[32:35], a[88:91], v[80:83]
    buffer_load_dwordx4 v96, s[28:31], s57 offen offset:0  lds
    v_mov_b32 v211, v209
    v_mfma_f32_16x16x32_bf16 v[80:83], a[36:39], a[92:95], v[80:83]
    s_nop 1
    ds_read_b64_tr_b16 a[64:65], v114 offset:8192
    v_mfma_f32_16x16x32_bf16 v[84:87], a[40:43], a[88:91], v[84:87]
    ds_read_b64_tr_b16 a[66:67], v114 offset:8704
    v_mfma_f32_16x16x32_bf16 v[84:87], a[44:47], a[92:95], v[84:87]
    buffer_load_dwordx4 v97, s[28:31], s57 offen offset:1024  lds
    v_permlane32_swap_b32 v208, v210
    v_mfma_f32_16x16x32_bf16 v[88:91], a[48:51], a[88:91], v[88:91]
    ds_read_b64_tr_b16 a[68:69], v114 offset:12288
    v_permlane32_swap_b32 v209, v211
    v_mfma_f32_16x16x32_bf16 v[88:91], a[52:55], a[92:95], v[88:91]
    ds_read_b64_tr_b16 a[70:71], v114 offset:12800
    v_add_f32 v208, v208, v210
    v_mfma_f32_16x16x32_bf16 v[92:95], a[56:59], a[88:91], v[92:95]
    v_add_f32 v209, v209, v211
    v_add_f32_dpp v192, v192, v192 row_ror:8 row_mask:0xf bank_mask:0xf
    v_mfma_f32_16x16x32_bf16 v[92:95], a[60:63], a[92:95], v[92:95]
    s_waitcnt lgkmcnt(10)
    ds_read_b128 a[8:11], v106 offset:2048
    v_add_f32_dpp v193, v193, v193 row_ror:8 row_mask:0xf bank_mask:0xf
    v_mfma_f32_16x16x32_bf16 v[0:3], a[96:99], a[32:35], v[0:3]
    ds_read_b128 a[12:15], v107 offset:2048
    v_add_f32_dpp v194, v194, v194 row_ror:8 row_mask:0xf bank_mask:0xf
    v_mfma_f32_16x16x32_bf16 v[0:3], a[100:103], a[36:39], v[0:3]
    buffer_load_dwordx4 v98, s[28:31], s57 offen offset:2048  lds
    v_add_f32_dpp v195, v195, v195 row_ror:8 row_mask:0xf bank_mask:0xf
    v_mfma_f32_16x16x32_bf16 v[4:7], a[96:99], a[40:43], v[4:7]
    ds_read_b128 a[16:19], v106 offset:4096
    v_mfma_f32_16x16x32_bf16 v[4:7], a[100:103], a[44:47], v[4:7]
    ds_read_b128 a[20:23], v107 offset:4096
    v_add_f32_dpp v196, v196, v196 row_ror:8 row_mask:0xf bank_mask:0xf
    v_mfma_f32_16x16x32_bf16 v[8:11], a[96:99], a[48:51], v[8:11]
    buffer_load_dwordx4 v99, s[28:31], s57 offen offset:3072  lds
    v_add_f32_dpp v197, v197, v197 row_ror:8 row_mask:0xf bank_mask:0xf
    v_mfma_f32_16x16x32_bf16 v[8:11], a[100:103], a[52:55], v[8:11]
    ds_read_b128 a[24:27], v106 offset:6144
    v_add_f32_dpp v198, v198, v198 row_ror:8 row_mask:0xf bank_mask:0xf
    v_mfma_f32_16x16x32_bf16 v[12:15], a[96:99], a[56:59], v[12:15]
    ds_read_b128 a[28:31], v107 offset:6144
    v_add_f32_dpp v199, v199, v199 row_ror:8 row_mask:0xf bank_mask:0xf
    v_mfma_f32_16x16x32_bf16 v[12:15], a[100:103], a[60:63], v[12:15]
    s_waitcnt lgkmcnt(12)
    v_add_f32_dpp v200, v200, v200 row_ror:8 row_mask:0xf bank_mask:0xf
    v_add_f32_dpp v201, v201, v201 row_ror:8 row_mask:0xf bank_mask:0xf
    v_mfma_f32_16x16x32_bf16 v[16:19], a[104:107], a[32:35], v[16:19]
    ds_read_b64_tr_b16 a[72:73], v115 offset:8192
    v_add_f32_dpp v202, v202, v202 row_ror:8 row_mask:0xf bank_mask:0xf
    v_mfma_f32_16x16x32_bf16 v[16:19], a[108:111], a[36:39], v[16:19]
    s_add_u32 m0, s54, 81920
    ds_read_b64_tr_b16 a[74:75], v115 offset:8704
    v_add_f32_dpp v203, v203, v203 row_ror:8 row_mask:0xf bank_mask:0xf
    v_mfma_f32_16x16x32_bf16 v[20:23], a[104:107], a[40:43], v[20:23]
    buffer_load_dwordx4 v100, s[24:27], s56 offen offset:0  lds
    v_add_f32_dpp v204, v204, v204 row_ror:8 row_mask:0xf bank_mask:0xf
    v_mfma_f32_16x16x32_bf16 v[20:23], a[108:111], a[44:47], v[20:23]
    ds_read_b64_tr_b16 a[76:77], v115 offset:12288
    v_mfma_f32_16x16x32_bf16 v[24:27], a[104:107], a[48:51], v[24:27]
    ds_read_b64_tr_b16 a[78:79], v115 offset:12800
    v_add_f32_dpp v205, v205, v205 row_ror:8 row_mask:0xf bank_mask:0xf
    v_mfma_f32_16x16x32_bf16 v[24:27], a[108:111], a[52:55], v[24:27]
    buffer_load_dwordx4 v101, s[24:27], s56 offen offset:1024  lds
    v_add_f32_dpp v206, v206, v206 row_ror:8 row_mask:0xf bank_mask:0xf
    v_mfma_f32_16x16x32_bf16 v[28:31], a[104:107], a[56:59], v[28:31]
    ds_read_b64_tr_b16 a[80:81], v114 offset:16384
    v_add_f32_dpp v207, v207, v207 row_ror:8 row_mask:0xf bank_mask:0xf
    v_mfma_f32_16x16x32_bf16 v[28:31], a[108:111], a[60:63], v[28:31]
    s_waitcnt lgkmcnt(9)
    ds_read_b64_tr_b16 a[82:83], v114 offset:16896
    v_add_f32_dpp v192, v192, v192 row_ror:4 row_mask:0xf bank_mask:0xf
    v_mfma_f32_16x16x32_bf16 v[32:35], a[64:67], a[0:3], v[32:35]
    v_add_f32_dpp v193, v193, v193 row_ror:4 row_mask:0xf bank_mask:0xf
    v_add_f32_dpp v194, v194, v194 row_ror:4 row_mask:0xf bank_mask:0xf
    v_mfma_f32_16x16x32_bf16 v[32:35], a[68:71], a[4:7], v[32:35]
    ds_read_b64_tr_b16 a[84:85], v114 offset:20480
    v_add_f32_dpp v195, v195, v195 row_ror:4 row_mask:0xf bank_mask:0xf
    v_mfma_f32_16x16x32_bf16 v[36:39], a[64:67], a[8:11], v[36:39]
    s_add_u32 m0, s54, 90112
    ds_read_b64_tr_b16 a[86:87], v114 offset:20992
    v_add_f32_dpp v196, v196, v196 row_ror:4 row_mask:0xf bank_mask:0xf
    v_mfma_f32_16x16x32_bf16 v[36:39], a[68:71], a[12:15], v[36:39]
    s_waitcnt lgkmcnt(8)
    buffer_load_dwordx4 v102, s[24:27], s56 offen offset:0  lds
    v_add_f32_dpp v197, v197, v197 row_ror:4 row_mask:0xf bank_mask:0xf
    v_mfma_f32_16x16x32_bf16 v[40:43], a[64:67], a[16:19], v[40:43]
    ds_read_b64_tr_b16 a[88:89], v115 offset:16384
    v_mfma_f32_16x16x32_bf16 v[40:43], a[68:71], a[20:23], v[40:43]
    ds_read_b64_tr_b16 a[90:91], v115 offset:16896
    v_add_f32_dpp v198, v198, v198 row_ror:4 row_mask:0xf bank_mask:0xf
    v_mfma_f32_16x16x32_bf16 v[44:47], a[64:67], a[24:27], v[44:47]
    buffer_load_dwordx4 v103, s[24:27], s56 offen offset:1024  lds
    v_add_f32_dpp v199, v199, v199 row_ror:4 row_mask:0xf bank_mask:0xf
    v_mfma_f32_16x16x32_bf16 v[44:47], a[68:71], a[28:31], v[44:47]
    s_waitcnt lgkmcnt(6)
    ds_read_b64_tr_b16 a[92:93], v115 offset:20480
    v_add_f32_dpp v200, v200, v200 row_ror:4 row_mask:0xf bank_mask:0xf
    v_mfma_f32_16x16x32_bf16 v[48:51], a[72:75], a[0:3], v[48:51]
    ds_read_b64_tr_b16 a[94:95], v115 offset:20992
    v_add_f32_dpp v201, v201, v201 row_ror:4 row_mask:0xf bank_mask:0xf
    v_mfma_f32_16x16x32_bf16 v[48:51], a[76:79], a[4:7], v[48:51]
    v_add_f32_dpp v202, v202, v202 row_ror:4 row_mask:0xf bank_mask:0xf
    v_add_f32_dpp v203, v203, v203 row_ror:4 row_mask:0xf bank_mask:0xf
    v_mfma_f32_16x16x32_bf16 v[52:55], a[72:75], a[8:11], v[52:55]
    ds_read_b64_tr_b16 a[96:97], v114 offset:0
    v_add_f32_dpp v204, v204, v204 row_ror:4 row_mask:0xf bank_mask:0xf
    v_mfma_f32_16x16x32_bf16 v[52:55], a[76:79], a[12:15], v[52:55]
    s_add_u32 m0, s54, 98304
    ds_read_b64_tr_b16 a[98:99], v114 offset:512
    v_add_f32_dpp v205, v205, v205 row_ror:4 row_mask:0xf bank_mask:0xf
    v_mfma_f32_16x16x32_bf16 v[56:59], a[72:75], a[16:19], v[56:59]
    buffer_load_dwordx4 v104, s[24:27], s56 offen offset:0  lds
    v_add_f32_dpp v206, v206, v206 row_ror:4 row_mask:0xf bank_mask:0xf
    v_mfma_f32_16x16x32_bf16 v[56:59], a[76:79], a[20:23], v[56:59]
    ds_read_b64_tr_b16 a[100:101], v114 offset:4096
    v_add_f32_dpp v207, v207, v207 row_ror:4 row_mask:0xf bank_mask:0xf
    v_mfma_f32_16x16x32_bf16 v[60:63], a[72:75], a[24:27], v[60:63]
    ds_read_b64_tr_b16 a[102:103], v114 offset:4608
    v_mfma_f32_16x16x32_bf16 v[60:63], a[76:79], a[28:31], v[60:63]
    s_waitcnt lgkmcnt(8)
    buffer_load_dwordx4 v105, s[24:27], s56 offen offset:1024  lds
    v_add_f32_dpp v192, v192, v192 row_ror:2 row_mask:0xf bank_mask:0xf
    v_mfma_f32_16x16x32_bf16 v[64:67], a[0:3], a[80:83], v[64:67]
    ds_read_b64_tr_b16 a[104:105], v115 offset:0
    v_add_f32_dpp v193, v193, v193 row_ror:2 row_mask:0xf bank_mask:0xf
    v_mfma_f32_16x16x32_bf16 v[64:67], a[4:7], a[84:87], v[64:67]
    s_add_u32 s63, s63, 1
    ds_read_b64_tr_b16 a[106:107], v115 offset:512
    v_add_f32_dpp v194, v194, v194 row_ror:2 row_mask:0xf bank_mask:0xf
    v_mfma_f32_16x16x32_bf16 v[68:71], a[8:11], a[80:83], v[68:71]
    s_and_b32 s63, s63, 15
    v_add_f32_dpp v195, v195, v195 row_ror:2 row_mask:0xf bank_mask:0xf
    v_add_f32_dpp v196, v196, v196 row_ror:2 row_mask:0xf bank_mask:0xf
    v_mfma_f32_16x16x32_bf16 v[68:71], a[12:15], a[84:87], v[68:71]
    s_mul_i32 s56, s63, 393216
    ds_read_b64_tr_b16 a[108:109], v115 offset:4096
    v_add_f32_dpp v197, v197, v197 row_ror:2 row_mask:0xf bank_mask:0xf
    v_mfma_f32_16x16x32_bf16 v[72:75], a[16:19], a[80:83], v[72:75]
    s_lshl_b32 s57, s63, 7
    ds_read_b64_tr_b16 a[110:111], v115 offset:4608
    v_add_f32_dpp v198, v198, v198 row_ror:2 row_mask:0xf bank_mask:0xf
    v_mfma_f32_16x16x32_bf16 v[72:75], a[20:23], a[84:87], v[72:75]
    s_waitcnt vmcnt(10)
    s_barrier
    v_add_f32_dpp v199, v199, v199 row_ror:2 row_mask:0xf bank_mask:0xf
    v_mfma_f32_16x16x32_bf16 v[76:79], a[24:27], a[80:83], v[76:79]
L_stub_2:
    s_cbranch_execz L_warm_start_ret
    ds_read_b128 a[32:35], v108 offset:0
    v_add_f32_dpp v200, v200, v200 row_ror:2 row_mask:0xf bank_mask:0xf
    v_mfma_f32_16x16x32_bf16 v[76:79], a[28:31], a[84:87], v[76:79]
    s_waitcnt lgkmcnt(9)
    s_add_u32 m0, s53, 122880
    ds_read_b128 a[36:39], v109 offset:0
    v_mfma_f32_16x16x32_bf16 v[80:83], a[0:3], a[88:91], v[80:83]
    buffer_load_dwordx4 v96, s[28:31], s57 offen offset:0  lds
    v_add_f32_dpp v201, v201, v201 row_ror:2 row_mask:0xf bank_mask:0xf
    v_mfma_f32_16x16x32_bf16 v[80:83], a[4:7], a[92:95], v[80:83]
    ds_read_b64_tr_b16 a[64:65], v116 offset:8192
    v_add_f32_dpp v202, v202, v202 row_ror:2 row_mask:0xf bank_mask:0xf
    v_mfma_f32_16x16x32_bf16 v[84:87], a[8:11], a[88:91], v[84:87]
    ds_read_b64_tr_b16 a[66:67], v116 offset:8704
    v_add_f32_dpp v203, v203, v203 row_ror:2 row_mask:0xf bank_mask:0xf
    v_mfma_f32_16x16x32_bf16 v[84:87], a[12:15], a[92:95], v[84:87]
    buffer_load_dwordx4 v97, s[28:31], s57 offen offset:1024  lds
    v_add_f32_dpp v204, v204, v204 row_ror:2 row_mask:0xf bank_mask:0xf
    v_mfma_f32_16x16x32_bf16 v[88:91], a[16:19], a[88:91], v[88:91]
    ds_read_b64_tr_b16 a[68:69], v116 offset:12288
    v_add_f32_dpp v205, v205, v205 row_ror:2 row_mask:0xf bank_mask:0xf
    v_mfma_f32_16x16x32_bf16 v[88:91], a[20:23], a[92:95], v[88:91]
    ds_read_b64_tr_b16 a[70:71], v116 offset:12800
    v_add_f32_dpp v206, v206, v206 row_ror:2 row_mask:0xf bank_mask:0xf
    v_mfma_f32_16x16x32_bf16 v[92:95], a[24:27], a[88:91], v[92:95]
    v_add_f32_dpp v207, v207, v207 row_ror:2 row_mask:0xf bank_mask:0xf
    v_add_f32_dpp v192, v192, v192 row_ror:1 row_mask:0xf bank_mask:0xf
    v_mfma_f32_16x16x32_bf16 v[92:95], a[28:31], a[92:95], v[92:95]
    s_waitcnt lgkmcnt(10)
    ds_read_b128 a[40:43], v108 offset:2048
    v_add_f32_dpp v193, v193, v193 row_ror:1 row_mask:0xf bank_mask:0xf
    v_mfma_f32_16x16x32_bf16 v[0:3], a[96:99], a[0:3], v[0:3]
    ds_read_b128 a[44:47], v109 offset:2048
    v_mfma_f32_16x16x32_bf16 v[0:3], a[100:103], a[4:7], v[0:3]
    buffer_load_dwordx4 v98, s[28:31], s57 offen offset:2048  lds
    v_add_f32_dpp v194, v194, v194 row_ror:1 row_mask:0xf bank_mask:0xf
    v_mfma_f32_16x16x32_bf16 v[4:7], a[96:99], a[8:11], v[4:7]
    ds_read_b128 a[48:51], v108 offset:4096
    v_add_f32_dpp v195, v195, v195 row_ror:1 row_mask:0xf bank_mask:0xf
    v_mfma_f32_16x16x32_bf16 v[4:7], a[100:103], a[12:15], v[4:7]
    ds_read_b128 a[52:55], v109 offset:4096
    v_add_f32_dpp v196, v196, v196 row_ror:1 row_mask:0xf bank_mask:0xf
    v_mfma_f32_16x16x32_bf16 v[8:11], a[96:99], a[16:19], v[8:11]
    buffer_load_dwordx4 v99, s[28:31], s57 offen offset:3072  lds
    v_add_f32_dpp v197, v197, v197 row_ror:1 row_mask:0xf bank_mask:0xf
    v_mfma_f32_16x16x32_bf16 v[8:11], a[100:103], a[20:23], v[8:11]
    ds_read_b128 a[56:59], v108 offset:6144
    v_add_f32_dpp v198, v198, v198 row_ror:1 row_mask:0xf bank_mask:0xf
    v_mfma_f32_16x16x32_bf16 v[12:15], a[96:99], a[24:27], v[12:15]
    ds_read_b128 a[60:63], v109 offset:6144
    v_add_f32_dpp v199, v199, v199 row_ror:1 row_mask:0xf bank_mask:0xf
    v_mfma_f32_16x16x32_bf16 v[12:15], a[100:103], a[28:31], v[12:15]
    s_waitcnt lgkmcnt(12)
    v_add_f32_dpp v200, v200, v200 row_ror:1 row_mask:0xf bank_mask:0xf
    v_add_f32_dpp v201, v201, v201 row_ror:1 row_mask:0xf bank_mask:0xf
    v_mfma_f32_16x16x32_bf16 v[16:19], a[104:107], a[0:3], v[16:19]
    ds_read_b64_tr_b16 a[72:73], v117 offset:8192
    v_add_f32_dpp v202, v202, v202 row_ror:1 row_mask:0xf bank_mask:0xf
    v_mfma_f32_16x16x32_bf16 v[16:19], a[108:111], a[4:7], v[16:19]
    s_add_u32 m0, s54, 122880
    ds_read_b64_tr_b16 a[74:75], v117 offset:8704
    v_mfma_f32_16x16x32_bf16 v[20:23], a[104:107], a[8:11], v[20:23]
    buffer_load_dwordx4 v100, s[24:27], s56 offen offset:0  lds
    v_add_f32_dpp v203, v203, v203 row_ror:1 row_mask:0xf bank_mask:0xf
    v_mfma_f32_16x16x32_bf16 v[20:23], a[108:111], a[12:15], v[20:23]
    ds_read_b64_tr_b16 a[76:77], v117 offset:12288
    v_add_f32_dpp v204, v204, v204 row_ror:1 row_mask:0xf bank_mask:0xf
    v_mfma_f32_16x16x32_bf16 v[24:27], a[104:107], a[16:19], v[24:27]
    ds_read_b64_tr_b16 a[78:79], v117 offset:12800
    v_add_f32_dpp v205, v205, v205 row_ror:1 row_mask:0xf bank_mask:0xf
    v_mfma_f32_16x16x32_bf16 v[24:27], a[108:111], a[20:23], v[24:27]
    buffer_load_dwordx4 v101, s[24:27], s56 offen offset:1024  lds
    v_add_f32_dpp v206, v206, v206 row_ror:1 row_mask:0xf bank_mask:0xf
    v_mfma_f32_16x16x32_bf16 v[28:31], a[104:107], a[24:27], v[28:31]
    ds_read_b64_tr_b16 a[80:81], v116 offset:16384
    v_add_f32_dpp v207, v207, v207 row_ror:1 row_mask:0xf bank_mask:0xf
    v_mfma_f32_16x16x32_bf16 v[28:31], a[108:111], a[28:31], v[28:31]
    s_waitcnt lgkmcnt(9)
    ds_read_b64_tr_b16 a[82:83], v116 offset:16896
    v_mfma_f32_16x16x32_bf16 v[32:35], a[64:67], a[32:35], v[32:35]
    v_mfma_f32_16x16x32_bf16 v[32:35], a[68:71], a[36:39], v[32:35]
    ds_read_b64_tr_b16 a[84:85], v116 offset:20480
    v_fmac_f32_dpp v80, v224, v209 row_newbcast:0 row_mask:0xf bank_mask:0xf
    v_mfma_f32_16x16x32_bf16 v[36:39], a[64:67], a[40:43], v[36:39]
    s_add_u32 m0, s54, 131072
    ds_read_b64_tr_b16 a[86:87], v116 offset:20992
    v_fmac_f32_dpp v81, v224, v209 row_newbcast:1 row_mask:0xf bank_mask:0xf
    v_mfma_f32_16x16x32_bf16 v[36:39], a[68:71], a[44:47], v[36:39]
    s_waitcnt lgkmcnt(8)
    buffer_load_dwordx4 v102, s[24:27], s56 offen offset:0  lds
    v_fmac_f32_dpp v82, v224, v209 row_newbcast:2 row_mask:0xf bank_mask:0xf
    v_mfma_f32_16x16x32_bf16 v[40:43], a[64:67], a[48:51], v[40:43]
    ds_read_b64_tr_b16 a[88:89], v117 offset:16384
    v_fmac_f32_dpp v83, v224, v209 row_newbcast:3 row_mask:0xf bank_mask:0xf
    v_mfma_f32_16x16x32_bf16 v[40:43], a[68:71], a[52:55], v[40:43]
    ds_read_b64_tr_b16 a[90:91], v117 offset:16896
    v_fmac_f32_dpp v84, v224, v209 row_newbcast:4 row_mask:0xf bank_mask:0xf
    v_mfma_f32_16x16x32_bf16 v[44:47], a[64:67], a[56:59], v[44:47]
    buffer_load_dwordx4 v103, s[24:27], s56 offen offset:1024  lds
    v_fmac_f32_dpp v85, v224, v209 row_newbcast:5 row_mask:0xf bank_mask:0xf
    v_mfma_f32_16x16x32_bf16 v[44:47], a[68:71], a[60:63], v[44:47]
    s_waitcnt lgkmcnt(6)
    ds_read_b64_tr_b16 a[92:93], v117 offset:20480
    v_fmac_f32_dpp v86, v224, v209 row_newbcast:6 row_mask:0xf bank_mask:0xf
    v_mfma_f32_16x16x32_bf16 v[48:51], a[72:75], a[32:35], v[48:51]
    ds_read_b64_tr_b16 a[94:95], v117 offset:20992
    v_fmac_f32_dpp v87, v224, v209 row_newbcast:7 row_mask:0xf bank_mask:0xf
    v_mfma_f32_16x16x32_bf16 v[48:51], a[76:79], a[36:39], v[48:51]
    v_fmac_f32_dpp v88, v224, v209 row_newbcast:8 row_mask:0xf bank_mask:0xf
    v_fmac_f32_dpp v89, v224, v209 row_newbcast:9 row_mask:0xf bank_mask:0xf
    v_mfma_f32_16x16x32_bf16 v[52:55], a[72:75], a[40:43], v[52:55]
    ds_read_b64_tr_b16 a[96:97], v116 offset:0
    v_fmac_f32_dpp v90, v224, v209 row_newbcast:10 row_mask:0xf bank_mask:0xf
    v_mfma_f32_16x16x32_bf16 v[52:55], a[76:79], a[44:47], v[52:55]
    s_add_u32 m0, s54, 139264
    ds_read_b64_tr_b16 a[98:99], v116 offset:512
    v_fmac_f32_dpp v91, v224, v209 row_newbcast:11 row_mask:0xf bank_mask:0xf
    v_mfma_f32_16x16x32_bf16 v[56:59], a[72:75], a[48:51], v[56:59]
    buffer_load_dwordx4 v104, s[24:27], s56 offen offset:0  lds
    v_fmac_f32_dpp v92, v224, v209 row_newbcast:12 row_mask:0xf bank_mask:0xf
    v_mfma_f32_16x16x32_bf16 v[56:59], a[76:79], a[52:55], v[56:59]
    ds_read_b64_tr_b16 a[100:101], v116 offset:4096
    v_fmac_f32_dpp v93, v224, v209 row_newbcast:13 row_mask:0xf bank_mask:0xf
    v_mfma_f32_16x16x32_bf16 v[60:63], a[72:75], a[56:59], v[60:63]
    ds_read_b64_tr_b16 a[102:103], v116 offset:4608
    v_fmac_f32_dpp v94, v224, v209 row_newbcast:14 row_mask:0xf bank_mask:0xf
    v_mfma_f32_16x16x32_bf16 v[60:63], a[76:79], a[60:63], v[60:63]
    s_waitcnt lgkmcnt(8)
    buffer_load_dwordx4 v105, s[24:27], s56 offen offset:1024  lds
    v_fmac_f32_dpp v95, v224, v209 row_newbcast:15 row_mask:0xf bank_mask:0xf
    v_mfma_f32_16x16x32_bf16 v[64:67], a[32:35], a[80:83], v[64:67]
    ds_read_b64_tr_b16 a[104:105], v117 offset:0
    v_mfma_f32_16x16x32_bf16 v[64:67], a[36:39], a[84:87], v[64:67]
    ds_read_b64_tr_b16 a[106:107], v117 offset:512
    v_fmac_f32 v16, v196, v216
    v_mfma_f32_16x16x32_bf16 v[68:71], a[40:43], a[80:83], v[68:71]
    v_fmac_f32 v17, v197, v216
    v_fmac_f32 v18, v198, v216
    v_mfma_f32_16x16x32_bf16 v[68:71], a[44:47], a[84:87], v[68:71]
    ds_read_b64_tr_b16 a[108:109], v117 offset:4096
    v_fmac_f32 v19, v199, v216
    v_mfma_f32_16x16x32_bf16 v[72:75], a[48:51], a[80:83], v[72:75]
    ds_read_b64_tr_b16 a[110:111], v117 offset:4608
    v_mfma_f32_16x16x32_bf16 v[72:75], a[52:55], a[84:87], v[72:75]
    s_waitcnt vmcnt(10)
    s_barrier
    v_fmac_f32 v20, v196, v217
    v_mfma_f32_16x16x32_bf16 v[76:79], a[56:59], a[80:83], v[76:79]
    ds_read_b128 a[0:3], v110 offset:0
    v_fmac_f32 v21, v197, v217
    v_mfma_f32_16x16x32_bf16 v[76:79], a[60:63], a[84:87], v[76:79]
    s_waitcnt lgkmcnt(9)
    ds_read_b128 a[4:7], v111 offset:0
    v_fmac_f32 v22, v198, v217
    v_mfma_f32_16x16x32_bf16 v[80:83], a[32:35], a[88:91], v[80:83]
    buffer_load_dwordx4 a[168:171], v236, s[28:31], s77 offen offset:0
    v_fmac_f32 v23, v199, v217
    v_mfma_f32_16x16x32_bf16 v[80:83], a[36:39], a[92:95], v[80:83]
    ds_read_b64_tr_b16 a[64:65], v118 offset:8192
    v_fmac_f32 v24, v196, v218
    v_mfma_f32_16x16x32_bf16 v[84:87], a[40:43], a[88:91], v[84:87]
    ds_read_b64_tr_b16 a[66:67], v118 offset:8704
    v_fmac_f32 v25, v197, v218
    v_mfma_f32_16x16x32_bf16 v[84:87], a[44:47], a[92:95], v[84:87]
    v_fmac_f32 v26, v198, v218
    v_fmac_f32 v27, v199, v218
    v_mfma_f32_16x16x32_bf16 v[88:91], a[48:51], a[88:91], v[88:91]
    s_add_u32 s24, s22, 8388608
    s_addc_u32 s25, s23, 0
    ds_read_b64_tr_b16 a[68:69], v118 offset:12288
    v_mfma_f32_16x16x32_bf16 v[88:91], a[52:55], a[92:95], v[88:91]
    ds_read_b64_tr_b16 a[70:71], v118 offset:12800
    v_fmac_f32 v28, v196, v219
    v_mfma_f32_16x16x32_bf16 v[92:95], a[56:59], a[88:91], v[92:95]
    v_fmac_f32 v29, v197, v219
    v_fmac_f32 v30, v198, v219
    v_mfma_f32_16x16x32_bf16 v[92:95], a[60:63], a[92:95], v[92:95]
    s_waitcnt lgkmcnt(10)
    ds_read_b128 a[8:11], v110 offset:2048
    v_fmac_f32 v31, v199, v219
    v_mfma_f32_16x16x32_bf16 v[0:3], a[96:99], a[32:35], v[0:3]
    s_mov_b32 s26, 8388608
    ds_read_b128 a[12:15], v111 offset:2048
    v_mfma_f32_16x16x32_bf16 v[0:3], a[100:103], a[36:39], v[0:3]
    buffer_load_dwordx4 a[172:175], v236, s[28:31], s77 offen offset:64
    v_fmac_f32 v48, v204, v216
    v_mfma_f32_16x16x32_bf16 v[4:7], a[96:99], a[40:43], v[4:7]
    ds_read_b128 a[16:19], v110 offset:4096
    v_fmac_f32 v49, v205, v216
    v_mfma_f32_16x16x32_bf16 v[4:7], a[100:103], a[44:47], v[4:7]
    ds_read_b128 a[20:23], v111 offset:4096
    v_fmac_f32 v50, v206, v216
    v_mfma_f32_16x16x32_bf16 v[8:11], a[96:99], a[48:51], v[8:11]
    s_lshl_b32 s54, s47, 10
    v_fmac_f32 v51, v207, v216
    s_lshl_b32 s58, s3, 20
    v_mfma_f32_16x16x32_bf16 v[8:11], a[100:103], a[52:55], v[8:11]
    ds_read_b128 a[24:27], v110 offset:6144
    v_fmac_f32 v52, v204, v217
    v_mfma_f32_16x16x32_bf16 v[12:15], a[96:99], a[56:59], v[12:15]
    ds_read_b128 a[28:31], v111 offset:6144
    v_fmac_f32 v53, v205, v217
    v_mfma_f32_16x16x32_bf16 v[12:15], a[100:103], a[60:63], v[12:15]
    s_waitcnt lgkmcnt(12)
    v_fmac_f32 v54, v206, v217
    v_fmac_f32 v55, v207, v217
    v_mfma_f32_16x16x32_bf16 v[16:19], a[104:107], a[32:35], v[16:19]
    ds_read_b64_tr_b16 a[72:73], v119 offset:8192
    v_fmac_f32 v56, v204, v218
    v_mfma_f32_16x16x32_bf16 v[16:19], a[108:111], a[36:39], v[16:19]
    ds_read_b64_tr_b16 a[74:75], v119 offset:8704
    v_fmac_f32 v57, v205, v218
    v_mfma_f32_16x16x32_bf16 v[20:23], a[104:107], a[40:43], v[20:23]
    buffer_load_dwordx4 a[176:179], v236, s[28:31], s78 offen offset:0
    v_fmac_f32 v58, v206, v218
    v_mfma_f32_16x16x32_bf16 v[20:23], a[108:111], a[44:47], v[20:23]
    ds_read_b64_tr_b16 a[76:77], v119 offset:12288
    v_fmac_f32 v59, v207, v218
    v_mfma_f32_16x16x32_bf16 v[24:27], a[104:107], a[48:51], v[24:27]
    s_add_u32 s53, s58, s54
    ds_read_b64_tr_b16 a[78:79], v119 offset:12800
    v_mfma_f32_16x16x32_bf16 v[24:27], a[108:111], a[52:55], v[24:27]
    s_and_b32 s51, s46, 3
    v_fmac_f32 v60, v204, v219
    v_fmac_f32 v61, v205, v219
    v_mfma_f32_16x16x32_bf16 v[28:31], a[104:107], a[56:59], v[28:31]
    ds_read_b64_tr_b16 a[80:81], v118 offset:16384
    v_fmac_f32 v62, v206, v219
    v_mfma_f32_16x16x32_bf16 v[28:31], a[108:111], a[60:63], v[28:31]
    s_waitcnt lgkmcnt(9)
    ds_read_b64_tr_b16 a[82:83], v118 offset:16896
    v_fmac_f32 v63, v207, v219
    v_mfma_f32_16x16x32_bf16 v[32:35], a[64:67], a[0:3], v[32:35]
    v_fmac_f32_dpp v64, v224, v208 row_newbcast:0 row_mask:0xf bank_mask:0xf
    v_fmac_f32_dpp v65, v224, v208 row_newbcast:1 row_mask:0xf bank_mask:0xf
    v_mfma_f32_16x16x32_bf16 v[32:35], a[68:71], a[4:7], v[32:35]
    ds_read_b64_tr_b16 a[84:85], v118 offset:20480
    v_fmac_f32_dpp v66, v224, v208 row_newbcast:2 row_mask:0xf bank_mask:0xf
    v_mfma_f32_16x16x32_bf16 v[36:39], a[64:67], a[8:11], v[36:39]
    ds_read_b64_tr_b16 a[86:87], v118 offset:20992
    v_fmac_f32_dpp v67, v224, v208 row_newbcast:3 row_mask:0xf bank_mask:0xf
    v_mfma_f32_16x16x32_bf16 v[36:39], a[68:71], a[12:15], v[36:39]
    s_waitcnt lgkmcnt(8)
    buffer_load_dwordx4 a[180:183], v236, s[28:31], s78 offen offset:64
    v_fmac_f32_dpp v68, v224, v208 row_newbcast:4 row_mask:0xf bank_mask:0xf
    v_mfma_f32_16x16x32_bf16 v[40:43], a[64:67], a[16:19], v[40:43]
    ds_read_b64_tr_b16 a[88:89], v119 offset:16384
    v_fmac_f32_dpp v69, v224, v208 row_newbcast:5 row_mask:0xf bank_mask:0xf
    v_mfma_f32_16x16x32_bf16 v[40:43], a[68:71], a[20:23], v[40:43]
    s_lshl_b32 s51, s51, 7
    ds_read_b64_tr_b16 a[90:91], v119 offset:16896
    v_fmac_f32_dpp v70, v224, v208 row_newbcast:6 row_mask:0xf bank_mask:0xf
    v_mfma_f32_16x16x32_bf16 v[44:47], a[64:67], a[24:27], v[44:47]
    v_fmac_f32_dpp v71, v224, v208 row_newbcast:7 row_mask:0xf bank_mask:0xf
    v_fmac_f32_dpp v72, v224, v208 row_newbcast:8 row_mask:0xf bank_mask:0xf
    v_mfma_f32_16x16x32_bf16 v[44:47], a[68:71], a[28:31], v[44:47]
    s_waitcnt lgkmcnt(6)
    ds_read_b64_tr_b16 a[92:93], v119 offset:20480
    v_fmac_f32_dpp v73, v224, v208 row_newbcast:9 row_mask:0xf bank_mask:0xf
    v_mfma_f32_16x16x32_bf16 v[48:51], a[72:75], a[0:3], v[48:51]
    ds_read_b64_tr_b16 a[94:95], v119 offset:20992
    v_fmac_f32_dpp v74, v224, v208 row_newbcast:10 row_mask:0xf bank_mask:0xf
    v_mfma_f32_16x16x32_bf16 v[48:51], a[76:79], a[4:7], v[48:51]
    s_waitcnt vmcnt(4)
    s_barrier
    v_fmac_f32_dpp v75, v224, v208 row_newbcast:11 row_mask:0xf bank_mask:0xf
    v_mfma_f32_16x16x32_bf16 v[52:55], a[72:75], a[8:11], v[52:55]
    ds_read_b128 a[32:35], v112 offset:0
    v_fmac_f32_dpp v76, v224, v208 row_newbcast:12 row_mask:0xf bank_mask:0xf
    v_mfma_f32_16x16x32_bf16 v[52:55], a[76:79], a[12:15], v[52:55]
    ds_read_b128 a[36:39], v113 offset:0
    v_fmac_f32_dpp v77, v224, v208 row_newbcast:13 row_mask:0xf bank_mask:0xf
    v_mfma_f32_16x16x32_bf16 v[56:59], a[72:75], a[16:19], v[56:59]
    ds_read_b64_tr_b16 a[96:97], v120 offset:8192
    v_fmac_f32_dpp v78, v224, v208 row_newbcast:14 row_mask:0xf bank_mask:0xf
    v_mfma_f32_16x16x32_bf16 v[56:59], a[76:79], a[20:23], v[56:59]
    ds_read_b64_tr_b16 a[98:99], v120 offset:8704
    v_fmac_f32_dpp v79, v224, v208 row_newbcast:15 row_mask:0xf bank_mask:0xf
    v_mfma_f32_16x16x32_bf16 v[60:63], a[72:75], a[24:27], v[60:63]
    s_add_u32 s54, s54, s51
    v_fmac_f32 v32, v200, v216
    v_fmac_f32 v33, v201, v216
    v_mfma_f32_16x16x32_bf16 v[60:63], a[76:79], a[28:31], v[60:63]
    s_waitcnt lgkmcnt(8)
    s_add_u32 s58, s58, s54
    ds_read_b64_tr_b16 a[100:101], v120 offset:12288
    v_mfma_f32_16x16x32_bf16 v[64:67], a[0:3], a[80:83], v[64:67]
    ds_read_b64_tr_b16 a[102:103], v120 offset:12800
    v_fmac_f32 v34, v202, v216
    v_mfma_f32_16x16x32_bf16 v[64:67], a[4:7], a[84:87], v[64:67]
    ds_read_b128 a[40:43], v112 offset:2048
    v_fmac_f32 v35, v203, v216
    v_mfma_f32_16x16x32_bf16 v[68:71], a[8:11], a[80:83], v[68:71]
    ds_read_b128 a[44:47], v113 offset:2048
    v_fmac_f32 v36, v200, v217
    v_mfma_f32_16x16x32_bf16 v[68:71], a[12:15], a[84:87], v[68:71]
    v_fmac_f32 v37, v201, v217
    v_mov_b32 v229, 1
    v_mfma_f32_16x16x32_bf16 v[72:75], a[16:19], a[80:83], v[72:75]
    ds_read_b128 a[48:51], v112 offset:4096
    v_fmac_f32 v38, v202, v217
    v_mfma_f32_16x16x32_bf16 v[72:75], a[20:23], a[84:87], v[72:75]
    ds_read_b128 a[52:55], v113 offset:4096
    v_fmac_f32 v39, v203, v217
    v_mfma_f32_16x16x32_bf16 v[76:79], a[24:27], a[80:83], v[76:79]
    ds_read_b128 a[56:59], v112 offset:6144
    v_mov_b32 v230, 0
    v_mov_b32 v228, -0.5
    v_mfma_f32_16x16x32_bf16 v[76:79], a[28:31], a[84:87], v[76:79]
    s_waitcnt lgkmcnt(11)
    ds_read_b128 a[60:63], v113 offset:6144
    v_fmac_f32 v40, v200, v218
    v_mfma_f32_16x16x32_bf16 v[80:83], a[0:3], a[88:91], v[80:83]
    v_fmac_f32 v41, v201, v218
    v_fmac_f32 v42, v202, v218
    v_mfma_f32_16x16x32_bf16 v[80:83], a[4:7], a[92:95], v[80:83]
    s_lshl_b32 s72, s3, 19
    ds_read_b64_tr_b16 a[104:105], v121 offset:8192
    v_mfma_f32_16x16x32_bf16 v[84:87], a[8:11], a[88:91], v[84:87]
    v_fmac_f32 v43, v203, v218
    v_fmac_f32 v44, v200, v219
    v_mfma_f32_16x16x32_bf16 v[84:87], a[12:15], a[92:95], v[84:87]
    ds_read_b64_tr_b16 a[106:107], v121 offset:8704
    v_fmac_f32 v45, v201, v219
    v_mfma_f32_16x16x32_bf16 v[88:91], a[16:19], a[88:91], v[88:91]
    s_lshl_b32 s73, s93, 7
    v_fmac_f32 v46, v202, v219
    v_mfma_f32_16x16x32_bf16 v[88:91], a[20:23], a[92:95], v[88:91]
    ds_read_b64_tr_b16 a[108:109], v121 offset:12288
    v_fmac_f32 v47, v203, v219
    v_mfma_f32_16x16x32_bf16 v[92:95], a[24:27], a[88:91], v[92:95]
    s_add_u32 s72, s72, s73
    s_lshl_b32 s73, s3, 15
    v_mfma_f32_16x16x32_bf16 v[92:95], a[28:31], a[92:95], v[92:95]
    s_waitcnt lgkmcnt(7)
    s_mov_b32 s63, -1
    ds_read_b64_tr_b16 a[110:111], v121 offset:12800
    v_fmac_f32 v0, v192, v216
    v_mfma_f32_16x16x32_bf16 v[32:35], a[96:99], a[32:35], v[32:35]
    v_fmac_f32 v1, v193, v216
    v_mfma_f32_16x16x32_bf16 v[32:35], a[100:103], a[36:39], v[32:35]
    ds_read_b64_tr_b16 a[64:65], v120 offset:16384
    v_fmac_f32 v2, v194, v216
    v_mfma_f32_16x16x32_bf16 v[36:39], a[96:99], a[40:43], v[36:39]
    s_add_u32 s40, s22, 39845888
    s_addc_u32 s41, s23, 0
    v_fmac_f32 v3, v195, v216
    v_mfma_f32_16x16x32_bf16 v[36:39], a[100:103], a[44:47], v[36:39]
    s_waitcnt lgkmcnt(5)
    ds_read_b64_tr_b16 a[66:67], v120 offset:16896
    v_fmac_f32 v4, v192, v217
    v_mfma_f32_16x16x32_bf16 v[40:43], a[96:99], a[48:51], v[40:43]
    s_mov_b32 s42, 125829120
    v_fmac_f32 v5, v193, v217
    v_mfma_f32_16x16x32_bf16 v[40:43], a[100:103], a[52:55], v[40:43]
    ds_read_b64_tr_b16 a[68:69], v120 offset:20480
    v_fmac_f32 v6, v194, v217
    v_mfma_f32_16x16x32_bf16 v[44:47], a[96:99], a[56:59], v[44:47]
    s_lshl_b32 s56, s2, 2
    v_fmac_f32 v7, v195, v217
    v_mfma_f32_16x16x32_bf16 v[44:47], a[100:103], a[60:63], v[44:47]
    s_waitcnt lgkmcnt(3)
    s_add_u32 s56, s56, s3
    ds_read_b64_tr_b16 a[70:71], v120 offset:20992
    v_fmac_f32 v8, v192, v218
    v_mfma_f32_16x16x32_bf16 v[48:51], a[104:107], a[32:35], v[48:51]
    s_lshl_b32 s56, s56, 12
    v_fmac_f32 v9, v193, v218
    v_mfma_f32_16x16x32_bf16 v[48:51], a[108:111], a[36:39], v[48:51]
    ds_read_b64_tr_b16 a[72:73], v121 offset:16384
    v_fmac_f32 v10, v194, v218
    v_mfma_f32_16x16x32_bf16 v[52:55], a[104:107], a[40:43], v[52:55]
    s_add_u32 s56, s56, 60817408
    v_fmac_f32 v11, v195, v218
    v_mfma_f32_16x16x32_bf16 v[52:55], a[108:111], a[44:47], v[52:55]
    ds_read_b64_tr_b16 a[74:75], v121 offset:16896
    v_fmac_f32 v12, v192, v219
    v_mfma_f32_16x16x32_bf16 v[56:59], a[104:107], a[48:51], v[56:59]
    v_fmac_f32 v13, v193, v219
    v_mfma_f32_16x16x32_bf16 v[56:59], a[108:111], a[52:55], v[56:59]
    ds_read_b64_tr_b16 a[76:77], v121 offset:20480
    v_fmac_f32 v14, v194, v219
    v_mfma_f32_16x16x32_bf16 v[60:63], a[104:107], a[56:59], v[60:63]
    v_fmac_f32 v15, v195, v219
    v_mfma_f32_16x16x32_bf16 v[60:63], a[108:111], a[60:63], v[60:63]
    s_waitcnt lgkmcnt(3)
    ds_read_b64_tr_b16 a[78:79], v121 offset:20992
    v_mfma_f32_16x16x32_bf16 v[64:67], a[32:35], a[64:67], v[64:67]
    v_mul_f32 v32, v32, v220
    v_mul_f32 v33, v33, v220
    v_mul_f32 v34, v34, v220
    v_mul_f32 v35, v35, v220
    v_mfma_f32_16x16x32_bf16 v[64:67], a[36:39], a[68:71], v[64:67]
    ds_read_b64_tr_b16 a[80:81], v118 offset:0
    v_mul_f32 v48, v48, v220
    v_mul_f32 v49, v49, v220
    v_mfma_f32_16x16x32_bf16 v[68:71], a[40:43], a[64:67], v[68:71]
    v_mul_f32 v50, v50, v220
    v_mul_f32 v51, v51, v220
    v_cvt_pk_bf16_f32 v32, v32, v33
    v_cvt_pk_bf16_f32 v33, v34, v35
    v_mfma_f32_16x16x32_bf16 v[68:71], a[44:47], a[68:71], v[68:71]
    ds_read_b64_tr_b16 a[82:83], v118 offset:512
    v_cvt_pk_bf16_f32 v34, v48, v49
    v_cvt_pk_bf16_f32 v35, v50, v51
    v_mfma_f32_16x16x32_bf16 v[72:75], a[48:51], a[64:67], v[72:75]
    buffer_store_dwordx4 v[32:35], v244, s[24:27], s61 offen offset:0 sc1
    ds_write_b128 v247, v[32:35] offset:0
    v_mul_f32 v36, v36, v221
    v_mul_f32 v37, v37, v221
    v_mfma_f32_16x16x32_bf16 v[72:75], a[52:55], a[68:71], v[72:75]
    ds_read_b64_tr_b16 a[84:85], v118 offset:4096
    v_mul_f32 v38, v38, v221
    v_mul_f32 v39, v39, v221
    v_mfma_f32_16x16x32_bf16 v[76:79], a[56:59], a[64:67], v[76:79]
    v_mul_f32 v52, v52, v221
    v_mul_f32 v53, v53, v221
    v_mul_f32 v54, v54, v221
    v_mul_f32 v55, v55, v221
    v_mfma_f32_16x16x32_bf16 v[76:79], a[60:63], a[68:71], v[76:79]
    s_waitcnt lgkmcnt(4)
    ds_read_b64_tr_b16 a[86:87], v118 offset:4608
    v_cvt_pk_bf16_f32 v36, v36, v37
    v_cvt_pk_bf16_f32 v37, v38, v39
    v_mfma_f32_16x16x32_bf16 v[80:83], a[32:35], a[72:75], v[80:83]
    v_cvt_pk_bf16_f32 v38, v52, v53
    v_cvt_pk_bf16_f32 v39, v54, v55
    buffer_store_dwordx4 v[36:39], v244, s[24:27], s61 offen offset:128 sc1
    ds_write_b128 v247, v[36:39] offset:128
    v_mfma_f32_16x16x32_bf16 v[80:83], a[36:39], a[76:79], v[80:83]
    ds_read_b64_tr_b16 a[88:89], v119 offset:0
    v_mul_f32 v40, v40, v222
    v_mul_f32 v41, v41, v222
    v_mul_f32 v42, v42, v222
    v_mfma_f32_16x16x32_bf16 v[84:87], a[40:43], a[72:75], v[84:87]
    v_mul_f32 v43, v43, v222
    v_mul_f32 v56, v56, v222
    v_mul_f32 v57, v57, v222
    v_mfma_f32_16x16x32_bf16 v[84:87], a[44:47], a[76:79], v[84:87]
    ds_read_b64_tr_b16 a[90:91], v119 offset:512
    v_mul_f32 v58, v58, v222
    v_mul_f32 v59, v59, v222
    v_cvt_pk_bf16_f32 v40, v40, v41
    v_mfma_f32_16x16x32_bf16 v[88:91], a[48:51], a[72:75], v[88:91]
    v_cvt_pk_bf16_f32 v41, v42, v43
    v_cvt_pk_bf16_f32 v42, v56, v57
    v_cvt_pk_bf16_f32 v43, v58, v59
    v_mfma_f32_16x16x32_bf16 v[88:91], a[52:55], a[76:79], v[88:91]
    ds_read_b64_tr_b16 a[92:93], v119 offset:4096
    buffer_store_dwordx4 v[40:43], v244, s[24:27], s62 offen offset:0 sc1
    ds_write_b128 v247, v[40:43] offset:4096
    v_mul_f32 v44, v44, v223
    v_mfma_f32_16x16x32_bf16 v[92:95], a[56:59], a[72:75], v[92:95]
    v_mul_f32 v45, v45, v223
    v_mul_f32 v46, v46, v223
    v_mul_f32 v47, v47, v223
    v_mfma_f32_16x16x32_bf16 v[92:95], a[60:63], a[76:79], v[92:95]
    s_waitcnt lgkmcnt(5)
    ds_read_b64_tr_b16 a[94:95], v119 offset:4608
    v_mul_f32 v60, v60, v223
    v_mul_f32 v61, v61, v223
    v_mul_f32 v62, v62, v223
    v_mfma_f32_16x16x32_bf16 v[0:3], a[80:83], a[0:3], v[0:3]
    v_mul_f32 v63, v63, v223
    v_cvt_pk_bf16_f32 v44, v44, v45
    v_cvt_pk_bf16_f32 v45, v46, v47
    v_mfma_f32_16x16x32_bf16 v[0:3], a[84:87], a[4:7], v[0:3]
    ds_read_b64_tr_b16 a[96:97], v120 offset:0
    v_cvt_pk_bf16_f32 v46, v60, v61
    v_cvt_pk_bf16_f32 v47, v62, v63
    buffer_store_dwordx4 v[44:47], v244, s[24:27], s62 offen offset:128 sc1
    v_mfma_f32_16x16x32_bf16 v[4:7], a[80:83], a[8:11], v[4:7]
    ds_write_b128 v247, v[44:47] offset:4224
    v_mul_f32_dpp v64, v225, v64 row_newbcast:0 row_mask:0xf bank_mask:0xf
    v_mul_f32_dpp v65, v225, v65 row_newbcast:1 row_mask:0xf bank_mask:0xf
    v_mul_f32_dpp v66, v225, v66 row_newbcast:2 row_mask:0xf bank_mask:0xf
    v_mfma_f32_16x16x32_bf16 v[4:7], a[84:87], a[12:15], v[4:7]
    ds_read_b64_tr_b16 a[98:99], v120 offset:512
    v_mul_f32_dpp v67, v225, v67 row_newbcast:3 row_mask:0xf bank_mask:0xf
    v_mul_f32_dpp v68, v225, v68 row_newbcast:4 row_mask:0xf bank_mask:0xf
    v_mfma_f32_16x16x32_bf16 v[8:11], a[80:83], a[16:19], v[8:11]
    v_mul_f32_dpp v69, v225, v69 row_newbcast:5 row_mask:0xf bank_mask:0xf
    v_mul_f32_dpp v70, v225, v70 row_newbcast:6 row_mask:0xf bank_mask:0xf
    v_mul_f32_dpp v71, v225, v71 row_newbcast:7 row_mask:0xf bank_mask:0xf
    v_cvt_pk_bf16_f32 v64, v64, v65
    v_mfma_f32_16x16x32_bf16 v[8:11], a[84:87], a[20:23], v[8:11]
    ds_read_b64_tr_b16 a[100:101], v120 offset:4096
    v_cvt_pk_bf16_f32 v65, v66, v67
    v_cvt_pk_bf16_f32 v66, v68, v69
    v_mfma_f32_16x16x32_bf16 v[12:15], a[80:83], a[24:27], v[12:15]
    v_cvt_pk_bf16_f32 v67, v70, v71
    buffer_store_dwordx4 v[64:67], v243, s[24:27], s61 offen offset:2048 sc1
    ds_write_b128 v246, v[64:67] offset:2048
    v_mul_f32_dpp v72, v225, v72 row_newbcast:8 row_mask:0xf bank_mask:0xf
    v_mfma_f32_16x16x32_bf16 v[12:15], a[84:87], a[28:31], v[12:15]
    s_waitcnt lgkmcnt(5)
    ds_read_b64_tr_b16 a[102:103], v120 offset:4608
    v_mul_f32_dpp v73, v225, v73 row_newbcast:9 row_mask:0xf bank_mask:0xf
    v_mul_f32_dpp v74, v225, v74 row_newbcast:10 row_mask:0xf bank_mask:0xf
    v_mfma_f32_16x16x32_bf16 v[16:19], a[88:91], a[0:3], v[16:19]
    v_mul_f32_dpp v75, v225, v75 row_newbcast:11 row_mask:0xf bank_mask:0xf
    v_mul_f32_dpp v76, v225, v76 row_newbcast:12 row_mask:0xf bank_mask:0xf
    v_mul_f32_dpp v77, v225, v77 row_newbcast:13 row_mask:0xf bank_mask:0xf
    v_mul_f32_dpp v78, v225, v78 row_newbcast:14 row_mask:0xf bank_mask:0xf
    v_mfma_f32_16x16x32_bf16 v[16:19], a[92:95], a[4:7], v[16:19]
    ds_read_b64_tr_b16 a[104:105], v121 offset:0
    v_mul_f32_dpp v79, v225, v79 row_newbcast:15 row_mask:0xf bank_mask:0xf
    v_cvt_pk_bf16_f32 v72, v72, v73
    v_mfma_f32_16x16x32_bf16 v[20:23], a[88:91], a[8:11], v[20:23]
    v_cvt_pk_bf16_f32 v73, v74, v75
    v_cvt_pk_bf16_f32 v74, v76, v77
    v_cvt_pk_bf16_f32 v75, v78, v79
    buffer_store_dwordx4 v[72:75], v243, s[24:27], s62 offen offset:2048 sc1
    v_mfma_f32_16x16x32_bf16 v[20:23], a[92:95], a[12:15], v[20:23]
    ds_read_b64_tr_b16 a[106:107], v121 offset:512
    ds_write_b128 v246, v[72:75] offset:6144
    v_mul_f32_dpp v80, v225, v80 row_newbcast:0 row_mask:0xf bank_mask:0xf
    v_mul_f32_dpp v81, v225, v81 row_newbcast:1 row_mask:0xf bank_mask:0xf
    v_mfma_f32_16x16x32_bf16 v[24:27], a[88:91], a[16:19], v[24:27]
    v_mul_f32_dpp v82, v225, v82 row_newbcast:2 row_mask:0xf bank_mask:0xf
    v_mul_f32_dpp v83, v225, v83 row_newbcast:3 row_mask:0xf bank_mask:0xf
    v_mul_f32_dpp v84, v225, v84 row_newbcast:4 row_mask:0xf bank_mask:0xf
    v_mfma_f32_16x16x32_bf16 v[24:27], a[92:95], a[20:23], v[24:27]
    ds_read_b64_tr_b16 a[108:109], v121 offset:4096
    v_mul_f32_dpp v85, v225, v85 row_newbcast:5 row_mask:0xf bank_mask:0xf
    v_mul_f32_dpp v86, v225, v86 row_newbcast:6 row_mask:0xf bank_mask:0xf
    v_mul_f32_dpp v87, v225, v87 row_newbcast:7 row_mask:0xf bank_mask:0xf
    v_mfma_f32_16x16x32_bf16 v[28:31], a[88:91], a[24:27], v[28:31]
    v_cvt_pk_bf16_f32 v80, v80, v81
    v_cvt_pk_bf16_f32 v81, v82, v83
    v_cvt_pk_bf16_f32 v82, v84, v85
    v_mfma_f32_16x16x32_bf16 v[28:31], a[92:95], a[28:31], v[28:31]
    s_waitcnt lgkmcnt(4)
    ds_read_b64_tr_b16 a[110:111], v121 offset:4608
    v_cvt_pk_bf16_f32 v83, v86, v87
    buffer_store_dwordx4 v[80:83], v243, s[24:27], s61 offen offset:2304 sc1
    ds_write_b128 v246, v[80:83] offset:2304
    v_mfma_f32_16x16x32_bf16 v[0:3], a[96:99], a[32:35], v[0:3]
    v_mul_f32_dpp v88, v225, v88 row_newbcast:8 row_mask:0xf bank_mask:0xf
    v_mul_f32_dpp v89, v225, v89 row_newbcast:9 row_mask:0xf bank_mask:0xf
    v_mul_f32_dpp v90, v225, v90 row_newbcast:10 row_mask:0xf bank_mask:0xf
    v_mfma_f32_16x16x32_bf16 v[0:3], a[100:103], a[36:39], v[0:3]
    v_mul_f32_dpp v91, v225, v91 row_newbcast:11 row_mask:0xf bank_mask:0xf
    v_mul_f32_dpp v92, v225, v92 row_newbcast:12 row_mask:0xf bank_mask:0xf
    v_mul_f32_dpp v93, v225, v93 row_newbcast:13 row_mask:0xf bank_mask:0xf
    v_mul_f32_dpp v94, v225, v94 row_newbcast:14 row_mask:0xf bank_mask:0xf
    v_mfma_f32_16x16x32_bf16 v[4:7], a[96:99], a[40:43], v[4:7]
    v_mul_f32_dpp v95, v225, v95 row_newbcast:15 row_mask:0xf bank_mask:0xf
    v_cvt_pk_bf16_f32 v88, v88, v89
    v_cvt_pk_bf16_f32 v89, v90, v91
    v_mfma_f32_16x16x32_bf16 v[4:7], a[100:103], a[44:47], v[4:7]
    v_cvt_pk_bf16_f32 v90, v92, v93
    v_cvt_pk_bf16_f32 v91, v94, v95
    buffer_store_dwordx4 v[88:91], v243, s[24:27], s62 offen offset:2304 sc1
    ds_write_b128 v246, v[88:91] offset:6400
    v_mfma_f32_16x16x32_bf16 v[8:11], a[96:99], a[48:51], v[8:11]
    ds_read_b128 a[184:187], v157 offset:0
    v_mfma_f32_16x16x32_bf16 v[8:11], a[100:103], a[52:55], v[8:11]
    ds_read_b128 a[188:191], v157 offset:1024
    v_mfma_f32_16x16x32_bf16 v[12:15], a[96:99], a[56:59], v[12:15]
    ds_read_b128 a[192:195], v157 offset:2048
    v_mfma_f32_16x16x32_bf16 v[12:15], a[100:103], a[60:63], v[12:15]
    s_waitcnt lgkmcnt(5)
    ds_read_b128 a[196:199], v157 offset:3072
    v_mfma_f32_16x16x32_bf16 v[16:19], a[104:107], a[32:35], v[16:19]
    ds_read_b128 a[200:203], v157 offset:4096
    v_mfma_f32_16x16x32_bf16 v[16:19], a[108:111], a[36:39], v[16:19]
    ds_read_b128 a[204:207], v157 offset:5120
    ds_read_b128 a[208:211], v157 offset:6144
    v_mfma_f32_16x16x32_bf16 v[20:23], a[104:107], a[40:43], v[20:23]
    ds_read_b128 a[212:215], v157 offset:7168
    v_mfma_f32_16x16x32_bf16 v[20:23], a[108:111], a[44:47], v[20:23]
    v_mul_f32 v216, 0x3e8293ee, v220
    v_mfma_f32_16x16x32_bf16 v[24:27], a[104:107], a[48:51], v[24:27]
    v_mul_f32 v217, 0x3e8293ee, v221
    v_mfma_f32_16x16x32_bf16 v[24:27], a[108:111], a[52:55], v[24:27]
    v_mul_f32 v218, 0x3e8293ee, v222
    v_mfma_f32_16x16x32_bf16 v[28:31], a[104:107], a[56:59], v[28:31]
    v_mul_f32 v219, 0x3e8293ee, v223
    v_mfma_f32_16x16x32_bf16 v[28:31], a[108:111], a[60:63], v[28:31]
    s_waitcnt lgkmcnt(6)
    v_pk_mul_f32 v[0:1], v[0:1], v[216:217] op_sel:[0,0] op_sel_hi:[1,0]
    v_pk_mul_f32 v[2:3], v[2:3], v[216:217] op_sel:[0,0] op_sel_hi:[1,0]
    v_pk_mul_f32 v[4:5], v[4:5], v[216:217] op_sel:[0,1] op_sel_hi:[1,1]
L_stub_3:
    s_cbranch_execz L_warm_start_ret
    v_pk_mul_f32 v[6:7], v[6:7], v[216:217] op_sel:[0,1] op_sel_hi:[1,1]
    v_pk_mul_f32 v[8:9], v[8:9], v[218:219] op_sel:[0,0] op_sel_hi:[1,0]
    v_pk_mul_f32 v[10:11], v[10:11], v[218:219] op_sel:[0,0] op_sel_hi:[1,0]
    v_pk_mul_f32 v[12:13], v[12:13], v[218:219] op_sel:[0,1] op_sel_hi:[1,1]
    v_pk_mul_f32 v[14:15], v[14:15], v[218:219] op_sel:[0,1] op_sel_hi:[1,1]
    v_pk_mul_f32 v[16:17], v[16:17], v[216:217] op_sel:[0,0] op_sel_hi:[1,0]
    v_pk_mul_f32 v[18:19], v[18:19], v[216:217] op_sel:[0,0] op_sel_hi:[1,0]
    v_cvt_pk_bf16_f32 v0, v0, v1
    v_cvt_pk_bf16_f32 v1, v2, v3
    v_cvt_pk_bf16_f32 v2, v16, v17
    v_cvt_pk_bf16_f32 v3, v18, v19
    v_pk_mul_f32 v[20:21], v[20:21], v[216:217] op_sel:[0,1] op_sel_hi:[1,1]
    v_pk_mul_f32 v[22:23], v[22:23], v[216:217] op_sel:[0,1] op_sel_hi:[1,1]
    v_cvt_pk_bf16_f32 v4, v4, v5
    v_cvt_pk_bf16_f32 v5, v6, v7
    v_cvt_pk_bf16_f32 v6, v20, v21
    v_cvt_pk_bf16_f32 v7, v22, v23
    v_pk_mul_f32 v[24:25], v[24:25], v[218:219] op_sel:[0,0] op_sel_hi:[1,0]
    v_pk_mul_f32 v[26:27], v[26:27], v[218:219] op_sel:[0,0] op_sel_hi:[1,0]
    v_cvt_pk_bf16_f32 v8, v8, v9
    v_cvt_pk_bf16_f32 v9, v10, v11
    v_cvt_pk_bf16_f32 v10, v24, v25
    v_cvt_pk_bf16_f32 v11, v26, v27
    v_pk_mul_f32 v[28:29], v[28:29], v[218:219] op_sel:[0,1] op_sel_hi:[1,1]
    v_pk_mul_f32 v[30:31], v[30:31], v[218:219] op_sel:[0,1] op_sel_hi:[1,1]
    v_cvt_pk_bf16_f32 v12, v12, v13
    v_cvt_pk_bf16_f32 v13, v14, v15
    v_cvt_pk_bf16_f32 v14, v28, v29
    v_cvt_pk_bf16_f32 v15, v30, v31
    s_nop 0
    v_permlane16_swap_b32 v0, v4
    v_permlane16_swap_b32 v1, v5
    v_permlane16_swap_b32 v2, v6
    v_permlane16_swap_b32 v3, v7
    v_permlane16_swap_b32 v8, v12
    v_permlane16_swap_b32 v9, v13
    v_permlane16_swap_b32 v10, v14
    v_permlane16_swap_b32 v11, v15
    ds_write_b128 v158, v[0:3] offset:0
    ds_write_b128 v158, v[4:7] offset:1024
    ds_write_b128 v158, v[8:11] offset:2048
    ds_write_b128 v158, v[12:15] offset:3072
    v_mfma_f32_32x32x16_bf16 v[16:31], a[184:187], v[0:3], 0
    v_mfma_f32_32x32x16_bf16 v[16:31], a[188:191], v[4:7], v[16:31]
    v_mfma_f32_32x32x16_bf16 v[32:47], a[184:187], v[8:11], 0
    v_mfma_f32_32x32x16_bf16 v[32:47], a[188:191], v[12:15], v[32:47]
    s_waitcnt lgkmcnt(0)
    s_barrier
    ds_read_b128 a[112:115], v160 offset:0
    ds_read_b128 a[116:119], v160 offset:1024
    ds_read_b128 a[120:123], v160 offset:2048
    ds_read_b128 a[124:127], v160 offset:3072
    s_nop 3
    v_max3_f32 v164, v16, v17, v18
    v_max3_f32 v224, v19, v20, v21
    v_max3_f32 v164, v164, v22, v23
    v_max3_f32 v224, v224, v24, v25
    v_max3_f32 v164, v164, v26, v27
    v_max3_f32 v224, v224, v28, v29
    v_max3_f32 v164, v164, v30, v31
    v_max_f32 v164, v164, v224
    s_waitcnt lgkmcnt(0)
    v_mfma_f32_32x32x16_bf16 v[16:31], a[184:187], a[112:115], 0
    v_mfma_f32_32x32x16_bf16 v[16:31], a[188:191], a[116:119], v[16:31]
    v_max3_f32 v165, v32, v33, v34
    v_max3_f32 v225, v35, v36, v37
    v_max3_f32 v165, v165, v38, v39
    v_max3_f32 v225, v225, v40, v41
    v_max3_f32 v165, v165, v42, v43
    v_max3_f32 v225, v225, v44, v45
    v_max3_f32 v165, v165, v46, v47
    v_max_f32 v165, v165, v225
    v_mfma_f32_32x32x16_bf16 v[32:47], a[184:187], a[120:123], 0
    v_mfma_f32_32x32x16_bf16 v[32:47], a[188:191], a[124:127], v[32:47]
    v_mov_b32 v226, v164
    v_mov_b32 v227, v165
    v_mov_b32 v228, -1.0
    v_permlane32_swap_b32 v164, v226
    v_permlane32_swap_b32 v165, v227
    v_max_f32 v164, v164, v226
    v_max_f32 v165, v165, v227
    v_pk_mul_f32 v[48:49], v[164:165], v[228:229] op_sel:[0,0] op_sel_hi:[0,0]
    v_pk_mul_f32 v[50:51], v[164:165], v[228:229] op_sel:[0,0] op_sel_hi:[0,0]
    v_pk_mul_f32 v[52:53], v[164:165], v[228:229] op_sel:[0,0] op_sel_hi:[0,0]
    v_pk_mul_f32 v[54:55], v[164:165], v[228:229] op_sel:[0,0] op_sel_hi:[0,0]
    v_pk_mul_f32 v[56:57], v[164:165], v[228:229] op_sel:[0,0] op_sel_hi:[0,0]
    v_pk_mul_f32 v[58:59], v[164:165], v[228:229] op_sel:[0,0] op_sel_hi:[0,0]
    v_pk_mul_f32 v[60:61], v[164:165], v[228:229] op_sel:[0,0] op_sel_hi:[0,0]
    v_pk_mul_f32 v[62:63], v[164:165], v[228:229] op_sel:[0,0] op_sel_hi:[0,0]
    v_pk_mul_f32 v[64:65], v[164:165], v[228:229] op_sel:[1,0] op_sel_hi:[1,0]
    v_pk_mul_f32 v[66:67], v[164:165], v[228:229] op_sel:[1,0] op_sel_hi:[1,0]
    v_pk_mul_f32 v[68:69], v[164:165], v[228:229] op_sel:[1,0] op_sel_hi:[1,0]
    v_pk_mul_f32 v[70:71], v[164:165], v[228:229] op_sel:[1,0] op_sel_hi:[1,0]
    v_pk_mul_f32 v[72:73], v[164:165], v[228:229] op_sel:[1,0] op_sel_hi:[1,0]
    v_pk_mul_f32 v[74:75], v[164:165], v[228:229] op_sel:[1,0] op_sel_hi:[1,0]
    v_pk_mul_f32 v[76:77], v[164:165], v[228:229] op_sel:[1,0] op_sel_hi:[1,0]
    v_pk_mul_f32 v[78:79], v[164:165], v[228:229] op_sel:[1,0] op_sel_hi:[1,0]
    s_waitcnt vmcnt(0)
    s_barrier
    buffer_atomic_add v229, v237, s[88:91], s53 offen sc0 sc1
    v_max3_f32 v166, v16, v17, v18
    v_max3_f32 v224, v19, v20, v21
    v_max3_f32 v166, v166, v22, v23
    v_max3_f32 v224, v224, v24, v25
    v_max3_f32 v166, v166, v26, v27
    v_max3_f32 v224, v224, v28, v29
    v_max3_f32 v166, v166, v30, v31
    v_max_f32 v166, v166, v224
    v_mfma_f32_32x32x16_bf16 v[16:31], a[184:187], v[0:3], v[48:63]
    v_mfma_f32_32x32x16_bf16 v[16:31], a[188:191], v[4:7], v[16:31]
    v_max3_f32 v167, v32, v33, v34
    v_max3_f32 v225, v35, v36, v37
    v_max3_f32 v167, v167, v38, v39
    v_max3_f32 v225, v225, v40, v41
    v_max3_f32 v167, v167, v42, v43
    v_max3_f32 v225, v225, v44, v45
    v_max3_f32 v167, v167, v46, v47
    v_max_f32 v167, v167, v225
    v_mov_b32 v226, v166
    v_mov_b32 v227, v167
    v_mov_b32 v228, -1.0
    v_permlane32_swap_b32 v166, v226
    v_permlane32_swap_b32 v167, v227
    v_max_f32 v166, v166, v226
    v_max_f32 v167, v167, v227
    v_pk_mul_f32 v[80:81], v[166:167], v[228:229] op_sel:[0,0] op_sel_hi:[0,0]
    v_pk_mul_f32 v[82:83], v[166:167], v[228:229] op_sel:[0,0] op_sel_hi:[0,0]
    v_pk_mul_f32 v[84:85], v[166:167], v[228:229] op_sel:[0,0] op_sel_hi:[0,0]
    v_pk_mul_f32 v[86:87], v[166:167], v[228:229] op_sel:[0,0] op_sel_hi:[0,0]
    v_pk_mul_f32 v[88:89], v[166:167], v[228:229] op_sel:[0,0] op_sel_hi:[0,0]
    v_pk_mul_f32 v[90:91], v[166:167], v[228:229] op_sel:[0,0] op_sel_hi:[0,0]
    v_pk_mul_f32 v[92:93], v[166:167], v[228:229] op_sel:[0,0] op_sel_hi:[0,0]
    v_pk_mul_f32 v[94:95], v[166:167], v[228:229] op_sel:[0,0] op_sel_hi:[0,0]
    v_pk_mul_f32 v[96:97], v[166:167], v[228:229] op_sel:[1,0] op_sel_hi:[1,0]
    v_pk_mul_f32 v[98:99], v[166:167], v[228:229] op_sel:[1,0] op_sel_hi:[1,0]
    v_pk_mul_f32 v[100:101], v[166:167], v[228:229] op_sel:[1,0] op_sel_hi:[1,0]
    v_pk_mul_f32 v[102:103], v[166:167], v[228:229] op_sel:[1,0] op_sel_hi:[1,0]
    v_pk_mul_f32 v[104:105], v[166:167], v[228:229] op_sel:[1,0] op_sel_hi:[1,0]
    v_pk_mul_f32 v[106:107], v[166:167], v[228:229] op_sel:[1,0] op_sel_hi:[1,0]
    v_pk_mul_f32 v[108:109], v[166:167], v[228:229] op_sel:[1,0] op_sel_hi:[1,0]
    v_pk_mul_f32 v[110:111], v[166:167], v[228:229] op_sel:[1,0] op_sel_hi:[1,0]
    v_mfma_f32_32x32x16_bf16 v[32:47], a[184:187], v[8:11], v[64:79]
    v_exp_f32 v16, v16
    v_exp_f32 v17, v17
    v_exp_f32 v18, v18
    v_exp_f32 v19, v19
    v_mfma_f32_32x32x16_bf16 v[32:47], a[188:191], v[12:15], v[32:47]
    v_exp_f32 v20, v20
    v_cvt_pk_bf16_f32 v112, v16, v17
    v_exp_f32 v21, v21
    v_cvt_pk_bf16_f32 v113, v18, v19
    v_exp_f32 v22, v22
    v_exp_f32 v23, v23
    v_cvt_pk_bf16_f32 v114, v20, v21
    v_exp_f32 v24, v24
    v_exp_f32 v25, v25
    v_cvt_pk_bf16_f32 v115, v22, v23
    v_exp_f32 v26, v26
    v_exp_f32 v27, v27
    v_cvt_pk_bf16_f32 v116, v24, v25
    v_exp_f32 v28, v28
    v_cvt_pk_bf16_f32 v117, v26, v27
    v_exp_f32 v29, v29
    v_exp_f32 v30, v30
    v_exp_f32 v31, v31
    v_cvt_pk_bf16_f32 v118, v28, v29
    v_cvt_pk_bf16_f32 v119, v30, v31
    v_mfma_f32_32x32x16_bf16 v[16:31], a[184:187], a[112:115], v[80:95]
    v_exp_f32 v32, v32
    v_exp_f32 v33, v33
    v_exp_f32 v34, v34
    v_exp_f32 v35, v35
    v_mfma_f32_32x32x16_bf16 v[16:31], a[188:191], a[116:119], v[16:31]
    v_exp_f32 v36, v36
    v_cvt_pk_bf16_f32 v120, v32, v33
    v_exp_f32 v37, v37
    v_cvt_pk_bf16_f32 v121, v34, v35
    v_exp_f32 v38, v38
    v_mfma_f32_32x32x16_bf16 v[192:207], a[192:195], v[112:115], 0
    v_exp_f32 v39, v39
    v_cvt_pk_bf16_f32 v122, v36, v37
    v_exp_f32 v40, v40
    v_exp_f32 v41, v41
    v_cvt_pk_bf16_f32 v123, v38, v39
    v_mfma_f32_32x32x16_bf16 v[192:207], a[196:199], v[116:119], v[192:207]
    v_exp_f32 v42, v42
    v_exp_f32 v43, v43
    v_cvt_pk_bf16_f32 v124, v40, v41
    v_exp_f32 v44, v44
    v_cvt_pk_bf16_f32 v125, v42, v43
    v_smfmac_f32_16x16x64_bf16 v[176:179], v[152:155], v[112:119], v156
    buffer_atomic_add v230, v237, s[88:91], s58 offen sc0 sc1
    v_exp_f32 v45, v45
    v_exp_f32 v46, v46
    v_exp_f32 v47, v47
    v_cvt_pk_bf16_f32 v126, v44, v45
    v_cvt_pk_bf16_f32 v127, v46, v47
    v_mfma_f32_32x32x16_bf16 v[32:47], a[184:187], a[120:123], v[96:111]
    v_exp_f32 v16, v16
    v_exp_f32 v17, v17
    v_exp_f32 v18, v18
    v_exp_f32 v19, v19
    v_mfma_f32_32x32x16_bf16 v[32:47], a[188:191], a[124:127], v[32:47]
    v_exp_f32 v20, v20
    v_cvt_pk_bf16_f32 v112, v16, v17
    v_exp_f32 v21, v21
    v_cvt_pk_bf16_f32 v113, v18, v19
    v_exp_f32 v22, v22
    v_mfma_f32_32x32x16_bf16 v[208:223], a[192:195], v[120:123], 0
    v_exp_f32 v23, v23
    v_cvt_pk_bf16_f32 v114, v20, v21
    v_exp_f32 v24, v24
    v_exp_f32 v25, v25
    v_cvt_pk_bf16_f32 v115, v22, v23
    v_mfma_f32_32x32x16_bf16 v[208:223], a[196:199], v[124:127], v[208:223]
    v_exp_f32 v26, v26
    v_exp_f32 v27, v27
    v_cvt_pk_bf16_f32 v116, v24, v25
    v_exp_f32 v28, v28
    v_cvt_pk_bf16_f32 v117, v26, v27
    v_smfmac_f32_16x16x64_bf16 v[180:183], v[152:155], v[120:127], v156
    v_exp_f32 v29, v29
    v_exp_f32 v30, v30
    v_exp_f32 v31, v31
    v_cvt_pk_bf16_f32 v118, v28, v29
    v_cvt_pk_bf16_f32 v119, v30, v31
    v_mfma_f32_32x32x16_bf16 v[16:31], a[200:203], v[0:3], v[48:63]
    s_add_u32 s63, s63, 1
    v_exp_f32 v32, v32
    v_exp_f32 v33, v33
    v_exp_f32 v34, v34
    v_exp_f32 v35, v35
    v_mfma_f32_32x32x16_bf16 v[16:31], a[204:207], v[4:7], v[16:31]
    s_cmp_eq_u32 s63, s46
    v_exp_f32 v36, v36
    v_cvt_pk_bf16_f32 v120, v32, v33
    v_exp_f32 v37, v37
    v_cvt_pk_bf16_f32 v121, v34, v35
    v_exp_f32 v38, v38
    v_mfma_f32_32x32x16_bf16 a[128:143], a[192:195], v[112:115], 0
    s_addc_u32 s63, s63, 0
    v_exp_f32 v39, v39
    v_cvt_pk_bf16_f32 v122, v36, v37
    v_exp_f32 v40, v40
    v_exp_f32 v41, v41
    v_cvt_pk_bf16_f32 v123, v38, v39
    v_mfma_f32_32x32x16_bf16 a[128:143], a[196:199], v[116:119], a[128:143]
    s_lshl_b32 s57, s63, 14
    v_exp_f32 v42, v42
    v_exp_f32 v43, v43
    v_cvt_pk_bf16_f32 v124, v40, v41
    v_exp_f32 v44, v44
    v_cvt_pk_bf16_f32 v125, v42, v43
    v_smfmac_f32_16x16x64_bf16 v[184:187], v[152:155], v[112:119], v156
    s_add_u32 s57, s57, s52
    v_exp_f32 v45, v45
    v_exp_f32 v46, v46
    v_exp_f32 v47, v47
    v_cvt_pk_bf16_f32 v126, v44, v45
    v_cvt_pk_bf16_f32 v127, v46, v47
    s_cmp_eq_u32 s3, 0
    s_cbranch_scc1 L_sequential_preLN__softmax_full_mha__glu_gated_swiglu__prompt_kernel_poller_7
    s_mov_b64 exec, 0
    s_cmp_eq_u32 s3, 1
    s_cbranch_scc1 L_stub_4
    s_cmp_eq_u32 s3, 2
    s_cbranch_scc1 L_stub_5
    s_branch L_stub_6
L_warm_w9_ret:
    s_mov_b64 exec, -1
    s_branch L_sequential_preLN__softmax_full_mha__glu_gated_swiglu__prompt_kernel_pdone_6
L_sequential_preLN__softmax_full_mha__glu_gated_swiglu__prompt_kernel_poller_7:
    s_mov_b32 s50, 262144
    s_mov_b64 exec, 1
    s_waitcnt vmcnt(0)
    v_cmp_gt_u32 vcc, 16, v230
    s_nop 4
    s_cbranch_vccz L_sequential_preLN__softmax_full_mha__glu_gated_swiglu__prompt_kernel_pend_9
L_sequential_preLN__softmax_full_mha__glu_gated_swiglu__prompt_kernel_poll_8:
    v_mov_b32 v225, 0
    s_sub_u32 s50, s50, 1
    s_cbranch_scc1 L_sequential_preLN__softmax_full_mha__glu_gated_swiglu__prompt_kernel_pend_9
    buffer_atomic_add v225, v237, s[88:91], s54 offen sc0 sc1
    s_waitcnt vmcnt(0)
    v_cmp_gt_u32 vcc, 16, v225
    s_nop 4
    s_cbranch_vccnz L_sequential_preLN__softmax_full_mha__glu_gated_swiglu__prompt_kernel_poll_8
L_sequential_preLN__softmax_full_mha__glu_gated_swiglu__prompt_kernel_pend_9:
    s_mov_b64 exec, -1
L_sequential_preLN__softmax_full_mha__glu_gated_swiglu__prompt_kernel_pdone_6:
    s_waitcnt vmcnt(0)
    s_barrier
L_att_code:
    buffer_load_dwordx4 a[0:3], v233, s[24:27], s57 offen offset:0 sc1
    buffer_load_dwordx4 a[4:7], v233, s[24:27], s57 offen offset:1024 sc1
    buffer_load_dwordx4 a[8:11], v233, s[24:27], s57 offen offset:2048 sc1
    buffer_load_dwordx4 a[12:15], v233, s[24:27], s57 offen offset:3072 sc1
    v_mfma_f32_32x32x16_bf16 v[32:47], a[200:203], v[8:11], v[64:79]
    s_add_u32 s57, s57, 4096
    v_exp_f32 v16, v16
    v_exp_f32 v17, v17
    v_exp_f32 v18, v18
    v_exp_f32 v19, v19
    v_mfma_f32_32x32x16_bf16 v[32:47], a[204:207], v[12:15], v[32:47]
    v_exp_f32 v20, v20
    v_cvt_pk_bf16_f32 v112, v16, v17
    v_exp_f32 v21, v21
    v_cvt_pk_bf16_f32 v113, v18, v19
    v_exp_f32 v22, v22
    v_mfma_f32_32x32x16_bf16 a[144:159], a[192:195], v[120:123], 0
    v_exp_f32 v23, v23
    v_cvt_pk_bf16_f32 v114, v20, v21
    v_exp_f32 v24, v24
    v_exp_f32 v25, v25
    v_cvt_pk_bf16_f32 v115, v22, v23
    v_mfma_f32_32x32x16_bf16 a[144:159], a[196:199], v[124:127], a[144:159]
    v_exp_f32 v26, v26
    v_exp_f32 v27, v27
    v_cvt_pk_bf16_f32 v116, v24, v25
    v_exp_f32 v28, v28
    v_cvt_pk_bf16_f32 v117, v26, v27
    v_smfmac_f32_16x16x64_bf16 v[188:191], v[152:155], v[120:127], v156
    v_exp_f32 v29, v29
    v_exp_f32 v30, v30
    v_exp_f32 v31, v31
    v_cvt_pk_bf16_f32 v118, v28, v29
    v_cvt_pk_bf16_f32 v119, v30, v31
    v_mfma_f32_32x32x16_bf16 v[16:31], a[200:203], a[112:115], v[80:95]
    v_exp_f32 v32, v32
    v_exp_f32 v33, v33
    v_exp_f32 v34, v34
    v_exp_f32 v35, v35
    v_mfma_f32_32x32x16_bf16 v[16:31], a[204:207], a[116:119], v[16:31]
    v_exp_f32 v36, v36
    v_cvt_pk_bf16_f32 v120, v32, v33
    v_exp_f32 v37, v37
    v_cvt_pk_bf16_f32 v121, v34, v35
    v_exp_f32 v38, v38
    v_mfma_f32_32x32x16_bf16 v[192:207], a[208:211], v[112:115], v[192:207]
    v_exp_f32 v39, v39
    v_cvt_pk_bf16_f32 v122, v36, v37
    v_exp_f32 v40, v40
    v_exp_f32 v41, v41
    v_cvt_pk_bf16_f32 v123, v38, v39
    v_mfma_f32_32x32x16_bf16 v[192:207], a[212:215], v[116:119], v[192:207]
    v_exp_f32 v42, v42
    v_exp_f32 v43, v43
    v_cvt_pk_bf16_f32 v124, v40, v41
    v_exp_f32 v44, v44
    v_cvt_pk_bf16_f32 v125, v42, v43
    v_smfmac_f32_16x16x64_bf16 v[176:179], v[152:155], v[112:119], v156
    buffer_load_dwordx4 a[16:19], v233, s[24:27], s57 offen offset:0 sc1
    buffer_load_dwordx4 a[20:23], v233, s[24:27], s57 offen offset:1024 sc1
    buffer_load_dwordx4 a[24:27], v233, s[24:27], s57 offen offset:2048 sc1
    buffer_load_dwordx4 a[28:31], v233, s[24:27], s57 offen offset:3072 sc1
    v_exp_f32 v45, v45
    v_exp_f32 v46, v46
    v_exp_f32 v47, v47
    v_cvt_pk_bf16_f32 v126, v44, v45
    v_cvt_pk_bf16_f32 v127, v46, v47
    v_mfma_f32_32x32x16_bf16 v[32:47], a[200:203], a[120:123], v[96:111]
    s_add_u32 s63, s63, 1
    v_exp_f32 v16, v16
    v_exp_f32 v17, v17
    v_exp_f32 v18, v18
    v_exp_f32 v19, v19
    v_mfma_f32_32x32x16_bf16 v[32:47], a[204:207], a[124:127], v[32:47]
    s_cmp_eq_u32 s63, s46
    v_exp_f32 v20, v20
    v_cvt_pk_bf16_f32 v112, v16, v17
    v_exp_f32 v21, v21
    v_cvt_pk_bf16_f32 v113, v18, v19
    v_exp_f32 v22, v22
    v_mfma_f32_32x32x16_bf16 v[208:223], a[208:211], v[120:123], v[208:223]
    v_exp_f32 v23, v23
    v_cvt_pk_bf16_f32 v114, v20, v21
    v_exp_f32 v24, v24
    v_exp_f32 v25, v25
    v_cvt_pk_bf16_f32 v115, v22, v23
    v_mfma_f32_32x32x16_bf16 v[208:223], a[212:215], v[124:127], v[208:223]
    s_addc_u32 s63, s63, 0
    v_exp_f32 v26, v26
    v_exp_f32 v27, v27
    v_cvt_pk_bf16_f32 v116, v24, v25
    v_exp_f32 v28, v28
    v_cvt_pk_bf16_f32 v117, v26, v27
    v_smfmac_f32_16x16x64_bf16 v[180:183], v[152:155], v[120:127], v156
    s_waitcnt vmcnt(4)
    v_exp_f32 v29, v29
    v_exp_f32 v30, v30
    v_exp_f32 v31, v31
    v_cvt_pk_bf16_f32 v118, v28, v29
    v_cvt_pk_bf16_f32 v119, v30, v31
    v_mfma_f32_32x32x16_bf16 v[16:31], a[0:3], v[0:3], v[48:63]
    s_lshl_b32 s57, s63, 14
    v_exp_f32 v32, v32
    v_exp_f32 v33, v33
    v_exp_f32 v34, v34
    v_exp_f32 v35, v35
    v_mfma_f32_32x32x16_bf16 v[16:31], a[4:7], v[4:7], v[16:31]
    v_exp_f32 v36, v36
    v_cvt_pk_bf16_f32 v120, v32, v33
    v_exp_f32 v37, v37
    v_cvt_pk_bf16_f32 v121, v34, v35
    v_exp_f32 v38, v38
    v_mfma_f32_32x32x16_bf16 a[128:143], a[208:211], v[112:115], a[128:143]
    s_add_u32 s57, s57, s52
    v_exp_f32 v39, v39
    v_cvt_pk_bf16_f32 v122, v36, v37
    v_exp_f32 v40, v40
    v_exp_f32 v41, v41
    v_cvt_pk_bf16_f32 v123, v38, v39
    v_mfma_f32_32x32x16_bf16 a[128:143], a[212:215], v[116:119], a[128:143]
    v_exp_f32 v42, v42
    v_exp_f32 v43, v43
    v_cvt_pk_bf16_f32 v124, v40, v41
    v_exp_f32 v44, v44
    v_cvt_pk_bf16_f32 v125, v42, v43
    v_smfmac_f32_16x16x64_bf16 v[184:187], v[152:155], v[112:119], v156
    buffer_load_dwordx4 a[32:35], v233, s[24:27], s57 offen offset:0 sc1
    buffer_load_dwordx4 a[36:39], v233, s[24:27], s57 offen offset:1024 sc1
    buffer_load_dwordx4 a[40:43], v233, s[24:27], s57 offen offset:2048 sc1
    buffer_load_dwordx4 a[44:47], v233, s[24:27], s57 offen offset:3072 sc1
    v_exp_f32 v45, v45
    v_exp_f32 v46, v46
    v_exp_f32 v47, v47
    v_cvt_pk_bf16_f32 v126, v44, v45
    v_cvt_pk_bf16_f32 v127, v46, v47
    v_mfma_f32_32x32x16_bf16 v[32:47], a[0:3], v[8:11], v[64:79]
    s_add_u32 s57, s57, 4096
    v_exp_f32 v16, v16
    v_exp_f32 v17, v17
    v_exp_f32 v18, v18
    v_exp_f32 v19, v19
    v_mfma_f32_32x32x16_bf16 v[32:47], a[4:7], v[12:15], v[32:47]
    v_exp_f32 v20, v20
    v_cvt_pk_bf16_f32 v112, v16, v17
    v_exp_f32 v21, v21
    v_cvt_pk_bf16_f32 v113, v18, v19
    v_exp_f32 v22, v22
    v_mfma_f32_32x32x16_bf16 a[144:159], a[208:211], v[120:123], a[144:159]
    v_exp_f32 v23, v23
    v_cvt_pk_bf16_f32 v114, v20, v21
    v_exp_f32 v24, v24
    v_exp_f32 v25, v25
    v_cvt_pk_bf16_f32 v115, v22, v23
    v_mfma_f32_32x32x16_bf16 a[144:159], a[212:215], v[124:127], a[144:159]
    v_exp_f32 v26, v26
    v_exp_f32 v27, v27
    v_cvt_pk_bf16_f32 v116, v24, v25
    v_exp_f32 v28, v28
    v_cvt_pk_bf16_f32 v117, v26, v27
    v_smfmac_f32_16x16x64_bf16 v[188:191], v[152:155], v[120:127], v156
    v_exp_f32 v29, v29
    v_exp_f32 v30, v30
    v_exp_f32 v31, v31
    v_cvt_pk_bf16_f32 v118, v28, v29
    v_cvt_pk_bf16_f32 v119, v30, v31
    v_mfma_f32_32x32x16_bf16 v[16:31], a[0:3], a[112:115], v[80:95]
    v_exp_f32 v32, v32
    v_exp_f32 v33, v33
    v_exp_f32 v34, v34
    v_exp_f32 v35, v35
    v_mfma_f32_32x32x16_bf16 v[16:31], a[4:7], a[116:119], v[16:31]
    v_exp_f32 v36, v36
    v_cvt_pk_bf16_f32 v120, v32, v33
    v_exp_f32 v37, v37
    v_cvt_pk_bf16_f32 v121, v34, v35
    v_exp_f32 v38, v38
    v_mfma_f32_32x32x16_bf16 v[192:207], a[8:11], v[112:115], v[192:207]
    v_exp_f32 v39, v39
    v_cvt_pk_bf16_f32 v122, v36, v37
    v_exp_f32 v40, v40
    v_exp_f32 v41, v41
    v_cvt_pk_bf16_f32 v123, v38, v39
    v_mfma_f32_32x32x16_bf16 v[192:207], a[12:15], v[116:119], v[192:207]
    v_exp_f32 v42, v42
    v_exp_f32 v43, v43
    v_cvt_pk_bf16_f32 v124, v40, v41
    v_exp_f32 v44, v44
    v_cvt_pk_bf16_f32 v125, v42, v43
    v_smfmac_f32_16x16x64_bf16 v[176:179], v[152:155], v[112:119], v156
    buffer_load_dwordx4 a[48:51], v233, s[24:27], s57 offen offset:0 sc1
    buffer_load_dwordx4 a[52:55], v233, s[24:27], s57 offen offset:1024 sc1
    buffer_load_dwordx4 a[56:59], v233, s[24:27], s57 offen offset:2048 sc1
    buffer_load_dwordx4 a[60:63], v233, s[24:27], s57 offen offset:3072 sc1
    v_exp_f32 v45, v45
    v_exp_f32 v46, v46
    v_exp_f32 v47, v47
    v_cvt_pk_bf16_f32 v126, v44, v45
    v_cvt_pk_bf16_f32 v127, v46, v47
    v_mfma_f32_32x32x16_bf16 v[32:47], a[0:3], a[120:123], v[96:111]
    s_add_u32 s63, s63, 1
    v_exp_f32 v16, v16
    v_exp_f32 v17, v17
    v_exp_f32 v18, v18
    v_exp_f32 v19, v19
    v_mfma_f32_32x32x16_bf16 v[32:47], a[4:7], a[124:127], v[32:47]
    s_cmp_eq_u32 s63, s46
    v_exp_f32 v20, v20
    v_cvt_pk_bf16_f32 v112, v16, v17
    v_exp_f32 v21, v21
    v_cvt_pk_bf16_f32 v113, v18, v19
    v_exp_f32 v22, v22
    v_mfma_f32_32x32x16_bf16 v[208:223], a[8:11], v[120:123], v[208:223]
    v_exp_f32 v23, v23
    v_cvt_pk_bf16_f32 v114, v20, v21
    v_exp_f32 v24, v24
    v_exp_f32 v25, v25
    v_cvt_pk_bf16_f32 v115, v22, v23
    v_mfma_f32_32x32x16_bf16 v[208:223], a[12:15], v[124:127], v[208:223]
    s_addc_u32 s63, s63, 0
    v_exp_f32 v26, v26
    v_exp_f32 v27, v27
    v_cvt_pk_bf16_f32 v116, v24, v25
    v_exp_f32 v28, v28
    v_cvt_pk_bf16_f32 v117, v26, v27
    v_smfmac_f32_16x16x64_bf16 v[180:183], v[152:155], v[120:127], v156
    s_waitcnt vmcnt(8)
    v_exp_f32 v29, v29
    v_exp_f32 v30, v30
    v_exp_f32 v31, v31
    v_cvt_pk_bf16_f32 v118, v28, v29
    v_cvt_pk_bf16_f32 v119, v30, v31
    v_mfma_f32_32x32x16_bf16 v[16:31], a[16:19], v[0:3], v[48:63]
    s_lshl_b32 s57, s63, 14
    v_exp_f32 v32, v32
    v_exp_f32 v33, v33
    v_exp_f32 v34, v34
    v_exp_f32 v35, v35
    v_mfma_f32_32x32x16_bf16 v[16:31], a[20:23], v[4:7], v[16:31]
    v_exp_f32 v36, v36
    v_cvt_pk_bf16_f32 v120, v32, v33
    v_exp_f32 v37, v37
    v_cvt_pk_bf16_f32 v121, v34, v35
    v_exp_f32 v38, v38
    v_mfma_f32_32x32x16_bf16 a[128:143], a[8:11], v[112:115], a[128:143]
    s_add_u32 s57, s57, s52
    v_exp_f32 v39, v39
    v_cvt_pk_bf16_f32 v122, v36, v37
    v_exp_f32 v40, v40
    v_exp_f32 v41, v41
    v_cvt_pk_bf16_f32 v123, v38, v39
    v_mfma_f32_32x32x16_bf16 a[128:143], a[12:15], v[116:119], a[128:143]
    v_exp_f32 v42, v42
    v_exp_f32 v43, v43
    v_cvt_pk_bf16_f32 v124, v40, v41
    v_exp_f32 v44, v44
    v_cvt_pk_bf16_f32 v125, v42, v43
    v_smfmac_f32_16x16x64_bf16 v[184:187], v[152:155], v[112:119], v156
    buffer_load_dwordx4 a[184:187], v233, s[24:27], s57 offen offset:0 sc1
    buffer_load_dwordx4 a[188:191], v233, s[24:27], s57 offen offset:1024 sc1
    buffer_load_dwordx4 a[192:195], v233, s[24:27], s57 offen offset:2048 sc1
    buffer_load_dwordx4 a[196:199], v233, s[24:27], s57 offen offset:3072 sc1
    global_load_dword v238, v[252:253], off
    v_exp_f32 v45, v45
    v_exp_f32 v46, v46
    v_exp_f32 v47, v47
    v_cvt_pk_bf16_f32 v126, v44, v45
    v_cvt_pk_bf16_f32 v127, v46, v47
    v_mfma_f32_32x32x16_bf16 v[32:47], a[16:19], v[8:11], v[64:79]
    s_add_u32 s57, s57, 4096
    v_exp_f32 v16, v16
    v_exp_f32 v17, v17
    v_exp_f32 v18, v18
    v_exp_f32 v19, v19
    v_mfma_f32_32x32x16_bf16 v[32:47], a[20:23], v[12:15], v[32:47]
    v_exp_f32 v20, v20
    v_cvt_pk_bf16_f32 v112, v16, v17
    v_exp_f32 v21, v21
    v_cvt_pk_bf16_f32 v113, v18, v19
    v_exp_f32 v22, v22
    v_mfma_f32_32x32x16_bf16 a[144:159], a[8:11], v[120:123], a[144:159]
    v_exp_f32 v23, v23
    v_cvt_pk_bf16_f32 v114, v20, v21
    v_exp_f32 v24, v24
    v_exp_f32 v25, v25
    v_cvt_pk_bf16_f32 v115, v22, v23
    v_mfma_f32_32x32x16_bf16 a[144:159], a[12:15], v[124:127], a[144:159]
    v_exp_f32 v26, v26
    v_exp_f32 v27, v27
    v_cvt_pk_bf16_f32 v116, v24, v25
    v_exp_f32 v28, v28
    v_cvt_pk_bf16_f32 v117, v26, v27
    v_smfmac_f32_16x16x64_bf16 v[188:191], v[152:155], v[120:127], v156
    v_exp_f32 v29, v29
    v_exp_f32 v30, v30
    v_exp_f32 v31, v31
    v_cvt_pk_bf16_f32 v118, v28, v29
    v_cvt_pk_bf16_f32 v119, v30, v31
    v_mfma_f32_32x32x16_bf16 v[16:31], a[16:19], a[112:115], v[80:95]
    v_exp_f32 v32, v32
    v_exp_f32 v33, v33
    v_exp_f32 v34, v34
    v_exp_f32 v35, v35
    v_mfma_f32_32x32x16_bf16 v[16:31], a[20:23], a[116:119], v[16:31]
    v_exp_f32 v36, v36
    v_cvt_pk_bf16_f32 v120, v32, v33
    v_exp_f32 v37, v37
    v_cvt_pk_bf16_f32 v121, v34, v35
    v_exp_f32 v38, v38
    v_mfma_f32_32x32x16_bf16 v[192:207], a[24:27], v[112:115], v[192:207]
    v_exp_f32 v39, v39
    v_cvt_pk_bf16_f32 v122, v36, v37
    v_exp_f32 v40, v40
    v_exp_f32 v41, v41
    v_cvt_pk_bf16_f32 v123, v38, v39
    v_mfma_f32_32x32x16_bf16 v[192:207], a[28:31], v[116:119], v[192:207]
    v_exp_f32 v42, v42
    v_exp_f32 v43, v43
    v_cvt_pk_bf16_f32 v124, v40, v41
    v_exp_f32 v44, v44
    v_cvt_pk_bf16_f32 v125, v42, v43
    v_smfmac_f32_16x16x64_bf16 v[176:179], v[152:155], v[112:119], v156
    buffer_load_dwordx4 a[200:203], v233, s[24:27], s57 offen offset:0 sc1
    buffer_load_dwordx4 a[204:207], v233, s[24:27], s57 offen offset:1024 sc1
    buffer_load_dwordx4 a[208:211], v233, s[24:27], s57 offen offset:2048 sc1
    buffer_load_dwordx4 a[212:215], v233, s[24:27], s57 offen offset:3072 sc1
    v_exp_f32 v45, v45
    v_exp_f32 v46, v46
    v_exp_f32 v47, v47
    v_cvt_pk_bf16_f32 v126, v44, v45
    v_cvt_pk_bf16_f32 v127, v46, v47
    v_mfma_f32_32x32x16_bf16 v[32:47], a[16:19], a[120:123], v[96:111]
    s_add_u32 s63, s63, 1
    v_exp_f32 v16, v16
    v_exp_f32 v17, v17
    v_exp_f32 v18, v18
    v_exp_f32 v19, v19
    v_mfma_f32_32x32x16_bf16 v[32:47], a[20:23], a[124:127], v[32:47]
    s_cmp_eq_u32 s63, s46
    v_exp_f32 v20, v20
    v_cvt_pk_bf16_f32 v112, v16, v17
    v_exp_f32 v21, v21
    v_cvt_pk_bf16_f32 v113, v18, v19
    v_exp_f32 v22, v22
    v_mfma_f32_32x32x16_bf16 v[208:223], a[24:27], v[120:123], v[208:223]
    v_exp_f32 v23, v23
    v_cvt_pk_bf16_f32 v114, v20, v21
    v_exp_f32 v24, v24
    v_exp_f32 v25, v25
    v_cvt_pk_bf16_f32 v115, v22, v23
    v_mfma_f32_32x32x16_bf16 v[208:223], a[28:31], v[124:127], v[208:223]
    s_addc_u32 s63, s63, 0
    v_exp_f32 v26, v26
    v_exp_f32 v27, v27
    v_cvt_pk_bf16_f32 v116, v24, v25
    v_exp_f32 v28, v28
    v_cvt_pk_bf16_f32 v117, v26, v27
    v_smfmac_f32_16x16x64_bf16 v[180:183], v[152:155], v[120:127], v156
    s_waitcnt vmcnt(13)
    v_exp_f32 v29, v29
    v_exp_f32 v30, v30
    v_exp_f32 v31, v31
    v_cvt_pk_bf16_f32 v118, v28, v29
    v_cvt_pk_bf16_f32 v119, v30, v31
    v_mfma_f32_32x32x16_bf16 v[16:31], a[32:35], v[0:3], v[48:63]
    s_lshl_b32 s57, s63, 14
    v_exp_f32 v32, v32
    v_exp_f32 v33, v33
    v_exp_f32 v34, v34
    v_exp_f32 v35, v35
    v_mfma_f32_32x32x16_bf16 v[16:31], a[36:39], v[4:7], v[16:31]
    v_exp_f32 v36, v36
    v_cvt_pk_bf16_f32 v120, v32, v33
    v_exp_f32 v37, v37
    v_cvt_pk_bf16_f32 v121, v34, v35
    v_exp_f32 v38, v38
    v_mfma_f32_32x32x16_bf16 a[128:143], a[24:27], v[112:115], a[128:143]
    s_add_u32 s57, s57, s52
    v_exp_f32 v39, v39
    v_cvt_pk_bf16_f32 v122, v36, v37
    v_exp_f32 v40, v40
    v_exp_f32 v41, v41
    v_cvt_pk_bf16_f32 v123, v38, v39
    v_mfma_f32_32x32x16_bf16 a[128:143], a[28:31], v[116:119], a[128:143]
    v_exp_f32 v42, v42
    v_exp_f32 v43, v43
    v_cvt_pk_bf16_f32 v124, v40, v41
    v_exp_f32 v44, v44
    v_cvt_pk_bf16_f32 v125, v42, v43
    v_smfmac_f32_16x16x64_bf16 v[184:187], v[152:155], v[112:119], v156
    buffer_load_dwordx4 a[0:3], v233, s[24:27], s57 offen offset:0 sc1
    buffer_load_dwordx4 a[4:7], v233, s[24:27], s57 offen offset:1024 sc1
    buffer_load_dwordx4 a[8:11], v233, s[24:27], s57 offen offset:2048 sc1
L_stub_4:
    s_cbranch_execz L_stub_7
    buffer_load_dwordx4 a[12:15], v233, s[24:27], s57 offen offset:3072 sc1
    v_exp_f32 v45, v45
    v_exp_f32 v46, v46
    v_exp_f32 v47, v47
    v_cvt_pk_bf16_f32 v126, v44, v45
    v_cvt_pk_bf16_f32 v127, v46, v47
    v_mfma_f32_32x32x16_bf16 v[32:47], a[32:35], v[8:11], v[64:79]
    s_lshl_b32 s62, s2, 2
    v_exp_f32 v16, v16
    v_exp_f32 v17, v17
    v_exp_f32 v18, v18
    v_exp_f32 v19, v19
    v_mfma_f32_32x32x16_bf16 v[32:47], a[36:39], v[12:15], v[32:47]
    s_add_u32 s62, s62, s3
    v_exp_f32 v20, v20
    v_cvt_pk_bf16_f32 v112, v16, v17
    v_exp_f32 v21, v21
    v_cvt_pk_bf16_f32 v113, v18, v19
    v_exp_f32 v22, v22
    v_mfma_f32_32x32x16_bf16 a[144:159], a[24:27], v[120:123], a[144:159]
    s_lshl_b32 s62, s62, 11
    v_exp_f32 v23, v23
    v_cvt_pk_bf16_f32 v114, v20, v21
    v_exp_f32 v24, v24
    v_exp_f32 v25, v25
    v_cvt_pk_bf16_f32 v115, v22, v23
    v_mfma_f32_32x32x16_bf16 a[144:159], a[28:31], v[124:127], a[144:159]
    v_exp_f32 v26, v26
    v_exp_f32 v27, v27
    v_cvt_pk_bf16_f32 v116, v24, v25
    v_exp_f32 v28, v28
    v_cvt_pk_bf16_f32 v117, v26, v27
    v_smfmac_f32_16x16x64_bf16 v[188:191], v[152:155], v[120:127], v156
    buffer_load_dword v238, v234, s[80:83], s62 offen
    v_exp_f32 v29, v29
    v_exp_f32 v30, v30
    v_exp_f32 v31, v31
    v_cvt_pk_bf16_f32 v118, v28, v29
    v_cvt_pk_bf16_f32 v119, v30, v31
    v_mfma_f32_32x32x16_bf16 v[16:31], a[32:35], a[112:115], v[80:95]
    s_add_u32 s57, s57, 4096
    v_exp_f32 v32, v32
    v_exp_f32 v33, v33
    v_exp_f32 v34, v34
    v_exp_f32 v35, v35
    v_mfma_f32_32x32x16_bf16 v[16:31], a[36:39], a[116:119], v[16:31]
    v_exp_f32 v36, v36
    v_cvt_pk_bf16_f32 v120, v32, v33
    v_exp_f32 v37, v37
    v_cvt_pk_bf16_f32 v121, v34, v35
    v_exp_f32 v38, v38
    v_mfma_f32_32x32x16_bf16 v[192:207], a[40:43], v[112:115], v[192:207]
    v_exp_f32 v39, v39
    v_cvt_pk_bf16_f32 v122, v36, v37
    v_exp_f32 v40, v40
    v_exp_f32 v41, v41
    v_cvt_pk_bf16_f32 v123, v38, v39
    v_mfma_f32_32x32x16_bf16 v[192:207], a[44:47], v[116:119], v[192:207]
    v_exp_f32 v42, v42
    v_exp_f32 v43, v43
    v_cvt_pk_bf16_f32 v124, v40, v41
    v_exp_f32 v44, v44
    v_cvt_pk_bf16_f32 v125, v42, v43
    v_smfmac_f32_16x16x64_bf16 v[176:179], v[152:155], v[112:119], v156
    buffer_load_dwordx4 a[16:19], v233, s[24:27], s57 offen offset:0 sc1
    buffer_load_dwordx4 a[20:23], v233, s[24:27], s57 offen offset:1024 sc1
    buffer_load_dwordx4 a[24:27], v233, s[24:27], s57 offen offset:2048 sc1
    buffer_load_dwordx4 a[28:31], v233, s[24:27], s57 offen offset:3072 sc1
    v_exp_f32 v45, v45
    v_exp_f32 v46, v46
    v_exp_f32 v47, v47
    v_cvt_pk_bf16_f32 v126, v44, v45
    v_cvt_pk_bf16_f32 v127, v46, v47
    v_mfma_f32_32x32x16_bf16 v[32:47], a[32:35], a[120:123], v[96:111]
    s_add_u32 s63, s63, 1
    v_exp_f32 v16, v16
    v_exp_f32 v17, v17
    v_exp_f32 v18, v18
    v_exp_f32 v19, v19
    v_mfma_f32_32x32x16_bf16 v[32:47], a[36:39], a[124:127], v[32:47]
    s_cmp_eq_u32 s63, s46
    v_exp_f32 v20, v20
    v_cvt_pk_bf16_f32 v112, v16, v17
    v_exp_f32 v21, v21
    v_cvt_pk_bf16_f32 v113, v18, v19
    v_exp_f32 v22, v22
    v_mfma_f32_32x32x16_bf16 v[208:223], a[40:43], v[120:123], v[208:223]
    v_exp_f32 v23, v23
    v_cvt_pk_bf16_f32 v114, v20, v21
    v_exp_f32 v24, v24
    v_exp_f32 v25, v25
    v_cvt_pk_bf16_f32 v115, v22, v23
    v_mfma_f32_32x32x16_bf16 v[208:223], a[44:47], v[124:127], v[208:223]
    s_addc_u32 s63, s63, 0
    v_exp_f32 v26, v26
    v_exp_f32 v27, v27
    v_cvt_pk_bf16_f32 v116, v24, v25
    v_exp_f32 v28, v28
    v_cvt_pk_bf16_f32 v117, v26, v27
    v_smfmac_f32_16x16x64_bf16 v[180:183], v[152:155], v[120:127], v156
    s_waitcnt vmcnt(18)
    v_exp_f32 v29, v29
    v_exp_f32 v30, v30
    v_exp_f32 v31, v31
    v_cvt_pk_bf16_f32 v118, v28, v29
    v_cvt_pk_bf16_f32 v119, v30, v31
    v_mfma_f32_32x32x16_bf16 v[16:31], a[48:51], v[0:3], v[48:63]
    v_exp_f32 v32, v32
    v_exp_f32 v33, v33
    v_exp_f32 v34, v34
    v_exp_f32 v35, v35
    v_mfma_f32_32x32x16_bf16 v[16:31], a[52:55], v[4:7], v[16:31]
    s_lshl_b32 s57, s63, 14
    v_exp_f32 v36, v36
    v_cvt_pk_bf16_f32 v120, v32, v33
    v_exp_f32 v37, v37
    v_cvt_pk_bf16_f32 v121, v34, v35
    v_exp_f32 v38, v38
    v_mfma_f32_32x32x16_bf16 a[128:143], a[40:43], v[112:115], a[128:143]
    s_add_u32 s57, s57, s52
    v_exp_f32 v39, v39
    v_cvt_pk_bf16_f32 v122, v36, v37
    v_exp_f32 v40, v40
    v_exp_f32 v41, v41
    v_cvt_pk_bf16_f32 v123, v38, v39
    v_mfma_f32_32x32x16_bf16 a[128:143], a[44:47], v[116:119], a[128:143]
    v_exp_f32 v42, v42
    v_exp_f32 v43, v43
    v_cvt_pk_bf16_f32 v124, v40, v41
    v_exp_f32 v44, v44
    v_cvt_pk_bf16_f32 v125, v42, v43
    v_smfmac_f32_16x16x64_bf16 v[184:187], v[152:155], v[112:119], v156
    v_exp_f32 v45, v45
    v_exp_f32 v46, v46
    v_exp_f32 v47, v47
    v_cvt_pk_bf16_f32 v126, v44, v45
    v_cvt_pk_bf16_f32 v127, v46, v47
    v_mfma_f32_32x32x16_bf16 v[32:47], a[48:51], v[8:11], v[64:79]
    s_add_u32 s58, s101, 229376
    v_exp_f32 v16, v16
    v_exp_f32 v17, v17
    v_exp_f32 v18, v18
    v_exp_f32 v19, v19
    v_mfma_f32_32x32x16_bf16 v[32:47], a[52:55], v[12:15], v[32:47]
    v_exp_f32 v20, v20
    v_cvt_pk_bf16_f32 v112, v16, v17
    v_exp_f32 v21, v21
    v_cvt_pk_bf16_f32 v113, v18, v19
    v_exp_f32 v22, v22
    v_mfma_f32_32x32x16_bf16 a[144:159], a[40:43], v[120:123], a[144:159]
    s_add_u32 m0, s73, 16384
    v_exp_f32 v23, v23
    v_cvt_pk_bf16_f32 v114, v20, v21
    v_exp_f32 v24, v24
    v_exp_f32 v25, v25
    v_cvt_pk_bf16_f32 v115, v22, v23
    v_mfma_f32_32x32x16_bf16 a[144:159], a[44:47], v[124:127], a[144:159]
    v_exp_f32 v26, v26
    v_exp_f32 v27, v27
    v_cvt_pk_bf16_f32 v116, v24, v25
    v_exp_f32 v28, v28
    v_cvt_pk_bf16_f32 v117, v26, v27
    v_smfmac_f32_16x16x64_bf16 v[188:191], v[152:155], v[120:127], v156
    buffer_load_dwordx4 a[32:35], v233, s[24:27], s57 offen offset:0 sc1
    buffer_load_dwordx4 a[36:39], v233, s[24:27], s57 offen offset:1024 sc1
    buffer_load_dwordx4 a[40:43], v233, s[24:27], s57 offen offset:2048 sc1
    buffer_load_dwordx4 a[44:47], v233, s[24:27], s57 offen offset:3072 sc1
    buffer_load_dwordx4 v168, s[36:39], s58 offen offset:0 lds
    buffer_load_dwordx4 v169, s[36:39], s58 offen offset:1024 lds
    v_exp_f32 v29, v29
    v_exp_f32 v30, v30
    v_exp_f32 v31, v31
    v_cvt_pk_bf16_f32 v118, v28, v29
    v_cvt_pk_bf16_f32 v119, v30, v31
    v_mfma_f32_32x32x16_bf16 v[16:31], a[48:51], a[112:115], v[80:95]
    s_add_u32 s57, s57, 4096
    v_exp_f32 v32, v32
    v_exp_f32 v33, v33
    v_exp_f32 v34, v34
    v_exp_f32 v35, v35
    v_mfma_f32_32x32x16_bf16 v[16:31], a[52:55], a[116:119], v[16:31]
    v_exp_f32 v36, v36
    v_cvt_pk_bf16_f32 v120, v32, v33
    v_exp_f32 v37, v37
    v_cvt_pk_bf16_f32 v121, v34, v35
    v_exp_f32 v38, v38
    v_mfma_f32_32x32x16_bf16 v[192:207], a[56:59], v[112:115], v[192:207]
    v_exp_f32 v39, v39
    v_cvt_pk_bf16_f32 v122, v36, v37
    v_exp_f32 v40, v40
    v_exp_f32 v41, v41
    v_cvt_pk_bf16_f32 v123, v38, v39
    v_mfma_f32_32x32x16_bf16 v[192:207], a[60:63], v[116:119], v[192:207]
    v_exp_f32 v42, v42
    v_exp_f32 v43, v43
    v_cvt_pk_bf16_f32 v124, v40, v41
    v_exp_f32 v44, v44
    v_cvt_pk_bf16_f32 v125, v42, v43
    v_smfmac_f32_16x16x64_bf16 v[176:179], v[152:155], v[112:119], v156
    v_exp_f32 v45, v45
    v_exp_f32 v46, v46
    v_exp_f32 v47, v47
    v_cvt_pk_bf16_f32 v126, v44, v45
    v_cvt_pk_bf16_f32 v127, v46, v47
    v_mfma_f32_32x32x16_bf16 v[32:47], a[48:51], a[120:123], v[96:111]
    v_exp_f32 v16, v16
    v_exp_f32 v17, v17
    v_exp_f32 v18, v18
    v_exp_f32 v19, v19
    v_mfma_f32_32x32x16_bf16 v[32:47], a[52:55], a[124:127], v[32:47]
    s_add_u32 s66, s74, 0
    v_exp_f32 v20, v20
    v_cvt_pk_bf16_f32 v112, v16, v17
    v_exp_f32 v21, v21
    v_cvt_pk_bf16_f32 v113, v18, v19
    v_exp_f32 v22, v22
    v_mfma_f32_32x32x16_bf16 v[208:223], a[56:59], v[120:123], v[208:223]
    v_exp_f32 v23, v23
    v_cvt_pk_bf16_f32 v114, v20, v21
    v_exp_f32 v24, v24
    v_exp_f32 v25, v25
    v_cvt_pk_bf16_f32 v115, v22, v23
    v_mfma_f32_32x32x16_bf16 v[208:223], a[60:63], v[124:127], v[208:223]
    v_exp_f32 v26, v26
    v_exp_f32 v27, v27
    v_cvt_pk_bf16_f32 v116, v24, v25
    v_exp_f32 v28, v28
    v_cvt_pk_bf16_f32 v117, v26, v27
    v_smfmac_f32_16x16x64_bf16 v[180:183], v[152:155], v[120:127], v156
    s_waitcnt vmcnt(20)
    v_exp_f32 v29, v29
    v_exp_f32 v30, v30
    v_exp_f32 v31, v31
    v_cvt_pk_bf16_f32 v118, v28, v29
    v_cvt_pk_bf16_f32 v119, v30, v31
    v_mfma_f32_32x32x16_bf16 v[16:31], a[184:187], v[0:3], v[48:63]
    v_exp_f32 v32, v32
    v_exp_f32 v33, v33
    v_exp_f32 v34, v34
    v_exp_f32 v35, v35
    v_mfma_f32_32x32x16_bf16 v[16:31], a[188:191], v[4:7], v[16:31]
    v_exp_f32 v36, v36
    v_cvt_pk_bf16_f32 v120, v32, v33
    v_exp_f32 v37, v37
    v_cvt_pk_bf16_f32 v121, v34, v35
    v_exp_f32 v38, v38
    v_mfma_f32_32x32x16_bf16 a[128:143], a[56:59], v[112:115], a[128:143]
    s_add_u32 m0, s55, 131072
    v_exp_f32 v39, v39
    v_cvt_pk_bf16_f32 v122, v36, v37
    v_exp_f32 v40, v40
    v_exp_f32 v41, v41
    v_cvt_pk_bf16_f32 v123, v38, v39
    v_mfma_f32_32x32x16_bf16 a[128:143], a[60:63], v[116:119], a[128:143]
    v_exp_f32 v42, v42
    v_exp_f32 v43, v43
    v_cvt_pk_bf16_f32 v124, v40, v41
    v_exp_f32 v44, v44
    v_cvt_pk_bf16_f32 v125, v42, v43
    v_smfmac_f32_16x16x64_bf16 v[184:187], v[152:155], v[112:119], v156
    v_exp_f32 v45, v45
    v_exp_f32 v46, v46
    v_exp_f32 v47, v47
    v_cvt_pk_bf16_f32 v126, v44, v45
    v_cvt_pk_bf16_f32 v127, v46, v47
    v_mfma_f32_32x32x16_bf16 v[32:47], a[184:187], v[8:11], v[64:79]
    v_exp_f32 v16, v16
    v_exp_f32 v17, v17
    v_exp_f32 v18, v18
    v_exp_f32 v19, v19
    v_mfma_f32_32x32x16_bf16 v[32:47], a[188:191], v[12:15], v[32:47]
    v_exp_f32 v20, v20
    v_cvt_pk_bf16_f32 v112, v16, v17
    v_exp_f32 v21, v21
    v_cvt_pk_bf16_f32 v113, v18, v19
    v_exp_f32 v22, v22
    v_mfma_f32_32x32x16_bf16 a[144:159], a[56:59], v[120:123], a[144:159]
    v_exp_f32 v23, v23
    v_cvt_pk_bf16_f32 v114, v20, v21
    v_exp_f32 v24, v24
    v_exp_f32 v25, v25
    v_cvt_pk_bf16_f32 v115, v22, v23
    v_mfma_f32_32x32x16_bf16 a[144:159], a[60:63], v[124:127], a[144:159]
    v_exp_f32 v26, v26
    v_exp_f32 v27, v27
    v_cvt_pk_bf16_f32 v116, v24, v25
    v_exp_f32 v28, v28
    v_cvt_pk_bf16_f32 v117, v26, v27
    v_smfmac_f32_16x16x64_bf16 v[188:191], v[152:155], v[120:127], v156
    buffer_load_dwordx4 a[48:51], v233, s[24:27], s57 offen offset:0 sc1
    buffer_load_dwordx4 a[52:55], v233, s[24:27], s57 offen offset:1024 sc1
    buffer_load_dwordx4 a[56:59], v233, s[24:27], s57 offen offset:2048 sc1
    buffer_load_dwordx4 a[60:63], v233, s[24:27], s57 offen offset:3072 sc1
    buffer_load_dwordx4 v161, s[84:87], s66 offen lds
    buffer_load_dwordx4 v239, s[84:87], s66 offen offset:1024 lds
    v_exp_f32 v29, v29
    v_exp_f32 v30, v30
    v_exp_f32 v31, v31
    v_cvt_pk_bf16_f32 v118, v28, v29
    v_cvt_pk_bf16_f32 v119, v30, v31
    v_mfma_f32_32x32x16_bf16 v[16:31], a[184:187], a[112:115], v[80:95]
    s_add_u32 s63, s63, 1
    v_exp_f32 v32, v32
    v_exp_f32 v33, v33
    v_exp_f32 v34, v34
    v_exp_f32 v35, v35
    v_mfma_f32_32x32x16_bf16 v[16:31], a[188:191], a[116:119], v[16:31]
    v_exp_f32 v36, v36
    v_cvt_pk_bf16_f32 v120, v32, v33
    v_exp_f32 v37, v37
    v_cvt_pk_bf16_f32 v121, v34, v35
    v_exp_f32 v38, v38
    v_mfma_f32_32x32x16_bf16 v[192:207], a[192:195], v[112:115], v[192:207]
    s_cmp_eq_u32 s63, s46
    v_exp_f32 v39, v39
    v_cvt_pk_bf16_f32 v122, v36, v37
    v_exp_f32 v40, v40
    v_exp_f32 v41, v41
    v_cvt_pk_bf16_f32 v123, v38, v39
    v_mfma_f32_32x32x16_bf16 v[192:207], a[196:199], v[116:119], v[192:207]
    v_exp_f32 v42, v42
    v_exp_f32 v43, v43
    v_cvt_pk_bf16_f32 v124, v40, v41
    v_exp_f32 v44, v44
    v_cvt_pk_bf16_f32 v125, v42, v43
    v_smfmac_f32_16x16x64_bf16 v[176:179], v[152:155], v[112:119], v156
    v_exp_f32 v45, v45
    v_exp_f32 v46, v46
    v_exp_f32 v47, v47
    v_cvt_pk_bf16_f32 v126, v44, v45
    v_cvt_pk_bf16_f32 v127, v46, v47
    v_mfma_f32_32x32x16_bf16 v[32:47], a[184:187], a[120:123], v[96:111]
    s_addc_u32 s63, s63, 0
    v_exp_f32 v16, v16
    v_exp_f32 v17, v17
    v_exp_f32 v18, v18
    v_exp_f32 v19, v19
    v_mfma_f32_32x32x16_bf16 v[32:47], a[188:191], a[124:127], v[32:47]
    v_exp_f32 v20, v20
    v_cvt_pk_bf16_f32 v112, v16, v17
    v_exp_f32 v21, v21
    v_cvt_pk_bf16_f32 v113, v18, v19
    v_exp_f32 v22, v22
    v_mfma_f32_32x32x16_bf16 v[208:223], a[192:195], v[120:123], v[208:223]
    s_lshl_b32 s57, s63, 14
    v_exp_f32 v23, v23
    v_cvt_pk_bf16_f32 v114, v20, v21
    v_exp_f32 v24, v24
    v_exp_f32 v25, v25
    v_cvt_pk_bf16_f32 v115, v22, v23
    v_mfma_f32_32x32x16_bf16 v[208:223], a[196:199], v[124:127], v[208:223]
    v_exp_f32 v26, v26
    v_exp_f32 v27, v27
    v_cvt_pk_bf16_f32 v116, v24, v25
    v_exp_f32 v28, v28
    v_cvt_pk_bf16_f32 v117, v26, v27
    v_smfmac_f32_16x16x64_bf16 v[180:183], v[152:155], v[120:127], v156
    s_waitcnt vmcnt(21)
    v_exp_f32 v29, v29
    v_exp_f32 v30, v30
    v_exp_f32 v31, v31
    v_cvt_pk_bf16_f32 v118, v28, v29
    v_cvt_pk_bf16_f32 v119, v30, v31
    v_mfma_f32_32x32x16_bf16 v[16:31], a[200:203], v[0:3], v[48:63]
    v_exp_f32 v32, v32
    v_exp_f32 v33, v33
    v_exp_f32 v34, v34
    v_exp_f32 v35, v35
    v_mfma_f32_32x32x16_bf16 v[16:31], a[204:207], v[4:7], v[16:31]
    s_add_u32 s57, s57, s52
    v_exp_f32 v36, v36
    v_cvt_pk_bf16_f32 v120, v32, v33
    v_exp_f32 v37, v37
    v_cvt_pk_bf16_f32 v121, v34, v35
    v_exp_f32 v38, v38
    v_mfma_f32_32x32x16_bf16 a[128:143], a[192:195], v[112:115], a[128:143]
    v_exp_f32 v39, v39
    v_cvt_pk_bf16_f32 v122, v36, v37
    v_exp_f32 v40, v40
    v_exp_f32 v41, v41
    v_cvt_pk_bf16_f32 v123, v38, v39
    v_mfma_f32_32x32x16_bf16 a[128:143], a[196:199], v[116:119], a[128:143]
    s_add_u32 s68, s72, 0
    v_exp_f32 v42, v42
    v_exp_f32 v43, v43
    v_cvt_pk_bf16_f32 v124, v40, v41
    v_exp_f32 v44, v44
    v_cvt_pk_bf16_f32 v125, v42, v43
    v_smfmac_f32_16x16x64_bf16 v[184:187], v[152:155], v[112:119], v156
    v_exp_f32 v45, v45
    v_exp_f32 v46, v46
    v_exp_f32 v47, v47
    v_cvt_pk_bf16_f32 v126, v44, v45
    v_cvt_pk_bf16_f32 v127, v46, v47
    v_mfma_f32_32x32x16_bf16 v[32:47], a[200:203], v[8:11], v[64:79]
    v_exp_f32 v16, v16
    v_exp_f32 v17, v17
    v_exp_f32 v18, v18
    v_exp_f32 v19, v19
    v_mfma_f32_32x32x16_bf16 v[32:47], a[204:207], v[12:15], v[32:47]
    s_add_u32 m0, s73, 0
    v_exp_f32 v20, v20
    v_cvt_pk_bf16_f32 v112, v16, v17
    v_exp_f32 v21, v21
    v_cvt_pk_bf16_f32 v113, v18, v19
    v_exp_f32 v22, v22
    v_mfma_f32_32x32x16_bf16 a[144:159], a[192:195], v[120:123], a[144:159]
    v_exp_f32 v23, v23
    v_cvt_pk_bf16_f32 v114, v20, v21
    v_exp_f32 v24, v24
    v_exp_f32 v25, v25
    v_cvt_pk_bf16_f32 v115, v22, v23
    v_mfma_f32_32x32x16_bf16 a[144:159], a[196:199], v[124:127], a[144:159]
    v_exp_f32 v26, v26
    v_exp_f32 v27, v27
    v_cvt_pk_bf16_f32 v116, v24, v25
    v_exp_f32 v28, v28
    v_cvt_pk_bf16_f32 v117, v26, v27
    v_smfmac_f32_16x16x64_bf16 v[188:191], v[152:155], v[120:127], v156
    buffer_load_dwordx4 a[184:187], v233, s[24:27], s57 offen offset:0 sc1
    buffer_load_dwordx4 a[188:191], v233, s[24:27], s57 offen offset:1024 sc1
    buffer_load_dwordx4 a[192:195], v233, s[24:27], s57 offen offset:2048 sc1
    buffer_load_dwordx4 v161, s[80:83], s68 offen lds
    buffer_load_dwordx4 v239, s[80:83], s68 offen offset:1024 lds
    s_add_u32 m0, s73, 16384
    buffer_load_dwordx4 a[196:199], v233, s[24:27], s57 offen offset:3072 sc1
    buffer_load_dwordx4 v170, s[36:39], s58 offen offset:2048 lds
    buffer_load_dwordx4 v171, s[36:39], s58 offen offset:3072 lds
    v_exp_f32 v29, v29
    v_exp_f32 v30, v30
    v_exp_f32 v31, v31
    v_cvt_pk_bf16_f32 v118, v28, v29
    v_cvt_pk_bf16_f32 v119, v30, v31
    v_mfma_f32_32x32x16_bf16 v[16:31], a[200:203], a[112:115], v[80:95]
    s_add_u32 s57, s57, 4096
    v_exp_f32 v32, v32
    v_exp_f32 v33, v33
    v_exp_f32 v34, v34
    v_exp_f32 v35, v35
    v_mfma_f32_32x32x16_bf16 v[16:31], a[204:207], a[116:119], v[16:31]
    v_exp_f32 v36, v36
    v_cvt_pk_bf16_f32 v120, v32, v33
    v_exp_f32 v37, v37
    v_cvt_pk_bf16_f32 v121, v34, v35
    v_exp_f32 v38, v38
    v_mfma_f32_32x32x16_bf16 v[192:207], a[208:211], v[112:115], v[192:207]
    v_exp_f32 v39, v39
    v_cvt_pk_bf16_f32 v122, v36, v37
    v_exp_f32 v40, v40
    v_exp_f32 v41, v41
    v_cvt_pk_bf16_f32 v123, v38, v39
    v_mfma_f32_32x32x16_bf16 v[192:207], a[212:215], v[116:119], v[192:207]
    v_exp_f32 v42, v42
    v_exp_f32 v43, v43
    v_cvt_pk_bf16_f32 v124, v40, v41
    v_exp_f32 v44, v44
    v_cvt_pk_bf16_f32 v125, v42, v43
    v_smfmac_f32_16x16x64_bf16 v[176:179], v[152:155], v[112:119], v156
    v_exp_f32 v45, v45
    v_exp_f32 v46, v46
    v_exp_f32 v47, v47
    v_cvt_pk_bf16_f32 v126, v44, v45
    v_cvt_pk_bf16_f32 v127, v46, v47
    v_mfma_f32_32x32x16_bf16 v[32:47], a[200:203], a[120:123], v[96:111]
    v_exp_f32 v16, v16
    v_exp_f32 v17, v17
    v_exp_f32 v18, v18
    v_exp_f32 v19, v19
    v_mfma_f32_32x32x16_bf16 v[32:47], a[204:207], a[124:127], v[32:47]
    v_exp_f32 v20, v20
    v_cvt_pk_bf16_f32 v112, v16, v17
    v_exp_f32 v21, v21
    v_cvt_pk_bf16_f32 v113, v18, v19
    v_exp_f32 v22, v22
    v_mfma_f32_32x32x16_bf16 v[208:223], a[208:211], v[120:123], v[208:223]
    v_exp_f32 v23, v23
    v_cvt_pk_bf16_f32 v114, v20, v21
    v_exp_f32 v24, v24
    v_exp_f32 v25, v25
    v_cvt_pk_bf16_f32 v115, v22, v23
    v_mfma_f32_32x32x16_bf16 v[208:223], a[212:215], v[124:127], v[208:223]
    v_exp_f32 v26, v26
    v_exp_f32 v27, v27
    v_cvt_pk_bf16_f32 v116, v24, v25
    v_exp_f32 v28, v28
    v_cvt_pk_bf16_f32 v117, v26, v27
    v_smfmac_f32_16x16x64_bf16 v[180:183], v[152:155], v[120:127], v156
    s_waitcnt vmcnt(25)
    v_exp_f32 v29, v29
    v_exp_f32 v30, v30
    v_exp_f32 v31, v31
    v_cvt_pk_bf16_f32 v118, v28, v29
    v_cvt_pk_bf16_f32 v119, v30, v31
    v_mfma_f32_32x32x16_bf16 v[16:31], a[0:3], v[0:3], v[48:63]
    v_exp_f32 v32, v32
    v_exp_f32 v33, v33
    v_exp_f32 v34, v34
    v_exp_f32 v35, v35
    v_mfma_f32_32x32x16_bf16 v[16:31], a[4:7], v[4:7], v[16:31]
    v_exp_f32 v36, v36
    v_cvt_pk_bf16_f32 v120, v32, v33
    v_exp_f32 v37, v37
    v_cvt_pk_bf16_f32 v121, v34, v35
    v_exp_f32 v38, v38
    v_mfma_f32_32x32x16_bf16 a[128:143], a[208:211], v[112:115], a[128:143]
    v_exp_f32 v39, v39
    v_cvt_pk_bf16_f32 v122, v36, v37
    v_exp_f32 v40, v40
    v_exp_f32 v41, v41
    v_cvt_pk_bf16_f32 v123, v38, v39
    v_mfma_f32_32x32x16_bf16 a[128:143], a[212:215], v[116:119], a[128:143]
    v_exp_f32 v42, v42
    v_exp_f32 v43, v43
    v_cvt_pk_bf16_f32 v124, v40, v41
    v_exp_f32 v44, v44
    v_cvt_pk_bf16_f32 v125, v42, v43
    v_smfmac_f32_16x16x64_bf16 v[184:187], v[152:155], v[112:119], v156
    v_exp_f32 v45, v45
    v_exp_f32 v46, v46
    v_exp_f32 v47, v47
    v_cvt_pk_bf16_f32 v126, v44, v45
    v_cvt_pk_bf16_f32 v127, v46, v47
    v_mfma_f32_32x32x16_bf16 v[32:47], a[0:3], v[8:11], v[64:79]
    v_exp_f32 v16, v16
    v_exp_f32 v17, v17
    v_exp_f32 v18, v18
    v_exp_f32 v19, v19
    v_mfma_f32_32x32x16_bf16 v[32:47], a[4:7], v[12:15], v[32:47]
    v_exp_f32 v20, v20
    v_cvt_pk_bf16_f32 v112, v16, v17
    v_exp_f32 v21, v21
    v_cvt_pk_bf16_f32 v113, v18, v19
    v_exp_f32 v22, v22
    v_mfma_f32_32x32x16_bf16 a[144:159], a[208:211], v[120:123], a[144:159]
    v_exp_f32 v23, v23
    v_cvt_pk_bf16_f32 v114, v20, v21
    v_exp_f32 v24, v24
    v_exp_f32 v25, v25
    v_cvt_pk_bf16_f32 v115, v22, v23
    v_mfma_f32_32x32x16_bf16 a[144:159], a[212:215], v[124:127], a[144:159]
    v_exp_f32 v26, v26
    v_exp_f32 v27, v27
    v_cvt_pk_bf16_f32 v116, v24, v25
    v_exp_f32 v28, v28
    v_cvt_pk_bf16_f32 v117, v26, v27
    v_smfmac_f32_16x16x64_bf16 v[188:191], v[152:155], v[120:127], v156
    buffer_load_dwordx4 a[200:203], v233, s[24:27], s57 offen offset:0 sc1
    buffer_load_dwordx4 a[204:207], v233, s[24:27], s57 offen offset:1024 sc1
    buffer_load_dwordx4 a[208:211], v233, s[24:27], s57 offen offset:2048 sc1
    buffer_load_dwordx4 a[212:215], v233, s[24:27], s57 offen offset:3072 sc1
    v_exp_f32 v29, v29
    v_exp_f32 v30, v30
    v_exp_f32 v31, v31
    v_cvt_pk_bf16_f32 v118, v28, v29
    v_cvt_pk_bf16_f32 v119, v30, v31
    v_mfma_f32_32x32x16_bf16 v[16:31], a[0:3], a[112:115], v[80:95]
    s_add_u32 s63, s63, 1
    v_exp_f32 v32, v32
    v_exp_f32 v33, v33
    v_exp_f32 v34, v34
    v_exp_f32 v35, v35
    v_mfma_f32_32x32x16_bf16 v[16:31], a[4:7], a[116:119], v[16:31]
    v_exp_f32 v36, v36
    v_cvt_pk_bf16_f32 v120, v32, v33
    v_exp_f32 v37, v37
    v_cvt_pk_bf16_f32 v121, v34, v35
    v_exp_f32 v38, v38
    v_mfma_f32_32x32x16_bf16 v[192:207], a[8:11], v[112:115], v[192:207]
    s_cmp_eq_u32 s63, s46
    v_exp_f32 v39, v39
    v_cvt_pk_bf16_f32 v122, v36, v37
    v_exp_f32 v40, v40
    v_exp_f32 v41, v41
    v_cvt_pk_bf16_f32 v123, v38, v39
    v_mfma_f32_32x32x16_bf16 v[192:207], a[12:15], v[116:119], v[192:207]
    v_exp_f32 v42, v42
    v_exp_f32 v43, v43
    v_cvt_pk_bf16_f32 v124, v40, v41
    v_exp_f32 v44, v44
    v_cvt_pk_bf16_f32 v125, v42, v43
    v_smfmac_f32_16x16x64_bf16 v[176:179], v[152:155], v[112:119], v156
    v_exp_f32 v45, v45
    v_exp_f32 v46, v46
    v_exp_f32 v47, v47
    v_cvt_pk_bf16_f32 v126, v44, v45
    v_cvt_pk_bf16_f32 v127, v46, v47
    v_mfma_f32_32x32x16_bf16 v[32:47], a[0:3], a[120:123], v[96:111]
    s_addc_u32 s63, s63, 0
    v_exp_f32 v16, v16
    v_exp_f32 v17, v17
    v_exp_f32 v18, v18
    v_exp_f32 v19, v19
    v_mfma_f32_32x32x16_bf16 v[32:47], a[4:7], a[124:127], v[32:47]
    v_exp_f32 v20, v20
    v_cvt_pk_bf16_f32 v112, v16, v17
    v_exp_f32 v21, v21
    v_cvt_pk_bf16_f32 v113, v18, v19
    v_exp_f32 v22, v22
    v_mfma_f32_32x32x16_bf16 v[208:223], a[8:11], v[120:123], v[208:223]
    s_lshl_b32 s57, s63, 14
    v_exp_f32 v23, v23
    v_cvt_pk_bf16_f32 v114, v20, v21
    v_exp_f32 v24, v24
    v_exp_f32 v25, v25
    v_cvt_pk_bf16_f32 v115, v22, v23
    v_mfma_f32_32x32x16_bf16 v[208:223], a[12:15], v[124:127], v[208:223]
    v_exp_f32 v26, v26
    v_exp_f32 v27, v27
    v_cvt_pk_bf16_f32 v116, v24, v25
    v_exp_f32 v28, v28
    v_cvt_pk_bf16_f32 v117, v26, v27
    v_smfmac_f32_16x16x64_bf16 v[180:183], v[152:155], v[120:127], v156
    s_waitcnt vmcnt(24)
    v_exp_f32 v29, v29
    v_exp_f32 v30, v30
    v_exp_f32 v31, v31
    v_cvt_pk_bf16_f32 v118, v28, v29
    v_cvt_pk_bf16_f32 v119, v30, v31
    v_mfma_f32_32x32x16_bf16 v[16:31], a[16:19], v[0:3], v[48:63]
    v_exp_f32 v32, v32
    v_exp_f32 v33, v33
    v_exp_f32 v34, v34
    v_exp_f32 v35, v35
    v_mfma_f32_32x32x16_bf16 v[16:31], a[20:23], v[4:7], v[16:31]
    s_add_u32 s57, s57, s52
    v_exp_f32 v36, v36
    v_cvt_pk_bf16_f32 v120, v32, v33
    v_exp_f32 v37, v37
    v_cvt_pk_bf16_f32 v121, v34, v35
    v_exp_f32 v38, v38
    v_mfma_f32_32x32x16_bf16 a[128:143], a[8:11], v[112:115], a[128:143]
    v_exp_f32 v39, v39
    v_cvt_pk_bf16_f32 v122, v36, v37
    v_exp_f32 v40, v40
    v_exp_f32 v41, v41
    v_cvt_pk_bf16_f32 v123, v38, v39
    v_mfma_f32_32x32x16_bf16 a[128:143], a[12:15], v[116:119], a[128:143]
    s_add_u32 s68, s72, 32768
    v_exp_f32 v42, v42
    v_exp_f32 v43, v43
    v_cvt_pk_bf16_f32 v124, v40, v41
    v_exp_f32 v44, v44
    v_cvt_pk_bf16_f32 v125, v42, v43
    v_smfmac_f32_16x16x64_bf16 v[184:187], v[152:155], v[112:119], v156
    v_exp_f32 v45, v45
    v_exp_f32 v46, v46
    v_exp_f32 v47, v47
    v_cvt_pk_bf16_f32 v126, v44, v45
    v_cvt_pk_bf16_f32 v127, v46, v47
    v_mfma_f32_32x32x16_bf16 v[32:47], a[16:19], v[8:11], v[64:79]
    v_exp_f32 v16, v16
    v_exp_f32 v17, v17
    v_exp_f32 v18, v18
    v_exp_f32 v19, v19
    v_mfma_f32_32x32x16_bf16 v[32:47], a[20:23], v[12:15], v[32:47]
    s_add_u32 m0, s73, 2048
    v_exp_f32 v20, v20
    v_cvt_pk_bf16_f32 v112, v16, v17
    v_exp_f32 v21, v21
    v_cvt_pk_bf16_f32 v113, v18, v19
    v_exp_f32 v22, v22
    v_mfma_f32_32x32x16_bf16 a[144:159], a[8:11], v[120:123], a[144:159]
    v_exp_f32 v23, v23
    v_cvt_pk_bf16_f32 v114, v20, v21
    v_exp_f32 v24, v24
    v_exp_f32 v25, v25
    v_cvt_pk_bf16_f32 v115, v22, v23
    v_mfma_f32_32x32x16_bf16 a[144:159], a[12:15], v[124:127], a[144:159]
    v_exp_f32 v26, v26
    v_exp_f32 v27, v27
    v_cvt_pk_bf16_f32 v116, v24, v25
    v_exp_f32 v28, v28
    v_cvt_pk_bf16_f32 v117, v26, v27
    v_smfmac_f32_16x16x64_bf16 v[188:191], v[152:155], v[120:127], v156
    buffer_load_dwordx4 a[0:3], v233, s[24:27], s57 offen offset:0 sc1
    buffer_load_dwordx4 a[4:7], v233, s[24:27], s57 offen offset:1024 sc1
    buffer_load_dwordx4 a[8:11], v233, s[24:27], s57 offen offset:2048 sc1
    buffer_load_dwordx4 v161, s[80:83], s68 offen lds
    buffer_load_dwordx4 v239, s[80:83], s68 offen offset:1024 lds
    s_add_u32 m0, s73, 20480
    buffer_load_dwordx4 a[12:15], v233, s[24:27], s57 offen offset:3072 sc1
    buffer_load_dwordx4 v172, s[36:39], s58 offen offset:0 lds
    buffer_load_dwordx4 v173, s[36:39], s58 offen offset:1024 lds
    v_exp_f32 v29, v29
    v_exp_f32 v30, v30
    v_exp_f32 v31, v31
    v_cvt_pk_bf16_f32 v118, v28, v29
    v_cvt_pk_bf16_f32 v119, v30, v31
    v_mfma_f32_32x32x16_bf16 v[16:31], a[16:19], a[112:115], v[80:95]
    s_add_u32 s57, s57, 4096
    v_exp_f32 v32, v32
    v_exp_f32 v33, v33
    v_exp_f32 v34, v34
    v_exp_f32 v35, v35
    v_mfma_f32_32x32x16_bf16 v[16:31], a[20:23], a[116:119], v[16:31]
    v_exp_f32 v36, v36
L_stub_5:
    s_cbranch_execz L_stub_8
    v_cvt_pk_bf16_f32 v120, v32, v33
    v_exp_f32 v37, v37
    v_cvt_pk_bf16_f32 v121, v34, v35
    v_exp_f32 v38, v38
    v_mfma_f32_32x32x16_bf16 v[192:207], a[24:27], v[112:115], v[192:207]
    v_exp_f32 v39, v39
    v_cvt_pk_bf16_f32 v122, v36, v37
    v_exp_f32 v40, v40
    v_exp_f32 v41, v41
    v_cvt_pk_bf16_f32 v123, v38, v39
    v_mfma_f32_32x32x16_bf16 v[192:207], a[28:31], v[116:119], v[192:207]
    v_exp_f32 v42, v42
    v_exp_f32 v43, v43
    v_cvt_pk_bf16_f32 v124, v40, v41
    v_exp_f32 v44, v44
    v_cvt_pk_bf16_f32 v125, v42, v43
    v_smfmac_f32_16x16x64_bf16 v[176:179], v[152:155], v[112:119], v156
    v_exp_f32 v45, v45
    v_exp_f32 v46, v46
    v_exp_f32 v47, v47
    v_cvt_pk_bf16_f32 v126, v44, v45
    v_cvt_pk_bf16_f32 v127, v46, v47
    v_mfma_f32_32x32x16_bf16 v[32:47], a[16:19], a[120:123], v[96:111]
    v_exp_f32 v16, v16
    v_exp_f32 v17, v17
    v_exp_f32 v18, v18
    v_exp_f32 v19, v19
    v_mfma_f32_32x32x16_bf16 v[32:47], a[20:23], a[124:127], v[32:47]
    s_add_u32 s75, s74, 32768
    v_exp_f32 v20, v20
    v_cvt_pk_bf16_f32 v112, v16, v17
    v_exp_f32 v21, v21
    v_cvt_pk_bf16_f32 v113, v18, v19
    v_exp_f32 v22, v22
    v_mfma_f32_32x32x16_bf16 v[208:223], a[24:27], v[120:123], v[208:223]
    v_exp_f32 v23, v23
    v_cvt_pk_bf16_f32 v114, v20, v21
    v_exp_f32 v24, v24
    v_exp_f32 v25, v25
    v_cvt_pk_bf16_f32 v115, v22, v23
    v_mfma_f32_32x32x16_bf16 v[208:223], a[28:31], v[124:127], v[208:223]
    v_exp_f32 v26, v26
    v_exp_f32 v27, v27
    v_cvt_pk_bf16_f32 v116, v24, v25
    v_exp_f32 v28, v28
    v_cvt_pk_bf16_f32 v117, v26, v27
    v_smfmac_f32_16x16x64_bf16 v[180:183], v[152:155], v[120:127], v156
    s_waitcnt vmcnt(28)
    v_exp_f32 v29, v29
    v_exp_f32 v30, v30
    v_exp_f32 v31, v31
    v_cvt_pk_bf16_f32 v118, v28, v29
    v_cvt_pk_bf16_f32 v119, v30, v31
    v_mfma_f32_32x32x16_bf16 v[16:31], a[32:35], v[0:3], v[48:63]
    v_exp_f32 v32, v32
    v_exp_f32 v33, v33
    v_exp_f32 v34, v34
    v_exp_f32 v35, v35
    v_mfma_f32_32x32x16_bf16 v[16:31], a[36:39], v[4:7], v[16:31]
    v_exp_f32 v36, v36
    v_cvt_pk_bf16_f32 v120, v32, v33
    v_exp_f32 v37, v37
    v_cvt_pk_bf16_f32 v121, v34, v35
    v_exp_f32 v38, v38
    v_mfma_f32_32x32x16_bf16 a[128:143], a[24:27], v[112:115], a[128:143]
    s_add_u32 m0, s55, 133120
    v_exp_f32 v39, v39
    v_cvt_pk_bf16_f32 v122, v36, v37
    v_exp_f32 v40, v40
    v_exp_f32 v41, v41
    v_cvt_pk_bf16_f32 v123, v38, v39
    v_mfma_f32_32x32x16_bf16 a[128:143], a[28:31], v[116:119], a[128:143]
    v_exp_f32 v42, v42
    v_exp_f32 v43, v43
    v_cvt_pk_bf16_f32 v124, v40, v41
    v_exp_f32 v44, v44
    v_cvt_pk_bf16_f32 v125, v42, v43
    v_smfmac_f32_16x16x64_bf16 v[184:187], v[152:155], v[112:119], v156
    v_exp_f32 v45, v45
    v_exp_f32 v46, v46
    v_exp_f32 v47, v47
    v_cvt_pk_bf16_f32 v126, v44, v45
    v_cvt_pk_bf16_f32 v127, v46, v47
    v_mfma_f32_32x32x16_bf16 v[32:47], a[32:35], v[8:11], v[64:79]
    v_exp_f32 v16, v16
    v_exp_f32 v17, v17
    v_exp_f32 v18, v18
    v_exp_f32 v19, v19
    v_mfma_f32_32x32x16_bf16 v[32:47], a[36:39], v[12:15], v[32:47]
    v_exp_f32 v20, v20
    v_cvt_pk_bf16_f32 v112, v16, v17
    v_exp_f32 v21, v21
    v_cvt_pk_bf16_f32 v113, v18, v19
    v_exp_f32 v22, v22
    v_mfma_f32_32x32x16_bf16 a[144:159], a[24:27], v[120:123], a[144:159]
    v_exp_f32 v23, v23
    v_cvt_pk_bf16_f32 v114, v20, v21
    v_exp_f32 v24, v24
    v_exp_f32 v25, v25
    v_cvt_pk_bf16_f32 v115, v22, v23
    v_mfma_f32_32x32x16_bf16 a[144:159], a[28:31], v[124:127], a[144:159]
    v_exp_f32 v26, v26
    v_exp_f32 v27, v27
    v_cvt_pk_bf16_f32 v116, v24, v25
    v_exp_f32 v28, v28
    v_cvt_pk_bf16_f32 v117, v26, v27
    v_smfmac_f32_16x16x64_bf16 v[188:191], v[152:155], v[120:127], v156
    buffer_load_dwordx4 a[16:19], v233, s[24:27], s57 offen offset:0 sc1
    buffer_load_dwordx4 a[20:23], v233, s[24:27], s57 offen offset:1024 sc1
    buffer_load_dwordx4 a[24:27], v233, s[24:27], s57 offen offset:2048 sc1
    buffer_load_dwordx4 a[28:31], v233, s[24:27], s57 offen offset:3072 sc1
    buffer_load_dwordx4 v161, s[84:87], s75 offen lds
    buffer_load_dwordx4 v239, s[84:87], s75 offen offset:1024 lds
    v_exp_f32 v29, v29
    v_exp_f32 v30, v30
    v_exp_f32 v31, v31
    v_cvt_pk_bf16_f32 v118, v28, v29
    v_cvt_pk_bf16_f32 v119, v30, v31
    v_mfma_f32_32x32x16_bf16 v[16:31], a[32:35], a[112:115], v[80:95]
    s_add_u32 s63, s63, 1
    v_exp_f32 v32, v32
    v_exp_f32 v33, v33
    v_exp_f32 v34, v34
    v_exp_f32 v35, v35
    v_mfma_f32_32x32x16_bf16 v[16:31], a[36:39], a[116:119], v[16:31]
    v_exp_f32 v36, v36
    v_cvt_pk_bf16_f32 v120, v32, v33
    v_exp_f32 v37, v37
    v_cvt_pk_bf16_f32 v121, v34, v35
    v_exp_f32 v38, v38
    v_mfma_f32_32x32x16_bf16 v[192:207], a[40:43], v[112:115], v[192:207]
    s_cmp_eq_u32 s63, s46
    v_exp_f32 v39, v39
    v_cvt_pk_bf16_f32 v122, v36, v37
    v_exp_f32 v40, v40
    v_exp_f32 v41, v41
    v_cvt_pk_bf16_f32 v123, v38, v39
    v_mfma_f32_32x32x16_bf16 v[192:207], a[44:47], v[116:119], v[192:207]
    v_exp_f32 v42, v42
    v_exp_f32 v43, v43
    v_cvt_pk_bf16_f32 v124, v40, v41
    v_exp_f32 v44, v44
    v_cvt_pk_bf16_f32 v125, v42, v43
    v_smfmac_f32_16x16x64_bf16 v[176:179], v[152:155], v[112:119], v156
    v_exp_f32 v45, v45
    v_exp_f32 v46, v46
    v_exp_f32 v47, v47
    v_cvt_pk_bf16_f32 v126, v44, v45
    v_cvt_pk_bf16_f32 v127, v46, v47
    v_mfma_f32_32x32x16_bf16 v[32:47], a[32:35], a[120:123], v[96:111]
    s_addc_u32 s63, s63, 0
    v_exp_f32 v16, v16
    v_exp_f32 v17, v17
    v_exp_f32 v18, v18
    v_exp_f32 v19, v19
    v_mfma_f32_32x32x16_bf16 v[32:47], a[36:39], a[124:127], v[32:47]
    v_exp_f32 v20, v20
    v_cvt_pk_bf16_f32 v112, v16, v17
    v_exp_f32 v21, v21
    v_cvt_pk_bf16_f32 v113, v18, v19
    v_exp_f32 v22, v22
    v_mfma_f32_32x32x16_bf16 v[208:223], a[40:43], v[120:123], v[208:223]
    s_lshl_b32 s57, s63, 14
    v_exp_f32 v23, v23
    v_cvt_pk_bf16_f32 v114, v20, v21
    v_exp_f32 v24, v24
    v_exp_f32 v25, v25
    v_cvt_pk_bf16_f32 v115, v22, v23
    v_mfma_f32_32x32x16_bf16 v[208:223], a[44:47], v[124:127], v[208:223]
    v_exp_f32 v26, v26
    v_exp_f32 v27, v27
    v_cvt_pk_bf16_f32 v116, v24, v25
    v_exp_f32 v28, v28
    v_cvt_pk_bf16_f32 v117, v26, v27
    v_smfmac_f32_16x16x64_bf16 v[180:183], v[152:155], v[120:127], v156
    s_waitcnt vmcnt(28)
    v_exp_f32 v29, v29
    v_exp_f32 v30, v30
    v_exp_f32 v31, v31
    v_cvt_pk_bf16_f32 v118, v28, v29
    v_cvt_pk_bf16_f32 v119, v30, v31
    v_mfma_f32_32x32x16_bf16 v[16:31], a[48:51], v[0:3], v[48:63]
    v_exp_f32 v32, v32
    v_exp_f32 v33, v33
    v_exp_f32 v34, v34
    v_exp_f32 v35, v35
    v_mfma_f32_32x32x16_bf16 v[16:31], a[52:55], v[4:7], v[16:31]
    s_add_u32 s57, s57, s52
    v_exp_f32 v36, v36
    v_cvt_pk_bf16_f32 v120, v32, v33
    v_exp_f32 v37, v37
    v_cvt_pk_bf16_f32 v121, v34, v35
    v_exp_f32 v38, v38
    v_mfma_f32_32x32x16_bf16 a[128:143], a[40:43], v[112:115], a[128:143]
    v_exp_f32 v39, v39
    v_cvt_pk_bf16_f32 v122, v36, v37
    v_exp_f32 v40, v40
    v_exp_f32 v41, v41
    v_cvt_pk_bf16_f32 v123, v38, v39
    v_mfma_f32_32x32x16_bf16 a[128:143], a[44:47], v[116:119], a[128:143]
    s_add_u32 s68, s72, 65536
    v_exp_f32 v42, v42
    v_exp_f32 v43, v43
    v_cvt_pk_bf16_f32 v124, v40, v41
    v_exp_f32 v44, v44
    v_cvt_pk_bf16_f32 v125, v42, v43
    v_smfmac_f32_16x16x64_bf16 v[184:187], v[152:155], v[112:119], v156
    v_exp_f32 v45, v45
    v_exp_f32 v46, v46
    v_exp_f32 v47, v47
    v_cvt_pk_bf16_f32 v126, v44, v45
    v_cvt_pk_bf16_f32 v127, v46, v47
    v_mfma_f32_32x32x16_bf16 v[32:47], a[48:51], v[8:11], v[64:79]
    v_exp_f32 v16, v16
    v_exp_f32 v17, v17
    v_exp_f32 v18, v18
    v_exp_f32 v19, v19
    v_mfma_f32_32x32x16_bf16 v[32:47], a[52:55], v[12:15], v[32:47]
    s_add_u32 m0, s73, 4096
    v_exp_f32 v20, v20
    v_cvt_pk_bf16_f32 v112, v16, v17
    v_exp_f32 v21, v21
    v_cvt_pk_bf16_f32 v113, v18, v19
    v_exp_f32 v22, v22
    v_mfma_f32_32x32x16_bf16 a[144:159], a[40:43], v[120:123], a[144:159]
    v_exp_f32 v23, v23
    v_cvt_pk_bf16_f32 v114, v20, v21
    v_exp_f32 v24, v24
    v_exp_f32 v25, v25
    v_cvt_pk_bf16_f32 v115, v22, v23
    v_mfma_f32_32x32x16_bf16 a[144:159], a[44:47], v[124:127], a[144:159]
    v_exp_f32 v26, v26
    v_exp_f32 v27, v27
    v_cvt_pk_bf16_f32 v116, v24, v25
    v_exp_f32 v28, v28
    v_cvt_pk_bf16_f32 v117, v26, v27
    v_smfmac_f32_16x16x64_bf16 v[188:191], v[152:155], v[120:127], v156
    buffer_load_dwordx4 a[32:35], v233, s[24:27], s57 offen offset:0 sc1
    buffer_load_dwordx4 a[36:39], v233, s[24:27], s57 offen offset:1024 sc1
    buffer_load_dwordx4 v161, s[80:83], s68 offen lds
    buffer_load_dwordx4 v239, s[80:83], s68 offen offset:1024 lds
    s_add_u32 m0, s73, 24576
    buffer_load_dwordx4 a[40:43], v233, s[24:27], s57 offen offset:2048 sc1
    buffer_load_dwordx4 v168, s[36:39], s101 offen offset:0 lds
    s_add_u32 m0, s73, 20480
    buffer_load_dwordx4 a[44:47], v233, s[24:27], s57 offen offset:3072 sc1
    buffer_load_dwordx4 v174, s[36:39], s58 offen offset:2048 lds
    v_exp_f32 v29, v29
    v_exp_f32 v30, v30
    v_exp_f32 v31, v31
    v_cvt_pk_bf16_f32 v118, v28, v29
    v_cvt_pk_bf16_f32 v119, v30, v31
    v_mfma_f32_32x32x16_bf16 v[16:31], a[48:51], a[112:115], v[80:95]
    s_add_u32 s57, s57, 4096
    v_exp_f32 v32, v32
    v_exp_f32 v33, v33
    v_exp_f32 v34, v34
    v_exp_f32 v35, v35
    v_mfma_f32_32x32x16_bf16 v[16:31], a[52:55], a[116:119], v[16:31]
    v_exp_f32 v36, v36
    v_cvt_pk_bf16_f32 v120, v32, v33
    v_exp_f32 v37, v37
    v_cvt_pk_bf16_f32 v121, v34, v35
    v_exp_f32 v38, v38
    v_mfma_f32_32x32x16_bf16 v[192:207], a[56:59], v[112:115], v[192:207]
    v_exp_f32 v39, v39
    v_cvt_pk_bf16_f32 v122, v36, v37
    v_exp_f32 v40, v40
    v_exp_f32 v41, v41
    v_cvt_pk_bf16_f32 v123, v38, v39
    v_mfma_f32_32x32x16_bf16 v[192:207], a[60:63], v[116:119], v[192:207]
    v_exp_f32 v42, v42
    v_exp_f32 v43, v43
    v_cvt_pk_bf16_f32 v124, v40, v41
    v_exp_f32 v44, v44
    v_cvt_pk_bf16_f32 v125, v42, v43
    v_smfmac_f32_16x16x64_bf16 v[176:179], v[152:155], v[112:119], v156
    v_exp_f32 v45, v45
    v_exp_f32 v46, v46
    v_exp_f32 v47, v47
    v_cvt_pk_bf16_f32 v126, v44, v45
    v_cvt_pk_bf16_f32 v127, v46, v47
    v_mfma_f32_32x32x16_bf16 v[32:47], a[48:51], a[120:123], v[96:111]
    v_exp_f32 v16, v16
    v_exp_f32 v17, v17
    v_exp_f32 v18, v18
    v_exp_f32 v19, v19
    v_mfma_f32_32x32x16_bf16 v[32:47], a[52:55], a[124:127], v[32:47]
    v_exp_f32 v20, v20
    v_cvt_pk_bf16_f32 v112, v16, v17
    v_exp_f32 v21, v21
    v_cvt_pk_bf16_f32 v113, v18, v19
    v_exp_f32 v22, v22
    v_mfma_f32_32x32x16_bf16 v[208:223], a[56:59], v[120:123], v[208:223]
    v_exp_f32 v23, v23
    v_cvt_pk_bf16_f32 v114, v20, v21
    v_exp_f32 v24, v24
    v_exp_f32 v25, v25
    v_cvt_pk_bf16_f32 v115, v22, v23
    v_mfma_f32_32x32x16_bf16 v[208:223], a[60:63], v[124:127], v[208:223]
    v_exp_f32 v26, v26
    v_exp_f32 v27, v27
    v_cvt_pk_bf16_f32 v116, v24, v25
    v_exp_f32 v28, v28
    v_cvt_pk_bf16_f32 v117, v26, v27
    v_smfmac_f32_16x16x64_bf16 v[180:183], v[152:155], v[120:127], v156
    s_waitcnt vmcnt(28)
    v_exp_f32 v29, v29
    v_exp_f32 v30, v30
    v_exp_f32 v31, v31
    v_cvt_pk_bf16_f32 v118, v28, v29
    v_cvt_pk_bf16_f32 v119, v30, v31
    v_mfma_f32_32x32x16_bf16 v[16:31], a[184:187], v[0:3], v[48:63]
    v_exp_f32 v32, v32
    v_exp_f32 v33, v33
    v_exp_f32 v34, v34
    v_exp_f32 v35, v35
    v_mfma_f32_32x32x16_bf16 v[16:31], a[188:191], v[4:7], v[16:31]
    v_exp_f32 v36, v36
    v_cvt_pk_bf16_f32 v120, v32, v33
    v_exp_f32 v37, v37
    v_cvt_pk_bf16_f32 v121, v34, v35
    v_exp_f32 v38, v38
    v_mfma_f32_32x32x16_bf16 a[128:143], a[56:59], v[112:115], a[128:143]
    v_exp_f32 v39, v39
    v_cvt_pk_bf16_f32 v122, v36, v37
    v_exp_f32 v40, v40
    v_exp_f32 v41, v41
    v_cvt_pk_bf16_f32 v123, v38, v39
    v_mfma_f32_32x32x16_bf16 a[128:143], a[60:63], v[116:119], a[128:143]
    v_exp_f32 v42, v42
    v_exp_f32 v43, v43
    v_cvt_pk_bf16_f32 v124, v40, v41
    v_exp_f32 v44, v44
    v_cvt_pk_bf16_f32 v125, v42, v43
    v_smfmac_f32_16x16x64_bf16 v[184:187], v[152:155], v[112:119], v156
    v_exp_f32 v45, v45
    v_exp_f32 v46, v46
    v_exp_f32 v47, v47
    v_cvt_pk_bf16_f32 v126, v44, v45
    v_cvt_pk_bf16_f32 v127, v46, v47
    v_mfma_f32_32x32x16_bf16 v[32:47], a[184:187], v[8:11], v[64:79]
    v_exp_f32 v16, v16
    v_exp_f32 v17, v17
    v_exp_f32 v18, v18
    v_exp_f32 v19, v19
    v_mfma_f32_32x32x16_bf16 v[32:47], a[188:191], v[12:15], v[32:47]
    v_exp_f32 v20, v20
    v_cvt_pk_bf16_f32 v112, v16, v17
    v_exp_f32 v21, v21
    v_cvt_pk_bf16_f32 v113, v18, v19
    v_exp_f32 v22, v22
    v_mfma_f32_32x32x16_bf16 a[144:159], a[56:59], v[120:123], a[144:159]
    v_exp_f32 v23, v23
    v_cvt_pk_bf16_f32 v114, v20, v21
    v_exp_f32 v24, v24
    v_exp_f32 v25, v25
    v_cvt_pk_bf16_f32 v115, v22, v23
    v_mfma_f32_32x32x16_bf16 a[144:159], a[60:63], v[124:127], a[144:159]
    v_exp_f32 v26, v26
    v_exp_f32 v27, v27
    v_cvt_pk_bf16_f32 v116, v24, v25
    v_exp_f32 v28, v28
    v_cvt_pk_bf16_f32 v117, v26, v27
    v_smfmac_f32_16x16x64_bf16 v[188:191], v[152:155], v[120:127], v156
    buffer_load_dwordx4 a[48:51], v233, s[24:27], s57 offen offset:0 sc1
    buffer_load_dwordx4 a[52:55], v233, s[24:27], s57 offen offset:1024 sc1
    buffer_load_dwordx4 a[56:59], v233, s[24:27], s57 offen offset:2048 sc1
    buffer_load_dwordx4 a[60:63], v233, s[24:27], s57 offen offset:3072 sc1
    v_exp_f32 v29, v29
    v_exp_f32 v30, v30
    v_exp_f32 v31, v31
    v_cvt_pk_bf16_f32 v118, v28, v29
    v_cvt_pk_bf16_f32 v119, v30, v31
    v_mfma_f32_32x32x16_bf16 v[16:31], a[184:187], a[112:115], v[80:95]
    s_add_u32 s63, s63, 1
    v_exp_f32 v32, v32
    v_exp_f32 v33, v33
    v_exp_f32 v34, v34
    v_exp_f32 v35, v35
    v_mfma_f32_32x32x16_bf16 v[16:31], a[188:191], a[116:119], v[16:31]
    v_exp_f32 v36, v36
    v_cvt_pk_bf16_f32 v120, v32, v33
    v_exp_f32 v37, v37
    v_cvt_pk_bf16_f32 v121, v34, v35
    v_exp_f32 v38, v38
    v_mfma_f32_32x32x16_bf16 v[192:207], a[192:195], v[112:115], v[192:207]
    s_cmp_eq_u32 s63, s46
    v_exp_f32 v39, v39
    v_cvt_pk_bf16_f32 v122, v36, v37
    v_exp_f32 v40, v40
    v_exp_f32 v41, v41
    v_cvt_pk_bf16_f32 v123, v38, v39
    v_mfma_f32_32x32x16_bf16 v[192:207], a[196:199], v[116:119], v[192:207]
    v_exp_f32 v42, v42
    v_exp_f32 v43, v43
    v_cvt_pk_bf16_f32 v124, v40, v41
    v_exp_f32 v44, v44
    v_cvt_pk_bf16_f32 v125, v42, v43
    v_smfmac_f32_16x16x64_bf16 v[176:179], v[152:155], v[112:119], v156
    v_exp_f32 v45, v45
    v_exp_f32 v46, v46
    v_exp_f32 v47, v47
    v_cvt_pk_bf16_f32 v126, v44, v45
    v_cvt_pk_bf16_f32 v127, v46, v47
    v_mfma_f32_32x32x16_bf16 v[32:47], a[184:187], a[120:123], v[96:111]
    s_addc_u32 s63, s63, 0
    v_exp_f32 v16, v16
    v_exp_f32 v17, v17
    v_exp_f32 v18, v18
    v_exp_f32 v19, v19
    v_mfma_f32_32x32x16_bf16 v[32:47], a[188:191], a[124:127], v[32:47]
    v_exp_f32 v20, v20
    v_cvt_pk_bf16_f32 v112, v16, v17
    v_exp_f32 v21, v21
    v_cvt_pk_bf16_f32 v113, v18, v19
    v_exp_f32 v22, v22
    v_mfma_f32_32x32x16_bf16 v[208:223], a[192:195], v[120:123], v[208:223]
    s_lshl_b32 s57, s63, 14
    v_exp_f32 v23, v23
    v_cvt_pk_bf16_f32 v114, v20, v21
    v_exp_f32 v24, v24
    v_exp_f32 v25, v25
    v_cvt_pk_bf16_f32 v115, v22, v23
    v_mfma_f32_32x32x16_bf16 v[208:223], a[196:199], v[124:127], v[208:223]
    v_exp_f32 v26, v26
    v_exp_f32 v27, v27
    v_cvt_pk_bf16_f32 v116, v24, v25
    v_exp_f32 v28, v28
    v_cvt_pk_bf16_f32 v117, v26, v27
    v_smfmac_f32_16x16x64_bf16 v[180:183], v[152:155], v[120:127], v156
    s_waitcnt vmcnt(26)
    v_exp_f32 v29, v29
    v_exp_f32 v30, v30
    v_exp_f32 v31, v31
    v_cvt_pk_bf16_f32 v118, v28, v29
    v_cvt_pk_bf16_f32 v119, v30, v31
    v_mfma_f32_32x32x16_bf16 v[16:31], a[200:203], v[0:3], v[48:63]
    v_exp_f32 v32, v32
    v_exp_f32 v33, v33
    v_exp_f32 v34, v34
    v_exp_f32 v35, v35
    v_mfma_f32_32x32x16_bf16 v[16:31], a[204:207], v[4:7], v[16:31]
    s_add_u32 s57, s57, s52
    v_exp_f32 v36, v36
    v_cvt_pk_bf16_f32 v120, v32, v33
    v_exp_f32 v37, v37
    v_cvt_pk_bf16_f32 v121, v34, v35
    v_exp_f32 v38, v38
    v_mfma_f32_32x32x16_bf16 a[128:143], a[192:195], v[112:115], a[128:143]
    v_exp_f32 v39, v39
    v_cvt_pk_bf16_f32 v122, v36, v37
    v_exp_f32 v40, v40
    v_exp_f32 v41, v41
    v_cvt_pk_bf16_f32 v123, v38, v39
    v_mfma_f32_32x32x16_bf16 a[128:143], a[196:199], v[116:119], a[128:143]
    s_add_u32 s68, s72, 98304
    v_exp_f32 v42, v42
    v_exp_f32 v43, v43
    v_cvt_pk_bf16_f32 v124, v40, v41
    v_exp_f32 v44, v44
    v_cvt_pk_bf16_f32 v125, v42, v43
    v_smfmac_f32_16x16x64_bf16 v[184:187], v[152:155], v[112:119], v156
    v_exp_f32 v45, v45
    v_exp_f32 v46, v46
    v_exp_f32 v47, v47
    v_cvt_pk_bf16_f32 v126, v44, v45
    v_cvt_pk_bf16_f32 v127, v46, v47
    v_mfma_f32_32x32x16_bf16 v[32:47], a[200:203], v[8:11], v[64:79]
    v_exp_f32 v16, v16
    v_exp_f32 v17, v17
    v_exp_f32 v18, v18
    v_exp_f32 v19, v19
    v_mfma_f32_32x32x16_bf16 v[32:47], a[204:207], v[12:15], v[32:47]
    s_add_u32 m0, s73, 6144
    v_exp_f32 v20, v20
    v_cvt_pk_bf16_f32 v112, v16, v17
    v_exp_f32 v21, v21
    v_cvt_pk_bf16_f32 v113, v18, v19
    v_exp_f32 v22, v22
    v_mfma_f32_32x32x16_bf16 a[144:159], a[192:195], v[120:123], a[144:159]
    v_exp_f32 v23, v23
    v_cvt_pk_bf16_f32 v114, v20, v21
    v_exp_f32 v24, v24
    v_exp_f32 v25, v25
    v_cvt_pk_bf16_f32 v115, v22, v23
    v_mfma_f32_32x32x16_bf16 a[144:159], a[196:199], v[124:127], a[144:159]
    v_exp_f32 v26, v26
    v_exp_f32 v27, v27
    v_cvt_pk_bf16_f32 v116, v24, v25
    v_exp_f32 v28, v28
    v_cvt_pk_bf16_f32 v117, v26, v27
    v_smfmac_f32_16x16x64_bf16 v[188:191], v[152:155], v[120:127], v156
    buffer_load_dwordx4 a[184:187], v233, s[24:27], s57 offen offset:0 sc1
    buffer_load_dwordx4 a[188:191], v233, s[24:27], s57 offen offset:1024 sc1
    buffer_load_dwordx4 a[192:195], v233, s[24:27], s57 offen offset:2048 sc1
    buffer_load_dwordx4 v161, s[80:83], s68 offen lds
    buffer_load_dwordx4 v239, s[80:83], s68 offen offset:1024 lds
    s_add_u32 m0, s73, 24576
    buffer_load_dwordx4 a[196:199], v233, s[24:27], s57 offen offset:3072 sc1
    buffer_load_dwordx4 v169, s[36:39], s101 offen offset:1024 lds
    buffer_load_dwordx4 v170, s[36:39], s101 offen offset:2048 lds
    v_exp_f32 v29, v29
    v_exp_f32 v30, v30
    v_exp_f32 v31, v31
    v_cvt_pk_bf16_f32 v118, v28, v29
    v_cvt_pk_bf16_f32 v119, v30, v31
    v_mfma_f32_32x32x16_bf16 v[16:31], a[200:203], a[112:115], v[80:95]
    s_add_u32 s57, s57, 4096
    v_exp_f32 v32, v32
    v_exp_f32 v33, v33
    v_exp_f32 v34, v34
    v_exp_f32 v35, v35
    v_mfma_f32_32x32x16_bf16 v[16:31], a[204:207], a[116:119], v[16:31]
    v_exp_f32 v36, v36
    v_cvt_pk_bf16_f32 v120, v32, v33
    v_exp_f32 v37, v37
    v_cvt_pk_bf16_f32 v121, v34, v35
    v_exp_f32 v38, v38
    v_mfma_f32_32x32x16_bf16 v[192:207], a[208:211], v[112:115], v[192:207]
    v_exp_f32 v39, v39
    v_cvt_pk_bf16_f32 v122, v36, v37
    v_exp_f32 v40, v40
    v_exp_f32 v41, v41
    v_cvt_pk_bf16_f32 v123, v38, v39
    v_mfma_f32_32x32x16_bf16 v[192:207], a[212:215], v[116:119], v[192:207]
    v_exp_f32 v42, v42
    v_exp_f32 v43, v43
    v_cvt_pk_bf16_f32 v124, v40, v41
    v_exp_f32 v44, v44
    v_cvt_pk_bf16_f32 v125, v42, v43
    v_smfmac_f32_16x16x64_bf16 v[176:179], v[152:155], v[112:119], v156
    v_exp_f32 v45, v45
    v_exp_f32 v46, v46
    v_exp_f32 v47, v47
    v_cvt_pk_bf16_f32 v126, v44, v45
    v_cvt_pk_bf16_f32 v127, v46, v47
    v_mfma_f32_32x32x16_bf16 v[32:47], a[200:203], a[120:123], v[96:111]
    v_exp_f32 v16, v16
    v_exp_f32 v17, v17
    v_exp_f32 v18, v18
    v_exp_f32 v19, v19
    v_mfma_f32_32x32x16_bf16 v[32:47], a[204:207], a[124:127], v[32:47]
    s_add_u32 s66, s74, 65536
    v_exp_f32 v20, v20
    v_cvt_pk_bf16_f32 v112, v16, v17
    v_exp_f32 v21, v21
    v_cvt_pk_bf16_f32 v113, v18, v19
    v_exp_f32 v22, v22
    v_mfma_f32_32x32x16_bf16 v[208:223], a[208:211], v[120:123], v[208:223]
    v_exp_f32 v23, v23
    v_cvt_pk_bf16_f32 v114, v20, v21
    v_exp_f32 v24, v24
    v_exp_f32 v25, v25
    v_cvt_pk_bf16_f32 v115, v22, v23
    v_mfma_f32_32x32x16_bf16 v[208:223], a[212:215], v[124:127], v[208:223]
    v_exp_f32 v26, v26
    v_exp_f32 v27, v27
    v_cvt_pk_bf16_f32 v116, v24, v25
    v_exp_f32 v28, v28
    v_cvt_pk_bf16_f32 v117, v26, v27
    v_smfmac_f32_16x16x64_bf16 v[180:183], v[152:155], v[120:127], v156
    s_waitcnt vmcnt(28)
    v_exp_f32 v29, v29
    v_exp_f32 v30, v30
    v_exp_f32 v31, v31
    v_cvt_pk_bf16_f32 v118, v28, v29
    v_cvt_pk_bf16_f32 v119, v30, v31
    v_mfma_f32_32x32x16_bf16 v[16:31], a[0:3], v[0:3], v[48:63]
    v_exp_f32 v32, v32
    v_exp_f32 v33, v33
    v_exp_f32 v34, v34
    v_exp_f32 v35, v35
    v_mfma_f32_32x32x16_bf16 v[16:31], a[4:7], v[4:7], v[16:31]
    v_exp_f32 v36, v36
    v_cvt_pk_bf16_f32 v120, v32, v33
    v_exp_f32 v37, v37
    v_cvt_pk_bf16_f32 v121, v34, v35
    v_exp_f32 v38, v38
    v_mfma_f32_32x32x16_bf16 a[128:143], a[208:211], v[112:115], a[128:143]
    s_add_u32 m0, s55, 135168
    v_exp_f32 v39, v39
    v_cvt_pk_bf16_f32 v122, v36, v37
    v_exp_f32 v40, v40
    v_exp_f32 v41, v41
    v_cvt_pk_bf16_f32 v123, v38, v39
    v_mfma_f32_32x32x16_bf16 a[128:143], a[212:215], v[116:119], a[128:143]
    v_exp_f32 v42, v42
    v_exp_f32 v43, v43
    v_cvt_pk_bf16_f32 v124, v40, v41
    v_exp_f32 v44, v44
    v_cvt_pk_bf16_f32 v125, v42, v43
    v_smfmac_f32_16x16x64_bf16 v[184:187], v[152:155], v[112:119], v156
    v_exp_f32 v45, v45
    v_exp_f32 v46, v46
    v_exp_f32 v47, v47
    v_cvt_pk_bf16_f32 v126, v44, v45
    v_cvt_pk_bf16_f32 v127, v46, v47
    v_mfma_f32_32x32x16_bf16 v[32:47], a[0:3], v[8:11], v[64:79]
    v_exp_f32 v16, v16
    v_exp_f32 v17, v17
    v_exp_f32 v18, v18
    v_exp_f32 v19, v19
    v_mfma_f32_32x32x16_bf16 v[32:47], a[4:7], v[12:15], v[32:47]
    v_exp_f32 v20, v20
    v_cvt_pk_bf16_f32 v112, v16, v17
    v_exp_f32 v21, v21
    v_cvt_pk_bf16_f32 v113, v18, v19
    v_exp_f32 v22, v22
    v_mfma_f32_32x32x16_bf16 a[144:159], a[208:211], v[120:123], a[144:159]
    v_exp_f32 v23, v23
    v_cvt_pk_bf16_f32 v114, v20, v21
    v_exp_f32 v24, v24
    v_exp_f32 v25, v25
    v_cvt_pk_bf16_f32 v115, v22, v23
    v_mfma_f32_32x32x16_bf16 a[144:159], a[212:215], v[124:127], a[144:159]
    v_exp_f32 v26, v26
    v_exp_f32 v27, v27
    v_cvt_pk_bf16_f32 v116, v24, v25
    v_exp_f32 v28, v28
    v_cvt_pk_bf16_f32 v117, v26, v27
    v_smfmac_f32_16x16x64_bf16 v[188:191], v[152:155], v[120:127], v156
    buffer_load_dwordx4 a[200:203], v233, s[24:27], s57 offen offset:0 sc1
    buffer_load_dwordx4 a[204:207], v233, s[24:27], s57 offen offset:1024 sc1
    buffer_load_dwordx4 a[208:211], v233, s[24:27], s57 offen offset:2048 sc1
    buffer_load_dwordx4 a[212:215], v233, s[24:27], s57 offen offset:3072 sc1
    buffer_load_dwordx4 v161, s[84:87], s66 offen lds
    buffer_load_dwordx4 v239, s[84:87], s66 offen offset:1024 lds
    v_exp_f32 v29, v29
    v_exp_f32 v30, v30
    v_exp_f32 v31, v31
    v_cvt_pk_bf16_f32 v118, v28, v29
    v_cvt_pk_bf16_f32 v119, v30, v31
    v_mfma_f32_32x32x16_bf16 v[16:31], a[0:3], a[112:115], v[80:95]
    s_add_u32 s63, s63, 1
    v_exp_f32 v32, v32
    v_exp_f32 v33, v33
    v_exp_f32 v34, v34
    v_exp_f32 v35, v35
    v_mfma_f32_32x32x16_bf16 v[16:31], a[4:7], a[116:119], v[16:31]
    v_exp_f32 v36, v36
    v_cvt_pk_bf16_f32 v120, v32, v33
    v_exp_f32 v37, v37
    v_cvt_pk_bf16_f32 v121, v34, v35
    v_exp_f32 v38, v38
    v_mfma_f32_32x32x16_bf16 v[192:207], a[8:11], v[112:115], v[192:207]
    s_cmp_eq_u32 s63, s46
    v_exp_f32 v39, v39
    v_cvt_pk_bf16_f32 v122, v36, v37
    v_exp_f32 v40, v40
    v_exp_f32 v41, v41
    v_cvt_pk_bf16_f32 v123, v38, v39
    v_mfma_f32_32x32x16_bf16 v[192:207], a[12:15], v[116:119], v[192:207]
    v_exp_f32 v42, v42
    v_exp_f32 v43, v43
    v_cvt_pk_bf16_f32 v124, v40, v41
    v_exp_f32 v44, v44
    v_cvt_pk_bf16_f32 v125, v42, v43
    v_smfmac_f32_16x16x64_bf16 v[176:179], v[152:155], v[112:119], v156
    s_waitcnt vmcnt(18)
    ds_read_b64_tr_b16 a[68:69], v162 offset:0
    ds_read_b64_tr_b16 a[70:71], v162 offset:3584
    ds_read_b64_tr_b16 a[76:77], v162 offset:32
    v_exp_f32 v45, v45
    v_exp_f32 v46, v46
    v_exp_f32 v47, v47
    v_cvt_pk_bf16_f32 v126, v44, v45
    v_cvt_pk_bf16_f32 v127, v46, v47
    v_mfma_f32_32x32x16_bf16 v[32:47], a[0:3], a[120:123], v[96:111]
    s_addc_u32 s63, s63, 0
    v_exp_f32 v16, v16
    v_exp_f32 v17, v17
    v_exp_f32 v18, v18
    v_exp_f32 v19, v19
    v_mfma_f32_32x32x16_bf16 v[32:47], a[4:7], a[124:127], v[32:47]
    v_exp_f32 v20, v20
    v_cvt_pk_bf16_f32 v112, v16, v17
    v_exp_f32 v21, v21
    v_cvt_pk_bf16_f32 v113, v18, v19
    v_exp_f32 v22, v22
    v_mfma_f32_32x32x16_bf16 v[208:223], a[8:11], v[120:123], v[208:223]
    s_lshl_b32 s57, s63, 14
    v_exp_f32 v23, v23
    v_cvt_pk_bf16_f32 v114, v20, v21
    v_exp_f32 v24, v24
    v_exp_f32 v25, v25
    v_cvt_pk_bf16_f32 v115, v22, v23
    v_mfma_f32_32x32x16_bf16 v[208:223], a[12:15], v[124:127], v[208:223]
    v_exp_f32 v26, v26
    v_exp_f32 v27, v27
    v_cvt_pk_bf16_f32 v116, v24, v25
    v_exp_f32 v28, v28
    v_cvt_pk_bf16_f32 v117, v26, v27
    v_smfmac_f32_16x16x64_bf16 v[180:183], v[152:155], v[120:127], v156
L_stub_6:
    s_cbranch_execz L_stub_9
    ds_read_b64_tr_b16 a[78:79], v162 offset:3616
    ds_read_b64_tr_b16 a[84:85], v162 offset:64
    v_exp_f32 v29, v29
    v_exp_f32 v30, v30
    v_exp_f32 v31, v31
    v_cvt_pk_bf16_f32 v118, v28, v29
    v_cvt_pk_bf16_f32 v119, v30, v31
    v_mfma_f32_32x32x16_bf16 v[16:31], a[16:19], v[0:3], v[48:63]
    v_exp_f32 v32, v32
    v_exp_f32 v33, v33
    v_exp_f32 v34, v34
    v_exp_f32 v35, v35
    v_mfma_f32_32x32x16_bf16 v[16:31], a[20:23], v[4:7], v[16:31]
    s_add_u32 s57, s57, s52
    v_exp_f32 v36, v36
    v_cvt_pk_bf16_f32 v120, v32, v33
    v_exp_f32 v37, v37
    v_cvt_pk_bf16_f32 v121, v34, v35
    v_exp_f32 v38, v38
    v_mfma_f32_32x32x16_bf16 a[128:143], a[8:11], v[112:115], a[128:143]
    v_exp_f32 v39, v39
    v_cvt_pk_bf16_f32 v122, v36, v37
    v_exp_f32 v40, v40
    v_exp_f32 v41, v41
    v_cvt_pk_bf16_f32 v123, v38, v39
    v_mfma_f32_32x32x16_bf16 a[128:143], a[12:15], v[116:119], a[128:143]
    s_add_u32 s68, s72, 131072
    v_exp_f32 v42, v42
    v_exp_f32 v43, v43
    v_cvt_pk_bf16_f32 v124, v40, v41
    v_exp_f32 v44, v44
    v_cvt_pk_bf16_f32 v125, v42, v43
    v_smfmac_f32_16x16x64_bf16 v[184:187], v[152:155], v[112:119], v156
    ds_read_b64_tr_b16 a[86:87], v162 offset:3648
    ds_read_b64_tr_b16 a[92:93], v162 offset:96
    v_exp_f32 v45, v45
    v_exp_f32 v46, v46
    v_exp_f32 v47, v47
    v_cvt_pk_bf16_f32 v126, v44, v45
    v_cvt_pk_bf16_f32 v127, v46, v47
    v_mfma_f32_32x32x16_bf16 v[32:47], a[16:19], v[8:11], v[64:79]
    v_exp_f32 v16, v16
    v_exp_f32 v17, v17
    v_exp_f32 v18, v18
    v_exp_f32 v19, v19
    v_mfma_f32_32x32x16_bf16 v[32:47], a[20:23], v[12:15], v[32:47]
    s_add_u32 m0, s73, 8192
    v_exp_f32 v20, v20
    v_cvt_pk_bf16_f32 v112, v16, v17
    v_exp_f32 v21, v21
    v_cvt_pk_bf16_f32 v113, v18, v19
    v_exp_f32 v22, v22
    v_mfma_f32_32x32x16_bf16 a[144:159], a[8:11], v[120:123], a[144:159]
    v_exp_f32 v23, v23
    v_cvt_pk_bf16_f32 v114, v20, v21
    v_exp_f32 v24, v24
    v_exp_f32 v25, v25
    v_cvt_pk_bf16_f32 v115, v22, v23
    v_mfma_f32_32x32x16_bf16 a[144:159], a[12:15], v[124:127], a[144:159]
    v_exp_f32 v26, v26
    v_exp_f32 v27, v27
    v_cvt_pk_bf16_f32 v116, v24, v25
    v_exp_f32 v28, v28
    v_cvt_pk_bf16_f32 v117, v26, v27
    v_smfmac_f32_16x16x64_bf16 v[188:191], v[152:155], v[120:127], v156
    buffer_load_dwordx4 a[0:3], v233, s[24:27], s57 offen offset:0 sc1
    buffer_load_dwordx4 a[4:7], v233, s[24:27], s57 offen offset:1024 sc1
    buffer_load_dwordx4 v161, s[80:83], s68 offen lds
    buffer_load_dwordx4 v239, s[80:83], s68 offen offset:1024 lds
    s_add_u32 m0, s73, 24576
    buffer_load_dwordx4 a[8:11], v233, s[24:27], s57 offen offset:2048 sc1
    buffer_load_dwordx4 v171, s[36:39], s101 offen offset:3072 lds
    s_add_u32 m0, s73, 28672
    buffer_load_dwordx4 a[12:15], v233, s[24:27], s57 offen offset:3072 sc1
    buffer_load_dwordx4 v172, s[36:39], s101 offen offset:0 lds
    global_load_dword v238, v[252:253], off
    v_exp_f32 v29, v29
    v_exp_f32 v30, v30
    v_exp_f32 v31, v31
    v_cvt_pk_bf16_f32 v118, v28, v29
    v_cvt_pk_bf16_f32 v119, v30, v31
    v_mfma_f32_32x32x16_bf16 v[16:31], a[16:19], a[112:115], v[80:95]
    s_add_u32 s57, s57, 4096
    v_exp_f32 v32, v32
    v_exp_f32 v33, v33
    v_exp_f32 v34, v34
    v_exp_f32 v35, v35
    v_mfma_f32_32x32x16_bf16 v[16:31], a[20:23], a[116:119], v[16:31]
    v_exp_f32 v36, v36
    v_cvt_pk_bf16_f32 v120, v32, v33
    v_exp_f32 v37, v37
    v_cvt_pk_bf16_f32 v121, v34, v35
    v_exp_f32 v38, v38
    v_mfma_f32_32x32x16_bf16 v[192:207], a[24:27], v[112:115], v[192:207]
    v_exp_f32 v39, v39
    v_cvt_pk_bf16_f32 v122, v36, v37
    v_exp_f32 v40, v40
    v_exp_f32 v41, v41
    v_cvt_pk_bf16_f32 v123, v38, v39
    v_mfma_f32_32x32x16_bf16 v[192:207], a[28:31], v[116:119], v[192:207]
    v_exp_f32 v42, v42
    v_exp_f32 v43, v43
    v_cvt_pk_bf16_f32 v124, v40, v41
    v_exp_f32 v44, v44
    v_cvt_pk_bf16_f32 v125, v42, v43
    v_smfmac_f32_16x16x64_bf16 v[176:179], v[152:155], v[112:119], v156
    ds_read_b64_tr_b16 a[94:95], v162 offset:3680
    ds_read_b64_tr_b16 a[100:101], v162 offset:128
    ds_read_b64_tr_b16 a[102:103], v162 offset:3712
    v_exp_f32 v45, v45
    v_exp_f32 v46, v46
    v_exp_f32 v47, v47
    v_cvt_pk_bf16_f32 v126, v44, v45
    v_cvt_pk_bf16_f32 v127, v46, v47
    v_mfma_f32_32x32x16_bf16 v[32:47], a[16:19], a[120:123], v[96:111]
    v_exp_f32 v16, v16
    v_exp_f32 v17, v17
    v_exp_f32 v18, v18
    v_exp_f32 v19, v19
    v_mfma_f32_32x32x16_bf16 v[32:47], a[20:23], a[124:127], v[32:47]
    v_exp_f32 v20, v20
    v_cvt_pk_bf16_f32 v112, v16, v17
    v_exp_f32 v21, v21
    v_cvt_pk_bf16_f32 v113, v18, v19
    v_exp_f32 v22, v22
    v_mfma_f32_32x32x16_bf16 v[208:223], a[24:27], v[120:123], v[208:223]
    v_exp_f32 v23, v23
    v_cvt_pk_bf16_f32 v114, v20, v21
    v_exp_f32 v24, v24
    v_exp_f32 v25, v25
    v_cvt_pk_bf16_f32 v115, v22, v23
    v_mfma_f32_32x32x16_bf16 v[208:223], a[28:31], v[124:127], v[208:223]
    v_exp_f32 v26, v26
    v_exp_f32 v27, v27
    v_cvt_pk_bf16_f32 v116, v24, v25
    v_exp_f32 v28, v28
    v_cvt_pk_bf16_f32 v117, v26, v27
    v_smfmac_f32_16x16x64_bf16 v[180:183], v[152:155], v[120:127], v156
    ds_read_b64_tr_b16 a[108:109], v162 offset:160
    ds_read_b64_tr_b16 a[110:111], v162 offset:3744
    v_exp_f32 v29, v29
    v_exp_f32 v30, v30
    v_exp_f32 v31, v31
    v_cvt_pk_bf16_f32 v118, v28, v29
    v_cvt_pk_bf16_f32 v119, v30, v31
    v_mfma_f32_32x32x16_bf16 v[16:31], a[32:35], v[0:3], v[48:63]
    v_exp_f32 v32, v32
    v_exp_f32 v33, v33
    v_exp_f32 v34, v34
    v_exp_f32 v35, v35
    v_mfma_f32_32x32x16_bf16 v[16:31], a[36:39], v[4:7], v[16:31]
    v_exp_f32 v36, v36
    v_cvt_pk_bf16_f32 v120, v32, v33
    v_exp_f32 v37, v37
    v_cvt_pk_bf16_f32 v121, v34, v35
    v_exp_f32 v38, v38
    v_mfma_f32_32x32x16_bf16 a[128:143], a[24:27], v[112:115], a[128:143]
    v_exp_f32 v39, v39
    v_cvt_pk_bf16_f32 v122, v36, v37
    v_exp_f32 v40, v40
    v_exp_f32 v41, v41
    v_cvt_pk_bf16_f32 v123, v38, v39
    v_mfma_f32_32x32x16_bf16 a[128:143], a[28:31], v[116:119], a[128:143]
    v_exp_f32 v42, v42
    v_exp_f32 v43, v43
    v_cvt_pk_bf16_f32 v124, v40, v41
    v_exp_f32 v44, v44
    v_cvt_pk_bf16_f32 v125, v42, v43
    v_smfmac_f32_16x16x64_bf16 v[184:187], v[152:155], v[112:119], v156
    ds_read_b64_tr_b16 a[164:165], v162 offset:192
    ds_read_b64_tr_b16 a[166:167], v162 offset:3776
    v_exp_f32 v45, v45
    v_exp_f32 v46, v46
    v_exp_f32 v47, v47
    v_cvt_pk_bf16_f32 v126, v44, v45
    v_cvt_pk_bf16_f32 v127, v46, v47
    v_mfma_f32_32x32x16_bf16 v[32:47], a[32:35], v[8:11], v[64:79]
    v_exp_f32 v16, v16
    v_exp_f32 v17, v17
    v_exp_f32 v18, v18
    v_exp_f32 v19, v19
    v_mfma_f32_32x32x16_bf16 v[32:47], a[36:39], v[12:15], v[32:47]
    v_exp_f32 v20, v20
    v_cvt_pk_bf16_f32 v112, v16, v17
    v_exp_f32 v21, v21
    v_cvt_pk_bf16_f32 v113, v18, v19
    v_exp_f32 v22, v22
    v_mfma_f32_32x32x16_bf16 a[144:159], a[24:27], v[120:123], a[144:159]
    v_exp_f32 v23, v23
    v_cvt_pk_bf16_f32 v114, v20, v21
    v_exp_f32 v24, v24
    v_exp_f32 v25, v25
    v_cvt_pk_bf16_f32 v115, v22, v23
    v_mfma_f32_32x32x16_bf16 a[144:159], a[28:31], v[124:127], a[144:159]
    v_exp_f32 v26, v26
    v_exp_f32 v27, v27
    v_cvt_pk_bf16_f32 v116, v24, v25
    v_exp_f32 v28, v28
    v_cvt_pk_bf16_f32 v117, v26, v27
    v_smfmac_f32_16x16x64_bf16 v[188:191], v[152:155], v[120:127], v156
    s_waitcnt lgkmcnt(0)
    buffer_load_dwordx4 a[16:19], v233, s[24:27], s57 offen offset:0 sc1
    buffer_load_dwordx4 a[20:23], v233, s[24:27], s57 offen offset:1024 sc1
    buffer_load_dwordx4 a[24:27], v233, s[24:27], s57 offen offset:2048 sc1
    buffer_load_dwordx4 a[28:31], v233, s[24:27], s57 offen offset:3072 sc1
    v_exp_f32 v29, v29
    v_exp_f32 v30, v30
    v_exp_f32 v31, v31
    v_cvt_pk_bf16_f32 v118, v28, v29
    v_cvt_pk_bf16_f32 v119, v30, v31
    v_mfma_f32_32x32x16_bf16 v[16:31], a[32:35], a[112:115], v[80:95]
    s_add_u32 s63, s63, 1
    v_exp_f32 v32, v32
    v_exp_f32 v33, v33
    v_exp_f32 v34, v34
    v_exp_f32 v35, v35
    v_mfma_f32_32x32x16_bf16 v[16:31], a[36:39], a[116:119], v[16:31]
    v_exp_f32 v36, v36
    v_cvt_pk_bf16_f32 v120, v32, v33
    v_exp_f32 v37, v37
    v_cvt_pk_bf16_f32 v121, v34, v35
    v_exp_f32 v38, v38
    v_mfma_f32_32x32x16_bf16 v[192:207], a[40:43], v[112:115], v[192:207]
    s_cmp_eq_u32 s63, s46
    v_exp_f32 v39, v39
    v_cvt_pk_bf16_f32 v122, v36, v37
    v_exp_f32 v40, v40
    v_exp_f32 v41, v41
    v_cvt_pk_bf16_f32 v123, v38, v39
    v_mfma_f32_32x32x16_bf16 v[192:207], a[44:47], v[116:119], v[192:207]
    v_exp_f32 v42, v42
    v_exp_f32 v43, v43
    v_cvt_pk_bf16_f32 v124, v40, v41
    v_exp_f32 v44, v44
    v_cvt_pk_bf16_f32 v125, v42, v43
    v_smfmac_f32_16x16x64_bf16 v[176:179], v[152:155], v[112:119], v156
    v_exp_f32 v45, v45
    v_exp_f32 v46, v46
    v_exp_f32 v47, v47
    v_cvt_pk_bf16_f32 v126, v44, v45
    v_cvt_pk_bf16_f32 v127, v46, v47
    v_mfma_f32_32x32x16_bf16 v[32:47], a[32:35], a[120:123], v[96:111]
    s_addc_u32 s63, s63, 0
    v_exp_f32 v16, v16
    v_exp_f32 v17, v17
    v_exp_f32 v18, v18
    v_exp_f32 v19, v19
    v_mfma_f32_32x32x16_bf16 v[32:47], a[36:39], a[124:127], v[32:47]
    v_exp_f32 v20, v20
    v_cvt_pk_bf16_f32 v112, v16, v17
    v_exp_f32 v21, v21
    v_cvt_pk_bf16_f32 v113, v18, v19
    v_exp_f32 v22, v22
    v_mfma_f32_32x32x16_bf16 v[208:223], a[40:43], v[120:123], v[208:223]
    s_lshl_b32 s57, s63, 14
    v_exp_f32 v23, v23
    v_cvt_pk_bf16_f32 v114, v20, v21
    v_exp_f32 v24, v24
    v_exp_f32 v25, v25
    v_cvt_pk_bf16_f32 v115, v22, v23
    v_mfma_f32_32x32x16_bf16 v[208:223], a[44:47], v[124:127], v[208:223]
    v_exp_f32 v26, v26
    v_exp_f32 v27, v27
    v_cvt_pk_bf16_f32 v116, v24, v25
    v_exp_f32 v28, v28
    v_cvt_pk_bf16_f32 v117, v26, v27
    v_smfmac_f32_16x16x64_bf16 v[180:183], v[152:155], v[120:127], v156
    s_waitcnt vmcnt(27)
    v_exp_f32 v29, v29
    v_exp_f32 v30, v30
    v_exp_f32 v31, v31
    v_cvt_pk_bf16_f32 v118, v28, v29
    v_cvt_pk_bf16_f32 v119, v30, v31
    v_mfma_f32_32x32x16_bf16 v[16:31], a[48:51], v[0:3], v[48:63]
    v_exp_f32 v32, v32
    v_exp_f32 v33, v33
    v_exp_f32 v34, v34
    v_exp_f32 v35, v35
    v_mfma_f32_32x32x16_bf16 v[16:31], a[52:55], v[4:7], v[16:31]
    s_add_u32 s57, s57, s52
    v_exp_f32 v36, v36
    v_cvt_pk_bf16_f32 v120, v32, v33
    v_exp_f32 v37, v37
    v_cvt_pk_bf16_f32 v121, v34, v35
    v_exp_f32 v38, v38
    v_mfma_f32_32x32x16_bf16 a[128:143], a[40:43], v[112:115], a[128:143]
    v_exp_f32 v39, v39
    v_cvt_pk_bf16_f32 v122, v36, v37
    v_exp_f32 v40, v40
    v_exp_f32 v41, v41
    v_cvt_pk_bf16_f32 v123, v38, v39
    v_mfma_f32_32x32x16_bf16 a[128:143], a[44:47], v[116:119], a[128:143]
    s_add_u32 s68, s72, 163840
    v_exp_f32 v42, v42
    v_exp_f32 v43, v43
    v_cvt_pk_bf16_f32 v124, v40, v41
    v_exp_f32 v44, v44
    v_cvt_pk_bf16_f32 v125, v42, v43
    v_smfmac_f32_16x16x64_bf16 v[184:187], v[152:155], v[112:119], v156
    v_exp_f32 v45, v45
    v_exp_f32 v46, v46
    v_exp_f32 v47, v47
    v_cvt_pk_bf16_f32 v126, v44, v45
    v_cvt_pk_bf16_f32 v127, v46, v47
    v_mfma_f32_32x32x16_bf16 v[32:47], a[48:51], v[8:11], v[64:79]
    v_exp_f32 v16, v16
    v_exp_f32 v17, v17
    v_exp_f32 v18, v18
    v_exp_f32 v19, v19
    v_mfma_f32_32x32x16_bf16 v[32:47], a[52:55], v[12:15], v[32:47]
    s_add_u32 m0, s73, 10240
    v_exp_f32 v20, v20
    v_cvt_pk_bf16_f32 v112, v16, v17
    v_exp_f32 v21, v21
    v_cvt_pk_bf16_f32 v113, v18, v19
    v_exp_f32 v22, v22
    v_mfma_f32_32x32x16_bf16 a[144:159], a[40:43], v[120:123], a[144:159]
    v_exp_f32 v23, v23
    v_cvt_pk_bf16_f32 v114, v20, v21
    v_exp_f32 v24, v24
    v_exp_f32 v25, v25
    v_cvt_pk_bf16_f32 v115, v22, v23
    v_mfma_f32_32x32x16_bf16 a[144:159], a[44:47], v[124:127], a[144:159]
    v_exp_f32 v26, v26
    v_exp_f32 v27, v27
    v_cvt_pk_bf16_f32 v116, v24, v25
    v_exp_f32 v28, v28
    v_cvt_pk_bf16_f32 v117, v26, v27
    v_smfmac_f32_16x16x64_bf16 v[188:191], v[152:155], v[120:127], v156
    buffer_load_dwordx4 a[32:35], v233, s[24:27], s57 offen offset:0 sc1
    buffer_load_dwordx4 a[36:39], v233, s[24:27], s57 offen offset:1024 sc1
    buffer_load_dwordx4 a[40:43], v233, s[24:27], s57 offen offset:2048 sc1
    buffer_load_dwordx4 v161, s[80:83], s68 offen lds
    buffer_load_dwordx4 v239, s[80:83], s68 offen offset:1024 lds
    s_add_u32 m0, s73, 28672
    buffer_load_dwordx4 a[44:47], v233, s[24:27], s57 offen offset:3072 sc1
    buffer_load_dwordx4 v173, s[36:39], s101 offen offset:1024 lds
    buffer_load_dwordx4 v174, s[36:39], s101 offen offset:2048 lds
    v_exp_f32 v29, v29
    v_exp_f32 v30, v30
    v_exp_f32 v31, v31
    v_cvt_pk_bf16_f32 v118, v28, v29
    v_cvt_pk_bf16_f32 v119, v30, v31
    v_mfma_f32_32x32x16_bf16 v[16:31], a[48:51], a[112:115], v[80:95]
    s_add_u32 s57, s57, 4096
    v_exp_f32 v32, v32
    v_exp_f32 v33, v33
    v_exp_f32 v34, v34
    v_exp_f32 v35, v35
    v_mfma_f32_32x32x16_bf16 v[16:31], a[52:55], a[116:119], v[16:31]
    v_exp_f32 v36, v36
    v_cvt_pk_bf16_f32 v120, v32, v33
    v_exp_f32 v37, v37
    v_cvt_pk_bf16_f32 v121, v34, v35
    v_exp_f32 v38, v38
    v_mfma_f32_32x32x16_bf16 v[192:207], a[56:59], v[112:115], v[192:207]
    v_exp_f32 v39, v39
    v_cvt_pk_bf16_f32 v122, v36, v37
    v_exp_f32 v40, v40
    v_exp_f32 v41, v41
    v_cvt_pk_bf16_f32 v123, v38, v39
    v_mfma_f32_32x32x16_bf16 v[192:207], a[60:63], v[116:119], v[192:207]
    v_exp_f32 v42, v42
    v_exp_f32 v43, v43
    v_cvt_pk_bf16_f32 v124, v40, v41
    v_exp_f32 v44, v44
    v_cvt_pk_bf16_f32 v125, v42, v43
    v_smfmac_f32_16x16x64_bf16 v[176:179], v[152:155], v[112:119], v156
    v_exp_f32 v45, v45
    v_exp_f32 v46, v46
    v_exp_f32 v47, v47
    v_cvt_pk_bf16_f32 v126, v44, v45
    v_cvt_pk_bf16_f32 v127, v46, v47
    v_mfma_f32_32x32x16_bf16 v[32:47], a[48:51], a[120:123], v[96:111]
    v_exp_f32 v16, v16
    v_exp_f32 v17, v17
    v_exp_f32 v18, v18
    v_exp_f32 v19, v19
    v_mfma_f32_32x32x16_bf16 v[32:47], a[52:55], a[124:127], v[32:47]
    s_add_u32 s75, s74, 98304
    v_exp_f32 v20, v20
    v_cvt_pk_bf16_f32 v112, v16, v17
    v_exp_f32 v21, v21
    v_cvt_pk_bf16_f32 v113, v18, v19
    v_exp_f32 v22, v22
    v_mfma_f32_32x32x16_bf16 v[208:223], a[56:59], v[120:123], v[208:223]
    v_exp_f32 v23, v23
    v_cvt_pk_bf16_f32 v114, v20, v21
    v_exp_f32 v24, v24
    v_exp_f32 v25, v25
    v_cvt_pk_bf16_f32 v115, v22, v23
    v_mfma_f32_32x32x16_bf16 v[208:223], a[60:63], v[124:127], v[208:223]
    v_exp_f32 v26, v26
    v_exp_f32 v27, v27
    v_cvt_pk_bf16_f32 v116, v24, v25
    v_exp_f32 v28, v28
    v_cvt_pk_bf16_f32 v117, v26, v27
    v_smfmac_f32_16x16x64_bf16 v[180:183], v[152:155], v[120:127], v156
    s_waitcnt vmcnt(29)
    v_exp_f32 v29, v29
    v_exp_f32 v30, v30
    v_exp_f32 v31, v31
    v_cvt_pk_bf16_f32 v118, v28, v29
    v_cvt_pk_bf16_f32 v119, v30, v31
    v_mfma_f32_32x32x16_bf16 v[16:31], a[184:187], v[0:3], v[48:63]
    v_exp_f32 v32, v32
    v_exp_f32 v33, v33
    v_exp_f32 v34, v34
    v_exp_f32 v35, v35
    v_mfma_f32_32x32x16_bf16 v[16:31], a[188:191], v[4:7], v[16:31]
    v_exp_f32 v36, v36
    v_cvt_pk_bf16_f32 v120, v32, v33
    v_exp_f32 v37, v37
    v_cvt_pk_bf16_f32 v121, v34, v35
    v_exp_f32 v38, v38
    v_mfma_f32_32x32x16_bf16 a[128:143], a[56:59], v[112:115], a[128:143]
    s_add_u32 m0, s55, 137216
    v_exp_f32 v39, v39
    v_cvt_pk_bf16_f32 v122, v36, v37
    v_exp_f32 v40, v40
    v_exp_f32 v41, v41
    v_cvt_pk_bf16_f32 v123, v38, v39
    v_mfma_f32_32x32x16_bf16 a[128:143], a[60:63], v[116:119], a[128:143]
    v_exp_f32 v42, v42
    v_exp_f32 v43, v43
    v_cvt_pk_bf16_f32 v124, v40, v41
    v_exp_f32 v44, v44
    v_cvt_pk_bf16_f32 v125, v42, v43
    v_smfmac_f32_16x16x64_bf16 v[184:187], v[152:155], v[112:119], v156
    v_exp_f32 v45, v45
    v_exp_f32 v46, v46
    v_exp_f32 v47, v47
    v_cvt_pk_bf16_f32 v126, v44, v45
    v_cvt_pk_bf16_f32 v127, v46, v47
    v_mfma_f32_32x32x16_bf16 v[32:47], a[184:187], v[8:11], v[64:79]
    v_exp_f32 v16, v16
    v_exp_f32 v17, v17
    v_exp_f32 v18, v18
    v_exp_f32 v19, v19
    v_mfma_f32_32x32x16_bf16 v[32:47], a[188:191], v[12:15], v[32:47]
    v_exp_f32 v20, v20
    v_cvt_pk_bf16_f32 v112, v16, v17
    v_exp_f32 v21, v21
    v_cvt_pk_bf16_f32 v113, v18, v19
    v_exp_f32 v22, v22
    v_mfma_f32_32x32x16_bf16 a[144:159], a[56:59], v[120:123], a[144:159]
    v_exp_f32 v23, v23
    v_cvt_pk_bf16_f32 v114, v20, v21
    v_exp_f32 v24, v24
    v_exp_f32 v25, v25
    v_cvt_pk_bf16_f32 v115, v22, v23
    v_mfma_f32_32x32x16_bf16 a[144:159], a[60:63], v[124:127], a[144:159]
    v_exp_f32 v26, v26
    v_exp_f32 v27, v27
    v_cvt_pk_bf16_f32 v116, v24, v25
    v_exp_f32 v28, v28
    v_cvt_pk_bf16_f32 v117, v26, v27
    v_smfmac_f32_16x16x64_bf16 v[188:191], v[152:155], v[120:127], v156
    buffer_load_dwordx4 a[48:51], v233, s[24:27], s57 offen offset:0 sc1
    buffer_load_dwordx4 a[52:55], v233, s[24:27], s57 offen offset:1024 sc1
    buffer_load_dwordx4 a[56:59], v233, s[24:27], s57 offen offset:2048 sc1
    buffer_load_dwordx4 a[60:63], v233, s[24:27], s57 offen offset:3072 sc1
    buffer_load_dwordx4 v161, s[84:87], s75 offen lds
    buffer_load_dwordx4 v239, s[84:87], s75 offen offset:1024 lds
    v_exp_f32 v29, v29
    v_exp_f32 v30, v30
    v_exp_f32 v31, v31
    v_cvt_pk_bf16_f32 v118, v28, v29
    v_cvt_pk_bf16_f32 v119, v30, v31
    v_mfma_f32_32x32x16_bf16 v[16:31], a[184:187], a[112:115], v[80:95]
    s_add_u32 s63, s63, 1
    v_exp_f32 v32, v32
    v_exp_f32 v33, v33
    v_exp_f32 v34, v34
    v_exp_f32 v35, v35
    v_mfma_f32_32x32x16_bf16 v[16:31], a[188:191], a[116:119], v[16:31]
    v_exp_f32 v36, v36
    v_cvt_pk_bf16_f32 v120, v32, v33
    v_exp_f32 v37, v37
    v_cvt_pk_bf16_f32 v121, v34, v35
    v_exp_f32 v38, v38
    v_mfma_f32_32x32x16_bf16 v[192:207], a[192:195], v[112:115], v[192:207]
    s_cmp_eq_u32 s63, s46
    v_exp_f32 v39, v39
    v_cvt_pk_bf16_f32 v122, v36, v37
    v_exp_f32 v40, v40
    v_exp_f32 v41, v41
    v_cvt_pk_bf16_f32 v123, v38, v39
    v_mfma_f32_32x32x16_bf16 v[192:207], a[196:199], v[116:119], v[192:207]
    v_exp_f32 v42, v42
    v_exp_f32 v43, v43
    v_cvt_pk_bf16_f32 v124, v40, v41
    v_exp_f32 v44, v44
    v_cvt_pk_bf16_f32 v125, v42, v43
    v_smfmac_f32_16x16x64_bf16 v[176:179], v[152:155], v[112:119], v156
    v_exp_f32 v45, v45
    v_exp_f32 v46, v46
    v_exp_f32 v47, v47
    v_cvt_pk_bf16_f32 v126, v44, v45
    v_cvt_pk_bf16_f32 v127, v46, v47
    v_mfma_f32_32x32x16_bf16 v[32:47], a[184:187], a[120:123], v[96:111]
    s_addc_u32 s63, s63, 0
    v_exp_f32 v16, v16
    v_exp_f32 v17, v17
    v_exp_f32 v18, v18
    v_exp_f32 v19, v19
    v_mfma_f32_32x32x16_bf16 v[32:47], a[188:191], a[124:127], v[32:47]
    v_exp_f32 v20, v20
    v_cvt_pk_bf16_f32 v112, v16, v17
    v_exp_f32 v21, v21
    v_cvt_pk_bf16_f32 v113, v18, v19
    v_exp_f32 v22, v22
    v_mfma_f32_32x32x16_bf16 v[208:223], a[192:195], v[120:123], v[208:223]
    s_lshl_b32 s57, s63, 14
    v_exp_f32 v23, v23
    v_cvt_pk_bf16_f32 v114, v20, v21
    v_exp_f32 v24, v24
    v_exp_f32 v25, v25
    v_cvt_pk_bf16_f32 v115, v22, v23
    v_mfma_f32_32x32x16_bf16 v[208:223], a[196:199], v[124:127], v[208:223]
    v_exp_f32 v26, v26
    v_exp_f32 v27, v27
    v_cvt_pk_bf16_f32 v116, v24, v25
    v_exp_f32 v28, v28
    v_cvt_pk_bf16_f32 v117, v26, v27
    v_smfmac_f32_16x16x64_bf16 v[180:183], v[152:155], v[120:127], v156
    s_waitcnt vmcnt(29)
    v_exp_f32 v29, v29
    v_exp_f32 v30, v30
    v_exp_f32 v31, v31
    v_cvt_pk_bf16_f32 v118, v28, v29
    v_cvt_pk_bf16_f32 v119, v30, v31
    v_mfma_f32_32x32x16_bf16 v[16:31], a[200:203], v[0:3], v[48:63]
    v_exp_f32 v32, v32
    v_exp_f32 v33, v33
    v_exp_f32 v34, v34
    v_exp_f32 v35, v35
    v_mfma_f32_32x32x16_bf16 v[16:31], a[204:207], v[4:7], v[16:31]
    s_add_u32 s57, s57, s52
    v_exp_f32 v36, v36
    v_cvt_pk_bf16_f32 v120, v32, v33
    v_exp_f32 v37, v37
    v_cvt_pk_bf16_f32 v121, v34, v35
    v_exp_f32 v38, v38
    v_mfma_f32_32x32x16_bf16 a[128:143], a[192:195], v[112:115], a[128:143]
    v_exp_f32 v39, v39
    v_cvt_pk_bf16_f32 v122, v36, v37
    v_exp_f32 v40, v40
    v_exp_f32 v41, v41
    v_cvt_pk_bf16_f32 v123, v38, v39
    v_mfma_f32_32x32x16_bf16 a[128:143], a[196:199], v[116:119], a[128:143]
    s_add_u32 s68, s72, 196608
    v_exp_f32 v42, v42
    v_exp_f32 v43, v43
    v_cvt_pk_bf16_f32 v124, v40, v41
    v_exp_f32 v44, v44
    v_cvt_pk_bf16_f32 v125, v42, v43
    v_smfmac_f32_16x16x64_bf16 v[184:187], v[152:155], v[112:119], v156
    v_exp_f32 v45, v45
    v_exp_f32 v46, v46
    v_exp_f32 v47, v47
    v_cvt_pk_bf16_f32 v126, v44, v45
    v_cvt_pk_bf16_f32 v127, v46, v47
    v_mfma_f32_32x32x16_bf16 v[32:47], a[200:203], v[8:11], v[64:79]
    v_exp_f32 v16, v16
    v_exp_f32 v17, v17
    v_exp_f32 v18, v18
    v_exp_f32 v19, v19
    v_mfma_f32_32x32x16_bf16 v[32:47], a[204:207], v[12:15], v[32:47]
    s_add_u32 m0, s73, 12288
    v_exp_f32 v20, v20
    v_cvt_pk_bf16_f32 v112, v16, v17
    v_exp_f32 v21, v21
    v_cvt_pk_bf16_f32 v113, v18, v19
    v_exp_f32 v22, v22
    v_mfma_f32_32x32x16_bf16 a[144:159], a[192:195], v[120:123], a[144:159]
    v_exp_f32 v23, v23
    v_cvt_pk_bf16_f32 v114, v20, v21
    v_exp_f32 v24, v24
    v_exp_f32 v25, v25
    v_cvt_pk_bf16_f32 v115, v22, v23
    v_mfma_f32_32x32x16_bf16 a[144:159], a[196:199], v[124:127], a[144:159]
    v_exp_f32 v26, v26
    v_exp_f32 v27, v27
    v_cvt_pk_bf16_f32 v116, v24, v25
    v_exp_f32 v28, v28
    v_cvt_pk_bf16_f32 v117, v26, v27
    v_smfmac_f32_16x16x64_bf16 v[188:191], v[152:155], v[120:127], v156
    buffer_load_dwordx4 a[184:187], v233, s[24:27], s57 offen offset:0 sc1
    buffer_load_dwordx4 a[188:191], v233, s[24:27], s57 offen offset:1024 sc1
    buffer_load_dwordx4 a[192:195], v233, s[24:27], s57 offen offset:2048 sc1
    buffer_load_dwordx4 a[196:199], v233, s[24:27], s57 offen offset:3072 sc1
    buffer_load_dwordx4 v161, s[80:83], s68 offen lds
    buffer_load_dwordx4 v239, s[80:83], s68 offen offset:1024 lds
    v_exp_f32 v29, v29
    v_exp_f32 v30, v30
    v_exp_f32 v31, v31
    v_cvt_pk_bf16_f32 v118, v28, v29
    v_cvt_pk_bf16_f32 v119, v30, v31
    v_mfma_f32_32x32x16_bf16 v[16:31], a[200:203], a[112:115], v[80:95]
    s_add_u32 s57, s57, 4096
    v_exp_f32 v32, v32
    v_exp_f32 v33, v33
    v_exp_f32 v34, v34
    v_exp_f32 v35, v35
    v_mfma_f32_32x32x16_bf16 v[16:31], a[204:207], a[116:119], v[16:31]
    v_exp_f32 v36, v36
    v_cvt_pk_bf16_f32 v120, v32, v33
    v_exp_f32 v37, v37
    v_cvt_pk_bf16_f32 v121, v34, v35
    v_exp_f32 v38, v38
    v_mfma_f32_32x32x16_bf16 v[192:207], a[208:211], v[112:115], v[192:207]
    v_exp_f32 v39, v39
    v_cvt_pk_bf16_f32 v122, v36, v37
    v_exp_f32 v40, v40
    v_exp_f32 v41, v41
    v_cvt_pk_bf16_f32 v123, v38, v39
    v_mfma_f32_32x32x16_bf16 v[192:207], a[212:215], v[116:119], v[192:207]
    v_exp_f32 v42, v42
    v_exp_f32 v43, v43
    v_cvt_pk_bf16_f32 v124, v40, v41
    v_exp_f32 v44, v44
    v_cvt_pk_bf16_f32 v125, v42, v43
    v_smfmac_f32_16x16x64_bf16 v[176:179], v[152:155], v[112:119], v156
    v_exp_f32 v45, v45
    v_exp_f32 v46, v46
    v_exp_f32 v47, v47
    v_cvt_pk_bf16_f32 v126, v44, v45
    v_cvt_pk_bf16_f32 v127, v46, v47
    v_mfma_f32_32x32x16_bf16 v[32:47], a[200:203], a[120:123], v[96:111]
    v_exp_f32 v16, v16
    v_exp_f32 v17, v17
    v_exp_f32 v18, v18
    v_exp_f32 v19, v19
    v_mfma_f32_32x32x16_bf16 v[32:47], a[204:207], a[124:127], v[32:47]
    s_add_u32 s68, s72, 229376
    v_exp_f32 v20, v20
    v_cvt_pk_bf16_f32 v112, v16, v17
    v_exp_f32 v21, v21
    v_cvt_pk_bf16_f32 v113, v18, v19
    v_exp_f32 v22, v22
    v_mfma_f32_32x32x16_bf16 v[208:223], a[208:211], v[120:123], v[208:223]
    v_exp_f32 v23, v23
    v_cvt_pk_bf16_f32 v114, v20, v21
    v_exp_f32 v24, v24
    v_exp_f32 v25, v25
    v_cvt_pk_bf16_f32 v115, v22, v23
    v_mfma_f32_32x32x16_bf16 v[208:223], a[212:215], v[124:127], v[208:223]
    v_exp_f32 v26, v26
    v_exp_f32 v27, v27
    v_cvt_pk_bf16_f32 v116, v24, v25
    v_exp_f32 v28, v28
    v_cvt_pk_bf16_f32 v117, v26, v27
    v_smfmac_f32_16x16x64_bf16 v[180:183], v[152:155], v[120:127], v156
    s_waitcnt vmcnt(26)
    v_exp_f32 v29, v29
    v_exp_f32 v30, v30
    v_exp_f32 v31, v31
    v_cvt_pk_bf16_f32 v118, v28, v29
    v_cvt_pk_bf16_f32 v119, v30, v31
    v_mfma_f32_32x32x16_bf16 v[16:31], a[0:3], v[0:3], v[48:63]
    v_exp_f32 v32, v32
    v_exp_f32 v33, v33
    v_exp_f32 v34, v34
    v_exp_f32 v35, v35
    v_mfma_f32_32x32x16_bf16 v[16:31], a[4:7], v[4:7], v[16:31]
    v_exp_f32 v36, v36
    v_cvt_pk_bf16_f32 v120, v32, v33
    v_exp_f32 v37, v37
    v_cvt_pk_bf16_f32 v121, v34, v35
    v_exp_f32 v38, v38
    v_mfma_f32_32x32x16_bf16 a[128:143], a[208:211], v[112:115], a[128:143]
    s_add_u32 m0, s73, 14336
    v_exp_f32 v39, v39
    v_cvt_pk_bf16_f32 v122, v36, v37
    v_exp_f32 v40, v40
    v_exp_f32 v41, v41
    v_cvt_pk_bf16_f32 v123, v38, v39
    v_mfma_f32_32x32x16_bf16 a[128:143], a[212:215], v[116:119], a[128:143]
    v_exp_f32 v42, v42
    v_exp_f32 v43, v43
    v_cvt_pk_bf16_f32 v124, v40, v41
    v_exp_f32 v44, v44
    v_cvt_pk_bf16_f32 v125, v42, v43
    v_smfmac_f32_16x16x64_bf16 v[184:187], v[152:155], v[112:119], v156
    v_exp_f32 v45, v45
    v_exp_f32 v46, v46
    v_exp_f32 v47, v47
    v_cvt_pk_bf16_f32 v126, v44, v45
L_stub_7:
    s_cbranch_execz L_warm_w9_ret
    v_cvt_pk_bf16_f32 v127, v46, v47
    v_mfma_f32_32x32x16_bf16 v[32:47], a[0:3], v[8:11], v[64:79]
    v_exp_f32 v16, v16
    v_exp_f32 v17, v17
    v_exp_f32 v18, v18
    v_exp_f32 v19, v19
    v_mfma_f32_32x32x16_bf16 v[32:47], a[4:7], v[12:15], v[32:47]
    v_exp_f32 v20, v20
    v_cvt_pk_bf16_f32 v112, v16, v17
    v_exp_f32 v21, v21
    v_cvt_pk_bf16_f32 v113, v18, v19
    v_exp_f32 v22, v22
    v_mfma_f32_32x32x16_bf16 a[144:159], a[208:211], v[120:123], a[144:159]
    v_exp_f32 v23, v23
    v_cvt_pk_bf16_f32 v114, v20, v21
    v_exp_f32 v24, v24
    v_exp_f32 v25, v25
    v_cvt_pk_bf16_f32 v115, v22, v23
    v_mfma_f32_32x32x16_bf16 a[144:159], a[212:215], v[124:127], a[144:159]
    v_exp_f32 v26, v26
    v_exp_f32 v27, v27
    v_cvt_pk_bf16_f32 v116, v24, v25
    v_exp_f32 v28, v28
    v_cvt_pk_bf16_f32 v117, v26, v27
    v_smfmac_f32_16x16x64_bf16 v[188:191], v[152:155], v[120:127], v156
    buffer_load_dwordx4 a[200:203], v233, s[24:27], s57 offen offset:0 sc1
    buffer_load_dwordx4 a[204:207], v233, s[24:27], s57 offen offset:1024 sc1
    buffer_load_dwordx4 a[208:211], v233, s[24:27], s57 offen offset:2048 sc1
    buffer_load_dwordx4 a[212:215], v233, s[24:27], s57 offen offset:3072 sc1
    buffer_load_dwordx4 v161, s[80:83], s68 offen lds
    buffer_load_dwordx4 v239, s[80:83], s68 offen offset:1024 lds
    v_exp_f32 v29, v29
    v_exp_f32 v30, v30
    v_exp_f32 v31, v31
    v_cvt_pk_bf16_f32 v118, v28, v29
    v_cvt_pk_bf16_f32 v119, v30, v31
    v_mfma_f32_32x32x16_bf16 v[16:31], a[0:3], a[112:115], v[80:95]
    s_add_u32 s63, s63, 1
    v_exp_f32 v32, v32
    v_exp_f32 v33, v33
    v_exp_f32 v34, v34
    v_exp_f32 v35, v35
    v_mfma_f32_32x32x16_bf16 v[16:31], a[4:7], a[116:119], v[16:31]
    v_exp_f32 v36, v36
    v_cvt_pk_bf16_f32 v120, v32, v33
    v_exp_f32 v37, v37
    v_cvt_pk_bf16_f32 v121, v34, v35
    v_exp_f32 v38, v38
    v_mfma_f32_32x32x16_bf16 v[192:207], a[8:11], v[112:115], v[192:207]
    s_cmp_eq_u32 s63, s46
    v_exp_f32 v39, v39
    v_cvt_pk_bf16_f32 v122, v36, v37
    v_exp_f32 v40, v40
    v_exp_f32 v41, v41
    v_cvt_pk_bf16_f32 v123, v38, v39
    v_mfma_f32_32x32x16_bf16 v[192:207], a[12:15], v[116:119], v[192:207]
    v_exp_f32 v42, v42
    v_exp_f32 v43, v43
    v_cvt_pk_bf16_f32 v124, v40, v41
    v_exp_f32 v44, v44
    v_cvt_pk_bf16_f32 v125, v42, v43
    v_smfmac_f32_16x16x64_bf16 v[176:179], v[152:155], v[112:119], v156
    s_waitcnt vmcnt(18)
    ds_read_b64_tr_b16 a[64:65], v162 offset:8192
    ds_read_b64_tr_b16 a[66:67], v162 offset:11776
    ds_read_b64_tr_b16 a[72:73], v162 offset:8224
    v_exp_f32 v45, v45
    v_exp_f32 v46, v46
    v_exp_f32 v47, v47
    v_cvt_pk_bf16_f32 v126, v44, v45
    v_cvt_pk_bf16_f32 v127, v46, v47
    v_mfma_f32_32x32x16_bf16 v[32:47], a[0:3], a[120:123], v[96:111]
    s_addc_u32 s63, s63, 0
    v_exp_f32 v16, v16
    v_exp_f32 v17, v17
    v_exp_f32 v18, v18
    v_exp_f32 v19, v19
    v_mfma_f32_32x32x16_bf16 v[32:47], a[4:7], a[124:127], v[32:47]
    v_exp_f32 v20, v20
    v_cvt_pk_bf16_f32 v112, v16, v17
    v_exp_f32 v21, v21
    v_cvt_pk_bf16_f32 v113, v18, v19
    v_exp_f32 v22, v22
    v_mfma_f32_32x32x16_bf16 v[208:223], a[8:11], v[120:123], v[208:223]
    s_lshl_b32 s57, s63, 14
    v_exp_f32 v23, v23
    v_cvt_pk_bf16_f32 v114, v20, v21
    v_exp_f32 v24, v24
    v_exp_f32 v25, v25
    v_cvt_pk_bf16_f32 v115, v22, v23
    v_mfma_f32_32x32x16_bf16 v[208:223], a[12:15], v[124:127], v[208:223]
    v_exp_f32 v26, v26
    v_exp_f32 v27, v27
    v_cvt_pk_bf16_f32 v116, v24, v25
    v_exp_f32 v28, v28
    v_cvt_pk_bf16_f32 v117, v26, v27
    v_smfmac_f32_16x16x64_bf16 v[180:183], v[152:155], v[120:127], v156
    ds_read_b64_tr_b16 a[74:75], v162 offset:11808
    ds_read_b64_tr_b16 a[80:81], v162 offset:8256
    v_exp_f32 v29, v29
    v_exp_f32 v30, v30
    v_exp_f32 v31, v31
    v_cvt_pk_bf16_f32 v118, v28, v29
    v_cvt_pk_bf16_f32 v119, v30, v31
    v_mfma_f32_32x32x16_bf16 v[16:31], a[16:19], v[0:3], v[48:63]
    v_exp_f32 v32, v32
    v_exp_f32 v33, v33
    v_exp_f32 v34, v34
    v_exp_f32 v35, v35
    v_mfma_f32_32x32x16_bf16 v[16:31], a[20:23], v[4:7], v[16:31]
    s_add_u32 s57, s57, s52
    v_exp_f32 v36, v36
    v_cvt_pk_bf16_f32 v120, v32, v33
    v_exp_f32 v37, v37
    v_cvt_pk_bf16_f32 v121, v34, v35
    v_exp_f32 v38, v38
    v_mfma_f32_32x32x16_bf16 a[128:143], a[8:11], v[112:115], a[128:143]
    v_exp_f32 v39, v39
    v_cvt_pk_bf16_f32 v122, v36, v37
    v_exp_f32 v40, v40
    v_exp_f32 v41, v41
    v_cvt_pk_bf16_f32 v123, v38, v39
    v_mfma_f32_32x32x16_bf16 a[128:143], a[12:15], v[116:119], a[128:143]
    s_add_u32 s68, s72, 262144
    v_exp_f32 v42, v42
    v_exp_f32 v43, v43
    v_cvt_pk_bf16_f32 v124, v40, v41
    v_exp_f32 v44, v44
    v_cvt_pk_bf16_f32 v125, v42, v43
    v_smfmac_f32_16x16x64_bf16 v[184:187], v[152:155], v[112:119], v156
    ds_read_b64_tr_b16 a[82:83], v162 offset:11840
    ds_read_b64_tr_b16 a[88:89], v162 offset:8288
    v_exp_f32 v45, v45
    v_exp_f32 v46, v46
    v_exp_f32 v47, v47
    v_cvt_pk_bf16_f32 v126, v44, v45
    v_cvt_pk_bf16_f32 v127, v46, v47
    v_mfma_f32_32x32x16_bf16 v[32:47], a[16:19], v[8:11], v[64:79]
    v_exp_f32 v16, v16
    v_exp_f32 v17, v17
    v_exp_f32 v18, v18
    v_exp_f32 v19, v19
    v_mfma_f32_32x32x16_bf16 v[32:47], a[20:23], v[12:15], v[32:47]
    s_add_u32 m0, s73, 16384
    v_exp_f32 v20, v20
    v_cvt_pk_bf16_f32 v112, v16, v17
    v_exp_f32 v21, v21
    v_cvt_pk_bf16_f32 v113, v18, v19
    v_exp_f32 v22, v22
    v_mfma_f32_32x32x16_bf16 a[144:159], a[8:11], v[120:123], a[144:159]
    v_exp_f32 v23, v23
    v_cvt_pk_bf16_f32 v114, v20, v21
    v_exp_f32 v24, v24
    v_exp_f32 v25, v25
    v_cvt_pk_bf16_f32 v115, v22, v23
    v_mfma_f32_32x32x16_bf16 a[144:159], a[12:15], v[124:127], a[144:159]
    v_exp_f32 v26, v26
    v_exp_f32 v27, v27
    v_cvt_pk_bf16_f32 v116, v24, v25
    v_exp_f32 v28, v28
    v_cvt_pk_bf16_f32 v117, v26, v27
    v_smfmac_f32_16x16x64_bf16 v[188:191], v[152:155], v[120:127], v156
    buffer_load_dwordx4 a[0:3], v233, s[24:27], s57 offen offset:0 sc1
    buffer_load_dwordx4 a[4:7], v233, s[24:27], s57 offen offset:1024 sc1
    buffer_load_dwordx4 a[8:11], v233, s[24:27], s57 offen offset:2048 sc1
    buffer_load_dwordx4 a[12:15], v233, s[24:27], s57 offen offset:3072 sc1
    buffer_load_dwordx4 v161, s[80:83], s68 offen lds
    buffer_load_dwordx4 v239, s[80:83], s68 offen offset:1024 lds
    v_exp_f32 v29, v29
    v_exp_f32 v30, v30
    v_exp_f32 v31, v31
    v_cvt_pk_bf16_f32 v118, v28, v29
    v_cvt_pk_bf16_f32 v119, v30, v31
    v_mfma_f32_32x32x16_bf16 v[16:31], a[16:19], a[112:115], v[80:95]
    s_add_u32 s57, s57, 4096
    v_exp_f32 v32, v32
    v_exp_f32 v33, v33
    v_exp_f32 v34, v34
    v_exp_f32 v35, v35
    v_mfma_f32_32x32x16_bf16 v[16:31], a[20:23], a[116:119], v[16:31]
    v_exp_f32 v36, v36
    v_cvt_pk_bf16_f32 v120, v32, v33
    v_exp_f32 v37, v37
    v_cvt_pk_bf16_f32 v121, v34, v35
    v_exp_f32 v38, v38
    v_mfma_f32_32x32x16_bf16 v[192:207], a[24:27], v[112:115], v[192:207]
    v_exp_f32 v39, v39
    v_cvt_pk_bf16_f32 v122, v36, v37
    v_exp_f32 v40, v40
    v_exp_f32 v41, v41
    v_cvt_pk_bf16_f32 v123, v38, v39
    v_mfma_f32_32x32x16_bf16 v[192:207], a[28:31], v[116:119], v[192:207]
    v_exp_f32 v42, v42
    v_exp_f32 v43, v43
    v_cvt_pk_bf16_f32 v124, v40, v41
    v_exp_f32 v44, v44
    v_cvt_pk_bf16_f32 v125, v42, v43
    v_smfmac_f32_16x16x64_bf16 v[176:179], v[152:155], v[112:119], v156
    ds_read_b64_tr_b16 a[90:91], v162 offset:11872
    ds_read_b64_tr_b16 a[96:97], v162 offset:8320
    ds_read_b64_tr_b16 a[98:99], v162 offset:11904
    s_waitcnt vmcnt(18)
    ds_read_b64_tr_b16 a[216:217], v248 offset:0
    ds_read_b64_tr_b16 a[218:219], v248 offset:1024
    ds_read_b64_tr_b16 a[220:221], v249 offset:0
    v_exp_f32 v45, v45
    v_exp_f32 v46, v46
    v_exp_f32 v47, v47
    v_cvt_pk_bf16_f32 v126, v44, v45
    v_cvt_pk_bf16_f32 v127, v46, v47
    v_mfma_f32_32x32x16_bf16 v[32:47], a[16:19], a[120:123], v[96:111]
    v_exp_f32 v16, v16
    v_exp_f32 v17, v17
    v_exp_f32 v18, v18
    v_exp_f32 v19, v19
    v_mfma_f32_32x32x16_bf16 v[32:47], a[20:23], a[124:127], v[32:47]
    s_add_u32 s68, s72, 294912
    v_exp_f32 v20, v20
    v_cvt_pk_bf16_f32 v112, v16, v17
    v_exp_f32 v21, v21
    v_cvt_pk_bf16_f32 v113, v18, v19
    v_exp_f32 v22, v22
    v_mfma_f32_32x32x16_bf16 v[208:223], a[24:27], v[120:123], v[208:223]
    v_exp_f32 v23, v23
    v_cvt_pk_bf16_f32 v114, v20, v21
    v_exp_f32 v24, v24
    v_exp_f32 v25, v25
    v_cvt_pk_bf16_f32 v115, v22, v23
    v_mfma_f32_32x32x16_bf16 v[208:223], a[28:31], v[124:127], v[208:223]
    v_exp_f32 v26, v26
    v_exp_f32 v27, v27
    v_cvt_pk_bf16_f32 v116, v24, v25
    v_exp_f32 v28, v28
    v_cvt_pk_bf16_f32 v117, v26, v27
    v_smfmac_f32_16x16x64_bf16 v[180:183], v[152:155], v[120:127], v156
    ds_read_b64_tr_b16 a[104:105], v162 offset:8352
    ds_read_b64_tr_b16 a[106:107], v162 offset:11936
    ds_read_b64_tr_b16 a[222:223], v249 offset:1024
    ds_read_b64_tr_b16 a[224:225], v250 offset:0
    ds_read_b64_tr_b16 a[226:227], v250 offset:1024
    v_exp_f32 v29, v29
    v_exp_f32 v30, v30
    v_exp_f32 v31, v31
    v_cvt_pk_bf16_f32 v118, v28, v29
    v_cvt_pk_bf16_f32 v119, v30, v31
    v_mfma_f32_32x32x16_bf16 v[16:31], a[32:35], v[0:3], v[48:63]
    v_exp_f32 v32, v32
    v_exp_f32 v33, v33
    v_exp_f32 v34, v34
    v_exp_f32 v35, v35
    v_mfma_f32_32x32x16_bf16 v[16:31], a[36:39], v[4:7], v[16:31]
    v_exp_f32 v36, v36
    v_cvt_pk_bf16_f32 v120, v32, v33
    v_exp_f32 v37, v37
    v_cvt_pk_bf16_f32 v121, v34, v35
    v_exp_f32 v38, v38
    v_mfma_f32_32x32x16_bf16 a[128:143], a[24:27], v[112:115], a[128:143]
    s_add_u32 m0, s73, 18432
    v_exp_f32 v39, v39
    v_cvt_pk_bf16_f32 v122, v36, v37
    v_exp_f32 v40, v40
    v_exp_f32 v41, v41
    v_cvt_pk_bf16_f32 v123, v38, v39
    v_mfma_f32_32x32x16_bf16 a[128:143], a[28:31], v[116:119], a[128:143]
    v_exp_f32 v42, v42
    v_exp_f32 v43, v43
    v_cvt_pk_bf16_f32 v124, v40, v41
    v_exp_f32 v44, v44
    v_cvt_pk_bf16_f32 v125, v42, v43
    v_smfmac_f32_16x16x64_bf16 v[184:187], v[152:155], v[112:119], v156
    ds_read_b64_tr_b16 a[160:161], v162 offset:8384
    ds_read_b64_tr_b16 a[162:163], v162 offset:11968
    ds_read_b64_tr_b16 a[228:229], v251 offset:0
    ds_read_b64_tr_b16 a[230:231], v251 offset:1024
    v_exp_f32 v45, v45
    v_exp_f32 v46, v46
    v_exp_f32 v47, v47
    v_cvt_pk_bf16_f32 v126, v44, v45
    v_cvt_pk_bf16_f32 v127, v46, v47
    v_mfma_f32_32x32x16_bf16 v[32:47], a[32:35], v[8:11], v[64:79]
    v_exp_f32 v16, v16
    v_exp_f32 v17, v17
    v_exp_f32 v18, v18
    v_exp_f32 v19, v19
    v_mfma_f32_32x32x16_bf16 v[32:47], a[36:39], v[12:15], v[32:47]
    v_exp_f32 v20, v20
    v_cvt_pk_bf16_f32 v112, v16, v17
    v_exp_f32 v21, v21
    v_cvt_pk_bf16_f32 v113, v18, v19
    v_exp_f32 v22, v22
    v_mfma_f32_32x32x16_bf16 a[144:159], a[24:27], v[120:123], a[144:159]
    v_exp_f32 v23, v23
    v_cvt_pk_bf16_f32 v114, v20, v21
    v_exp_f32 v24, v24
    v_exp_f32 v25, v25
    v_cvt_pk_bf16_f32 v115, v22, v23
    v_mfma_f32_32x32x16_bf16 a[144:159], a[28:31], v[124:127], a[144:159]
    v_exp_f32 v26, v26
    v_exp_f32 v27, v27
    v_cvt_pk_bf16_f32 v116, v24, v25
    v_exp_f32 v28, v28
    v_cvt_pk_bf16_f32 v117, v26, v27
    v_smfmac_f32_16x16x64_bf16 v[188:191], v[152:155], v[120:127], v156
    s_waitcnt lgkmcnt(0)
    buffer_load_dwordx4 a[16:19], v233, s[24:27], s57 offen offset:0 sc1
    buffer_load_dwordx4 a[20:23], v233, s[24:27], s57 offen offset:1024 sc1
    buffer_load_dwordx4 a[24:27], v233, s[24:27], s57 offen offset:2048 sc1
    buffer_load_dwordx4 a[28:31], v233, s[24:27], s57 offen offset:3072 sc1
    buffer_load_dwordx4 v161, s[80:83], s68 offen lds
    buffer_load_dwordx4 v239, s[80:83], s68 offen offset:1024 lds
    v_exp_f32 v29, v29
    v_exp_f32 v30, v30
    v_exp_f32 v31, v31
    v_cvt_pk_bf16_f32 v118, v28, v29
    v_cvt_pk_bf16_f32 v119, v30, v31
    v_mfma_f32_32x32x16_bf16 v[16:31], a[32:35], a[112:115], v[80:95]
    s_add_u32 s63, s63, 1
    v_exp_f32 v32, v32
    v_exp_f32 v33, v33
    v_exp_f32 v34, v34
    v_exp_f32 v35, v35
    v_mfma_f32_32x32x16_bf16 v[16:31], a[36:39], a[116:119], v[16:31]
    s_cmp_eq_u32 s63, s46
    v_exp_f32 v36, v36
    v_cvt_pk_bf16_f32 v120, v32, v33
    v_exp_f32 v37, v37
    v_cvt_pk_bf16_f32 v121, v34, v35
    v_exp_f32 v38, v38
    v_mfma_f32_32x32x16_bf16 v[192:207], a[40:43], v[112:115], v[192:207]
    v_exp_f32 v39, v39
    v_cvt_pk_bf16_f32 v122, v36, v37
    v_exp_f32 v40, v40
    v_exp_f32 v41, v41
    v_cvt_pk_bf16_f32 v123, v38, v39
    v_mfma_f32_32x32x16_bf16 v[192:207], a[44:47], v[116:119], v[192:207]
    s_addc_u32 s63, s63, 0
    v_exp_f32 v42, v42
    v_exp_f32 v43, v43
    v_cvt_pk_bf16_f32 v124, v40, v41
    v_exp_f32 v44, v44
    v_cvt_pk_bf16_f32 v125, v42, v43
    v_smfmac_f32_16x16x64_bf16 v[176:179], v[152:155], v[112:119], v156
    ds_read_b64_tr_b16 a[232:233], v248 offset:4096
    ds_read_b64_tr_b16 a[234:235], v248 offset:5120
    ds_read_b64_tr_b16 a[236:237], v249 offset:4096
    v_exp_f32 v45, v45
    v_exp_f32 v46, v46
    v_exp_f32 v47, v47
    v_cvt_pk_bf16_f32 v126, v44, v45
    v_cvt_pk_bf16_f32 v127, v46, v47
    v_mfma_f32_32x32x16_bf16 v[32:47], a[32:35], a[120:123], v[96:111]
    s_lshl_b32 s57, s63, 14
    v_exp_f32 v16, v16
    v_exp_f32 v17, v17
    v_exp_f32 v18, v18
    v_exp_f32 v19, v19
    v_mfma_f32_32x32x16_bf16 v[32:47], a[36:39], a[124:127], v[32:47]
    v_exp_f32 v20, v20
    v_cvt_pk_bf16_f32 v112, v16, v17
    v_exp_f32 v21, v21
    v_cvt_pk_bf16_f32 v113, v18, v19
    v_exp_f32 v22, v22
    v_mfma_f32_32x32x16_bf16 v[208:223], a[40:43], v[120:123], v[208:223]
    s_add_u32 s57, s57, s52
    v_exp_f32 v23, v23
    v_cvt_pk_bf16_f32 v114, v20, v21
    v_exp_f32 v24, v24
    v_exp_f32 v25, v25
    v_cvt_pk_bf16_f32 v115, v22, v23
    v_mfma_f32_32x32x16_bf16 v[208:223], a[44:47], v[124:127], v[208:223]
    v_exp_f32 v26, v26
    v_exp_f32 v27, v27
    v_cvt_pk_bf16_f32 v116, v24, v25
    v_exp_f32 v28, v28
    v_cvt_pk_bf16_f32 v117, v26, v27
    v_smfmac_f32_16x16x64_bf16 v[180:183], v[152:155], v[120:127], v156
    ds_read_b64_tr_b16 a[238:239], v249 offset:5120
    ds_read_b64_tr_b16 a[240:241], v250 offset:4096
    ds_read_b64_tr_b16 a[242:243], v250 offset:5120
    v_exp_f32 v29, v29
    v_exp_f32 v30, v30
    v_exp_f32 v31, v31
    v_cvt_pk_bf16_f32 v118, v28, v29
    v_cvt_pk_bf16_f32 v119, v30, v31
    v_mfma_f32_32x32x16_bf16 v[16:31], a[48:51], v[0:3], v[48:63]
    s_add_u32 s68, s72, 327680
    v_exp_f32 v32, v32
    v_exp_f32 v33, v33
    v_exp_f32 v34, v34
    v_exp_f32 v35, v35
    v_mfma_f32_32x32x16_bf16 v[16:31], a[52:55], v[4:7], v[16:31]
    s_add_u32 m0, s73, 20480
    v_exp_f32 v36, v36
    v_cvt_pk_bf16_f32 v120, v32, v33
    v_exp_f32 v37, v37
    v_cvt_pk_bf16_f32 v121, v34, v35
    v_exp_f32 v38, v38
    v_mfma_f32_32x32x16_bf16 a[128:143], a[40:43], v[112:115], a[128:143]
    v_exp_f32 v39, v39
    v_cvt_pk_bf16_f32 v122, v36, v37
    v_exp_f32 v40, v40
    v_exp_f32 v41, v41
    v_cvt_pk_bf16_f32 v123, v38, v39
    v_mfma_f32_32x32x16_bf16 a[128:143], a[44:47], v[116:119], a[128:143]
    s_add_u32 s65, s100, 4096
    v_exp_f32 v42, v42
    v_exp_f32 v43, v43
    v_cvt_pk_bf16_f32 v124, v40, v41
    v_exp_f32 v44, v44
    v_cvt_pk_bf16_f32 v125, v42, v43
    v_smfmac_f32_16x16x64_bf16 v[184:187], v[152:155], v[112:119], v156
    ds_read_b64_tr_b16 a[244:245], v251 offset:4096
    ds_read_b64_tr_b16 a[246:247], v251 offset:5120
    v_exp_f32 v45, v45
    v_exp_f32 v46, v46
    v_exp_f32 v47, v47
    v_cvt_pk_bf16_f32 v126, v44, v45
    v_cvt_pk_bf16_f32 v127, v46, v47
    v_mfma_f32_32x32x16_bf16 v[32:47], a[48:51], v[8:11], v[64:79]
    s_add_u32 s71, s100, 8192
    v_exp_f32 v16, v16
    v_exp_f32 v17, v17
    v_exp_f32 v18, v18
    v_exp_f32 v19, v19
    v_mfma_f32_32x32x16_bf16 v[32:47], a[52:55], v[12:15], v[32:47]
    v_exp_f32 v20, v20
    v_cvt_pk_bf16_f32 v112, v16, v17
    v_exp_f32 v21, v21
    v_cvt_pk_bf16_f32 v113, v18, v19
    v_exp_f32 v22, v22
    v_mfma_f32_32x32x16_bf16 a[144:159], a[40:43], v[120:123], a[144:159]
    s_add_u32 s53, s100, 12288
    v_exp_f32 v23, v23
    v_cvt_pk_bf16_f32 v114, v20, v21
    v_exp_f32 v24, v24
    v_exp_f32 v25, v25
    v_cvt_pk_bf16_f32 v115, v22, v23
    v_mfma_f32_32x32x16_bf16 a[144:159], a[44:47], v[124:127], a[144:159]
    v_exp_f32 v26, v26
    v_exp_f32 v27, v27
    v_cvt_pk_bf16_f32 v116, v24, v25
    v_exp_f32 v28, v28
    v_cvt_pk_bf16_f32 v117, v26, v27
    v_smfmac_f32_16x16x64_bf16 v[188:191], v[152:155], v[120:127], v156
    s_waitcnt lgkmcnt(0)
    buffer_store_dwordx4 a[68:71], v163, s[40:43], s100 offen offset:1024 sc1
    buffer_store_dwordx4 a[76:79], v163, s[40:43], s100 offen offset:3072 sc1
    buffer_load_dwordx4 a[32:35], v233, s[24:27], s57 offen offset:0 sc1
    buffer_load_dwordx4 a[36:39], v233, s[24:27], s57 offen offset:1024 sc1
    buffer_load_dwordx4 a[40:43], v233, s[24:27], s57 offen offset:2048 sc1
    buffer_load_dwordx4 a[44:47], v233, s[24:27], s57 offen offset:3072 sc1
    buffer_load_dwordx4 v161, s[80:83], s68 offen lds
    buffer_load_dwordx4 v239, s[80:83], s68 offen offset:1024 lds
    v_exp_f32 v29, v29
    v_exp_f32 v30, v30
    v_exp_f32 v31, v31
    v_cvt_pk_bf16_f32 v118, v28, v29
    v_cvt_pk_bf16_f32 v119, v30, v31
    v_mfma_f32_32x32x16_bf16 v[16:31], a[48:51], a[112:115], v[80:95]
    s_add_u32 s57, s57, 4096
    v_exp_f32 v32, v32
    v_exp_f32 v33, v33
    v_exp_f32 v34, v34
    v_exp_f32 v35, v35
    v_mfma_f32_32x32x16_bf16 v[16:31], a[52:55], a[116:119], v[16:31]
    v_exp_f32 v36, v36
    v_cvt_pk_bf16_f32 v120, v32, v33
    v_exp_f32 v37, v37
    v_cvt_pk_bf16_f32 v121, v34, v35
    v_exp_f32 v38, v38
    v_mfma_f32_32x32x16_bf16 v[192:207], a[56:59], v[112:115], v[192:207]
    v_exp_f32 v39, v39
    v_cvt_pk_bf16_f32 v122, v36, v37
    v_exp_f32 v40, v40
    v_exp_f32 v41, v41
    v_cvt_pk_bf16_f32 v123, v38, v39
    v_mfma_f32_32x32x16_bf16 v[192:207], a[60:63], v[116:119], v[192:207]
    v_exp_f32 v42, v42
    v_exp_f32 v43, v43
    v_cvt_pk_bf16_f32 v124, v40, v41
    v_exp_f32 v44, v44
    v_cvt_pk_bf16_f32 v125, v42, v43
    v_smfmac_f32_16x16x64_bf16 v[176:179], v[152:155], v[112:119], v156
    v_exp_f32 v45, v45
    v_exp_f32 v46, v46
    v_exp_f32 v47, v47
    v_cvt_pk_bf16_f32 v126, v44, v45
    v_cvt_pk_bf16_f32 v127, v46, v47
    v_mfma_f32_32x32x16_bf16 v[32:47], a[48:51], a[120:123], v[96:111]
    v_exp_f32 v16, v16
    v_exp_f32 v17, v17
    v_exp_f32 v18, v18
    v_exp_f32 v19, v19
    v_mfma_f32_32x32x16_bf16 v[32:47], a[52:55], a[124:127], v[32:47]
    s_add_u32 s68, s72, 360448
    v_exp_f32 v20, v20
    v_cvt_pk_bf16_f32 v112, v16, v17
    v_exp_f32 v21, v21
    v_cvt_pk_bf16_f32 v113, v18, v19
    v_exp_f32 v22, v22
    v_mfma_f32_32x32x16_bf16 v[208:223], a[56:59], v[120:123], v[208:223]
    v_exp_f32 v23, v23
    v_cvt_pk_bf16_f32 v114, v20, v21
    v_exp_f32 v24, v24
    v_exp_f32 v25, v25
    v_cvt_pk_bf16_f32 v115, v22, v23
    v_mfma_f32_32x32x16_bf16 v[208:223], a[60:63], v[124:127], v[208:223]
    v_exp_f32 v26, v26
    v_exp_f32 v27, v27
    v_cvt_pk_bf16_f32 v116, v24, v25
    v_exp_f32 v28, v28
    v_cvt_pk_bf16_f32 v117, v26, v27
    v_smfmac_f32_16x16x64_bf16 v[180:183], v[152:155], v[120:127], v156
    s_waitcnt vmcnt(28)
    v_exp_f32 v29, v29
    v_exp_f32 v30, v30
    v_exp_f32 v31, v31
    v_cvt_pk_bf16_f32 v118, v28, v29
    v_cvt_pk_bf16_f32 v119, v30, v31
    v_mfma_f32_32x32x16_bf16 v[16:31], a[184:187], v[0:3], v[48:63]
    v_exp_f32 v32, v32
    v_exp_f32 v33, v33
    v_exp_f32 v34, v34
    v_exp_f32 v35, v35
    v_mfma_f32_32x32x16_bf16 v[16:31], a[188:191], v[4:7], v[16:31]
    v_exp_f32 v36, v36
    v_cvt_pk_bf16_f32 v120, v32, v33
    v_exp_f32 v37, v37
    v_cvt_pk_bf16_f32 v121, v34, v35
    v_exp_f32 v38, v38
    v_mfma_f32_32x32x16_bf16 a[128:143], a[56:59], v[112:115], a[128:143]
    s_add_u32 m0, s73, 22528
    v_exp_f32 v39, v39
    v_cvt_pk_bf16_f32 v122, v36, v37
    v_exp_f32 v40, v40
    v_exp_f32 v41, v41
    v_cvt_pk_bf16_f32 v123, v38, v39
    v_mfma_f32_32x32x16_bf16 a[128:143], a[60:63], v[116:119], a[128:143]
    v_exp_f32 v42, v42
    v_exp_f32 v43, v43
    v_cvt_pk_bf16_f32 v124, v40, v41
    v_exp_f32 v44, v44
    v_cvt_pk_bf16_f32 v125, v42, v43
    v_smfmac_f32_16x16x64_bf16 v[184:187], v[152:155], v[112:119], v156
    v_exp_f32 v45, v45
    v_exp_f32 v46, v46
    v_exp_f32 v47, v47
    v_cvt_pk_bf16_f32 v126, v44, v45
    v_cvt_pk_bf16_f32 v127, v46, v47
    v_mfma_f32_32x32x16_bf16 v[32:47], a[184:187], v[8:11], v[64:79]
    v_exp_f32 v16, v16
    v_exp_f32 v17, v17
    v_exp_f32 v18, v18
    v_exp_f32 v19, v19
    v_mfma_f32_32x32x16_bf16 v[32:47], a[188:191], v[12:15], v[32:47]
    v_exp_f32 v20, v20
    v_cvt_pk_bf16_f32 v112, v16, v17
    v_exp_f32 v21, v21
    v_cvt_pk_bf16_f32 v113, v18, v19
    v_exp_f32 v22, v22
    v_mfma_f32_32x32x16_bf16 a[144:159], a[56:59], v[120:123], a[144:159]
    v_exp_f32 v23, v23
    v_cvt_pk_bf16_f32 v114, v20, v21
    v_exp_f32 v24, v24
    v_exp_f32 v25, v25
    v_cvt_pk_bf16_f32 v115, v22, v23
    v_mfma_f32_32x32x16_bf16 a[144:159], a[60:63], v[124:127], a[144:159]
    v_exp_f32 v26, v26
    v_exp_f32 v27, v27
    v_cvt_pk_bf16_f32 v116, v24, v25
    v_exp_f32 v28, v28
    v_cvt_pk_bf16_f32 v117, v26, v27
    v_smfmac_f32_16x16x64_bf16 v[188:191], v[152:155], v[120:127], v156
    buffer_store_dwordx4 a[84:87], v163, s[40:43], s65 offen offset:1024 sc1
    buffer_store_dwordx4 a[92:95], v163, s[40:43], s65 offen offset:3072 sc1
    buffer_load_dwordx4 a[48:51], v233, s[24:27], s57 offen offset:0 sc1
    buffer_load_dwordx4 a[52:55], v233, s[24:27], s57 offen offset:1024 sc1
    buffer_load_dwordx4 a[56:59], v233, s[24:27], s57 offen offset:2048 sc1
    buffer_load_dwordx4 a[60:63], v233, s[24:27], s57 offen offset:3072 sc1
    buffer_load_dwordx4 v161, s[80:83], s68 offen lds
    buffer_load_dwordx4 v239, s[80:83], s68 offen offset:1024 lds
    v_exp_f32 v29, v29
    v_exp_f32 v30, v30
    v_exp_f32 v31, v31
    v_cvt_pk_bf16_f32 v118, v28, v29
    v_cvt_pk_bf16_f32 v119, v30, v31
    v_mfma_f32_32x32x16_bf16 v[16:31], a[184:187], a[112:115], v[80:95]
    s_add_u32 s63, s63, 1
    v_exp_f32 v32, v32
    v_exp_f32 v33, v33
    v_exp_f32 v34, v34
    v_exp_f32 v35, v35
    v_mfma_f32_32x32x16_bf16 v[16:31], a[188:191], a[116:119], v[16:31]
    v_exp_f32 v36, v36
    v_cvt_pk_bf16_f32 v120, v32, v33
    v_exp_f32 v37, v37
    v_cvt_pk_bf16_f32 v121, v34, v35
    v_exp_f32 v38, v38
    v_mfma_f32_32x32x16_bf16 v[192:207], a[192:195], v[112:115], v[192:207]
    s_cmp_eq_u32 s63, s46
    v_exp_f32 v39, v39
    v_cvt_pk_bf16_f32 v122, v36, v37
    v_exp_f32 v40, v40
    v_exp_f32 v41, v41
    v_cvt_pk_bf16_f32 v123, v38, v39
    v_mfma_f32_32x32x16_bf16 v[192:207], a[196:199], v[116:119], v[192:207]
    v_exp_f32 v42, v42
    v_exp_f32 v43, v43
    v_cvt_pk_bf16_f32 v124, v40, v41
    v_exp_f32 v44, v44
    v_cvt_pk_bf16_f32 v125, v42, v43
    v_smfmac_f32_16x16x64_bf16 v[176:179], v[152:155], v[112:119], v156
    v_exp_f32 v45, v45
    v_exp_f32 v46, v46
    v_exp_f32 v47, v47
    v_cvt_pk_bf16_f32 v126, v44, v45
    v_cvt_pk_bf16_f32 v127, v46, v47
    v_mfma_f32_32x32x16_bf16 v[32:47], a[184:187], a[120:123], v[96:111]
    s_addc_u32 s63, s63, 0
    v_exp_f32 v16, v16
    v_exp_f32 v17, v17
    v_exp_f32 v18, v18
    v_exp_f32 v19, v19
    v_mfma_f32_32x32x16_bf16 v[32:47], a[188:191], a[124:127], v[32:47]
    v_exp_f32 v20, v20
    v_cvt_pk_bf16_f32 v112, v16, v17
    v_exp_f32 v21, v21
    v_cvt_pk_bf16_f32 v113, v18, v19
    v_exp_f32 v22, v22
    v_mfma_f32_32x32x16_bf16 v[208:223], a[192:195], v[120:123], v[208:223]
    s_lshl_b32 s57, s63, 14
    v_exp_f32 v23, v23
    v_cvt_pk_bf16_f32 v114, v20, v21
    v_exp_f32 v24, v24
    v_exp_f32 v25, v25
    v_cvt_pk_bf16_f32 v115, v22, v23
    v_mfma_f32_32x32x16_bf16 v[208:223], a[196:199], v[124:127], v[208:223]
    v_exp_f32 v26, v26
    v_exp_f32 v27, v27
    v_cvt_pk_bf16_f32 v116, v24, v25
    v_exp_f32 v28, v28
    v_cvt_pk_bf16_f32 v117, v26, v27
    v_smfmac_f32_16x16x64_bf16 v[180:183], v[152:155], v[120:127], v156
    s_waitcnt vmcnt(30)
    v_exp_f32 v29, v29
    v_exp_f32 v30, v30
    v_exp_f32 v31, v31
    v_cvt_pk_bf16_f32 v118, v28, v29
    v_cvt_pk_bf16_f32 v119, v30, v31
    v_mfma_f32_32x32x16_bf16 v[16:31], a[200:203], v[0:3], v[48:63]
    v_exp_f32 v32, v32
    v_exp_f32 v33, v33
    v_exp_f32 v34, v34
    v_exp_f32 v35, v35
    v_mfma_f32_32x32x16_bf16 v[16:31], a[204:207], v[4:7], v[16:31]
    s_add_u32 s57, s57, s52
    v_exp_f32 v36, v36
    v_cvt_pk_bf16_f32 v120, v32, v33
    v_exp_f32 v37, v37
    v_cvt_pk_bf16_f32 v121, v34, v35
    v_exp_f32 v38, v38
    v_mfma_f32_32x32x16_bf16 a[128:143], a[192:195], v[112:115], a[128:143]
    v_exp_f32 v39, v39
    v_cvt_pk_bf16_f32 v122, v36, v37
    v_exp_f32 v40, v40
    v_exp_f32 v41, v41
    v_cvt_pk_bf16_f32 v123, v38, v39
    v_mfma_f32_32x32x16_bf16 a[128:143], a[196:199], v[116:119], a[128:143]
    s_add_u32 s68, s72, 393216
    v_exp_f32 v42, v42
    v_exp_f32 v43, v43
    v_cvt_pk_bf16_f32 v124, v40, v41
    v_exp_f32 v44, v44
    v_cvt_pk_bf16_f32 v125, v42, v43
    v_smfmac_f32_16x16x64_bf16 v[184:187], v[152:155], v[112:119], v156
    v_exp_f32 v45, v45
    v_exp_f32 v46, v46
    v_exp_f32 v47, v47
    v_cvt_pk_bf16_f32 v126, v44, v45
    v_cvt_pk_bf16_f32 v127, v46, v47
    v_mfma_f32_32x32x16_bf16 v[32:47], a[200:203], v[8:11], v[64:79]
    v_exp_f32 v16, v16
L_stub_8:
    s_cbranch_execz L_warm_w9_ret
    v_exp_f32 v17, v17
    v_exp_f32 v18, v18
    v_exp_f32 v19, v19
    v_mfma_f32_32x32x16_bf16 v[32:47], a[204:207], v[12:15], v[32:47]
    s_add_u32 m0, s73, 24576
    v_exp_f32 v20, v20
    v_cvt_pk_bf16_f32 v112, v16, v17
    v_exp_f32 v21, v21
    v_cvt_pk_bf16_f32 v113, v18, v19
    v_exp_f32 v22, v22
    v_mfma_f32_32x32x16_bf16 a[144:159], a[192:195], v[120:123], a[144:159]
    v_exp_f32 v23, v23
    v_cvt_pk_bf16_f32 v114, v20, v21
    v_exp_f32 v24, v24
    v_exp_f32 v25, v25
    v_cvt_pk_bf16_f32 v115, v22, v23
    v_mfma_f32_32x32x16_bf16 a[144:159], a[196:199], v[124:127], a[144:159]
    v_exp_f32 v26, v26
    v_exp_f32 v27, v27
    v_cvt_pk_bf16_f32 v116, v24, v25
    v_exp_f32 v28, v28
    v_cvt_pk_bf16_f32 v117, v26, v27
    v_smfmac_f32_16x16x64_bf16 v[188:191], v[152:155], v[120:127], v156
    buffer_store_dwordx4 a[100:103], v163, s[40:43], s71 offen offset:1024 sc1
    buffer_store_dwordx4 a[108:111], v163, s[40:43], s71 offen offset:3072 sc1
    buffer_load_dwordx4 a[184:187], v233, s[24:27], s57 offen offset:0 sc1
    buffer_load_dwordx4 a[188:191], v233, s[24:27], s57 offen offset:1024 sc1
    buffer_load_dwordx4 a[192:195], v233, s[24:27], s57 offen offset:2048 sc1
    buffer_load_dwordx4 a[196:199], v233, s[24:27], s57 offen offset:3072 sc1
    buffer_load_dwordx4 v161, s[80:83], s68 offen lds
    buffer_load_dwordx4 v239, s[80:83], s68 offen offset:1024 lds
    v_exp_f32 v29, v29
    v_exp_f32 v30, v30
    v_exp_f32 v31, v31
    v_cvt_pk_bf16_f32 v118, v28, v29
    v_cvt_pk_bf16_f32 v119, v30, v31
    v_mfma_f32_32x32x16_bf16 v[16:31], a[200:203], a[112:115], v[80:95]
    s_add_u32 s57, s57, 4096
    v_exp_f32 v32, v32
    v_exp_f32 v33, v33
    v_exp_f32 v34, v34
    v_exp_f32 v35, v35
    v_mfma_f32_32x32x16_bf16 v[16:31], a[204:207], a[116:119], v[16:31]
    v_exp_f32 v36, v36
    v_cvt_pk_bf16_f32 v120, v32, v33
    v_exp_f32 v37, v37
    v_cvt_pk_bf16_f32 v121, v34, v35
    v_exp_f32 v38, v38
    v_mfma_f32_32x32x16_bf16 v[192:207], a[208:211], v[112:115], v[192:207]
    v_exp_f32 v39, v39
    v_cvt_pk_bf16_f32 v122, v36, v37
    v_exp_f32 v40, v40
    v_exp_f32 v41, v41
    v_cvt_pk_bf16_f32 v123, v38, v39
    v_mfma_f32_32x32x16_bf16 v[192:207], a[212:215], v[116:119], v[192:207]
    v_exp_f32 v42, v42
    v_exp_f32 v43, v43
    v_cvt_pk_bf16_f32 v124, v40, v41
    v_exp_f32 v44, v44
    v_cvt_pk_bf16_f32 v125, v42, v43
    v_smfmac_f32_16x16x64_bf16 v[176:179], v[152:155], v[112:119], v156
    v_exp_f32 v45, v45
    v_exp_f32 v46, v46
    v_exp_f32 v47, v47
    v_cvt_pk_bf16_f32 v126, v44, v45
    v_cvt_pk_bf16_f32 v127, v46, v47
    v_mfma_f32_32x32x16_bf16 v[32:47], a[200:203], a[120:123], v[96:111]
    v_exp_f32 v16, v16
    v_exp_f32 v17, v17
    v_exp_f32 v18, v18
    v_exp_f32 v19, v19
    v_mfma_f32_32x32x16_bf16 v[32:47], a[204:207], a[124:127], v[32:47]
    s_add_u32 s68, s72, 425984
    v_exp_f32 v20, v20
    v_cvt_pk_bf16_f32 v112, v16, v17
    v_exp_f32 v21, v21
    v_cvt_pk_bf16_f32 v113, v18, v19
    v_exp_f32 v22, v22
    v_mfma_f32_32x32x16_bf16 v[208:223], a[208:211], v[120:123], v[208:223]
    v_exp_f32 v23, v23
    v_cvt_pk_bf16_f32 v114, v20, v21
    v_exp_f32 v24, v24
    v_exp_f32 v25, v25
    v_cvt_pk_bf16_f32 v115, v22, v23
    v_mfma_f32_32x32x16_bf16 v[208:223], a[212:215], v[124:127], v[208:223]
    v_exp_f32 v26, v26
    v_exp_f32 v27, v27
    v_cvt_pk_bf16_f32 v116, v24, v25
    v_exp_f32 v28, v28
    v_cvt_pk_bf16_f32 v117, v26, v27
    v_smfmac_f32_16x16x64_bf16 v[180:183], v[152:155], v[120:127], v156
    s_waitcnt vmcnt(32)
    v_exp_f32 v29, v29
    v_exp_f32 v30, v30
    v_exp_f32 v31, v31
    v_cvt_pk_bf16_f32 v118, v28, v29
    v_cvt_pk_bf16_f32 v119, v30, v31
    v_mfma_f32_32x32x16_bf16 v[16:31], a[0:3], v[0:3], v[48:63]
    v_exp_f32 v32, v32
    v_exp_f32 v33, v33
    v_exp_f32 v34, v34
    v_exp_f32 v35, v35
    v_mfma_f32_32x32x16_bf16 v[16:31], a[4:7], v[4:7], v[16:31]
    v_exp_f32 v36, v36
    v_cvt_pk_bf16_f32 v120, v32, v33
    v_exp_f32 v37, v37
    v_cvt_pk_bf16_f32 v121, v34, v35
    v_exp_f32 v38, v38
    v_mfma_f32_32x32x16_bf16 a[128:143], a[208:211], v[112:115], a[128:143]
    s_add_u32 m0, s73, 26624
    v_exp_f32 v39, v39
    v_cvt_pk_bf16_f32 v122, v36, v37
    v_exp_f32 v40, v40
    v_exp_f32 v41, v41
    v_cvt_pk_bf16_f32 v123, v38, v39
    v_mfma_f32_32x32x16_bf16 a[128:143], a[212:215], v[116:119], a[128:143]
    v_exp_f32 v42, v42
    v_exp_f32 v43, v43
    v_cvt_pk_bf16_f32 v124, v40, v41
    v_exp_f32 v44, v44
    v_cvt_pk_bf16_f32 v125, v42, v43
    v_smfmac_f32_16x16x64_bf16 v[184:187], v[152:155], v[112:119], v156
    v_exp_f32 v45, v45
    v_exp_f32 v46, v46
    v_exp_f32 v47, v47
    v_cvt_pk_bf16_f32 v126, v44, v45
    v_cvt_pk_bf16_f32 v127, v46, v47
    v_mfma_f32_32x32x16_bf16 v[32:47], a[0:3], v[8:11], v[64:79]
    v_exp_f32 v16, v16
    v_exp_f32 v17, v17
    v_exp_f32 v18, v18
    v_exp_f32 v19, v19
    v_mfma_f32_32x32x16_bf16 v[32:47], a[4:7], v[12:15], v[32:47]
    v_exp_f32 v20, v20
    v_cvt_pk_bf16_f32 v112, v16, v17
    v_exp_f32 v21, v21
    v_cvt_pk_bf16_f32 v113, v18, v19
    v_exp_f32 v22, v22
    v_mfma_f32_32x32x16_bf16 a[144:159], a[208:211], v[120:123], a[144:159]
    v_exp_f32 v23, v23
    v_cvt_pk_bf16_f32 v114, v20, v21
    v_exp_f32 v24, v24
    v_exp_f32 v25, v25
    v_cvt_pk_bf16_f32 v115, v22, v23
    v_mfma_f32_32x32x16_bf16 a[144:159], a[212:215], v[124:127], a[144:159]
    v_exp_f32 v26, v26
    v_exp_f32 v27, v27
    v_cvt_pk_bf16_f32 v116, v24, v25
    v_exp_f32 v28, v28
    v_cvt_pk_bf16_f32 v117, v26, v27
    v_smfmac_f32_16x16x64_bf16 v[188:191], v[152:155], v[120:127], v156
    buffer_store_dwordx4 a[64:67], v163, s[40:43], s100 offen offset:0 sc1
    buffer_store_dwordx4 a[164:167], v163, s[40:43], s53 offen offset:1024 sc1
    buffer_load_dwordx4 a[200:203], v233, s[24:27], s57 offen offset:0 sc1
    buffer_load_dwordx4 a[204:207], v233, s[24:27], s57 offen offset:1024 sc1
    buffer_load_dwordx4 a[208:211], v233, s[24:27], s57 offen offset:2048 sc1
    buffer_load_dwordx4 a[212:215], v233, s[24:27], s57 offen offset:3072 sc1
    buffer_load_dwordx4 v161, s[80:83], s68 offen lds
    buffer_load_dwordx4 v239, s[80:83], s68 offen offset:1024 lds
    v_exp_f32 v29, v29
    v_exp_f32 v30, v30
    v_exp_f32 v31, v31
    v_cvt_pk_bf16_f32 v118, v28, v29
    v_cvt_pk_bf16_f32 v119, v30, v31
    v_mfma_f32_32x32x16_bf16 v[16:31], a[0:3], a[112:115], v[80:95]
    s_add_u32 s68, s72, 458752
    v_exp_f32 v32, v32
    v_exp_f32 v33, v33
    v_exp_f32 v34, v34
    v_exp_f32 v35, v35
    v_mfma_f32_32x32x16_bf16 v[16:31], a[4:7], a[116:119], v[16:31]
    v_exp_f32 v36, v36
    v_cvt_pk_bf16_f32 v120, v32, v33
    v_exp_f32 v37, v37
    v_cvt_pk_bf16_f32 v121, v34, v35
    v_exp_f32 v38, v38
    v_mfma_f32_32x32x16_bf16 v[192:207], a[8:11], v[112:115], v[192:207]
    v_exp_f32 v39, v39
    v_cvt_pk_bf16_f32 v122, v36, v37
    v_exp_f32 v40, v40
    v_exp_f32 v41, v41
    v_cvt_pk_bf16_f32 v123, v38, v39
    v_mfma_f32_32x32x16_bf16 v[192:207], a[12:15], v[116:119], v[192:207]
    v_exp_f32 v42, v42
    v_exp_f32 v43, v43
    v_cvt_pk_bf16_f32 v124, v40, v41
    v_exp_f32 v44, v44
    v_cvt_pk_bf16_f32 v125, v42, v43
    v_smfmac_f32_16x16x64_bf16 v[176:179], v[152:155], v[112:119], v156
    v_exp_f32 v45, v45
    v_exp_f32 v46, v46
    v_exp_f32 v47, v47
    v_cvt_pk_bf16_f32 v126, v44, v45
    v_cvt_pk_bf16_f32 v127, v46, v47
    v_mfma_f32_32x32x16_bf16 v[32:47], a[0:3], a[120:123], v[96:111]
    v_exp_f32 v16, v16
    v_exp_f32 v17, v17
    v_exp_f32 v18, v18
    v_exp_f32 v19, v19
    v_mfma_f32_32x32x16_bf16 v[32:47], a[4:7], a[124:127], v[32:47]
    v_exp_f32 v20, v20
    v_cvt_pk_bf16_f32 v112, v16, v17
    v_exp_f32 v21, v21
    v_cvt_pk_bf16_f32 v113, v18, v19
    v_exp_f32 v22, v22
    v_mfma_f32_32x32x16_bf16 v[208:223], a[8:11], v[120:123], v[208:223]
    v_exp_f32 v23, v23
    v_cvt_pk_bf16_f32 v114, v20, v21
    v_exp_f32 v24, v24
    v_exp_f32 v25, v25
    v_cvt_pk_bf16_f32 v115, v22, v23
    v_mfma_f32_32x32x16_bf16 v[208:223], a[12:15], v[124:127], v[208:223]
    v_exp_f32 v26, v26
    v_exp_f32 v27, v27
    v_cvt_pk_bf16_f32 v116, v24, v25
    v_exp_f32 v28, v28
    v_cvt_pk_bf16_f32 v117, v26, v27
    v_smfmac_f32_16x16x64_bf16 v[180:183], v[152:155], v[120:127], v156
    s_waitcnt vmcnt(34)
    v_exp_f32 v29, v29
    v_exp_f32 v30, v30
    v_exp_f32 v31, v31
    v_cvt_pk_bf16_f32 v118, v28, v29
    v_cvt_pk_bf16_f32 v119, v30, v31
    v_mfma_f32_32x32x16_bf16 v[16:31], a[16:19], v[0:3], v[48:63]
    s_add_u32 m0, s73, 28672
    v_exp_f32 v32, v32
    v_exp_f32 v33, v33
    v_exp_f32 v34, v34
    v_exp_f32 v35, v35
    v_mfma_f32_32x32x16_bf16 v[16:31], a[20:23], v[4:7], v[16:31]
    v_exp_f32 v36, v36
    v_cvt_pk_bf16_f32 v120, v32, v33
    v_exp_f32 v37, v37
    v_cvt_pk_bf16_f32 v121, v34, v35
    v_exp_f32 v38, v38
    v_mfma_f32_32x32x16_bf16 a[128:143], a[8:11], v[112:115], a[128:143]
    v_exp_f32 v39, v39
    v_cvt_pk_bf16_f32 v122, v36, v37
    v_exp_f32 v40, v40
    v_exp_f32 v41, v41
    v_cvt_pk_bf16_f32 v123, v38, v39
    v_mfma_f32_32x32x16_bf16 a[128:143], a[12:15], v[116:119], a[128:143]
    v_exp_f32 v42, v42
    v_exp_f32 v43, v43
    v_cvt_pk_bf16_f32 v124, v40, v41
    v_exp_f32 v44, v44
    v_cvt_pk_bf16_f32 v125, v42, v43
    v_smfmac_f32_16x16x64_bf16 v[184:187], v[152:155], v[112:119], v156
    v_exp_f32 v45, v45
    v_exp_f32 v46, v46
    v_exp_f32 v47, v47
    v_cvt_pk_bf16_f32 v126, v44, v45
    v_cvt_pk_bf16_f32 v127, v46, v47
    v_mfma_f32_32x32x16_bf16 v[32:47], a[16:19], v[8:11], v[64:79]
    v_exp_f32 v16, v16
    v_exp_f32 v17, v17
    v_exp_f32 v18, v18
    v_exp_f32 v19, v19
    v_mfma_f32_32x32x16_bf16 v[32:47], a[20:23], v[12:15], v[32:47]
    v_exp_f32 v20, v20
    v_cvt_pk_bf16_f32 v112, v16, v17
    v_exp_f32 v21, v21
    v_cvt_pk_bf16_f32 v113, v18, v19
    v_exp_f32 v22, v22
    v_mfma_f32_32x32x16_bf16 a[144:159], a[8:11], v[120:123], a[144:159]
    v_exp_f32 v23, v23
    v_cvt_pk_bf16_f32 v114, v20, v21
    v_exp_f32 v24, v24
    v_exp_f32 v25, v25
    v_cvt_pk_bf16_f32 v115, v22, v23
    v_mfma_f32_32x32x16_bf16 a[144:159], a[12:15], v[124:127], a[144:159]
    v_exp_f32 v26, v26
    v_exp_f32 v27, v27
    v_cvt_pk_bf16_f32 v116, v24, v25
    v_exp_f32 v28, v28
    v_cvt_pk_bf16_f32 v117, v26, v27
    v_smfmac_f32_16x16x64_bf16 v[188:191], v[152:155], v[120:127], v156
    buffer_store_dwordx4 a[72:75], v163, s[40:43], s100 offen offset:2048 sc1
    buffer_store_dwordx4 a[80:83], v163, s[40:43], s65 offen offset:0 sc1
    buffer_load_dwordx4 v161, s[80:83], s68 offen lds
    buffer_load_dwordx4 v239, s[80:83], s68 offen offset:1024 lds
    v_exp_f32 v29, v29
    v_exp_f32 v30, v30
    v_exp_f32 v31, v31
    v_cvt_pk_bf16_f32 v118, v28, v29
    v_cvt_pk_bf16_f32 v119, v30, v31
    v_mfma_f32_32x32x16_bf16 v[16:31], a[16:19], a[112:115], v[80:95]
    s_add_u32 s68, s72, 491520
    v_exp_f32 v32, v32
    v_exp_f32 v33, v33
    v_exp_f32 v34, v34
    v_exp_f32 v35, v35
    v_mfma_f32_32x32x16_bf16 v[16:31], a[20:23], a[116:119], v[16:31]
    v_exp_f32 v36, v36
    v_cvt_pk_bf16_f32 v120, v32, v33
    v_exp_f32 v37, v37
    v_cvt_pk_bf16_f32 v121, v34, v35
    v_exp_f32 v38, v38
    v_mfma_f32_32x32x16_bf16 v[192:207], a[24:27], v[112:115], v[192:207]
    v_exp_f32 v39, v39
    v_cvt_pk_bf16_f32 v122, v36, v37
    v_exp_f32 v40, v40
    v_exp_f32 v41, v41
    v_cvt_pk_bf16_f32 v123, v38, v39
    v_mfma_f32_32x32x16_bf16 v[192:207], a[28:31], v[116:119], v[192:207]
    v_exp_f32 v42, v42
    v_exp_f32 v43, v43
    v_cvt_pk_bf16_f32 v124, v40, v41
    v_exp_f32 v44, v44
    v_cvt_pk_bf16_f32 v125, v42, v43
    v_smfmac_f32_16x16x64_bf16 v[176:179], v[152:155], v[112:119], v156
    v_exp_f32 v45, v45
    v_exp_f32 v46, v46
    v_exp_f32 v47, v47
    v_cvt_pk_bf16_f32 v126, v44, v45
    v_cvt_pk_bf16_f32 v127, v46, v47
    v_mfma_f32_32x32x16_bf16 v[32:47], a[16:19], a[120:123], v[96:111]
    v_exp_f32 v16, v16
    v_exp_f32 v17, v17
    v_exp_f32 v18, v18
    v_exp_f32 v19, v19
    v_mfma_f32_32x32x16_bf16 v[32:47], a[20:23], a[124:127], v[32:47]
    v_exp_f32 v20, v20
    v_cvt_pk_bf16_f32 v112, v16, v17
    v_exp_f32 v21, v21
    v_cvt_pk_bf16_f32 v113, v18, v19
    v_exp_f32 v22, v22
    v_mfma_f32_32x32x16_bf16 v[208:223], a[24:27], v[120:123], v[208:223]
    v_exp_f32 v23, v23
    v_cvt_pk_bf16_f32 v114, v20, v21
    v_exp_f32 v24, v24
    v_exp_f32 v25, v25
    v_cvt_pk_bf16_f32 v115, v22, v23
    v_mfma_f32_32x32x16_bf16 v[208:223], a[28:31], v[124:127], v[208:223]
    v_exp_f32 v26, v26
    v_exp_f32 v27, v27
    v_cvt_pk_bf16_f32 v116, v24, v25
    v_exp_f32 v28, v28
    v_cvt_pk_bf16_f32 v117, v26, v27
    v_smfmac_f32_16x16x64_bf16 v[180:183], v[152:155], v[120:127], v156
    s_waitcnt vmcnt(30)
    v_exp_f32 v29, v29
    v_exp_f32 v30, v30
    v_exp_f32 v31, v31
    v_cvt_pk_bf16_f32 v118, v28, v29
    v_cvt_pk_bf16_f32 v119, v30, v31
    v_mfma_f32_32x32x16_bf16 v[16:31], a[32:35], v[0:3], v[48:63]
    s_add_u32 m0, s73, 30720
    v_exp_f32 v32, v32
    v_exp_f32 v33, v33
    v_exp_f32 v34, v34
    v_exp_f32 v35, v35
    v_mfma_f32_32x32x16_bf16 v[16:31], a[36:39], v[4:7], v[16:31]
    v_exp_f32 v36, v36
    v_cvt_pk_bf16_f32 v120, v32, v33
    v_exp_f32 v37, v37
    v_cvt_pk_bf16_f32 v121, v34, v35
    v_exp_f32 v38, v38
    v_mfma_f32_32x32x16_bf16 a[128:143], a[24:27], v[112:115], a[128:143]
    v_exp_f32 v39, v39
    v_cvt_pk_bf16_f32 v122, v36, v37
    v_exp_f32 v40, v40
    v_exp_f32 v41, v41
    v_cvt_pk_bf16_f32 v123, v38, v39
    v_mfma_f32_32x32x16_bf16 a[128:143], a[28:31], v[116:119], a[128:143]
    v_exp_f32 v42, v42
    v_exp_f32 v43, v43
    v_cvt_pk_bf16_f32 v124, v40, v41
    v_exp_f32 v44, v44
    v_cvt_pk_bf16_f32 v125, v42, v43
    v_smfmac_f32_16x16x64_bf16 v[184:187], v[152:155], v[112:119], v156
    v_exp_f32 v45, v45
    v_exp_f32 v46, v46
    v_exp_f32 v47, v47
    v_cvt_pk_bf16_f32 v126, v44, v45
    v_cvt_pk_bf16_f32 v127, v46, v47
    v_mfma_f32_32x32x16_bf16 v[32:47], a[32:35], v[8:11], v[64:79]
    v_exp_f32 v16, v16
    v_exp_f32 v17, v17
    v_exp_f32 v18, v18
    v_exp_f32 v19, v19
    v_mfma_f32_32x32x16_bf16 v[32:47], a[36:39], v[12:15], v[32:47]
    v_exp_f32 v20, v20
    v_cvt_pk_bf16_f32 v112, v16, v17
    v_exp_f32 v21, v21
    v_cvt_pk_bf16_f32 v113, v18, v19
    v_exp_f32 v22, v22
    v_mfma_f32_32x32x16_bf16 a[144:159], a[24:27], v[120:123], a[144:159]
    v_exp_f32 v23, v23
    v_cvt_pk_bf16_f32 v114, v20, v21
    v_exp_f32 v24, v24
    v_exp_f32 v25, v25
    v_cvt_pk_bf16_f32 v115, v22, v23
    v_mfma_f32_32x32x16_bf16 a[144:159], a[28:31], v[124:127], a[144:159]
    v_exp_f32 v26, v26
    v_exp_f32 v27, v27
    v_cvt_pk_bf16_f32 v116, v24, v25
    v_exp_f32 v28, v28
    v_cvt_pk_bf16_f32 v117, v26, v27
    v_smfmac_f32_16x16x64_bf16 v[188:191], v[152:155], v[120:127], v156
    buffer_store_dwordx4 a[88:91], v163, s[40:43], s65 offen offset:2048 sc1
    buffer_store_dwordx4 a[96:99], v163, s[40:43], s71 offen offset:0 sc1
    buffer_load_dwordx4 v161, s[80:83], s68 offen lds
    buffer_load_dwordx4 v239, s[80:83], s68 offen offset:1024 lds
    v_exp_f32 v29, v29
    v_exp_f32 v30, v30
    v_exp_f32 v31, v31
    v_cvt_pk_bf16_f32 v118, v28, v29
    v_cvt_pk_bf16_f32 v119, v30, v31
    v_mfma_f32_32x32x16_bf16 v[16:31], a[32:35], a[112:115], v[80:95]
    v_exp_f32 v32, v32
    v_exp_f32 v33, v33
    v_exp_f32 v34, v34
    v_exp_f32 v35, v35
    v_mfma_f32_32x32x16_bf16 v[16:31], a[36:39], a[116:119], v[16:31]
    v_exp_f32 v36, v36
    v_cvt_pk_bf16_f32 v120, v32, v33
    v_exp_f32 v37, v37
    v_cvt_pk_bf16_f32 v121, v34, v35
    v_exp_f32 v38, v38
    v_mfma_f32_32x32x16_bf16 v[192:207], a[40:43], v[112:115], v[192:207]
    v_exp_f32 v39, v39
    v_cvt_pk_bf16_f32 v122, v36, v37
    v_exp_f32 v40, v40
    v_exp_f32 v41, v41
    v_cvt_pk_bf16_f32 v123, v38, v39
    v_mfma_f32_32x32x16_bf16 v[192:207], a[44:47], v[116:119], v[192:207]
    v_exp_f32 v42, v42
    v_exp_f32 v43, v43
    v_cvt_pk_bf16_f32 v124, v40, v41
    v_exp_f32 v44, v44
    v_cvt_pk_bf16_f32 v125, v42, v43
    v_smfmac_f32_16x16x64_bf16 v[176:179], v[152:155], v[112:119], v156
    v_exp_f32 v45, v45
    v_exp_f32 v46, v46
    v_exp_f32 v47, v47
    v_cvt_pk_bf16_f32 v126, v44, v45
    v_cvt_pk_bf16_f32 v127, v46, v47
    v_mfma_f32_32x32x16_bf16 v[32:47], a[32:35], a[120:123], v[96:111]
    v_exp_f32 v16, v16
    v_exp_f32 v17, v17
    v_exp_f32 v18, v18
    v_exp_f32 v19, v19
    v_mfma_f32_32x32x16_bf16 v[32:47], a[36:39], a[124:127], v[32:47]
    v_exp_f32 v20, v20
    v_cvt_pk_bf16_f32 v112, v16, v17
    v_exp_f32 v21, v21
    v_cvt_pk_bf16_f32 v113, v18, v19
    v_exp_f32 v22, v22
    v_mfma_f32_32x32x16_bf16 v[208:223], a[40:43], v[120:123], v[208:223]
    v_exp_f32 v23, v23
    v_cvt_pk_bf16_f32 v114, v20, v21
    v_exp_f32 v24, v24
    v_exp_f32 v25, v25
    v_cvt_pk_bf16_f32 v115, v22, v23
    v_mfma_f32_32x32x16_bf16 v[208:223], a[44:47], v[124:127], v[208:223]
    v_exp_f32 v26, v26
    v_exp_f32 v27, v27
    v_cvt_pk_bf16_f32 v116, v24, v25
    v_exp_f32 v28, v28
    v_cvt_pk_bf16_f32 v117, v26, v27
    v_smfmac_f32_16x16x64_bf16 v[180:183], v[152:155], v[120:127], v156
    s_waitcnt vmcnt(26)
    v_exp_f32 v29, v29
    v_exp_f32 v30, v30
    v_exp_f32 v31, v31
    v_cvt_pk_bf16_f32 v118, v28, v29
    v_cvt_pk_bf16_f32 v119, v30, v31
    v_mfma_f32_32x32x16_bf16 v[16:31], a[48:51], v[0:3], v[48:63]
    v_exp_f32 v32, v32
    v_exp_f32 v33, v33
    v_exp_f32 v34, v34
    v_exp_f32 v35, v35
    v_mfma_f32_32x32x16_bf16 v[16:31], a[52:55], v[4:7], v[16:31]
    v_exp_f32 v36, v36
    v_cvt_pk_bf16_f32 v120, v32, v33
    v_exp_f32 v37, v37
    v_cvt_pk_bf16_f32 v121, v34, v35
    v_exp_f32 v38, v38
    v_mfma_f32_32x32x16_bf16 a[128:143], a[40:43], v[112:115], a[128:143]
    v_exp_f32 v39, v39
    v_cvt_pk_bf16_f32 v122, v36, v37
    v_exp_f32 v40, v40
    v_exp_f32 v41, v41
    v_cvt_pk_bf16_f32 v123, v38, v39
    v_mfma_f32_32x32x16_bf16 a[128:143], a[44:47], v[116:119], a[128:143]
    v_exp_f32 v42, v42
    v_exp_f32 v43, v43
    v_cvt_pk_bf16_f32 v124, v40, v41
    v_exp_f32 v44, v44
    v_cvt_pk_bf16_f32 v125, v42, v43
    v_smfmac_f32_16x16x64_bf16 v[184:187], v[152:155], v[112:119], v156
    v_exp_f32 v45, v45
    v_exp_f32 v46, v46
    v_exp_f32 v47, v47
    v_cvt_pk_bf16_f32 v126, v44, v45
    v_cvt_pk_bf16_f32 v127, v46, v47
    v_mfma_f32_32x32x16_bf16 v[32:47], a[48:51], v[8:11], v[64:79]
    v_exp_f32 v16, v16
    v_exp_f32 v17, v17
    v_exp_f32 v18, v18
    v_exp_f32 v19, v19
    v_mfma_f32_32x32x16_bf16 v[32:47], a[52:55], v[12:15], v[32:47]
    v_exp_f32 v20, v20
    v_cvt_pk_bf16_f32 v112, v16, v17
    v_exp_f32 v21, v21
    v_cvt_pk_bf16_f32 v113, v18, v19
    v_exp_f32 v22, v22
    v_mfma_f32_32x32x16_bf16 a[144:159], a[40:43], v[120:123], a[144:159]
    v_exp_f32 v23, v23
    v_cvt_pk_bf16_f32 v114, v20, v21
    v_exp_f32 v24, v24
    v_exp_f32 v25, v25
    v_cvt_pk_bf16_f32 v115, v22, v23
    v_mfma_f32_32x32x16_bf16 a[144:159], a[44:47], v[124:127], a[144:159]
    v_exp_f32 v26, v26
    v_exp_f32 v27, v27
    v_cvt_pk_bf16_f32 v116, v24, v25
    v_exp_f32 v28, v28
    v_cvt_pk_bf16_f32 v117, v26, v27
    v_smfmac_f32_16x16x64_bf16 v[188:191], v[152:155], v[120:127], v156
    buffer_store_dwordx4 a[104:107], v163, s[40:43], s71 offen offset:2048 sc1
    buffer_store_dwordx4 a[160:163], v163, s[40:43], s53 offen offset:0 sc1
    global_load_dword v238, v[252:253], off
    v_exp_f32 v29, v29
    v_exp_f32 v30, v30
    v_exp_f32 v31, v31
    v_cvt_pk_bf16_f32 v118, v28, v29
    v_cvt_pk_bf16_f32 v119, v30, v31
    v_mfma_f32_32x32x16_bf16 v[16:31], a[48:51], a[112:115], v[80:95]
    v_exp_f32 v32, v32
    v_exp_f32 v33, v33
    v_exp_f32 v34, v34
    v_exp_f32 v35, v35
    v_mfma_f32_32x32x16_bf16 v[16:31], a[52:55], a[116:119], v[16:31]
    v_exp_f32 v36, v36
    v_cvt_pk_bf16_f32 v120, v32, v33
    v_exp_f32 v37, v37
    v_cvt_pk_bf16_f32 v121, v34, v35
    v_exp_f32 v38, v38
    v_mfma_f32_32x32x16_bf16 v[192:207], a[56:59], v[112:115], v[192:207]
    v_exp_f32 v39, v39
    v_cvt_pk_bf16_f32 v122, v36, v37
    v_exp_f32 v40, v40
    v_exp_f32 v41, v41
    v_cvt_pk_bf16_f32 v123, v38, v39
    v_mfma_f32_32x32x16_bf16 v[192:207], a[60:63], v[116:119], v[192:207]
    v_exp_f32 v42, v42
    v_exp_f32 v43, v43
    v_cvt_pk_bf16_f32 v124, v40, v41
    v_exp_f32 v44, v44
    v_cvt_pk_bf16_f32 v125, v42, v43
    v_smfmac_f32_16x16x64_bf16 v[176:179], v[152:155], v[112:119], v156
    v_exp_f32 v45, v45
    v_exp_f32 v46, v46
    v_exp_f32 v47, v47
    v_cvt_pk_bf16_f32 v126, v44, v45
    v_cvt_pk_bf16_f32 v127, v46, v47
    v_mfma_f32_32x32x16_bf16 v[32:47], a[48:51], a[120:123], v[96:111]
    s_lshl_b32 s60, s46, 18
    v_exp_f32 v16, v16
    v_exp_f32 v17, v17
    v_exp_f32 v18, v18
    v_exp_f32 v19, v19
    v_mfma_f32_32x32x16_bf16 v[32:47], a[52:55], a[124:127], v[32:47]
    s_lshl_b32 s61, s48, 17
    v_exp_f32 v20, v20
    v_cvt_pk_bf16_f32 v112, v16, v17
    v_exp_f32 v21, v21
    v_cvt_pk_bf16_f32 v113, v18, v19
    v_exp_f32 v22, v22
    v_mfma_f32_32x32x16_bf16 v[208:223], a[56:59], v[120:123], v[208:223]
    s_add_u32 s60, s60, s61
    v_exp_f32 v23, v23
    v_cvt_pk_bf16_f32 v114, v20, v21
    v_exp_f32 v24, v24
    v_exp_f32 v25, v25
    v_cvt_pk_bf16_f32 v115, v22, v23
    v_mfma_f32_32x32x16_bf16 v[208:223], a[60:63], v[124:127], v[208:223]
    s_lshl_b32 s61, s67, 10
    v_exp_f32 v26, v26
    v_exp_f32 v27, v27
    v_cvt_pk_bf16_f32 v116, v24, v25
    v_exp_f32 v28, v28
    v_cvt_pk_bf16_f32 v117, v26, v27
    v_smfmac_f32_16x16x64_bf16 v[180:183], v[152:155], v[120:127], v156
    s_waitcnt vmcnt(21)
    v_exp_f32 v29, v29
    v_exp_f32 v30, v30
    v_exp_f32 v31, v31
    v_cvt_pk_bf16_f32 v118, v28, v29
    v_cvt_pk_bf16_f32 v119, v30, v31
    v_mfma_f32_32x32x16_bf16 v[16:31], a[184:187], a[112:115], v[80:95]
    s_add_u32 s60, s60, s61
    v_exp_f32 v32, v32
    v_exp_f32 v33, v33
    v_exp_f32 v34, v34
    v_exp_f32 v35, v35
    v_mfma_f32_32x32x16_bf16 v[16:31], a[188:191], a[116:119], v[16:31]
    s_add_u32 s61, s60, 65536
    v_exp_f32 v36, v36
    v_cvt_pk_bf16_f32 v120, v32, v33
    v_exp_f32 v37, v37
    v_cvt_pk_bf16_f32 v121, v34, v35
    v_exp_f32 v38, v38
    v_mfma_f32_32x32x16_bf16 a[128:143], a[56:59], v[112:115], a[128:143]
    s_mov_b32 s101, s79
    v_exp_f32 v39, v39
    v_cvt_pk_bf16_f32 v122, v36, v37
    v_exp_f32 v40, v40
    v_exp_f32 v41, v41
    v_cvt_pk_bf16_f32 v123, v38, v39
    v_mfma_f32_32x32x16_bf16 a[128:143], a[60:63], v[116:119], a[128:143]
    s_mov_b32 s100, s56
    v_exp_f32 v42, v42
    v_exp_f32 v43, v43
    v_cvt_pk_bf16_f32 v124, v40, v41
    v_exp_f32 v44, v44
    v_cvt_pk_bf16_f32 v125, v42, v43
    v_smfmac_f32_16x16x64_bf16 v[184:187], v[152:155], v[112:119], v156
    v_exp_f32 v45, v45
    v_exp_f32 v46, v46
    v_exp_f32 v47, v47
    v_cvt_pk_bf16_f32 v126, v44, v45
    v_cvt_pk_bf16_f32 v127, v46, v47
    v_mfma_f32_32x32x16_bf16 v[32:47], a[184:187], a[120:123], v[96:111]
    s_mov_b32 s34, 20971520
    v_exp_f32 v16, v16
    v_exp_f32 v17, v17
    v_exp_f32 v18, v18
    v_exp_f32 v19, v19
    v_mfma_f32_32x32x16_bf16 v[32:47], a[188:191], a[124:127], v[32:47]
    s_mov_b32 s70, 0x53800000
    v_exp_f32 v20, v20
    v_cvt_pk_bf16_f32 v112, v16, v17
    v_exp_f32 v21, v21
    v_cvt_pk_bf16_f32 v113, v18, v19
    v_exp_f32 v22, v22
    v_mfma_f32_32x32x16_bf16 a[144:159], a[56:59], v[120:123], a[144:159]
    s_add_u32 s32, s22, 33554432
    v_exp_f32 v23, v23
    v_cvt_pk_bf16_f32 v114, v20, v21
    v_exp_f32 v24, v24
    v_exp_f32 v25, v25
    v_cvt_pk_bf16_f32 v115, v22, v23
    v_mfma_f32_32x32x16_bf16 a[144:159], a[60:63], v[124:127], a[144:159]
    s_addc_u32 s33, s23, 0
    v_exp_f32 v26, v26
    v_exp_f32 v27, v27
    v_cvt_pk_bf16_f32 v116, v24, v25
    v_exp_f32 v28, v28
    v_cvt_pk_bf16_f32 v117, v26, v27
    v_smfmac_f32_16x16x64_bf16 v[188:191], v[152:155], v[120:127], v156
    s_waitcnt vmcnt(13)
    v_exp_f32 v29, v29
    v_exp_f32 v30, v30
    v_exp_f32 v31, v31
    v_cvt_pk_bf16_f32 v118, v28, v29
    v_cvt_pk_bf16_f32 v119, v30, v31
    v_mfma_f32_32x32x16_bf16 v[16:31], a[200:203], a[112:115], v[80:95]
    v_exp_f32 v32, v32
    v_exp_f32 v33, v33
    v_exp_f32 v34, v34
    v_exp_f32 v35, v35
    v_mfma_f32_32x32x16_bf16 v[16:31], a[204:207], a[116:119], v[16:31]
    v_exp_f32 v36, v36
    v_cvt_pk_bf16_f32 v120, v32, v33
    v_exp_f32 v37, v37
    v_cvt_pk_bf16_f32 v121, v34, v35
    v_exp_f32 v38, v38
    v_mfma_f32_32x32x16_bf16 a[128:143], a[192:195], v[112:115], a[128:143]
    v_exp_f32 v39, v39
    v_cvt_pk_bf16_f32 v122, v36, v37
    v_exp_f32 v40, v40
    v_exp_f32 v41, v41
    v_cvt_pk_bf16_f32 v123, v38, v39
    v_mfma_f32_32x32x16_bf16 a[128:143], a[196:199], v[116:119], a[128:143]
    v_exp_f32 v42, v42
    v_exp_f32 v43, v43
    v_cvt_pk_bf16_f32 v124, v40, v41
    v_exp_f32 v44, v44
    v_cvt_pk_bf16_f32 v125, v42, v43
    v_smfmac_f32_16x16x64_bf16 v[184:187], v[152:155], v[112:119], v156
    v_exp_f32 v45, v45
    v_exp_f32 v46, v46
    v_exp_f32 v47, v47
    v_cvt_pk_bf16_f32 v126, v44, v45
    v_cvt_pk_bf16_f32 v127, v46, v47
    v_mfma_f32_32x32x16_bf16 v[32:47], a[200:203], a[120:123], v[96:111]
    v_exp_f32 v16, v16
    v_exp_f32 v17, v17
    v_exp_f32 v18, v18
    v_exp_f32 v19, v19
    v_mfma_f32_32x32x16_bf16 v[32:47], a[204:207], a[124:127], v[32:47]
    v_exp_f32 v20, v20
    v_cvt_pk_bf16_f32 v112, v16, v17
L_stub_9:
    s_cbranch_execz L_warm_w9_ret
    v_exp_f32 v21, v21
    v_cvt_pk_bf16_f32 v113, v18, v19
    v_exp_f32 v22, v22
    v_mfma_f32_32x32x16_bf16 a[144:159], a[192:195], v[120:123], a[144:159]
    v_exp_f32 v23, v23
    v_cvt_pk_bf16_f32 v114, v20, v21
    v_exp_f32 v24, v24
    v_exp_f32 v25, v25
    v_cvt_pk_bf16_f32 v115, v22, v23
    v_mfma_f32_32x32x16_bf16 a[144:159], a[196:199], v[124:127], a[144:159]
    v_exp_f32 v26, v26
    v_exp_f32 v27, v27
    v_cvt_pk_bf16_f32 v116, v24, v25
    v_exp_f32 v28, v28
    v_cvt_pk_bf16_f32 v117, v26, v27
    v_smfmac_f32_16x16x64_bf16 v[188:191], v[152:155], v[120:127], v156
    v_add_u32 v160, s73, v233
    v_add_u32 v157, 0x20000, v157
    ds_read_b128 v[228:231], v160
    v_exp_f32 v29, v29
    v_exp_f32 v30, v30
    v_exp_f32 v31, v31
    v_cvt_pk_bf16_f32 v118, v28, v29
    v_cvt_pk_bf16_f32 v119, v30, v31
    v_mfma_f32_32x32x16_bf16 v[16:31], a[184:187], v[0:3], v[48:63]
    v_exp_f32 v32, v32
    v_exp_f32 v33, v33
    v_exp_f32 v34, v34
    v_exp_f32 v35, v35
    v_mfma_f32_32x32x16_bf16 v[16:31], a[188:191], v[4:7], v[16:31]
    v_exp_f32 v36, v36
    v_cvt_pk_bf16_f32 v120, v32, v33
    v_exp_f32 v37, v37
    v_cvt_pk_bf16_f32 v121, v34, v35
    v_exp_f32 v38, v38
    v_mfma_f32_32x32x16_bf16 a[128:143], a[208:211], v[112:115], a[128:143]
    v_exp_f32 v39, v39
    v_cvt_pk_bf16_f32 v122, v36, v37
    v_exp_f32 v40, v40
    v_exp_f32 v41, v41
    v_cvt_pk_bf16_f32 v123, v38, v39
    v_mfma_f32_32x32x16_bf16 a[128:143], a[212:215], v[116:119], a[128:143]
    v_exp_f32 v42, v42
    v_exp_f32 v43, v43
    v_cvt_pk_bf16_f32 v124, v40, v41
    v_exp_f32 v44, v44
    v_cvt_pk_bf16_f32 v125, v42, v43
    v_smfmac_f32_16x16x64_bf16 v[184:187], v[152:155], v[112:119], v156
    v_exp_f32 v45, v45
    v_exp_f32 v46, v46
    v_exp_f32 v47, v47
    v_cvt_pk_bf16_f32 v126, v44, v45
    v_cvt_pk_bf16_f32 v127, v46, v47
    v_mfma_f32_32x32x16_bf16 v[32:47], a[184:187], v[8:11], v[64:79]
    v_exp_f32 v16, v16
    v_exp_f32 v17, v17
    v_exp_f32 v18, v18
    v_exp_f32 v19, v19
    v_mfma_f32_32x32x16_bf16 v[32:47], a[188:191], v[12:15], v[32:47]
    ds_write_b128 v157, a[128:131] offset:0
    v_exp_f32 v20, v20
    v_cvt_pk_bf16_f32 v112, v16, v17
    v_exp_f32 v21, v21
    v_cvt_pk_bf16_f32 v113, v18, v19
    v_exp_f32 v22, v22
    v_mfma_f32_32x32x16_bf16 a[144:159], a[208:211], v[120:123], a[144:159]
    ds_write_b128 v157, a[132:135] offset:1024
    v_exp_f32 v23, v23
    v_cvt_pk_bf16_f32 v114, v20, v21
    v_exp_f32 v24, v24
    v_exp_f32 v25, v25
    v_cvt_pk_bf16_f32 v115, v22, v23
    v_mfma_f32_32x32x16_bf16 a[144:159], a[212:215], v[124:127], a[144:159]
    ds_write_b128 v157, a[136:139] offset:2048
    v_exp_f32 v26, v26
    v_exp_f32 v27, v27
    v_cvt_pk_bf16_f32 v116, v24, v25
    v_exp_f32 v28, v28
    v_cvt_pk_bf16_f32 v117, v26, v27
    v_smfmac_f32_16x16x64_bf16 v[188:191], v[152:155], v[120:127], v156
    ds_write_b128 v157, a[140:143] offset:3072
    v_exp_f32 v29, v29
    v_exp_f32 v30, v30
    v_exp_f32 v31, v31
    v_cvt_pk_bf16_f32 v118, v28, v29
    v_cvt_pk_bf16_f32 v119, v30, v31
    v_mfma_f32_32x32x16_bf16 v[16:31], a[200:203], v[0:3], v[48:63]
    v_exp_f32 v32, v32
    v_exp_f32 v33, v33
    v_exp_f32 v34, v34
    v_exp_f32 v35, v35
    v_mfma_f32_32x32x16_bf16 v[16:31], a[204:207], v[4:7], v[16:31]
    ds_write_b128 v157, a[144:147] offset:4096
    v_exp_f32 v36, v36
    v_cvt_pk_bf16_f32 v120, v32, v33
    v_exp_f32 v37, v37
    v_cvt_pk_bf16_f32 v121, v34, v35
    v_exp_f32 v38, v38
    v_mfma_f32_32x32x16_bf16 v[192:207], a[192:195], v[112:115], v[192:207]
    ds_write_b128 v157, a[148:151] offset:5120
    v_exp_f32 v39, v39
    v_cvt_pk_bf16_f32 v122, v36, v37
    v_exp_f32 v40, v40
    v_exp_f32 v41, v41
    v_cvt_pk_bf16_f32 v123, v38, v39
    v_mfma_f32_32x32x16_bf16 v[192:207], a[196:199], v[116:119], v[192:207]
    ds_write_b128 v157, a[152:155] offset:6144
    v_exp_f32 v42, v42
    v_exp_f32 v43, v43
    v_cvt_pk_bf16_f32 v124, v40, v41
    v_exp_f32 v44, v44
    v_cvt_pk_bf16_f32 v125, v42, v43
    v_smfmac_f32_16x16x64_bf16 v[176:179], v[152:155], v[112:119], v156
    ds_write_b128 v157, a[156:159] offset:7168
    v_add_f32 v224, v184, v185
    v_add_f32 v225, v188, v189
    v_mov_b32 v226, v166
    v_mov_b32 v227, v167
    v_exp_f32 v45, v45
    v_exp_f32 v46, v46
    v_exp_f32 v47, v47
    v_cvt_pk_bf16_f32 v126, v44, v45
    v_cvt_pk_bf16_f32 v127, v46, v47
    v_mfma_f32_32x32x16_bf16 v[32:47], a[200:203], v[8:11], v[64:79]
    ds_write_b128 v160, v[224:227]
    v_xor_b32 v157, 0x4000, v157
    v_xor_b32 v158, 0x10000, v160
    v_exp_f32 v16, v16
    v_exp_f32 v17, v17
    v_exp_f32 v18, v18
    v_exp_f32 v19, v19
    v_mfma_f32_32x32x16_bf16 v[32:47], a[204:207], v[12:15], v[32:47]
    v_exp_f32 v20, v20
    v_cvt_pk_bf16_f32 v112, v16, v17
    v_exp_f32 v21, v21
    v_cvt_pk_bf16_f32 v113, v18, v19
    v_exp_f32 v22, v22
    v_mfma_f32_32x32x16_bf16 v[208:223], a[192:195], v[120:123], v[208:223]
    v_exp_f32 v23, v23
    v_cvt_pk_bf16_f32 v114, v20, v21
    v_exp_f32 v24, v24
    v_exp_f32 v25, v25
    v_cvt_pk_bf16_f32 v115, v22, v23
    v_mfma_f32_32x32x16_bf16 v[208:223], a[196:199], v[124:127], v[208:223]
    v_exp_f32 v26, v26
    v_exp_f32 v27, v27
    v_cvt_pk_bf16_f32 v116, v24, v25
    v_exp_f32 v28, v28
    v_cvt_pk_bf16_f32 v117, v26, v27
    v_smfmac_f32_16x16x64_bf16 v[180:183], v[152:155], v[120:127], v156
    s_waitcnt lgkmcnt(0)
    s_barrier
    ds_read_b128 v[224:227], v158
    v_exp_f32 v29, v29
    v_exp_f32 v30, v30
    v_exp_f32 v31, v31
    v_cvt_pk_bf16_f32 v118, v28, v29
    v_cvt_pk_bf16_f32 v119, v30, v31
    v_exp_f32 v32, v32
    v_exp_f32 v33, v33
    v_exp_f32 v34, v34
    v_exp_f32 v35, v35
    v_exp_f32 v36, v36
    v_cvt_pk_bf16_f32 v120, v32, v33
    v_exp_f32 v37, v37
    v_cvt_pk_bf16_f32 v121, v34, v35
    v_exp_f32 v38, v38
    v_mfma_f32_32x32x16_bf16 v[192:207], a[208:211], v[112:115], v[192:207]
    ds_read_b128 v[80:83], v157 offset:0
    ds_read_b128 v[84:87], v157 offset:1024
    ds_read_b128 v[88:91], v157 offset:2048
    v_exp_f32 v39, v39
    v_cvt_pk_bf16_f32 v122, v36, v37
    v_exp_f32 v40, v40
    v_exp_f32 v41, v41
    v_cvt_pk_bf16_f32 v123, v38, v39
    v_mfma_f32_32x32x16_bf16 v[192:207], a[212:215], v[116:119], v[192:207]
    ds_read_b128 v[92:95], v157 offset:3072
    ds_read_b128 v[96:99], v157 offset:4096
    ds_read_b128 v[100:103], v157 offset:5120
    v_exp_f32 v42, v42
    v_exp_f32 v43, v43
    v_cvt_pk_bf16_f32 v124, v40, v41
    v_exp_f32 v44, v44
    v_cvt_pk_bf16_f32 v125, v42, v43
    v_smfmac_f32_16x16x64_bf16 v[176:179], v[152:155], v[112:119], v156
    ds_read_b128 v[104:107], v157 offset:6144
    ds_read_b128 v[108:111], v157 offset:7168
    v_exp_f32 v45, v45
    v_exp_f32 v46, v46
    v_exp_f32 v47, v47
    v_cvt_pk_bf16_f32 v126, v44, v45
    v_cvt_pk_bf16_f32 v127, v46, v47
    s_nop 1
    v_smfmac_f32_16x16x64_bf16 v[180:183], v[152:155], v[120:127], v156
    v_mfma_f32_32x32x16_bf16 v[208:223], a[208:211], v[120:123], v[208:223]
    v_mfma_f32_32x32x16_bf16 v[208:223], a[212:215], v[124:127], v[208:223]
    s_waitcnt lgkmcnt(8)
    v_max_f32 v250, v164, v226
    v_max_f32 v251, v165, v227
    v_sub_f32 v248, v164, v250
    v_sub_f32 v249, v165, v251
    v_sub_f32 v246, v226, v250
    v_sub_f32 v247, v227, v251
    v_add_f32 v244, v176, v177
    v_add_f32 v245, v180, v181
    v_add_f32 v242, v224, v225
    v_add_f32 v243, v244, v245
    v_add_f32 v242, v242, v243
    v_cmp_ngt_f32 vcc, s70, v242
    v_exp_f32 v248, v248
    v_exp_f32 v249, v249
    v_exp_f32 v246, v246
    v_exp_f32 v247, v247
    v_pk_mul_f32 v[244:245], v[244:245], v[248:249] op_sel:[0,0] op_sel_hi:[1,1]
    s_cbranch_vccnz L_sequential_preLN__softmax_full_mha__glu_gated_swiglu__prompt_kernel_fb_4
    v_pk_fma_f32 v[244:245], v[224:225], v[246:247], v[244:245] op_sel:[0,0,0] op_sel_hi:[1,1,1]
    v_rcp_f32 v250, v244
    v_rcp_f32 v251, v245
    s_waitcnt lgkmcnt(0)
    v_pk_mul_f32 v[244:245], v[248:249], v[250:251] op_sel:[0,0] op_sel_hi:[1,1]
    v_pk_mul_f32 v[246:247], v[246:247], v[250:251] op_sel:[0,0] op_sel_hi:[1,1]
L_sequential_preLN__softmax_full_mha__glu_gated_swiglu__prompt_kernel_nofb_5:
    v_pk_mul_f32 v[192:193], v[192:193], v[244:245] op_sel:[0,0] op_sel_hi:[1,0]
    v_pk_mul_f32 v[194:195], v[194:195], v[244:245] op_sel:[0,0] op_sel_hi:[1,0]
    v_pk_mul_f32 v[196:197], v[196:197], v[244:245] op_sel:[0,0] op_sel_hi:[1,0]
    v_pk_mul_f32 v[198:199], v[198:199], v[244:245] op_sel:[0,0] op_sel_hi:[1,0]
    v_pk_fma_f32 v[192:193], v[80:81], v[246:247], v[192:193] op_sel:[0,0,0] op_sel_hi:[1,0,1]
    v_pk_fma_f32 v[194:195], v[82:83], v[246:247], v[194:195] op_sel:[0,0,0] op_sel_hi:[1,0,1]
    v_pk_fma_f32 v[196:197], v[84:85], v[246:247], v[196:197] op_sel:[0,0,0] op_sel_hi:[1,0,1]
    v_pk_fma_f32 v[198:199], v[86:87], v[246:247], v[198:199] op_sel:[0,0,0] op_sel_hi:[1,0,1]
    v_cvt_pk_bf16_f32 v192, v192, v193
    v_cvt_pk_bf16_f32 v193, v194, v195
    v_cvt_pk_bf16_f32 v194, v196, v197
    v_cvt_pk_bf16_f32 v195, v198, v199
    buffer_store_dwordx4 v[192:195], v235, s[32:35], s60 offen offset:0 sc1
    v_pk_mul_f32 v[200:201], v[200:201], v[244:245] op_sel:[0,0] op_sel_hi:[1,0]
    v_pk_mul_f32 v[202:203], v[202:203], v[244:245] op_sel:[0,0] op_sel_hi:[1,0]
    v_pk_mul_f32 v[204:205], v[204:205], v[244:245] op_sel:[0,0] op_sel_hi:[1,0]
    v_pk_mul_f32 v[206:207], v[206:207], v[244:245] op_sel:[0,0] op_sel_hi:[1,0]
    v_pk_fma_f32 v[200:201], v[88:89], v[246:247], v[200:201] op_sel:[0,0,0] op_sel_hi:[1,0,1]
    v_pk_fma_f32 v[202:203], v[90:91], v[246:247], v[202:203] op_sel:[0,0,0] op_sel_hi:[1,0,1]
    v_pk_fma_f32 v[204:205], v[92:93], v[246:247], v[204:205] op_sel:[0,0,0] op_sel_hi:[1,0,1]
    v_pk_fma_f32 v[206:207], v[94:95], v[246:247], v[206:207] op_sel:[0,0,0] op_sel_hi:[1,0,1]
    v_cvt_pk_bf16_f32 v200, v200, v201
    v_cvt_pk_bf16_f32 v201, v202, v203
    v_cvt_pk_bf16_f32 v202, v204, v205
    v_cvt_pk_bf16_f32 v203, v206, v207
    buffer_store_dwordx4 v[200:203], v235, s[32:35], s60 offen offset:512 sc1
    v_pk_mul_f32 v[208:209], v[208:209], v[244:245] op_sel:[0,1] op_sel_hi:[1,1]
    v_pk_mul_f32 v[210:211], v[210:211], v[244:245] op_sel:[0,1] op_sel_hi:[1,1]
    v_pk_mul_f32 v[212:213], v[212:213], v[244:245] op_sel:[0,1] op_sel_hi:[1,1]
    v_pk_mul_f32 v[214:215], v[214:215], v[244:245] op_sel:[0,1] op_sel_hi:[1,1]
    v_pk_fma_f32 v[208:209], v[96:97], v[246:247], v[208:209] op_sel:[0,1,0] op_sel_hi:[1,1,1]
    v_pk_fma_f32 v[210:211], v[98:99], v[246:247], v[210:211] op_sel:[0,1,0] op_sel_hi:[1,1,1]
    v_pk_fma_f32 v[212:213], v[100:101], v[246:247], v[212:213] op_sel:[0,1,0] op_sel_hi:[1,1,1]
    v_pk_fma_f32 v[214:215], v[102:103], v[246:247], v[214:215] op_sel:[0,1,0] op_sel_hi:[1,1,1]
    v_cvt_pk_bf16_f32 v208, v208, v209
    v_cvt_pk_bf16_f32 v209, v210, v211
    v_cvt_pk_bf16_f32 v210, v212, v213
    v_cvt_pk_bf16_f32 v211, v214, v215
    buffer_store_dwordx4 v[208:211], v235, s[32:35], s61 offen offset:0 sc1
    v_pk_mul_f32 v[216:217], v[216:217], v[244:245] op_sel:[0,1] op_sel_hi:[1,1]
    v_pk_mul_f32 v[218:219], v[218:219], v[244:245] op_sel:[0,1] op_sel_hi:[1,1]
    v_pk_mul_f32 v[220:221], v[220:221], v[244:245] op_sel:[0,1] op_sel_hi:[1,1]
    v_pk_mul_f32 v[222:223], v[222:223], v[244:245] op_sel:[0,1] op_sel_hi:[1,1]
    v_pk_fma_f32 v[216:217], v[104:105], v[246:247], v[216:217] op_sel:[0,1,0] op_sel_hi:[1,1,1]
    v_pk_fma_f32 v[218:219], v[106:107], v[246:247], v[218:219] op_sel:[0,1,0] op_sel_hi:[1,1,1]
    v_pk_fma_f32 v[220:221], v[108:109], v[246:247], v[220:221] op_sel:[0,1,0] op_sel_hi:[1,1,1]
    v_pk_fma_f32 v[222:223], v[110:111], v[246:247], v[222:223] op_sel:[0,1,0] op_sel_hi:[1,1,1]
    v_cvt_pk_bf16_f32 v216, v216, v217
    v_cvt_pk_bf16_f32 v217, v218, v219
    v_cvt_pk_bf16_f32 v218, v220, v221
    v_cvt_pk_bf16_f32 v219, v222, v223
    buffer_store_dwordx4 v[216:219], v235, s[32:35], s61 offen offset:512 sc1
    s_add_u32 s28, s22, 0x1404000
    s_addc_u32 s29, s23, 0
    s_mov_b32 s30, 0x7000
    s_mov_b32 s31, 0x20000
    v_and_b32 v240, 15, v232
    v_lshrrev_b32 v241, 4, v232
    v_mov_b32 v246, 0x3f803f80
    v_lshlrev_b32 v239, 2, v232
    v_cmp_eq_u32 vcc, 0, v240
    v_accvgpr_read_b32 v128, a168
    s_nop 0
    v_cndmask_b32 v32, 0, v246, vcc
    v_mov_b32 v33, v32
    v_mov_b32 v34, v32
    v_mov_b32 v35, v32
    v_cmp_eq_u32 vcc, 4, v240
    v_accvgpr_read_b32 v129, a169
    s_nop 0
    v_cndmask_b32 v36, 0, v246, vcc
    v_mov_b32 v37, v36
    v_mov_b32 v38, v36
    v_mov_b32 v39, v36
    v_cmp_eq_u32 vcc, 8, v240
    v_accvgpr_read_b32 v130, a170
    s_nop 0
    v_cndmask_b32 v40, 0, v246, vcc
    v_mov_b32 v41, v40
    v_mov_b32 v42, v40
    v_mov_b32 v43, v40
    v_cmp_eq_u32 vcc, 12, v240
    v_accvgpr_read_b32 v131, a171
    s_nop 0
    v_cndmask_b32 v44, 0, v246, vcc
    v_mov_b32 v45, v44
    v_mov_b32 v46, v44
    v_mov_b32 v47, v44
    v_mfma_f32_16x16x32_bf16 v[168:171], v[32:35], a[64:67], 0
    v_mfma_f32_16x16x32_bf16 v[168:171], v[32:35], a[68:71], v[168:171]
    v_mfma_f32_16x16x32_bf16 v[168:171], v[36:39], a[72:75], v[168:171]
    v_mfma_f32_16x16x32_bf16 v[168:171], v[36:39], a[76:79], v[168:171]
    v_mfma_f32_16x16x32_bf16 v[168:171], v[40:43], a[80:83], v[168:171]
    v_mfma_f32_16x16x32_bf16 v[168:171], v[40:43], a[84:87], v[168:171]
    v_mfma_f32_16x16x32_bf16 v[168:171], v[44:47], a[88:91], v[168:171]
    v_mfma_f32_16x16x32_bf16 v[168:171], v[44:47], a[92:95], v[168:171]
    v_mfma_f32_16x16x32_bf16 v[172:175], v[32:35], a[96:99], 0
    v_mfma_f32_16x16x32_bf16 v[172:175], v[32:35], a[100:103], v[172:175]
    v_mfma_f32_16x16x32_bf16 v[172:175], v[36:39], a[104:107], v[172:175]
    v_mfma_f32_16x16x32_bf16 v[172:175], v[36:39], a[108:111], v[172:175]
    v_mfma_f32_16x16x32_bf16 v[172:175], v[40:43], a[160:163], v[172:175]
    v_mfma_f32_16x16x32_bf16 v[172:175], v[40:43], a[164:167], v[172:175]
    v_accvgpr_read_b32 v132, a172
    v_accvgpr_read_b32 v133, a173
    v_accvgpr_read_b32 v134, a174
    v_accvgpr_read_b32 v135, a175
    v_accvgpr_read_b32 v136, a176
    v_accvgpr_read_b32 v137, a177
    v_accvgpr_read_b32 v138, a178
    v_accvgpr_read_b32 v139, a179
    v_accvgpr_read_b32 v140, a180
    v_accvgpr_read_b32 v141, a181
    v_accvgpr_read_b32 v142, a182
    v_accvgpr_read_b32 v143, a183
    v_mov_b32 v76, v233
    v_permlane16_swap_b32 v128, v130
    v_permlane16_swap_b32 v129, v131
    v_permlane16_swap_b32 v132, v134
    v_permlane16_swap_b32 v133, v135
    v_permlane16_swap_b32 v136, v138
    v_permlane16_swap_b32 v137, v139
    v_permlane16_swap_b32 v140, v142
    v_permlane16_swap_b32 v141, v143
    v_lshlrev_b32 v0, 16, v128
    v_and_b32 v1, 0xffff0000, v128
    v_lshlrev_b32 v2, 16, v129
    v_and_b32 v3, 0xffff0000, v129
    v_lshlrev_b32 v8, 16, v130
    v_and_b32 v9, 0xffff0000, v130
    v_lshlrev_b32 v10, 16, v131
    v_and_b32 v11, 0xffff0000, v131
    v_lshlrev_b32 v16, 16, v132
    v_and_b32 v17, 0xffff0000, v132
    v_lshlrev_b32 v18, 16, v133
    v_and_b32 v19, 0xffff0000, v133
    v_lshlrev_b32 v24, 16, v134
    v_and_b32 v25, 0xffff0000, v134
    v_lshlrev_b32 v26, 16, v135
    v_and_b32 v27, 0xffff0000, v135
    v_lshlrev_b32 v4, 16, v136
    v_and_b32 v5, 0xffff0000, v136
    v_lshlrev_b32 v6, 16, v137
    v_and_b32 v7, 0xffff0000, v137
    v_lshlrev_b32 v12, 16, v138
    v_and_b32 v13, 0xffff0000, v138
    v_lshlrev_b32 v14, 16, v139
    v_and_b32 v15, 0xffff0000, v139
    v_lshlrev_b32 v20, 16, v140
    v_and_b32 v21, 0xffff0000, v140
    v_lshlrev_b32 v22, 16, v141
    v_and_b32 v23, 0xffff0000, v141
    v_lshlrev_b32 v28, 16, v142
    v_and_b32 v29, 0xffff0000, v142
    v_lshlrev_b32 v30, 16, v143
    v_and_b32 v31, 0xffff0000, v143
    v_bfe_u32 v247, v76, 7, 2
    v_add_u32 v247, 1, v247
    v_lshrrev_b32 v247, 2, v247
    v_mul_u32_u24 v247, 16776832, v247
    v_add_u32 v76, v76, v247
    v_mov_b32 v78, v76
    v_add_u32 v76, s64, v76
    v_add_u32 v77, 32768, v76
    v_and_b32 v247, 31, v232
    v_lshrrev_b32 v247, 2, v247
    v_lshrrev_b32 v248, 5, v232
    v_lshl_add_u32 v248, v248, 4, v247
    v_lshrrev_b32 v247, 1, v247
    v_lshlrev_b32 v247, 5, v247
    v_lshl_add_u32 v247, v248, 7, v247
    v_and_b32 v248, 3, v232
    v_lshl_add_u32 v64, v248, 3, v247
    v_xor_b32 v65, 32, v64
    v_xor_b32 v66, 64, v64
    v_xor_b32 v67, 96, v64
    v_add_u32 v68, 65536, v64
    v_add_u32 v69, 65536, v65
    v_add_u32 v70, 65536, v66
    v_add_u32 v71, 65536, v67
    s_add_u32 s36, s22, 109051904
    s_addc_u32 s37, s23, 0
    s_mov_b32 s38, 20971520
    s_add_u32 s40, s22, 20971520
    s_addc_u32 s41, s23, 0
    s_mov_b32 s42, 16384
    s_lshl_b32 s66, s93, 11
    s_add_u32 s65, s64, s66
    s_add_u32 s66, s65, 32768
    v_mov_b32 v224, 1
    s_lshl_b32 s60, s46, 10
    s_add_u32 s60, s60, 16384
    s_lshl_b32 s61, s3, 20
    s_add_u32 s61, s61, s60
    s_lshl_b32 s60, s92, 10
    s_add_u32 s60, s60, 16384
    s_and_b32 s51, s93, 3
    s_lshl_b32 s51, s51, 7
    s_add_u32 s60, s60, s51
    s_waitcnt vmcnt(0)
    s_barrier
    buffer_atomic_add v224, v237, s[88:91], s61 offen sc1
    ds_write_b128 v160, v[228:231]
    s_waitcnt lgkmcnt(0)
    s_cmp_eq_u32 s3, 0
    s_cbranch_scc1 L_sequential_preLN__softmax_full_mha__glu_gated_swiglu__prompt_kernel_poller_11
    s_mov_b64 exec, 0
    s_cmp_eq_u32 s3, 1
    s_cbranch_scc1 L_stub_10
    s_cmp_eq_u32 s3, 2
    s_cbranch_scc1 L_stub_11
    s_branch L_warm_w13_ret
L_warm_w13_ret:
    s_mov_b64 exec, -1
    s_branch L_sequential_preLN__softmax_full_mha__glu_gated_swiglu__prompt_kernel_pdone_10
L_sequential_preLN__softmax_full_mha__glu_gated_swiglu__prompt_kernel_poller_11:
    s_mov_b32 s50, 262144
    s_mov_b64 exec, 1
L_sequential_preLN__softmax_full_mha__glu_gated_swiglu__prompt_kernel_poll_12:
    v_mov_b32 v225, 0
    s_sub_u32 s50, s50, 1
    s_cbranch_scc1 L_sequential_preLN__softmax_full_mha__glu_gated_swiglu__prompt_kernel_pend_13
    buffer_atomic_add v225, v237, s[88:91], s60 offen sc0 sc1
    s_waitcnt vmcnt(0)
    v_cmp_gt_u32 vcc, 16, v225
    s_nop 4
    s_cbranch_vccnz L_sequential_preLN__softmax_full_mha__glu_gated_swiglu__prompt_kernel_poll_12
L_sequential_preLN__softmax_full_mha__glu_gated_swiglu__prompt_kernel_pend_13:
    s_mov_b64 exec, -1
L_sequential_preLN__softmax_full_mha__glu_gated_swiglu__prompt_kernel_pdone_10:
    s_waitcnt vmcnt(0)
    s_barrier
    s_mov_b32 s57, 0
    buffer_load_dwordx4 a[0:3], v76, s[32:35], s57 offen offset:0 sc1
    buffer_load_dwordx4 a[4:7], v77, s[32:35], s57 offen offset:0 sc1
    buffer_load_dwordx4 a[8:11], v76, s[32:35], s57 offen offset:1024 sc1
    buffer_load_dwordx4 a[12:15], v77, s[32:35], s57 offen offset:1024 sc1
    ds_read_b64_tr_b16 v[32:33], v64 offset:0
    ds_read_b64_tr_b16 v[34:35], v64 offset:1024
    ds_read_b64_tr_b16 v[36:37], v64 offset:4096
    ds_read_b64_tr_b16 v[38:39], v64 offset:5120
    ds_read_b64_tr_b16 v[40:41], v65 offset:0
    ds_read_b64_tr_b16 v[42:43], v65 offset:1024
    ds_read_b64_tr_b16 v[44:45], v65 offset:4096
    ds_read_b64_tr_b16 v[46:47], v65 offset:5120
    ds_read_b64_tr_b16 v[48:49], v66 offset:0
    ds_read_b64_tr_b16 v[50:51], v66 offset:1024
    ds_read_b64_tr_b16 v[52:53], v66 offset:4096
    ds_read_b64_tr_b16 v[54:55], v66 offset:5120
    buffer_load_dwordx4 a[16:19], v76, s[32:35], s57 offen offset:2048 sc1
    buffer_load_dwordx4 a[20:23], v77, s[32:35], s57 offen offset:2048 sc1
    buffer_load_dwordx4 a[24:27], v76, s[32:35], s57 offen offset:3072 sc1
    buffer_load_dwordx4 a[28:31], v77, s[32:35], s57 offen offset:3072 sc1
    s_mov_b32 s57, 4096
    buffer_load_dwordx4 a[32:35], v76, s[32:35], s57 offen offset:0 sc1
    buffer_load_dwordx4 a[36:39], v77, s[32:35], s57 offen offset:0 sc1
    buffer_load_dwordx4 a[40:43], v76, s[32:35], s57 offen offset:1024 sc1
    buffer_load_dwordx4 a[44:47], v77, s[32:35], s57 offen offset:1024 sc1
    buffer_load_dwordx4 a[48:51], v76, s[32:35], s57 offen offset:2048 sc1
    buffer_load_dwordx4 a[52:55], v77, s[32:35], s57 offen offset:2048 sc1
    buffer_load_dwordx4 a[56:59], v76, s[32:35], s57 offen offset:3072 sc1
    buffer_load_dwordx4 a[60:63], v77, s[32:35], s57 offen offset:3072 sc1
    s_waitcnt vmcnt(12)
    s_waitcnt lgkmcnt(8)
    v_mfma_f32_16x16x32_bf16 v[0:3], v[32:35], a[0:3], v[0:3]
    ds_read_b64_tr_b16 v[56:57], v67 offset:0
    v_mfma_f32_16x16x32_bf16 v[0:3], v[36:39], a[8:11], v[0:3]
    s_mov_b32 s57, 8192
    ds_read_b64_tr_b16 v[58:59], v67 offset:1024
    buffer_load_dwordx4 a[64:67], v76, s[32:35], s57 offen offset:0 sc1
    v_mfma_f32_16x16x32_bf16 v[4:7], v[32:35], a[4:7], v[4:7]
    ds_read_b64_tr_b16 v[60:61], v67 offset:4096
    v_mfma_f32_16x16x32_bf16 v[4:7], v[36:39], a[12:15], v[4:7]
    s_waitcnt lgkmcnt(7)
    ds_read_b64_tr_b16 v[62:63], v67 offset:5120
    v_mfma_f32_16x16x32_bf16 v[8:11], v[40:43], a[0:3], v[8:11]
    ds_read_b64_tr_b16 v[32:33], v64 offset:8192
    v_mfma_f32_16x16x32_bf16 v[8:11], v[44:47], a[8:11], v[8:11]
    ds_read_b64_tr_b16 v[34:35], v64 offset:9216
    buffer_load_dwordx4 a[68:71], v77, s[32:35], s57 offen offset:0 sc1
    v_mfma_f32_16x16x32_bf16 v[12:15], v[40:43], a[4:7], v[12:15]
    ds_read_b64_tr_b16 v[36:37], v64 offset:12288
    v_mfma_f32_16x16x32_bf16 v[12:15], v[44:47], a[12:15], v[12:15]
    s_waitcnt lgkmcnt(7)
    ds_read_b64_tr_b16 v[38:39], v64 offset:13312
    v_mfma_f32_16x16x32_bf16 v[16:19], v[48:51], a[0:3], v[16:19]
    ds_read_b64_tr_b16 v[40:41], v65 offset:8192
    v_mfma_f32_16x16x32_bf16 v[16:19], v[52:55], a[8:11], v[16:19]
    ds_read_b64_tr_b16 v[42:43], v65 offset:9216
    buffer_load_dwordx4 a[72:75], v76, s[32:35], s57 offen offset:1024 sc1
    v_mfma_f32_16x16x32_bf16 v[20:23], v[48:51], a[4:7], v[20:23]
    ds_read_b64_tr_b16 v[44:45], v65 offset:12288
    v_mfma_f32_16x16x32_bf16 v[20:23], v[52:55], a[12:15], v[20:23]
    s_waitcnt lgkmcnt(7)
    ds_read_b64_tr_b16 v[46:47], v65 offset:13312
    v_mfma_f32_16x16x32_bf16 v[24:27], v[56:59], a[0:3], v[24:27]
    ds_read_b64_tr_b16 v[48:49], v66 offset:8192
    v_mfma_f32_16x16x32_bf16 v[24:27], v[60:63], a[8:11], v[24:27]
    ds_read_b64_tr_b16 v[50:51], v66 offset:9216
    buffer_load_dwordx4 a[76:79], v77, s[32:35], s57 offen offset:1024 sc1
    v_mfma_f32_16x16x32_bf16 v[28:31], v[56:59], a[4:7], v[28:31]
    ds_read_b64_tr_b16 v[52:53], v66 offset:12288
    v_mfma_f32_16x16x32_bf16 v[28:31], v[60:63], a[12:15], v[28:31]
    s_waitcnt lgkmcnt(7)
    s_waitcnt vmcnt(12)
    ds_read_b64_tr_b16 v[54:55], v66 offset:13312
    v_mfma_f32_16x16x32_bf16 v[0:3], v[32:35], a[16:19], v[0:3]
    ds_read_b64_tr_b16 v[56:57], v67 offset:8192
    v_mfma_f32_16x16x32_bf16 v[0:3], v[36:39], a[24:27], v[0:3]
    ds_read_b64_tr_b16 v[58:59], v67 offset:9216
    buffer_load_dwordx4 a[80:83], v76, s[32:35], s57 offen offset:2048 sc1
    v_mfma_f32_16x16x32_bf16 v[4:7], v[32:35], a[20:23], v[4:7]
    ds_read_b64_tr_b16 v[60:61], v67 offset:12288
    v_mov_b32 v226, v168
    v_mfma_f32_16x16x32_bf16 v[4:7], v[36:39], a[28:31], v[4:7]
    s_waitcnt lgkmcnt(7)
    ds_read_b64_tr_b16 v[62:63], v67 offset:13312
    v_mfma_f32_16x16x32_bf16 v[8:11], v[40:43], a[16:19], v[8:11]
    ds_read_b64_tr_b16 v[32:33], v64 offset:16384
    v_mfma_f32_16x16x32_bf16 v[8:11], v[44:47], a[24:27], v[8:11]
    ds_read_b64_tr_b16 v[34:35], v64 offset:17408
    buffer_load_dwordx4 a[84:87], v77, s[32:35], s57 offen offset:2048 sc1
    v_mfma_f32_16x16x32_bf16 v[12:15], v[40:43], a[20:23], v[12:15]
    ds_read_b64_tr_b16 v[36:37], v64 offset:20480
    v_mov_b32 v227, v172
    v_mfma_f32_16x16x32_bf16 v[12:15], v[44:47], a[28:31], v[12:15]
    s_waitcnt lgkmcnt(7)
    ds_read_b64_tr_b16 v[38:39], v64 offset:21504
    v_mfma_f32_16x16x32_bf16 v[16:19], v[48:51], a[16:19], v[16:19]
    ds_read_b64_tr_b16 v[40:41], v65 offset:16384
    v_mfma_f32_16x16x32_bf16 v[16:19], v[52:55], a[24:27], v[16:19]
    ds_read_b64_tr_b16 v[42:43], v65 offset:17408
    buffer_load_dwordx4 a[88:91], v76, s[32:35], s57 offen offset:3072 sc1
    v_mfma_f32_16x16x32_bf16 v[20:23], v[48:51], a[20:23], v[20:23]
    ds_read_b64_tr_b16 v[44:45], v65 offset:20480
    v_mov_b32 v228, v239
    v_mfma_f32_16x16x32_bf16 v[20:23], v[52:55], a[28:31], v[20:23]
    s_waitcnt lgkmcnt(7)
    ds_read_b64_tr_b16 v[46:47], v65 offset:21504
    v_mfma_f32_16x16x32_bf16 v[24:27], v[56:59], a[16:19], v[24:27]
    ds_read_b64_tr_b16 v[48:49], v66 offset:16384
    v_mfma_f32_16x16x32_bf16 v[24:27], v[60:63], a[24:27], v[24:27]
    ds_read_b64_tr_b16 v[50:51], v66 offset:17408
    buffer_load_dwordx4 a[92:95], v77, s[32:35], s57 offen offset:3072 sc1
    v_mfma_f32_16x16x32_bf16 v[28:31], v[56:59], a[20:23], v[28:31]
    ds_read_b64_tr_b16 v[52:53], v66 offset:20480
    v_mfma_f32_16x16x32_bf16 v[28:31], v[60:63], a[28:31], v[28:31]
    s_waitcnt lgkmcnt(7)
    s_waitcnt vmcnt(12)
    ds_read_b64_tr_b16 v[54:55], v66 offset:21504
    v_mfma_f32_16x16x32_bf16 v[0:3], v[32:35], a[32:35], v[0:3]
    ds_read_b64_tr_b16 v[56:57], v67 offset:16384
    v_mfma_f32_16x16x32_bf16 v[0:3], v[36:39], a[40:43], v[0:3]
    s_mov_b32 s57, 12288
    ds_read_b64_tr_b16 v[58:59], v67 offset:17408
    buffer_load_dwordx4 a[96:99], v76, s[32:35], s57 offen offset:0 sc1
    v_mfma_f32_16x16x32_bf16 v[4:7], v[32:35], a[36:39], v[4:7]
    ds_read_b64_tr_b16 v[60:61], v67 offset:20480
    v_mfma_f32_16x16x32_bf16 v[4:7], v[36:39], a[44:47], v[4:7]
    s_waitcnt lgkmcnt(7)
    ds_read_b64_tr_b16 v[62:63], v67 offset:21504
    v_mfma_f32_16x16x32_bf16 v[8:11], v[40:43], a[32:35], v[8:11]
    ds_read_b64_tr_b16 v[32:33], v64 offset:24576
    v_mfma_f32_16x16x32_bf16 v[8:11], v[44:47], a[40:43], v[8:11]
    ds_read_b64_tr_b16 v[34:35], v64 offset:25600
    buffer_load_dwordx4 a[100:103], v77, s[32:35], s57 offen offset:0 sc1
    v_mfma_f32_16x16x32_bf16 v[12:15], v[40:43], a[36:39], v[12:15]
    ds_read_b64_tr_b16 v[36:37], v64 offset:28672
    v_mfma_f32_16x16x32_bf16 v[12:15], v[44:47], a[44:47], v[12:15]
    s_waitcnt lgkmcnt(7)
    ds_read_b64_tr_b16 v[38:39], v64 offset:29696
    v_mfma_f32_16x16x32_bf16 v[16:19], v[48:51], a[32:35], v[16:19]
    ds_read_b64_tr_b16 v[40:41], v65 offset:24576
    v_mfma_f32_16x16x32_bf16 v[16:19], v[52:55], a[40:43], v[16:19]
    ds_read_b64_tr_b16 v[42:43], v65 offset:25600
    buffer_load_dwordx4 a[104:107], v76, s[32:35], s57 offen offset:1024 sc1
    v_mfma_f32_16x16x32_bf16 v[20:23], v[48:51], a[36:39], v[20:23]
    s_mov_b32 s70, 16384
    ds_read_b64_tr_b16 v[44:45], v65 offset:28672
    v_mfma_f32_16x16x32_bf16 v[20:23], v[52:55], a[44:47], v[20:23]
    s_waitcnt lgkmcnt(7)
    ds_read_b64_tr_b16 v[46:47], v65 offset:29696
    v_mfma_f32_16x16x32_bf16 v[24:27], v[56:59], a[32:35], v[24:27]
    ds_read_b64_tr_b16 v[48:49], v66 offset:24576
    v_mfma_f32_16x16x32_bf16 v[24:27], v[60:63], a[40:43], v[24:27]
    ds_read_b64_tr_b16 v[50:51], v66 offset:25600
    buffer_load_dwordx4 a[108:111], v77, s[32:35], s57 offen offset:1024 sc1
    v_mfma_f32_16x16x32_bf16 v[28:31], v[56:59], a[36:39], v[28:31]
    ds_read_b64_tr_b16 v[52:53], v66 offset:28672
    v_mfma_f32_16x16x32_bf16 v[28:31], v[60:63], a[44:47], v[28:31]
    s_waitcnt lgkmcnt(7)
    s_waitcnt vmcnt(12)
    ds_read_b64_tr_b16 v[54:55], v66 offset:29696
    v_mfma_f32_16x16x32_bf16 v[0:3], v[32:35], a[48:51], v[0:3]
    ds_read_b64_tr_b16 v[56:57], v67 offset:24576
    v_mfma_f32_16x16x32_bf16 v[0:3], v[36:39], a[56:59], v[0:3]
    ds_read_b64_tr_b16 v[58:59], v67 offset:25600
    buffer_load_dwordx4 a[112:115], v76, s[32:35], s57 offen offset:2048 sc1
    v_mfma_f32_16x16x32_bf16 v[4:7], v[32:35], a[52:55], v[4:7]
    ds_read_b64_tr_b16 v[60:61], v67 offset:28672
    v_mfma_f32_16x16x32_bf16 v[4:7], v[36:39], a[60:63], v[4:7]
    s_waitcnt lgkmcnt(7)
    ds_read_b64_tr_b16 v[62:63], v67 offset:29696
    v_mfma_f32_16x16x32_bf16 v[8:11], v[40:43], a[48:51], v[8:11]
    ds_read_b64_tr_b16 v[32:33], v64 offset:32768
    v_mfma_f32_16x16x32_bf16 v[8:11], v[44:47], a[56:59], v[8:11]
    ds_read_b64_tr_b16 v[34:35], v64 offset:33792
    buffer_load_dwordx4 a[116:119], v77, s[32:35], s57 offen offset:2048 sc1
    v_mfma_f32_16x16x32_bf16 v[12:15], v[40:43], a[52:55], v[12:15]
    ds_read_b64_tr_b16 v[36:37], v64 offset:36864
    v_mfma_f32_16x16x32_bf16 v[12:15], v[44:47], a[60:63], v[12:15]
    s_waitcnt lgkmcnt(7)
    ds_read_b64_tr_b16 v[38:39], v64 offset:37888
    v_mfma_f32_16x16x32_bf16 v[16:19], v[48:51], a[48:51], v[16:19]
    ds_read_b64_tr_b16 v[40:41], v65 offset:32768
    v_mfma_f32_16x16x32_bf16 v[16:19], v[52:55], a[56:59], v[16:19]
    ds_read_b64_tr_b16 v[42:43], v65 offset:33792
    buffer_load_dwordx4 a[120:123], v76, s[32:35], s57 offen offset:3072 sc1
L_stub_10:
    s_cbranch_execz L_warm_w13_ret
    v_mfma_f32_16x16x32_bf16 v[20:23], v[48:51], a[52:55], v[20:23]
    ds_read_b64_tr_b16 v[44:45], v65 offset:36864
    v_mfma_f32_16x16x32_bf16 v[20:23], v[52:55], a[60:63], v[20:23]
    s_waitcnt lgkmcnt(7)
    ds_read_b64_tr_b16 v[46:47], v65 offset:37888
    v_mfma_f32_16x16x32_bf16 v[24:27], v[56:59], a[48:51], v[24:27]
    ds_read_b64_tr_b16 v[48:49], v66 offset:32768
    v_mfma_f32_16x16x32_bf16 v[24:27], v[60:63], a[56:59], v[24:27]
    ds_read_b64_tr_b16 v[50:51], v66 offset:33792
    buffer_load_dwordx4 a[124:127], v77, s[32:35], s57 offen offset:3072 sc1
    v_mfma_f32_16x16x32_bf16 v[28:31], v[56:59], a[52:55], v[28:31]
    ds_read_b64_tr_b16 v[52:53], v66 offset:36864
    v_mfma_f32_16x16x32_bf16 v[28:31], v[60:63], a[60:63], v[28:31]
    s_waitcnt lgkmcnt(7)
    s_waitcnt vmcnt(12)
    ds_read_b64_tr_b16 v[54:55], v66 offset:37888
    v_mfma_f32_16x16x32_bf16 v[0:3], v[32:35], a[64:67], v[0:3]
    ds_read_b64_tr_b16 v[56:57], v67 offset:32768
    v_mfma_f32_16x16x32_bf16 v[0:3], v[36:39], a[72:75], v[0:3]
    s_mov_b32 s57, 16384
    ds_read_b64_tr_b16 v[58:59], v67 offset:33792
    buffer_load_dwordx4 a[0:3], v76, s[32:35], s57 offen offset:0 sc1
    v_mfma_f32_16x16x32_bf16 v[4:7], v[32:35], a[68:71], v[4:7]
    ds_read_b64_tr_b16 v[60:61], v67 offset:36864
    v_mfma_f32_16x16x32_bf16 v[4:7], v[36:39], a[76:79], v[4:7]
    s_waitcnt lgkmcnt(7)
    ds_read_b64_tr_b16 v[62:63], v67 offset:37888
    v_mfma_f32_16x16x32_bf16 v[8:11], v[40:43], a[64:67], v[8:11]
    ds_read_b64_tr_b16 v[32:33], v64 offset:40960
    v_mfma_f32_16x16x32_bf16 v[8:11], v[44:47], a[72:75], v[8:11]
    ds_read_b64_tr_b16 v[34:35], v64 offset:41984
    buffer_load_dwordx4 a[4:7], v77, s[32:35], s57 offen offset:0 sc1
    v_mfma_f32_16x16x32_bf16 v[12:15], v[40:43], a[68:71], v[12:15]
    ds_read_b64_tr_b16 v[36:37], v64 offset:45056
    v_mfma_f32_16x16x32_bf16 v[12:15], v[44:47], a[76:79], v[12:15]
    s_waitcnt lgkmcnt(7)
    ds_read_b64_tr_b16 v[38:39], v64 offset:46080
    v_mfma_f32_16x16x32_bf16 v[16:19], v[48:51], a[64:67], v[16:19]
    ds_read_b64_tr_b16 v[40:41], v65 offset:40960
    v_mfma_f32_16x16x32_bf16 v[16:19], v[52:55], a[72:75], v[16:19]
    ds_read_b64_tr_b16 v[42:43], v65 offset:41984
    buffer_load_dwordx4 a[8:11], v76, s[32:35], s57 offen offset:1024 sc1
    v_mfma_f32_16x16x32_bf16 v[20:23], v[48:51], a[68:71], v[20:23]
    ds_read_b64_tr_b16 v[44:45], v65 offset:45056
    v_mfma_f32_16x16x32_bf16 v[20:23], v[52:55], a[76:79], v[20:23]
    s_waitcnt lgkmcnt(7)
    ds_read_b64_tr_b16 v[46:47], v65 offset:46080
    v_mfma_f32_16x16x32_bf16 v[24:27], v[56:59], a[64:67], v[24:27]
    ds_read_b64_tr_b16 v[48:49], v66 offset:40960
    v_mfma_f32_16x16x32_bf16 v[24:27], v[60:63], a[72:75], v[24:27]
    ds_read_b64_tr_b16 v[50:51], v66 offset:41984
    buffer_load_dwordx4 a[12:15], v77, s[32:35], s57 offen offset:1024 sc1
    v_mfma_f32_16x16x32_bf16 v[28:31], v[56:59], a[68:71], v[28:31]
    ds_read_b64_tr_b16 v[52:53], v66 offset:45056
    v_mfma_f32_16x16x32_bf16 v[28:31], v[60:63], a[76:79], v[28:31]
    s_waitcnt lgkmcnt(7)
    s_waitcnt vmcnt(12)
    ds_read_b64_tr_b16 v[54:55], v66 offset:46080
    v_mfma_f32_16x16x32_bf16 v[0:3], v[32:35], a[80:83], v[0:3]
    ds_read_b64_tr_b16 v[56:57], v67 offset:40960
    v_mfma_f32_16x16x32_bf16 v[0:3], v[36:39], a[88:91], v[0:3]
    ds_read_b64_tr_b16 v[58:59], v67 offset:41984
    buffer_load_dwordx4 a[16:19], v76, s[32:35], s57 offen offset:2048 sc1
    v_mfma_f32_16x16x32_bf16 v[4:7], v[32:35], a[84:87], v[4:7]
    ds_read_b64_tr_b16 v[60:61], v67 offset:45056
    v_lshlrev_b32 v248, 10, v240
    s_cmp_eq_u32 s3, 0
    s_cselect_b32 s50, 16, 0
    s_cselect_b32 s51, s70, s59
    v_mfma_f32_16x16x32_bf16 v[4:7], v[36:39], a[92:95], v[4:7]
    s_waitcnt lgkmcnt(7)
    ds_read_b64_tr_b16 v[62:63], v67 offset:46080
    v_mfma_f32_16x16x32_bf16 v[8:11], v[40:43], a[80:83], v[8:11]
    ds_read_b64_tr_b16 v[32:33], v64 offset:49152
    v_mfma_f32_16x16x32_bf16 v[8:11], v[44:47], a[88:91], v[8:11]
    ds_read_b64_tr_b16 v[34:35], v64 offset:50176
    buffer_load_dwordx4 a[20:23], v77, s[32:35], s57 offen offset:2048 sc1
    v_mfma_f32_16x16x32_bf16 v[12:15], v[40:43], a[84:87], v[12:15]
    ds_read_b64_tr_b16 v[36:37], v64 offset:53248
    v_mfma_f32_16x16x32_bf16 v[12:15], v[44:47], a[92:95], v[12:15]
    s_waitcnt lgkmcnt(7)
    ds_read_b64_tr_b16 v[38:39], v64 offset:54272
    v_mfma_f32_16x16x32_bf16 v[16:19], v[48:51], a[80:83], v[16:19]
    ds_read_b64_tr_b16 v[40:41], v65 offset:49152
    v_mfma_f32_16x16x32_bf16 v[16:19], v[52:55], a[88:91], v[16:19]
    ds_read_b64_tr_b16 v[42:43], v65 offset:50176
    buffer_load_dwordx4 a[24:27], v76, s[32:35], s57 offen offset:3072 sc1
    v_mfma_f32_16x16x32_bf16 v[20:23], v[48:51], a[84:87], v[20:23]
    ds_read_b64_tr_b16 v[44:45], v65 offset:53248
    v_mfma_f32_16x16x32_bf16 v[20:23], v[52:55], a[92:95], v[20:23]
    s_waitcnt lgkmcnt(7)
    ds_read_b64_tr_b16 v[46:47], v65 offset:54272
    v_mfma_f32_16x16x32_bf16 v[24:27], v[56:59], a[80:83], v[24:27]
    ds_read_b64_tr_b16 v[48:49], v66 offset:49152
    v_mfma_f32_16x16x32_bf16 v[24:27], v[60:63], a[88:91], v[24:27]
    ds_read_b64_tr_b16 v[50:51], v66 offset:50176
    buffer_load_dwordx4 a[28:31], v77, s[32:35], s57 offen offset:3072 sc1
    v_mfma_f32_16x16x32_bf16 v[28:31], v[56:59], a[84:87], v[28:31]
    ds_read_b64_tr_b16 v[52:53], v66 offset:53248
    v_mfma_f32_16x16x32_bf16 v[28:31], v[60:63], a[92:95], v[28:31]
    s_waitcnt lgkmcnt(7)
    s_waitcnt vmcnt(12)
    ds_read_b64_tr_b16 v[54:55], v66 offset:54272
    v_mfma_f32_16x16x32_bf16 v[0:3], v[32:35], a[96:99], v[0:3]
    ds_read_b64_tr_b16 v[56:57], v67 offset:49152
    v_mfma_f32_16x16x32_bf16 v[0:3], v[36:39], a[104:107], v[0:3]
    s_mov_b32 s57, 20480
    ds_read_b64_tr_b16 v[58:59], v67 offset:50176
    buffer_load_dwordx4 a[32:35], v76, s[32:35], s57 offen offset:0 sc1
    v_mfma_f32_16x16x32_bf16 v[4:7], v[32:35], a[100:103], v[4:7]
    ds_read_b64_tr_b16 v[60:61], v67 offset:53248
    v_mfma_f32_16x16x32_bf16 v[4:7], v[36:39], a[108:111], v[4:7]
    s_waitcnt lgkmcnt(7)
    ds_read_b64_tr_b16 v[62:63], v67 offset:54272
    v_mfma_f32_16x16x32_bf16 v[8:11], v[40:43], a[96:99], v[8:11]
    ds_read_b64_tr_b16 v[32:33], v64 offset:57344
    v_mfma_f32_16x16x32_bf16 v[8:11], v[44:47], a[104:107], v[8:11]
    ds_read_b64_tr_b16 v[34:35], v64 offset:58368
    buffer_load_dwordx4 a[36:39], v77, s[32:35], s57 offen offset:0 sc1
    v_mfma_f32_16x16x32_bf16 v[12:15], v[40:43], a[100:103], v[12:15]
    ds_read_b64_tr_b16 v[36:37], v64 offset:61440
    v_mfma_f32_16x16x32_bf16 v[12:15], v[44:47], a[108:111], v[12:15]
    s_waitcnt lgkmcnt(7)
    ds_read_b64_tr_b16 v[38:39], v64 offset:62464
    v_mfma_f32_16x16x32_bf16 v[16:19], v[48:51], a[96:99], v[16:19]
    ds_read_b64_tr_b16 v[40:41], v65 offset:57344
    v_mfma_f32_16x16x32_bf16 v[16:19], v[52:55], a[104:107], v[16:19]
    ds_read_b64_tr_b16 v[42:43], v65 offset:58368
    buffer_load_dwordx4 a[40:43], v76, s[32:35], s57 offen offset:1024 sc1
    v_mfma_f32_16x16x32_bf16 v[20:23], v[48:51], a[100:103], v[20:23]
    ds_read_b64_tr_b16 v[44:45], v65 offset:61440
    v_mfma_f32_16x16x32_bf16 v[20:23], v[52:55], a[108:111], v[20:23]
    s_waitcnt lgkmcnt(7)
    ds_read_b64_tr_b16 v[46:47], v65 offset:62464
    v_mfma_f32_16x16x32_bf16 v[24:27], v[56:59], a[96:99], v[24:27]
    ds_read_b64_tr_b16 v[48:49], v66 offset:57344
    v_mfma_f32_16x16x32_bf16 v[24:27], v[60:63], a[104:107], v[24:27]
    ds_read_b64_tr_b16 v[50:51], v66 offset:58368
    buffer_load_dwordx4 a[44:47], v77, s[32:35], s57 offen offset:1024 sc1
    v_mfma_f32_16x16x32_bf16 v[28:31], v[56:59], a[100:103], v[28:31]
    ds_read_b64_tr_b16 v[52:53], v66 offset:61440
    v_mfma_f32_16x16x32_bf16 v[28:31], v[60:63], a[108:111], v[28:31]
    s_waitcnt lgkmcnt(7)
    s_waitcnt vmcnt(12)
    ds_read_b64_tr_b16 v[54:55], v66 offset:62464
    v_mfma_f32_16x16x32_bf16 v[0:3], v[32:35], a[112:115], v[0:3]
    ds_read_b64_tr_b16 v[56:57], v67 offset:57344
    v_mfma_f32_16x16x32_bf16 v[0:3], v[36:39], a[120:123], v[0:3]
    ds_read_b64_tr_b16 v[58:59], v67 offset:58368
    buffer_load_dwordx4 a[48:51], v76, s[32:35], s57 offen offset:2048 sc1
    v_mfma_f32_16x16x32_bf16 v[4:7], v[32:35], a[116:119], v[4:7]
    ds_read_b64_tr_b16 v[60:61], v67 offset:61440
    v_mfma_f32_16x16x32_bf16 v[4:7], v[36:39], a[124:127], v[4:7]
    s_waitcnt lgkmcnt(7)
    ds_read_b64_tr_b16 v[62:63], v67 offset:62464
    v_mfma_f32_16x16x32_bf16 v[8:11], v[40:43], a[112:115], v[8:11]
    ds_read_b64_tr_b16 v[32:33], v68 offset:0
    v_mfma_f32_16x16x32_bf16 v[8:11], v[44:47], a[120:123], v[8:11]
    ds_read_b64_tr_b16 v[34:35], v68 offset:1024
    buffer_load_dwordx4 a[52:55], v77, s[32:35], s57 offen offset:2048 sc1
    v_mfma_f32_16x16x32_bf16 v[12:15], v[40:43], a[116:119], v[12:15]
    ds_read_b64_tr_b16 v[36:37], v68 offset:4096
    v_mfma_f32_16x16x32_bf16 v[12:15], v[44:47], a[124:127], v[12:15]
    s_waitcnt lgkmcnt(7)
    ds_read_b64_tr_b16 v[38:39], v68 offset:5120
    v_mfma_f32_16x16x32_bf16 v[16:19], v[48:51], a[112:115], v[16:19]
    ds_read_b64_tr_b16 v[40:41], v69 offset:0
    v_mfma_f32_16x16x32_bf16 v[16:19], v[52:55], a[120:123], v[16:19]
    ds_read_b64_tr_b16 v[42:43], v69 offset:1024
    buffer_load_dwordx4 a[56:59], v76, s[32:35], s57 offen offset:3072 sc1
    v_mfma_f32_16x16x32_bf16 v[20:23], v[48:51], a[116:119], v[20:23]
    ds_read_b64_tr_b16 v[44:45], v69 offset:4096
    v_mfma_f32_16x16x32_bf16 v[20:23], v[52:55], a[124:127], v[20:23]
    s_waitcnt lgkmcnt(7)
    ds_read_b64_tr_b16 v[46:47], v69 offset:5120
    v_mfma_f32_16x16x32_bf16 v[24:27], v[56:59], a[112:115], v[24:27]
    ds_read_b64_tr_b16 v[48:49], v70 offset:0
    v_mfma_f32_16x16x32_bf16 v[24:27], v[60:63], a[120:123], v[24:27]
    ds_read_b64_tr_b16 v[50:51], v70 offset:1024
    buffer_load_dwordx4 a[60:63], v77, s[32:35], s57 offen offset:3072 sc1
    v_mfma_f32_16x16x32_bf16 v[28:31], v[56:59], a[116:119], v[28:31]
    ds_read_b64_tr_b16 v[52:53], v70 offset:4096
    v_mfma_f32_16x16x32_bf16 v[28:31], v[60:63], a[124:127], v[28:31]
    s_waitcnt lgkmcnt(7)
    s_waitcnt vmcnt(12)
    ds_read_b64_tr_b16 v[54:55], v70 offset:5120
    v_mfma_f32_16x16x32_bf16 v[0:3], v[32:35], a[0:3], v[0:3]
    ds_read_b64_tr_b16 v[56:57], v71 offset:0
    v_mfma_f32_16x16x32_bf16 v[0:3], v[36:39], a[8:11], v[0:3]
    s_mov_b32 s57, 24576
    ds_read_b64_tr_b16 v[58:59], v71 offset:1024
    buffer_load_dwordx4 a[64:67], v76, s[32:35], s57 offen offset:0 sc1
    v_mfma_f32_16x16x32_bf16 v[4:7], v[32:35], a[4:7], v[4:7]
    ds_read_b64_tr_b16 v[60:61], v71 offset:4096
    v_mfma_f32_16x16x32_bf16 v[4:7], v[36:39], a[12:15], v[4:7]
    s_waitcnt lgkmcnt(7)
    ds_read_b64_tr_b16 v[62:63], v71 offset:5120
    v_mfma_f32_16x16x32_bf16 v[8:11], v[40:43], a[0:3], v[8:11]
    ds_read_b64_tr_b16 v[32:33], v68 offset:8192
    v_mfma_f32_16x16x32_bf16 v[8:11], v[44:47], a[8:11], v[8:11]
    ds_read_b64_tr_b16 v[34:35], v68 offset:9216
    buffer_load_dwordx4 a[68:71], v77, s[32:35], s57 offen offset:0 sc1
    v_mfma_f32_16x16x32_bf16 v[12:15], v[40:43], a[4:7], v[12:15]
    ds_read_b64_tr_b16 v[36:37], v68 offset:12288
    v_mfma_f32_16x16x32_bf16 v[12:15], v[44:47], a[12:15], v[12:15]
    s_waitcnt lgkmcnt(7)
    ds_read_b64_tr_b16 v[38:39], v68 offset:13312
    v_mfma_f32_16x16x32_bf16 v[16:19], v[48:51], a[0:3], v[16:19]
    ds_read_b64_tr_b16 v[40:41], v69 offset:8192
    v_mfma_f32_16x16x32_bf16 v[16:19], v[52:55], a[8:11], v[16:19]
    ds_read_b64_tr_b16 v[42:43], v69 offset:9216
    buffer_load_dwordx4 a[72:75], v76, s[32:35], s57 offen offset:1024 sc1
    v_mfma_f32_16x16x32_bf16 v[20:23], v[48:51], a[4:7], v[20:23]
    ds_read_b64_tr_b16 v[44:45], v69 offset:12288
    v_mfma_f32_16x16x32_bf16 v[20:23], v[52:55], a[12:15], v[20:23]
    s_waitcnt lgkmcnt(7)
    ds_read_b64_tr_b16 v[46:47], v69 offset:13312
    v_mfma_f32_16x16x32_bf16 v[24:27], v[56:59], a[0:3], v[24:27]
    ds_read_b64_tr_b16 v[48:49], v70 offset:8192
    v_mfma_f32_16x16x32_bf16 v[24:27], v[60:63], a[8:11], v[24:27]
    ds_read_b64_tr_b16 v[50:51], v70 offset:9216
    buffer_load_dwordx4 a[76:79], v77, s[32:35], s57 offen offset:1024 sc1
    v_mfma_f32_16x16x32_bf16 v[28:31], v[56:59], a[4:7], v[28:31]
    ds_read_b64_tr_b16 v[52:53], v70 offset:12288
    v_mfma_f32_16x16x32_bf16 v[28:31], v[60:63], a[12:15], v[28:31]
    s_waitcnt lgkmcnt(7)
    s_waitcnt vmcnt(12)
    ds_read_b64_tr_b16 v[54:55], v70 offset:13312
    v_mfma_f32_16x16x32_bf16 v[0:3], v[32:35], a[16:19], v[0:3]
    ds_read_b64_tr_b16 v[56:57], v71 offset:8192
    v_mfma_f32_16x16x32_bf16 v[0:3], v[36:39], a[24:27], v[0:3]
    ds_read_b64_tr_b16 v[58:59], v71 offset:9216
    buffer_load_dwordx4 a[80:83], v76, s[32:35], s57 offen offset:2048 sc1
    v_mfma_f32_16x16x32_bf16 v[4:7], v[32:35], a[20:23], v[4:7]
    ds_read_b64_tr_b16 v[60:61], v71 offset:12288
    v_mfma_f32_16x16x32_bf16 v[4:7], v[36:39], a[28:31], v[4:7]
    s_waitcnt lgkmcnt(7)
    ds_read_b64_tr_b16 v[62:63], v71 offset:13312
    v_mfma_f32_16x16x32_bf16 v[8:11], v[40:43], a[16:19], v[8:11]
    ds_read_b64_tr_b16 v[32:33], v68 offset:16384
    v_mfma_f32_16x16x32_bf16 v[8:11], v[44:47], a[24:27], v[8:11]
    ds_read_b64_tr_b16 v[34:35], v68 offset:17408
    buffer_load_dwordx4 a[84:87], v77, s[32:35], s57 offen offset:2048 sc1
    v_mfma_f32_16x16x32_bf16 v[12:15], v[40:43], a[20:23], v[12:15]
    ds_read_b64_tr_b16 v[36:37], v68 offset:20480
    v_mfma_f32_16x16x32_bf16 v[12:15], v[44:47], a[28:31], v[12:15]
    s_waitcnt lgkmcnt(7)
    ds_read_b64_tr_b16 v[38:39], v68 offset:21504
    v_mfma_f32_16x16x32_bf16 v[16:19], v[48:51], a[16:19], v[16:19]
    ds_read_b64_tr_b16 v[40:41], v69 offset:16384
    v_mfma_f32_16x16x32_bf16 v[16:19], v[52:55], a[24:27], v[16:19]
    ds_read_b64_tr_b16 v[42:43], v69 offset:17408
    buffer_load_dwordx4 a[88:91], v76, s[32:35], s57 offen offset:3072 sc1
    v_mfma_f32_16x16x32_bf16 v[20:23], v[48:51], a[20:23], v[20:23]
    ds_read_b64_tr_b16 v[44:45], v69 offset:20480
    v_mfma_f32_16x16x32_bf16 v[20:23], v[52:55], a[28:31], v[20:23]
    s_waitcnt lgkmcnt(7)
    ds_read_b64_tr_b16 v[46:47], v69 offset:21504
    v_mfma_f32_16x16x32_bf16 v[24:27], v[56:59], a[16:19], v[24:27]
    ds_read_b64_tr_b16 v[48:49], v70 offset:16384
    v_mfma_f32_16x16x32_bf16 v[24:27], v[60:63], a[24:27], v[24:27]
    ds_read_b64_tr_b16 v[50:51], v70 offset:17408
    buffer_load_dwordx4 a[92:95], v77, s[32:35], s57 offen offset:3072 sc1
    v_mfma_f32_16x16x32_bf16 v[28:31], v[56:59], a[20:23], v[28:31]
    ds_read_b64_tr_b16 v[52:53], v70 offset:20480
    v_mfma_f32_16x16x32_bf16 v[28:31], v[60:63], a[28:31], v[28:31]
    s_waitcnt lgkmcnt(7)
    s_waitcnt vmcnt(12)
    ds_read_b64_tr_b16 v[54:55], v70 offset:21504
    v_mfma_f32_16x16x32_bf16 v[0:3], v[32:35], a[32:35], v[0:3]
    ds_read_b64_tr_b16 v[56:57], v71 offset:16384
    v_mfma_f32_16x16x32_bf16 v[0:3], v[36:39], a[40:43], v[0:3]
    s_mov_b32 s57, 28672
    ds_read_b64_tr_b16 v[58:59], v71 offset:17408
    buffer_load_dwordx4 a[96:99], v76, s[32:35], s57 offen offset:0 sc1
    v_mfma_f32_16x16x32_bf16 v[4:7], v[32:35], a[36:39], v[4:7]
    ds_read_b64_tr_b16 v[60:61], v71 offset:20480
    v_mfma_f32_16x16x32_bf16 v[4:7], v[36:39], a[44:47], v[4:7]
    s_waitcnt lgkmcnt(7)
    ds_read_b64_tr_b16 v[62:63], v71 offset:21504
    v_mfma_f32_16x16x32_bf16 v[8:11], v[40:43], a[32:35], v[8:11]
    ds_read_b64_tr_b16 v[32:33], v68 offset:24576
    v_mfma_f32_16x16x32_bf16 v[8:11], v[44:47], a[40:43], v[8:11]
    ds_read_b64_tr_b16 v[34:35], v68 offset:25600
    buffer_load_dwordx4 a[100:103], v77, s[32:35], s57 offen offset:0 sc1
    v_mfma_f32_16x16x32_bf16 v[12:15], v[40:43], a[36:39], v[12:15]
    ds_read_b64_tr_b16 v[36:37], v68 offset:28672
    v_mfma_f32_16x16x32_bf16 v[12:15], v[44:47], a[44:47], v[12:15]
    s_waitcnt lgkmcnt(7)
    ds_read_b64_tr_b16 v[38:39], v68 offset:29696
    v_mfma_f32_16x16x32_bf16 v[16:19], v[48:51], a[32:35], v[16:19]
    ds_read_b64_tr_b16 v[40:41], v69 offset:24576
    v_mfma_f32_16x16x32_bf16 v[16:19], v[52:55], a[40:43], v[16:19]
    ds_read_b64_tr_b16 v[42:43], v69 offset:25600
    buffer_load_dwordx4 a[104:107], v76, s[32:35], s57 offen offset:1024 sc1
    v_mfma_f32_16x16x32_bf16 v[20:23], v[48:51], a[36:39], v[20:23]
    ds_read_b64_tr_b16 v[44:45], v69 offset:28672
    v_mfma_f32_16x16x32_bf16 v[20:23], v[52:55], a[44:47], v[20:23]
    s_waitcnt lgkmcnt(7)
    ds_read_b64_tr_b16 v[46:47], v69 offset:29696
    v_mfma_f32_16x16x32_bf16 v[24:27], v[56:59], a[32:35], v[24:27]
    ds_read_b64_tr_b16 v[48:49], v70 offset:24576
    v_mfma_f32_16x16x32_bf16 v[24:27], v[60:63], a[40:43], v[24:27]
    ds_read_b64_tr_b16 v[50:51], v70 offset:25600
    buffer_load_dwordx4 a[108:111], v77, s[32:35], s57 offen offset:1024 sc1
    v_mfma_f32_16x16x32_bf16 v[28:31], v[56:59], a[36:39], v[28:31]
    ds_read_b64_tr_b16 v[52:53], v70 offset:28672
    v_mfma_f32_16x16x32_bf16 v[28:31], v[60:63], a[44:47], v[28:31]
    s_waitcnt lgkmcnt(7)
    s_waitcnt vmcnt(12)
    ds_read_b64_tr_b16 v[54:55], v70 offset:29696
    v_mfma_f32_16x16x32_bf16 v[0:3], v[32:35], a[48:51], v[0:3]
    ds_read_b64_tr_b16 v[56:57], v71 offset:24576
    v_mfma_f32_16x16x32_bf16 v[0:3], v[36:39], a[56:59], v[0:3]
    ds_read_b64_tr_b16 v[58:59], v71 offset:25600
    buffer_load_dwordx4 a[112:115], v76, s[32:35], s57 offen offset:2048 sc1
    v_mfma_f32_16x16x32_bf16 v[4:7], v[32:35], a[52:55], v[4:7]
    ds_read_b64_tr_b16 v[60:61], v71 offset:28672
    v_mfma_f32_16x16x32_bf16 v[4:7], v[36:39], a[60:63], v[4:7]
    s_waitcnt lgkmcnt(7)
    ds_read_b64_tr_b16 v[62:63], v71 offset:29696
    v_mfma_f32_16x16x32_bf16 v[8:11], v[40:43], a[48:51], v[8:11]
    ds_read_b64_tr_b16 v[32:33], v68 offset:32768
    v_mfma_f32_16x16x32_bf16 v[8:11], v[44:47], a[56:59], v[8:11]
    ds_read_b64_tr_b16 v[34:35], v68 offset:33792
    buffer_load_dwordx4 a[116:119], v77, s[32:35], s57 offen offset:2048 sc1
    v_mfma_f32_16x16x32_bf16 v[12:15], v[40:43], a[52:55], v[12:15]
    ds_read_b64_tr_b16 v[36:37], v68 offset:36864
    v_mfma_f32_16x16x32_bf16 v[12:15], v[44:47], a[60:63], v[12:15]
    s_waitcnt lgkmcnt(7)
    ds_read_b64_tr_b16 v[38:39], v68 offset:37888
    v_mfma_f32_16x16x32_bf16 v[16:19], v[48:51], a[48:51], v[16:19]
    ds_read_b64_tr_b16 v[40:41], v69 offset:32768
    v_mfma_f32_16x16x32_bf16 v[16:19], v[52:55], a[56:59], v[16:19]
    ds_read_b64_tr_b16 v[42:43], v69 offset:33792
    buffer_load_dwordx4 a[120:123], v76, s[32:35], s57 offen offset:3072 sc1
    v_mfma_f32_16x16x32_bf16 v[20:23], v[48:51], a[52:55], v[20:23]
    ds_read_b64_tr_b16 v[44:45], v69 offset:36864
    v_mfma_f32_16x16x32_bf16 v[20:23], v[52:55], a[60:63], v[20:23]
    s_waitcnt lgkmcnt(7)
    ds_read_b64_tr_b16 v[46:47], v69 offset:37888
    v_mfma_f32_16x16x32_bf16 v[24:27], v[56:59], a[48:51], v[24:27]
    ds_read_b64_tr_b16 v[48:49], v70 offset:32768
    v_mfma_f32_16x16x32_bf16 v[24:27], v[60:63], a[56:59], v[24:27]
    ds_read_b64_tr_b16 v[50:51], v70 offset:33792
    buffer_load_dwordx4 a[124:127], v77, s[32:35], s57 offen offset:3072 sc1
    v_mfma_f32_16x16x32_bf16 v[28:31], v[56:59], a[52:55], v[28:31]
    ds_read_b64_tr_b16 v[52:53], v70 offset:36864
    v_mfma_f32_16x16x32_bf16 v[28:31], v[60:63], a[60:63], v[28:31]
    s_waitcnt lgkmcnt(7)
    s_waitcnt vmcnt(12)
    ds_read_b64_tr_b16 v[54:55], v70 offset:37888
    v_mfma_f32_16x16x32_bf16 v[0:3], v[32:35], a[64:67], v[0:3]
    ds_read_b64_tr_b16 v[56:57], v71 offset:32768
    v_mfma_f32_16x16x32_bf16 v[0:3], v[36:39], a[72:75], v[0:3]
    ds_read_b64_tr_b16 v[58:59], v71 offset:33792
    v_mfma_f32_16x16x32_bf16 v[4:7], v[32:35], a[68:71], v[4:7]
    ds_read_b64_tr_b16 v[60:61], v71 offset:36864
    v_mfma_f32_16x16x32_bf16 v[4:7], v[36:39], a[76:79], v[4:7]
    s_waitcnt lgkmcnt(7)
    ds_read_b64_tr_b16 v[62:63], v71 offset:37888
    buffer_load_dword v249, v248, s[88:91], s51 offen sc1
    v_mfma_f32_16x16x32_bf16 v[8:11], v[40:43], a[64:67], v[8:11]
    ds_read_b64_tr_b16 v[32:33], v68 offset:40960
    v_mfma_f32_16x16x32_bf16 v[8:11], v[44:47], a[72:75], v[8:11]
    ds_read_b64_tr_b16 v[34:35], v68 offset:41984
    v_mfma_f32_16x16x32_bf16 v[12:15], v[40:43], a[68:71], v[12:15]
    ds_read_b64_tr_b16 v[36:37], v68 offset:45056
    v_mfma_f32_16x16x32_bf16 v[12:15], v[44:47], a[76:79], v[12:15]
    s_waitcnt lgkmcnt(7)
    ds_read_b64_tr_b16 v[38:39], v68 offset:46080
    v_mfma_f32_16x16x32_bf16 v[16:19], v[48:51], a[64:67], v[16:19]
    ds_read_b64_tr_b16 v[40:41], v69 offset:40960
    v_mfma_f32_16x16x32_bf16 v[16:19], v[52:55], a[72:75], v[16:19]
    ds_read_b64_tr_b16 v[42:43], v69 offset:41984
    v_mfma_f32_16x16x32_bf16 v[20:23], v[48:51], a[68:71], v[20:23]
    ds_read_b64_tr_b16 v[44:45], v69 offset:45056
    v_mfma_f32_16x16x32_bf16 v[20:23], v[52:55], a[76:79], v[20:23]
    s_waitcnt lgkmcnt(7)
    ds_read_b64_tr_b16 v[46:47], v69 offset:46080
    v_mfma_f32_16x16x32_bf16 v[24:27], v[56:59], a[64:67], v[24:27]
    ds_read_b64_tr_b16 v[48:49], v70 offset:40960
    v_mfma_f32_16x16x32_bf16 v[24:27], v[60:63], a[72:75], v[24:27]
    ds_read_b64_tr_b16 v[50:51], v70 offset:41984
    v_mfma_f32_16x16x32_bf16 v[28:31], v[56:59], a[68:71], v[28:31]
    ds_read_b64_tr_b16 v[52:53], v70 offset:45056
    v_mfma_f32_16x16x32_bf16 v[28:31], v[60:63], a[76:79], v[28:31]
    s_waitcnt lgkmcnt(7)
    s_waitcnt vmcnt(9)
    ds_read_b64_tr_b16 v[54:55], v70 offset:46080
    v_mfma_f32_16x16x32_bf16 v[0:3], v[32:35], a[80:83], v[0:3]
    ds_read_b64_tr_b16 v[56:57], v71 offset:40960
    v_mfma_f32_16x16x32_bf16 v[0:3], v[36:39], a[88:91], v[0:3]
    ds_read_b64_tr_b16 v[58:59], v71 offset:41984
    v_mfma_f32_16x16x32_bf16 v[4:7], v[32:35], a[84:87], v[4:7]
    ds_read_b64_tr_b16 v[60:61], v71 offset:45056
    v_mfma_f32_16x16x32_bf16 v[4:7], v[36:39], a[92:95], v[4:7]
    s_waitcnt lgkmcnt(7)
    ds_read_b64_tr_b16 v[62:63], v71 offset:46080
    v_mfma_f32_16x16x32_bf16 v[8:11], v[40:43], a[80:83], v[8:11]
    ds_read_b64_tr_b16 v[32:33], v68 offset:49152
    v_mfma_f32_16x16x32_bf16 v[8:11], v[44:47], a[88:91], v[8:11]
    ds_read_b64_tr_b16 v[34:35], v68 offset:50176
    v_mfma_f32_16x16x32_bf16 v[12:15], v[40:43], a[84:87], v[12:15]
    ds_read_b64_tr_b16 v[36:37], v68 offset:53248
    v_mfma_f32_16x16x32_bf16 v[12:15], v[44:47], a[92:95], v[12:15]
    s_waitcnt lgkmcnt(7)
    ds_read_b64_tr_b16 v[38:39], v68 offset:54272
    v_mfma_f32_16x16x32_bf16 v[16:19], v[48:51], a[80:83], v[16:19]
    ds_read_b64_tr_b16 v[40:41], v69 offset:49152
    v_mfma_f32_16x16x32_bf16 v[16:19], v[52:55], a[88:91], v[16:19]
    ds_read_b64_tr_b16 v[42:43], v69 offset:50176
    v_mfma_f32_16x16x32_bf16 v[20:23], v[48:51], a[84:87], v[20:23]
    ds_read_b64_tr_b16 v[44:45], v69 offset:53248
    v_mfma_f32_16x16x32_bf16 v[20:23], v[52:55], a[92:95], v[20:23]
    s_waitcnt lgkmcnt(7)
    ds_read_b64_tr_b16 v[46:47], v69 offset:54272
    v_mfma_f32_16x16x32_bf16 v[24:27], v[56:59], a[80:83], v[24:27]
    ds_read_b64_tr_b16 v[48:49], v70 offset:49152
    v_mfma_f32_16x16x32_bf16 v[24:27], v[60:63], a[88:91], v[24:27]
    ds_read_b64_tr_b16 v[50:51], v70 offset:50176
    v_mfma_f32_16x16x32_bf16 v[28:31], v[56:59], a[84:87], v[28:31]
    ds_read_b64_tr_b16 v[52:53], v70 offset:53248
    v_mfma_f32_16x16x32_bf16 v[28:31], v[60:63], a[92:95], v[28:31]
    s_waitcnt lgkmcnt(7)
    s_waitcnt vmcnt(5)
    ds_read_b64_tr_b16 v[54:55], v70 offset:54272
    v_mfma_f32_16x16x32_bf16 v[0:3], v[32:35], a[96:99], v[0:3]
    ds_read_b64_tr_b16 v[56:57], v71 offset:49152
    v_mfma_f32_16x16x32_bf16 v[0:3], v[36:39], a[104:107], v[0:3]
    ds_read_b64_tr_b16 v[58:59], v71 offset:50176
    v_mfma_f32_16x16x32_bf16 v[4:7], v[32:35], a[100:103], v[4:7]
    ds_read_b64_tr_b16 v[60:61], v71 offset:53248
    v_mfma_f32_16x16x32_bf16 v[4:7], v[36:39], a[108:111], v[4:7]
    s_waitcnt lgkmcnt(7)
    ds_read_b64_tr_b16 v[62:63], v71 offset:54272
    v_mfma_f32_16x16x32_bf16 v[8:11], v[40:43], a[96:99], v[8:11]
    ds_read_b64_tr_b16 v[32:33], v68 offset:57344
    v_mfma_f32_16x16x32_bf16 v[8:11], v[44:47], a[104:107], v[8:11]
    ds_read_b64_tr_b16 v[34:35], v68 offset:58368
    v_mfma_f32_16x16x32_bf16 v[12:15], v[40:43], a[100:103], v[12:15]
    ds_read_b64_tr_b16 v[36:37], v68 offset:61440
    v_mfma_f32_16x16x32_bf16 v[12:15], v[44:47], a[108:111], v[12:15]
    s_waitcnt lgkmcnt(7)
    ds_read_b64_tr_b16 v[38:39], v68 offset:62464
    v_mfma_f32_16x16x32_bf16 v[16:19], v[48:51], a[96:99], v[16:19]
    ds_read_b64_tr_b16 v[40:41], v69 offset:57344
    v_mfma_f32_16x16x32_bf16 v[16:19], v[52:55], a[104:107], v[16:19]
    ds_read_b64_tr_b16 v[42:43], v69 offset:58368
    v_mfma_f32_16x16x32_bf16 v[20:23], v[48:51], a[100:103], v[20:23]
    ds_read_b64_tr_b16 v[44:45], v69 offset:61440
    v_mfma_f32_16x16x32_bf16 v[20:23], v[52:55], a[108:111], v[20:23]
    s_waitcnt lgkmcnt(7)
    ds_read_b64_tr_b16 v[46:47], v69 offset:62464
    v_mfma_f32_16x16x32_bf16 v[24:27], v[56:59], a[96:99], v[24:27]
    ds_read_b64_tr_b16 v[48:49], v70 offset:57344
    v_mfma_f32_16x16x32_bf16 v[24:27], v[60:63], a[104:107], v[24:27]
    ds_read_b64_tr_b16 v[50:51], v70 offset:58368
    v_mfma_f32_16x16x32_bf16 v[28:31], v[56:59], a[100:103], v[28:31]
    ds_read_b64_tr_b16 v[52:53], v70 offset:61440
    v_mfma_f32_16x16x32_bf16 v[28:31], v[60:63], a[108:111], v[28:31]
    s_waitcnt lgkmcnt(7)
    s_waitcnt vmcnt(1)
    ds_read_b64_tr_b16 v[54:55], v70 offset:62464
    v_mfma_f32_16x16x32_bf16 v[0:3], v[32:35], a[112:115], v[0:3]
    ds_read_b64_tr_b16 v[56:57], v71 offset:57344
    v_mfma_f32_16x16x32_bf16 v[0:3], v[36:39], a[120:123], v[0:3]
    ds_read_b64_tr_b16 v[58:59], v71 offset:58368
    v_mfma_f32_16x16x32_bf16 v[4:7], v[32:35], a[116:119], v[4:7]
    ds_read_b64_tr_b16 v[60:61], v71 offset:61440
    v_mfma_f32_16x16x32_bf16 v[4:7], v[36:39], a[124:127], v[4:7]
    s_waitcnt lgkmcnt(7)
    ds_read_b64_tr_b16 v[62:63], v71 offset:62464
    v_mfma_f32_16x16x32_bf16 v[8:11], v[40:43], a[112:115], v[8:11]
    v_mfma_f32_16x16x32_bf16 v[8:11], v[44:47], a[120:123], v[8:11]
    v_mfma_f32_16x16x32_bf16 v[12:15], v[40:43], a[116:119], v[12:15]
    v_mfma_f32_16x16x32_bf16 v[12:15], v[44:47], a[124:127], v[12:15]
    s_waitcnt lgkmcnt(4)
    v_mfma_f32_16x16x32_bf16 v[16:19], v[48:51], a[112:115], v[16:19]
    v_mfma_f32_16x16x32_bf16 v[16:19], v[52:55], a[120:123], v[16:19]
    s_waitcnt vmcnt(0)
    v_cmp_gt_u32 vcc, s50, v249
    v_mfma_f32_16x16x32_bf16 v[20:23], v[48:51], a[116:119], v[20:23]
    v_mfma_f32_16x16x32_bf16 v[20:23], v[52:55], a[124:127], v[20:23]
    s_waitcnt lgkmcnt(0)
    v_mfma_f32_16x16x32_bf16 v[24:27], v[56:59], a[112:115], v[24:27]
    v_mfma_f32_16x16x32_bf16 v[24:27], v[60:63], a[120:123], v[24:27]
    v_mfma_f32_16x16x32_bf16 v[28:31], v[56:59], a[116:119], v[28:31]
    s_cbranch_vccnz L_sequential_preLN__softmax_full_mha__glu_gated_swiglu__prompt_kernel_allspin_14
L_sequential_preLN__softmax_full_mha__glu_gated_swiglu__prompt_kernel_allspin_14_r:
    v_mfma_f32_16x16x32_bf16 v[28:31], v[60:63], a[124:127], v[28:31]
    s_barrier
    s_nop 3
    v_cvt_pk_bf16_f32 v128, v0, v1
    v_cvt_pk_bf16_f32 v129, v2, v3
    v_cvt_pk_bf16_f32 v130, v8, v9
    v_cvt_pk_bf16_f32 v131, v10, v11
    buffer_store_dwordx4 v[128:131], v78, s[36:39], s65 offen offset:0 sc1
    v_cvt_pk_bf16_f32 v132, v16, v17
    v_cvt_pk_bf16_f32 v133, v18, v19
    v_cvt_pk_bf16_f32 v134, v24, v25
    v_cvt_pk_bf16_f32 v135, v26, v27
    buffer_store_dwordx4 v[132:135], v78, s[36:39], s65 offen offset:1024 sc1
    v_cvt_pk_bf16_f32 v136, v4, v5
    v_cvt_pk_bf16_f32 v137, v6, v7
    v_cvt_pk_bf16_f32 v138, v12, v13
    v_cvt_pk_bf16_f32 v139, v14, v15
    buffer_store_dwordx4 v[136:139], v78, s[36:39], s66 offen offset:0 sc1
    v_cvt_pk_bf16_f32 v140, v20, v21
    v_cvt_pk_bf16_f32 v141, v22, v23
    v_cvt_pk_bf16_f32 v142, v28, v29
    v_cvt_pk_bf16_f32 v143, v30, v31
    buffer_store_dwordx4 v[140:143], v78, s[36:39], s66 offen offset:1024 sc1
    v_pk_add_f32 v[36:37], v[0:1], v[2:3] op_sel:[0,0] op_sel_hi:[1,1]
    v_pk_mul_f32 v[38:39], v[0:1], v[0:1] op_sel:[0,0] op_sel_hi:[1,1]
    v_pk_fma_f32 v[38:39], v[2:3], v[2:3], v[38:39] op_sel:[0,0,0] op_sel_hi:[1,1,1]
    v_pk_add_f32 v[36:37], v[36:37], v[8:9] op_sel:[0,0] op_sel_hi:[1,1]
    v_pk_fma_f32 v[38:39], v[8:9], v[8:9], v[38:39] op_sel:[0,0,0] op_sel_hi:[1,1,1]
    v_pk_add_f32 v[36:37], v[36:37], v[10:11] op_sel:[0,0] op_sel_hi:[1,1]
    v_pk_fma_f32 v[38:39], v[10:11], v[10:11], v[38:39] op_sel:[0,0,0] op_sel_hi:[1,1,1]
    v_pk_add_f32 v[36:37], v[36:37], v[16:17] op_sel:[0,0] op_sel_hi:[1,1]
    v_pk_fma_f32 v[38:39], v[16:17], v[16:17], v[38:39] op_sel:[0,0,0] op_sel_hi:[1,1,1]
    v_pk_add_f32 v[36:37], v[36:37], v[18:19] op_sel:[0,0] op_sel_hi:[1,1]
    v_pk_fma_f32 v[38:39], v[18:19], v[18:19], v[38:39] op_sel:[0,0,0] op_sel_hi:[1,1,1]
    v_pk_add_f32 v[36:37], v[36:37], v[24:25] op_sel:[0,0] op_sel_hi:[1,1]
    v_pk_fma_f32 v[38:39], v[24:25], v[24:25], v[38:39] op_sel:[0,0,0] op_sel_hi:[1,1,1]
    v_pk_add_f32 v[36:37], v[36:37], v[26:27] op_sel:[0,0] op_sel_hi:[1,1]
    v_pk_fma_f32 v[38:39], v[26:27], v[26:27], v[38:39] op_sel:[0,0,0] op_sel_hi:[1,1,1]
    v_add_f32 v32, v36, v37
    v_add_f32 v33, v38, v39
    v_pk_add_f32 v[36:37], v[4:5], v[6:7] op_sel:[0,0] op_sel_hi:[1,1]
    v_pk_mul_f32 v[38:39], v[4:5], v[4:5] op_sel:[0,0] op_sel_hi:[1,1]
    v_pk_fma_f32 v[38:39], v[6:7], v[6:7], v[38:39] op_sel:[0,0,0] op_sel_hi:[1,1,1]
    v_pk_add_f32 v[36:37], v[36:37], v[12:13] op_sel:[0,0] op_sel_hi:[1,1]
    v_pk_fma_f32 v[38:39], v[12:13], v[12:13], v[38:39] op_sel:[0,0,0] op_sel_hi:[1,1,1]
    v_pk_add_f32 v[36:37], v[36:37], v[14:15] op_sel:[0,0] op_sel_hi:[1,1]
    v_pk_fma_f32 v[38:39], v[14:15], v[14:15], v[38:39] op_sel:[0,0,0] op_sel_hi:[1,1,1]
    v_pk_add_f32 v[36:37], v[36:37], v[20:21] op_sel:[0,0] op_sel_hi:[1,1]
    v_pk_fma_f32 v[38:39], v[20:21], v[20:21], v[38:39] op_sel:[0,0,0] op_sel_hi:[1,1,1]
    v_pk_add_f32 v[36:37], v[36:37], v[22:23] op_sel:[0,0] op_sel_hi:[1,1]
    v_pk_fma_f32 v[38:39], v[22:23], v[22:23], v[38:39] op_sel:[0,0,0] op_sel_hi:[1,1,1]
    v_pk_add_f32 v[36:37], v[36:37], v[28:29] op_sel:[0,0] op_sel_hi:[1,1]
    v_pk_fma_f32 v[38:39], v[28:29], v[28:29], v[38:39] op_sel:[0,0,0] op_sel_hi:[1,1,1]
    v_pk_add_f32 v[36:37], v[36:37], v[30:31] op_sel:[0,0] op_sel_hi:[1,1]
    v_pk_fma_f32 v[38:39], v[30:31], v[30:31], v[38:39] op_sel:[0,0,0] op_sel_hi:[1,1,1]
    v_add_f32 v34, v36, v37
    v_add_f32 v35, v38, v39
    v_lshrrev_b32 v243, 1, v241
    v_lshl_add_u32 v243, v243, 4, v240
    v_permlane32_swap_b32 v32, v34
L_stub_11:
    s_cbranch_execz L_warm_w13_ret
    v_permlane32_swap_b32 v33, v35
    v_and_b32 v244, 1, v241
    v_add_f32 v32, v32, v34
    v_add_f32 v33, v33, v35
    v_lshlrev_b32 v243, 3, v243
    v_lshl_add_u32 v243, v244, 2, v243
    v_permlane16_swap_b32 v32, v33
    s_lshl_b32 s60, s76, 7
    v_add_f32 v32, v32, v33
    buffer_atomic_add_f32 v32, v243, s[40:43], s60 offen sc1
    v_mbcnt_lo_u32_b32 v235, -1, 0
    v_mbcnt_hi_u32_b32 v235, -1, v235
    s_and_b32 s46, s44, 1
    s_lshl_b32 s46, s46, 2
    s_and_b32 s47, s45, 3
    s_add_u32 s46, s46, s47
    s_lshr_b32 s47, s44, 1
    s_lshl_b32 s47, s47, 3
    s_lshr_b32 s79, s45, 2
    s_add_u32 s47, s47, s79
    s_add_u32 s24, s22, 134217728
    s_addc_u32 s25, s23, 0
    s_mov_b32 s26, 31457280
    s_mul_i32 s53, s3, 7168
    s_mul_i32 s52, s47, 458752
    s_add_u32 s52, s52, s53
    v_mov_b32 v231, v78
    s_add_u32 s56, s52, 0
    s_add_u32 m0, s53, 0
    s_nop 0
    buffer_load_dwordx4 v231, s[24:27], s56 offen offset:0 sc1 lds
    buffer_load_dwordx4 v231, s[24:27], s56 offen offset:1024 sc1 lds
    buffer_load_dwordx4 v231, s[24:27], s56 offen offset:2048 sc1 lds
    buffer_load_dwordx4 v231, s[24:27], s56 offen offset:3072 sc1 lds
    s_add_u32 s56, s52, 4096
    s_add_u32 m0, s53, 4096
    s_nop 0
    buffer_load_dwordx4 v231, s[24:27], s56 offen offset:0 sc1 lds
    buffer_load_dwordx4 v231, s[24:27], s56 offen offset:1024 sc1 lds
    buffer_load_dwordx4 v231, s[24:27], s56 offen offset:2048 sc1 lds
    v_mov_b32 v249, v237
    v_mov_b32 v253, 1
    s_lshl_b32 s60, s92, 10
    s_add_u32 s60, s60, 32768
    s_lshl_b32 s72, s3, 20
    s_add_u32 s72, s72, s60
    s_add_u32 s72, s72, 32768
    s_waitcnt vmcnt(8)
    s_barrier
    s_lshl_b32 s61, s3, 20
    s_add_u32 s61, s61, s60
    buffer_atomic_add v253, v249, s[88:91], s61 offen sc1
    s_add_u32 s56, s52, 28672
    s_add_u32 m0, s53, 28672
    s_nop 0
    buffer_load_dwordx4 v231, s[24:27], s56 offen offset:0 sc1 lds
    buffer_load_dwordx4 v231, s[24:27], s56 offen offset:1024 sc1 lds
    buffer_load_dwordx4 v231, s[24:27], s56 offen offset:2048 sc1 lds
    buffer_load_dwordx4 v231, s[24:27], s56 offen offset:3072 sc1 lds
    s_add_u32 s56, s52, 32768
    s_add_u32 m0, s53, 32768
    s_nop 0
    buffer_load_dwordx4 v231, s[24:27], s56 offen offset:0 sc1 lds
    buffer_load_dwordx4 v231, s[24:27], s56 offen offset:1024 sc1 lds
    buffer_load_dwordx4 v231, s[24:27], s56 offen offset:2048 sc1 lds
    s_lshl_b32 s48, s46, 4
    s_lshl_b32 s49, s3, 2
    s_add_u32 s48, s48, s49
    s_lshl_b32 s49, s48, 15
    s_lshl_b32 s55, s3, 10
    s_add_u32 s55, s55, 143360
    v_lshlrev_b32 v232, 4, v235
    v_add_u32 v233, 57344, v232
    v_add_u32 v234, 114688, v232
    s_lshl_b32 s62, s46, 11
    s_add_u32 s62, s62, 32768
    s_and_b32 s51, s47, 3
    s_lshl_b32 s51, s51, 7
    s_add_u32 s62, s62, s51
    v_and_b32 v48, 1, v235
    v_lshlrev_b32 v48, 10, v48
    s_add_u32 s40, s22, 0x1404000
    s_addc_u32 s41, s23, 0
    s_mov_b32 s42, 0x7000
    s_mov_b32 s43, 0x20000
    s_add_u32 s36, s22, 0x1400000
    s_addc_u32 s37, s23, 0
    s_mov_b32 s38, 0x4000
    s_mov_b32 s39, 0x20000
    s_add_u32 s28, s22, 0x6800000
    s_addc_u32 s29, s23, 0
    s_mov_b32 s30, 0x1400000
    s_mov_b32 s31, 0x20000
    s_add_u32 s32, s22, 0x4000000
    s_addc_u32 s33, s23, 0
    s_mov_b32 s34, 0x1e00000
    s_mov_b32 s35, 0x20000
    s_add_u32 s64, s22, 0x2600000
    s_addc_u32 s65, s23, 0
    s_mov_b32 s66, 0x3e00000
    s_mov_b32 s67, 0x20000
    s_add_u32 s71, s72, 16384
    s_add_u32 s70, s101, 4096
    s_mul_i32 s60, s48, 114688
    s_mul_i32 s61, s47, 3584
    s_add_u32 s60, s60, s61
    s_add_u32 s61, s60, 229376
    s_mul_i32 s58, s47, 448
    s_lshl_b32 s63, s48, 7
    s_lshl_b32 s94, s46, 1
    s_lshr_b32 s51, s47, 4
    s_add_u32 s94, s94, s51
    s_lshl_b32 s94, s94, 10
    s_add_u32 s94, s94, 49152
    s_getpc_b64 s[76:77]
L_sequential_preLN__softmax_full_mha__glu_gated_swiglu__prompt_kernel_pc_16:
    s_add_u32 s76, s76, L_sequential_preLN__softmax_full_mha__glu_gated_swiglu__prompt_kernel_code4_15-L_sequential_preLN__softmax_full_mha__glu_gated_swiglu__prompt_kernel_pc_16
    s_addc_u32 s77, s77, (L_sequential_preLN__softmax_full_mha__glu_gated_swiglu__prompt_kernel_code4_15-L_sequential_preLN__softmax_full_mha__glu_gated_swiglu__prompt_kernel_pc_16)>>32
    s_lshl_b32 s78, s45, 2
    s_add_u32 s78, s78, s3
    s_lshl_b32 s78, s78, 9
    v_and_b32 v250, 3, v235
    v_lshl_add_u32 v250, v250, 7, s78
    v_min_u32 v250, L_sequential_preLN__softmax_full_mha__glu_gated_swiglu__prompt_kernel_end-L_sequential_preLN__softmax_full_mha__glu_gated_swiglu__prompt_kernel_code4_15, v250
    v_mov_b32 v251, s77
    v_add_co_u32 v250, vcc, s76, v250
    s_nop 1
    v_addc_co_u32 v251, vcc, 0, v251, vcc
    global_load_dword v252, v[250:251], off
    s_cmp_eq_u32 s3, 0
    s_cbranch_scc1 L_sequential_preLN__softmax_full_mha__glu_gated_swiglu__prompt_kernel_poller_18
    s_mov_b64 exec, 0
    s_cmp_eq_u32 s3, 1
    s_cbranch_scc1 L_stub_12
    s_cmp_eq_u32 s3, 2
    s_cbranch_scc1 L_stub_13
    s_branch L_stub_14
L_warm_w20_ret:
    s_mov_b64 exec, -1
    s_branch L_sequential_preLN__softmax_full_mha__glu_gated_swiglu__prompt_kernel_pdone_17
L_sequential_preLN__softmax_full_mha__glu_gated_swiglu__prompt_kernel_poller_18:
    s_mov_b32 s50, 262144
    s_mov_b64 exec, 3
L_sequential_preLN__softmax_full_mha__glu_gated_swiglu__prompt_kernel_poll_19:
    v_mov_b32 v43, 0
    s_sub_u32 s50, s50, 1
    s_cbranch_scc1 L_sequential_preLN__softmax_full_mha__glu_gated_swiglu__prompt_kernel_pend_20
    buffer_atomic_add v43, v48, s[88:91], s62 offen sc0 sc1
    s_waitcnt vmcnt(0)
    v_cmp_gt_u32 vcc, 16, v43
    s_nop 4
    s_cbranch_vccnz L_sequential_preLN__softmax_full_mha__glu_gated_swiglu__prompt_kernel_poll_19
L_sequential_preLN__softmax_full_mha__glu_gated_swiglu__prompt_kernel_pend_20:
    s_mov_b64 exec, -1
L_sequential_preLN__softmax_full_mha__glu_gated_swiglu__prompt_kernel_pdone_17:
    s_waitcnt vmcnt(0)
    s_barrier
L_sequential_preLN__softmax_full_mha__glu_gated_swiglu__prompt_kernel_code4_15:
    s_add_u32 s57, s49, 0
    buffer_load_dwordx4 a[0:3], v231, s[28:31], s57 offen offset:0 sc1
    buffer_load_dwordx4 a[4:7], v231, s[28:31], s57 offen offset:1024 sc1
    s_add_u32 s57, s49, 32768
    buffer_load_dwordx4 a[8:11], v231, s[28:31], s57 offen offset:0 sc1
    buffer_load_dwordx4 a[12:15], v231, s[28:31], s57 offen offset:1024 sc1
    s_add_u32 s57, s49, 65536
    buffer_load_dwordx4 a[16:19], v231, s[28:31], s57 offen offset:0 sc1
    buffer_load_dwordx4 a[20:23], v231, s[28:31], s57 offen offset:1024 sc1
    s_add_u32 s57, s49, 98304
    buffer_load_dwordx4 a[24:27], v231, s[28:31], s57 offen offset:0 sc1
    buffer_load_dwordx4 a[28:31], v231, s[28:31], s57 offen offset:1024 sc1
    ds_read_b128 a[160:163], v232 offset:0
    ds_read_b128 a[164:167], v232 offset:1024
    ds_read_b128 a[168:171], v232 offset:2048
    ds_read_b128 a[172:175], v232 offset:3072
    s_add_u32 s57, s49, 2048
    buffer_load_dwordx4 a[32:35], v231, s[28:31], s57 offen offset:0 sc1
    buffer_load_dwordx4 a[36:39], v231, s[28:31], s57 offen offset:1024 sc1
    s_add_u32 s57, s49, 34816
    buffer_load_dwordx4 a[40:43], v231, s[28:31], s57 offen offset:0 sc1
    buffer_load_dwordx4 a[44:47], v231, s[28:31], s57 offen offset:1024 sc1
    s_waitcnt vmcnt(4)
    s_waitcnt lgkmcnt(2)
    v_mfma_f32_16x16x32_bf16 v[0:3], a[160:163], a[0:3], 0
    s_add_u32 s57, s49, 67584
    ds_read_b128 a[176:179], v232 offset:4096
    v_mfma_f32_16x16x32_bf16 v[0:3], a[164:167], a[4:7], v[0:3]
    buffer_load_dwordx4 a[48:51], v231, s[28:31], s57 offen offset:0 sc1
    v_mfma_f32_16x16x32_bf16 v[4:7], a[160:163], a[8:11], 0
    v_mfma_f32_16x16x32_bf16 v[4:7], a[164:167], a[12:15], v[4:7]
    v_mfma_f32_16x16x32_bf16 v[8:11], a[160:163], a[16:19], 0
    ds_read_b128 a[180:183], v232 offset:5120
    v_mfma_f32_16x16x32_bf16 v[8:11], a[164:167], a[20:23], v[8:11]
    buffer_load_dwordx4 a[52:55], v231, s[28:31], s57 offen offset:1024 sc1
    v_mfma_f32_16x16x32_bf16 v[12:15], a[160:163], a[24:27], 0
    v_mfma_f32_16x16x32_bf16 v[12:15], a[164:167], a[28:31], v[12:15]
    s_waitcnt lgkmcnt(2)
    v_mfma_f32_16x16x32_bf16 v[16:19], a[168:171], a[0:3], 0
    s_add_u32 s57, s49, 100352
    ds_read_b128 a[184:187], v232 offset:6144
    v_mfma_f32_16x16x32_bf16 v[16:19], a[172:175], a[4:7], v[16:19]
    buffer_load_dwordx4 a[56:59], v231, s[28:31], s57 offen offset:0 sc1
    v_mfma_f32_16x16x32_bf16 v[20:23], a[168:171], a[8:11], 0
    v_mfma_f32_16x16x32_bf16 v[20:23], a[172:175], a[12:15], v[20:23]
    v_mfma_f32_16x16x32_bf16 v[24:27], a[168:171], a[16:19], 0
    ds_read_b128 a[188:191], v232 offset:7168
    v_mfma_f32_16x16x32_bf16 v[24:27], a[172:175], a[20:23], v[24:27]
    buffer_load_dwordx4 a[60:63], v231, s[28:31], s57 offen offset:1024 sc1
    v_mfma_f32_16x16x32_bf16 v[28:31], a[168:171], a[24:27], 0
    v_mfma_f32_16x16x32_bf16 v[28:31], a[172:175], a[28:31], v[28:31]
    s_waitcnt lgkmcnt(2)
    v_mfma_f32_16x16x32_bf16 v[32:35], a[176:179], a[0:3], 0
    ds_read_b128 a[192:195], v232 offset:8192
    v_mfma_f32_16x16x32_bf16 v[32:35], a[180:183], a[4:7], v[32:35]
    v_mfma_f32_16x16x32_bf16 v[36:39], a[176:179], a[8:11], 0
    v_mfma_f32_16x16x32_bf16 v[36:39], a[180:183], a[12:15], v[36:39]
    v_mfma_f32_16x16x32_bf16 v[40:43], a[176:179], a[16:19], 0
    ds_read_b128 a[196:199], v232 offset:9216
    v_mfma_f32_16x16x32_bf16 v[40:43], a[180:183], a[20:23], v[40:43]
    v_mfma_f32_16x16x32_bf16 v[44:47], a[176:179], a[24:27], 0
    v_mfma_f32_16x16x32_bf16 v[44:47], a[180:183], a[28:31], v[44:47]
    s_waitcnt lgkmcnt(2)
    v_mfma_f32_16x16x32_bf16 v[48:51], a[184:187], a[0:3], 0
    s_add_u32 s56, s52, 57344
    ds_read_b128 a[200:203], v232 offset:10240
    s_add_u32 m0, s53, 57344
    v_mfma_f32_16x16x32_bf16 v[48:51], a[188:191], a[4:7], v[48:51]
    buffer_load_dwordx4 v231, s[24:27], s56 offen offset:0 sc1 lds
    v_mfma_f32_16x16x32_bf16 v[52:55], a[184:187], a[8:11], 0
    v_mfma_f32_16x16x32_bf16 v[52:55], a[188:191], a[12:15], v[52:55]
    v_mfma_f32_16x16x32_bf16 v[56:59], a[184:187], a[16:19], 0
    ds_read_b128 a[204:207], v232 offset:11264
    v_mfma_f32_16x16x32_bf16 v[56:59], a[188:191], a[20:23], v[56:59]
    v_mfma_f32_16x16x32_bf16 v[60:63], a[184:187], a[24:27], 0
    v_mfma_f32_16x16x32_bf16 v[60:63], a[188:191], a[28:31], v[60:63]
    s_waitcnt lgkmcnt(2)
    buffer_load_dwordx4 v231, s[24:27], s56 offen offset:1024 sc1 lds
    v_mfma_f32_16x16x32_bf16 v[64:67], a[192:195], a[0:3], 0
    ds_read_b128 a[208:211], v232 offset:12288
    v_mfma_f32_16x16x32_bf16 v[64:67], a[196:199], a[4:7], v[64:67]
    v_mfma_f32_16x16x32_bf16 v[68:71], a[192:195], a[8:11], 0
    v_mfma_f32_16x16x32_bf16 v[68:71], a[196:199], a[12:15], v[68:71]
    v_mfma_f32_16x16x32_bf16 v[72:75], a[192:195], a[16:19], 0
    ds_read_b128 a[212:215], v232 offset:13312
    v_mfma_f32_16x16x32_bf16 v[72:75], a[196:199], a[20:23], v[72:75]
    buffer_load_dwordx4 v231, s[24:27], s56 offen offset:2048 sc1 lds
    v_mfma_f32_16x16x32_bf16 v[76:79], a[192:195], a[24:27], 0
    v_mfma_f32_16x16x32_bf16 v[76:79], a[196:199], a[28:31], v[76:79]
    s_waitcnt lgkmcnt(2)
    v_mfma_f32_16x16x32_bf16 v[80:83], a[200:203], a[0:3], 0
    ds_read_b128 a[160:163], v232 offset:14336
    v_mfma_f32_16x16x32_bf16 v[80:83], a[204:207], a[4:7], v[80:83]
    v_mfma_f32_16x16x32_bf16 v[84:87], a[200:203], a[8:11], 0
    v_mfma_f32_16x16x32_bf16 v[84:87], a[204:207], a[12:15], v[84:87]
    buffer_load_dwordx4 v231, s[24:27], s56 offen offset:3072 sc1 lds
    v_mfma_f32_16x16x32_bf16 v[88:91], a[200:203], a[16:19], 0
    ds_read_b128 a[164:167], v232 offset:15360
    v_mfma_f32_16x16x32_bf16 v[88:91], a[204:207], a[20:23], v[88:91]
    v_mfma_f32_16x16x32_bf16 v[92:95], a[200:203], a[24:27], 0
    v_mfma_f32_16x16x32_bf16 v[92:95], a[204:207], a[28:31], v[92:95]
    s_waitcnt lgkmcnt(2)
    v_mfma_f32_16x16x32_bf16 v[96:99], a[208:211], a[0:3], 0
    s_add_u32 s57, s49, 4096
    ds_read_b128 a[168:171], v232 offset:16384
    v_mfma_f32_16x16x32_bf16 v[96:99], a[212:215], a[4:7], v[96:99]
    buffer_load_dwordx4 a[64:67], v231, s[28:31], s57 offen offset:0 sc1
    v_mfma_f32_16x16x32_bf16 v[100:103], a[208:211], a[8:11], 0
    v_mfma_f32_16x16x32_bf16 v[100:103], a[212:215], a[12:15], v[100:103]
    v_mfma_f32_16x16x32_bf16 v[104:107], a[208:211], a[16:19], 0
    ds_read_b128 a[172:175], v232 offset:17408
    v_mfma_f32_16x16x32_bf16 v[104:107], a[212:215], a[20:23], v[104:107]
    v_mfma_f32_16x16x32_bf16 v[108:111], a[208:211], a[24:27], 0
    v_mfma_f32_16x16x32_bf16 v[108:111], a[212:215], a[28:31], v[108:111]
    s_waitcnt lgkmcnt(2)
    buffer_load_dwordx4 a[68:71], v231, s[28:31], s57 offen offset:1024 sc1
    v_mfma_f32_16x16x32_bf16 v[112:115], a[160:163], a[0:3], 0
    ds_read_b128 a[176:179], v232 offset:18432
    v_mfma_f32_16x16x32_bf16 v[112:115], a[164:167], a[4:7], v[112:115]
    v_mfma_f32_16x16x32_bf16 v[116:119], a[160:163], a[8:11], 0
    v_mfma_f32_16x16x32_bf16 v[116:119], a[164:167], a[12:15], v[116:119]
    v_mfma_f32_16x16x32_bf16 v[120:123], a[160:163], a[16:19], 0
    s_add_u32 s57, s49, 36864
    ds_read_b128 a[180:183], v232 offset:19456
    v_mfma_f32_16x16x32_bf16 v[120:123], a[164:167], a[20:23], v[120:123]
    buffer_load_dwordx4 a[72:75], v231, s[28:31], s57 offen offset:0 sc1
    v_mfma_f32_16x16x32_bf16 v[124:127], a[160:163], a[24:27], 0
    v_mfma_f32_16x16x32_bf16 v[124:127], a[164:167], a[28:31], v[124:127]
    s_waitcnt lgkmcnt(2)
    v_mfma_f32_16x16x32_bf16 v[128:131], a[168:171], a[0:3], 0
    ds_read_b128 a[184:187], v232 offset:20480
    v_mfma_f32_16x16x32_bf16 v[128:131], a[172:175], a[4:7], v[128:131]
    v_mfma_f32_16x16x32_bf16 v[132:135], a[168:171], a[8:11], 0
    v_mfma_f32_16x16x32_bf16 v[132:135], a[172:175], a[12:15], v[132:135]
    buffer_load_dwordx4 a[76:79], v231, s[28:31], s57 offen offset:1024 sc1
    v_mfma_f32_16x16x32_bf16 v[136:139], a[168:171], a[16:19], 0
    ds_read_b128 a[188:191], v232 offset:21504
    v_mfma_f32_16x16x32_bf16 v[136:139], a[172:175], a[20:23], v[136:139]
    v_mfma_f32_16x16x32_bf16 v[140:143], a[168:171], a[24:27], 0
    v_mfma_f32_16x16x32_bf16 v[140:143], a[172:175], a[28:31], v[140:143]
    s_waitcnt lgkmcnt(2)
    v_mfma_f32_16x16x32_bf16 v[144:147], a[176:179], a[0:3], 0
    s_add_u32 s56, s52, 61440
    ds_read_b128 a[192:195], v232 offset:22528
    s_add_u32 m0, s53, 61440
    v_mfma_f32_16x16x32_bf16 v[144:147], a[180:183], a[4:7], v[144:147]
    buffer_load_dwordx4 v231, s[24:27], s56 offen offset:0 sc1 lds
    v_mfma_f32_16x16x32_bf16 v[148:151], a[176:179], a[8:11], 0
    v_mfma_f32_16x16x32_bf16 v[148:151], a[180:183], a[12:15], v[148:151]
    v_mfma_f32_16x16x32_bf16 v[152:155], a[176:179], a[16:19], 0
    ds_read_b128 a[196:199], v232 offset:23552
    v_mfma_f32_16x16x32_bf16 v[152:155], a[180:183], a[20:23], v[152:155]
    v_mfma_f32_16x16x32_bf16 v[156:159], a[176:179], a[24:27], 0
    v_mfma_f32_16x16x32_bf16 v[156:159], a[180:183], a[28:31], v[156:159]
    s_waitcnt lgkmcnt(2)
    buffer_load_dwordx4 v231, s[24:27], s56 offen offset:1024 sc1 lds
    v_mfma_f32_16x16x32_bf16 v[160:163], a[184:187], a[0:3], 0
    ds_read_b128 a[200:203], v232 offset:24576
    v_mfma_f32_16x16x32_bf16 v[160:163], a[188:191], a[4:7], v[160:163]
    v_mfma_f32_16x16x32_bf16 v[164:167], a[184:187], a[8:11], 0
    v_mfma_f32_16x16x32_bf16 v[164:167], a[188:191], a[12:15], v[164:167]
    v_mfma_f32_16x16x32_bf16 v[168:171], a[184:187], a[16:19], 0
    ds_read_b128 a[204:207], v232 offset:25600
    v_mfma_f32_16x16x32_bf16 v[168:171], a[188:191], a[20:23], v[168:171]
    buffer_load_dwordx4 v231, s[24:27], s56 offen offset:2048 sc1 lds
    v_mfma_f32_16x16x32_bf16 v[172:175], a[184:187], a[24:27], 0
    v_mfma_f32_16x16x32_bf16 v[172:175], a[188:191], a[28:31], v[172:175]
    s_waitcnt lgkmcnt(2)
    v_mfma_f32_16x16x32_bf16 v[176:179], a[192:195], a[0:3], 0
    ds_read_b128 a[208:211], v232 offset:26624
    v_mfma_f32_16x16x32_bf16 v[176:179], a[196:199], a[4:7], v[176:179]
    v_mfma_f32_16x16x32_bf16 v[180:183], a[192:195], a[8:11], 0
    s_add_u32 s57, s49, 69632
    v_mfma_f32_16x16x32_bf16 v[180:183], a[196:199], a[12:15], v[180:183]
    buffer_load_dwordx4 a[80:83], v231, s[28:31], s57 offen offset:0 sc1
    v_mfma_f32_16x16x32_bf16 v[184:187], a[192:195], a[16:19], 0
    ds_read_b128 a[212:215], v232 offset:27648
    v_mfma_f32_16x16x32_bf16 v[184:187], a[196:199], a[20:23], v[184:187]
    v_mfma_f32_16x16x32_bf16 v[188:191], a[192:195], a[24:27], 0
    v_mfma_f32_16x16x32_bf16 v[188:191], a[196:199], a[28:31], v[188:191]
    s_waitcnt lgkmcnt(2)
    s_waitcnt vmcnt(12)
    s_barrier
    v_mfma_f32_16x16x32_bf16 v[192:195], a[200:203], a[0:3], 0
    ds_read_b128 a[160:163], v232 offset:28672
    v_mfma_f32_16x16x32_bf16 v[192:195], a[204:207], a[4:7], v[192:195]
    buffer_load_dwordx4 a[84:87], v231, s[28:31], s57 offen offset:1024 sc1
    v_mfma_f32_16x16x32_bf16 v[196:199], a[200:203], a[8:11], 0
    v_mfma_f32_16x16x32_bf16 v[196:199], a[204:207], a[12:15], v[196:199]
    v_mfma_f32_16x16x32_bf16 v[200:203], a[200:203], a[16:19], 0
    ds_read_b128 a[164:167], v232 offset:29696
    v_mfma_f32_16x16x32_bf16 v[200:203], a[204:207], a[20:23], v[200:203]
    v_mfma_f32_16x16x32_bf16 v[204:207], a[200:203], a[24:27], 0
    s_add_u32 s57, s49, 102400
    v_mfma_f32_16x16x32_bf16 v[204:207], a[204:207], a[28:31], v[204:207]
    s_waitcnt lgkmcnt(2)
    buffer_load_dwordx4 a[88:91], v231, s[28:31], s57 offen offset:0 sc1
    v_mfma_f32_16x16x32_bf16 v[208:211], a[208:211], a[0:3], 0
    ds_read_b128 a[168:171], v232 offset:30720
    v_mfma_f32_16x16x32_bf16 v[208:211], a[212:215], a[4:7], v[208:211]
    v_mfma_f32_16x16x32_bf16 v[212:215], a[208:211], a[8:11], 0
    v_mfma_f32_16x16x32_bf16 v[212:215], a[212:215], a[12:15], v[212:215]
    v_mfma_f32_16x16x32_bf16 v[216:219], a[208:211], a[16:19], 0
    ds_read_b128 a[172:175], v232 offset:31744
    v_mfma_f32_16x16x32_bf16 v[216:219], a[212:215], a[20:23], v[216:219]
    buffer_load_dwordx4 a[92:95], v231, s[28:31], s57 offen offset:1024 sc1
    v_mfma_f32_16x16x32_bf16 v[220:223], a[208:211], a[24:27], 0
    v_mfma_f32_16x16x32_bf16 v[220:223], a[212:215], a[28:31], v[220:223]
    s_waitcnt lgkmcnt(2)
    v_mfma_f32_16x16x32_bf16 v[0:3], a[160:163], a[32:35], v[0:3]
    ds_read_b128 a[176:179], v232 offset:32768
    v_mfma_f32_16x16x32_bf16 v[0:3], a[164:167], a[36:39], v[0:3]
    v_mfma_f32_16x16x32_bf16 v[4:7], a[160:163], a[40:43], v[4:7]
    s_add_u32 s56, s52, 86016
    s_add_u32 m0, s53, 86016
    v_mfma_f32_16x16x32_bf16 v[4:7], a[164:167], a[44:47], v[4:7]
    buffer_load_dwordx4 v231, s[24:27], s56 offen offset:0 sc1 lds
    v_mfma_f32_16x16x32_bf16 v[8:11], a[160:163], a[48:51], v[8:11]
    ds_read_b128 a[180:183], v232 offset:33792
    v_mfma_f32_16x16x32_bf16 v[8:11], a[164:167], a[52:55], v[8:11]
    v_mfma_f32_16x16x32_bf16 v[12:15], a[160:163], a[56:59], v[12:15]
    v_mfma_f32_16x16x32_bf16 v[12:15], a[164:167], a[60:63], v[12:15]
    s_waitcnt lgkmcnt(2)
    v_mfma_f32_16x16x32_bf16 v[16:19], a[168:171], a[32:35], v[16:19]
    ds_read_b128 a[184:187], v232 offset:34816
    v_mfma_f32_16x16x32_bf16 v[16:19], a[172:175], a[36:39], v[16:19]
    buffer_load_dwordx4 v231, s[24:27], s56 offen offset:1024 sc1 lds
    v_mfma_f32_16x16x32_bf16 v[20:23], a[168:171], a[40:43], v[20:23]
    buffer_atomic_add_f32 v226, v228, s[40:43], s95 offen offset:0 sc1
    v_mfma_f32_16x16x32_bf16 v[20:23], a[172:175], a[44:47], v[20:23]
    v_mfma_f32_16x16x32_bf16 v[24:27], a[168:171], a[48:51], v[24:27]
    ds_read_b128 a[188:191], v232 offset:35840
    v_mfma_f32_16x16x32_bf16 v[24:27], a[172:175], a[52:55], v[24:27]
    v_mfma_f32_16x16x32_bf16 v[28:31], a[168:171], a[56:59], v[28:31]
    v_mfma_f32_16x16x32_bf16 v[28:31], a[172:175], a[60:63], v[28:31]
    s_waitcnt lgkmcnt(2)
    buffer_load_dwordx4 v231, s[24:27], s56 offen offset:2048 sc1 lds
    v_mfma_f32_16x16x32_bf16 v[32:35], a[176:179], a[32:35], v[32:35]
    ds_read_b128 a[192:195], v232 offset:36864
    v_mfma_f32_16x16x32_bf16 v[32:35], a[180:183], a[36:39], v[32:35]
    v_mfma_f32_16x16x32_bf16 v[36:39], a[176:179], a[40:43], v[36:39]
    v_mfma_f32_16x16x32_bf16 v[36:39], a[180:183], a[44:47], v[36:39]
    v_mfma_f32_16x16x32_bf16 v[40:43], a[176:179], a[48:51], v[40:43]
    ds_read_b128 a[196:199], v232 offset:37888
    v_mfma_f32_16x16x32_bf16 v[40:43], a[180:183], a[52:55], v[40:43]
    buffer_load_dwordx4 v231, s[24:27], s56 offen offset:3072 sc1 lds
    v_mfma_f32_16x16x32_bf16 v[44:47], a[176:179], a[56:59], v[44:47]
    v_mfma_f32_16x16x32_bf16 v[44:47], a[180:183], a[60:63], v[44:47]
    s_waitcnt lgkmcnt(2)
    v_mfma_f32_16x16x32_bf16 v[48:51], a[184:187], a[32:35], v[48:51]
    ds_read_b128 a[200:203], v232 offset:38912
    v_mfma_f32_16x16x32_bf16 v[48:51], a[188:191], a[36:39], v[48:51]
    buffer_atomic_add_f32 v227, v228, s[40:43], s95 offen offset:256 sc1
    v_mfma_f32_16x16x32_bf16 v[52:55], a[184:187], a[40:43], v[52:55]
    s_add_u32 s57, s49, 6144
    v_mfma_f32_16x16x32_bf16 v[52:55], a[188:191], a[44:47], v[52:55]
    buffer_load_dwordx4 a[96:99], v231, s[28:31], s57 offen offset:0 sc1
    v_mfma_f32_16x16x32_bf16 v[56:59], a[184:187], a[48:51], v[56:59]
    ds_read_b128 a[204:207], v232 offset:39936
    v_mfma_f32_16x16x32_bf16 v[56:59], a[188:191], a[52:55], v[56:59]
    v_mfma_f32_16x16x32_bf16 v[60:63], a[184:187], a[56:59], v[60:63]
    v_mfma_f32_16x16x32_bf16 v[60:63], a[188:191], a[60:63], v[60:63]
    s_waitcnt lgkmcnt(2)
    v_mfma_f32_16x16x32_bf16 v[64:67], a[192:195], a[32:35], v[64:67]
    ds_read_b128 a[208:211], v232 offset:40960
    v_mfma_f32_16x16x32_bf16 v[64:67], a[196:199], a[36:39], v[64:67]
    buffer_load_dwordx4 a[100:103], v231, s[28:31], s57 offen offset:1024 sc1
    v_mfma_f32_16x16x32_bf16 v[68:71], a[192:195], a[40:43], v[68:71]
    v_mfma_f32_16x16x32_bf16 v[68:71], a[196:199], a[44:47], v[68:71]
    v_mfma_f32_16x16x32_bf16 v[72:75], a[192:195], a[48:51], v[72:75]
    ds_read_b128 a[212:215], v232 offset:41984
    v_mfma_f32_16x16x32_bf16 v[72:75], a[196:199], a[52:55], v[72:75]
    v_mfma_f32_16x16x32_bf16 v[76:79], a[192:195], a[56:59], v[76:79]
    s_add_u32 s57, s49, 38912
    v_mfma_f32_16x16x32_bf16 v[76:79], a[196:199], a[60:63], v[76:79]
    s_waitcnt lgkmcnt(2)
    buffer_load_dwordx4 a[104:107], v231, s[28:31], s57 offen offset:0 sc1
    v_mfma_f32_16x16x32_bf16 v[80:83], a[200:203], a[32:35], v[80:83]
    ds_read_b128 a[160:163], v232 offset:43008
    v_mfma_f32_16x16x32_bf16 v[80:83], a[204:207], a[36:39], v[80:83]
    v_mfma_f32_16x16x32_bf16 v[84:87], a[200:203], a[40:43], v[84:87]
    v_mfma_f32_16x16x32_bf16 v[84:87], a[204:207], a[44:47], v[84:87]
    v_mfma_f32_16x16x32_bf16 v[88:91], a[200:203], a[48:51], v[88:91]
    ds_read_b128 a[164:167], v232 offset:44032
    v_mfma_f32_16x16x32_bf16 v[88:91], a[204:207], a[52:55], v[88:91]
    buffer_load_dwordx4 a[108:111], v231, s[28:31], s57 offen offset:1024 sc1
    v_mfma_f32_16x16x32_bf16 v[92:95], a[200:203], a[56:59], v[92:95]
    v_mfma_f32_16x16x32_bf16 v[92:95], a[204:207], a[60:63], v[92:95]
    s_waitcnt lgkmcnt(2)
    v_mfma_f32_16x16x32_bf16 v[96:99], a[208:211], a[32:35], v[96:99]
    ds_read_b128 a[168:171], v232 offset:45056
    v_mfma_f32_16x16x32_bf16 v[96:99], a[212:215], a[36:39], v[96:99]
    v_mfma_f32_16x16x32_bf16 v[100:103], a[208:211], a[40:43], v[100:103]
    s_add_u32 s56, s52, 90112
    s_add_u32 m0, s53, 90112
    v_mfma_f32_16x16x32_bf16 v[100:103], a[212:215], a[44:47], v[100:103]
    buffer_load_dwordx4 v231, s[24:27], s56 offen offset:0 sc1 lds
    v_mfma_f32_16x16x32_bf16 v[104:107], a[208:211], a[48:51], v[104:107]
    ds_read_b128 a[172:175], v232 offset:46080
    v_mfma_f32_16x16x32_bf16 v[104:107], a[212:215], a[52:55], v[104:107]
    v_mfma_f32_16x16x32_bf16 v[108:111], a[208:211], a[56:59], v[108:111]
    v_mfma_f32_16x16x32_bf16 v[108:111], a[212:215], a[60:63], v[108:111]
    s_waitcnt lgkmcnt(2)
    v_mfma_f32_16x16x32_bf16 v[112:115], a[160:163], a[32:35], v[112:115]
    ds_read_b128 a[176:179], v232 offset:47104
    v_mfma_f32_16x16x32_bf16 v[112:115], a[164:167], a[36:39], v[112:115]
    buffer_load_dwordx4 v231, s[24:27], s56 offen offset:1024 sc1 lds
    v_mfma_f32_16x16x32_bf16 v[116:119], a[160:163], a[40:43], v[116:119]
    buffer_store_dwordx4 a[216:219], v231, s[64:67], s101 offen offset:0 sc1
    v_mfma_f32_16x16x32_bf16 v[116:119], a[164:167], a[44:47], v[116:119]
    v_mfma_f32_16x16x32_bf16 v[120:123], a[160:163], a[48:51], v[120:123]
    ds_read_b128 a[180:183], v232 offset:48128
    v_mfma_f32_16x16x32_bf16 v[120:123], a[164:167], a[52:55], v[120:123]
    v_mfma_f32_16x16x32_bf16 v[124:127], a[160:163], a[56:59], v[124:127]
    v_mfma_f32_16x16x32_bf16 v[124:127], a[164:167], a[60:63], v[124:127]
    s_waitcnt lgkmcnt(2)
    buffer_load_dwordx4 v231, s[24:27], s56 offen offset:2048 sc1 lds
    v_mfma_f32_16x16x32_bf16 v[128:131], a[168:171], a[32:35], v[128:131]
    ds_read_b128 a[184:187], v232 offset:49152
    v_mfma_f32_16x16x32_bf16 v[128:131], a[172:175], a[36:39], v[128:131]
    v_mfma_f32_16x16x32_bf16 v[132:135], a[168:171], a[40:43], v[132:135]
    v_mfma_f32_16x16x32_bf16 v[132:135], a[172:175], a[44:47], v[132:135]
    v_mfma_f32_16x16x32_bf16 v[136:139], a[168:171], a[48:51], v[136:139]
    s_add_u32 s57, s49, 71680
    ds_read_b128 a[188:191], v232 offset:50176
    v_mfma_f32_16x16x32_bf16 v[136:139], a[172:175], a[52:55], v[136:139]
    buffer_load_dwordx4 a[112:115], v231, s[28:31], s57 offen offset:0 sc1
    v_mfma_f32_16x16x32_bf16 v[140:143], a[168:171], a[56:59], v[140:143]
    v_mfma_f32_16x16x32_bf16 v[140:143], a[172:175], a[60:63], v[140:143]
    s_waitcnt lgkmcnt(2)
    v_mfma_f32_16x16x32_bf16 v[144:147], a[176:179], a[32:35], v[144:147]
    ds_read_b128 a[192:195], v232 offset:51200
    v_mfma_f32_16x16x32_bf16 v[144:147], a[180:183], a[36:39], v[144:147]
    v_mfma_f32_16x16x32_bf16 v[148:151], a[176:179], a[40:43], v[148:151]
    v_mfma_f32_16x16x32_bf16 v[148:151], a[180:183], a[44:47], v[148:151]
    buffer_load_dwordx4 a[116:119], v231, s[28:31], s57 offen offset:1024 sc1
    v_mfma_f32_16x16x32_bf16 v[152:155], a[176:179], a[48:51], v[152:155]
    ds_read_b128 a[196:199], v232 offset:52224
    v_mfma_f32_16x16x32_bf16 v[152:155], a[180:183], a[52:55], v[152:155]
    v_mfma_f32_16x16x32_bf16 v[156:159], a[176:179], a[56:59], v[156:159]
    v_mfma_f32_16x16x32_bf16 v[156:159], a[180:183], a[60:63], v[156:159]
    s_waitcnt lgkmcnt(2)
    v_mfma_f32_16x16x32_bf16 v[160:163], a[184:187], a[32:35], v[160:163]
    s_add_u32 s57, s49, 104448
    ds_read_b128 a[200:203], v232 offset:53248
    v_mfma_f32_16x16x32_bf16 v[160:163], a[188:191], a[36:39], v[160:163]
    buffer_load_dwordx4 a[120:123], v231, s[28:31], s57 offen offset:0 sc1
    v_mfma_f32_16x16x32_bf16 v[164:167], a[184:187], a[40:43], v[164:167]
    v_mfma_f32_16x16x32_bf16 v[164:167], a[188:191], a[44:47], v[164:167]
    v_mfma_f32_16x16x32_bf16 v[168:171], a[184:187], a[48:51], v[168:171]
    ds_read_b128 a[204:207], v232 offset:54272
    v_mfma_f32_16x16x32_bf16 v[168:171], a[188:191], a[52:55], v[168:171]
    v_mfma_f32_16x16x32_bf16 v[172:175], a[184:187], a[56:59], v[172:175]
    v_mfma_f32_16x16x32_bf16 v[172:175], a[188:191], a[60:63], v[172:175]
    s_waitcnt lgkmcnt(2)
    buffer_load_dwordx4 a[124:127], v231, s[28:31], s57 offen offset:1024 sc1
    v_mfma_f32_16x16x32_bf16 v[176:179], a[192:195], a[32:35], v[176:179]
    ds_read_b128 a[208:211], v232 offset:55296
    v_mfma_f32_16x16x32_bf16 v[176:179], a[196:199], a[36:39], v[176:179]
    v_mfma_f32_16x16x32_bf16 v[180:183], a[192:195], a[40:43], v[180:183]
    v_mfma_f32_16x16x32_bf16 v[180:183], a[196:199], a[44:47], v[180:183]
    v_mfma_f32_16x16x32_bf16 v[184:187], a[192:195], a[48:51], v[184:187]
    s_add_u32 s56, s52, 114688
    ds_read_b128 a[212:215], v232 offset:56320
    s_add_u32 m0, s53, 114688
    v_mfma_f32_16x16x32_bf16 v[184:187], a[196:199], a[52:55], v[184:187]
    buffer_load_dwordx4 v231, s[24:27], s56 offen offset:0 sc1 lds
    v_mfma_f32_16x16x32_bf16 v[188:191], a[192:195], a[56:59], v[188:191]
    v_mfma_f32_16x16x32_bf16 v[188:191], a[196:199], a[60:63], v[188:191]
    s_waitcnt lgkmcnt(2)
    s_waitcnt vmcnt(19)
    s_barrier
    v_mfma_f32_16x16x32_bf16 v[192:195], a[200:203], a[32:35], v[192:195]
    ds_read_b128 a[160:163], v233 offset:0
    v_mfma_f32_16x16x32_bf16 v[192:195], a[204:207], a[36:39], v[192:195]
    buffer_store_dwordx4 a[220:223], v231, s[64:67], s101 offen offset:1024 sc1
    v_mfma_f32_16x16x32_bf16 v[196:199], a[200:203], a[40:43], v[196:199]
    v_mfma_f32_16x16x32_bf16 v[196:199], a[204:207], a[44:47], v[196:199]
    buffer_load_dwordx4 v231, s[24:27], s56 offen offset:1024 sc1 lds
    v_mfma_f32_16x16x32_bf16 v[200:203], a[200:203], a[48:51], v[200:203]
    ds_read_b128 a[164:167], v233 offset:1024
    v_mfma_f32_16x16x32_bf16 v[200:203], a[204:207], a[52:55], v[200:203]
    v_mfma_f32_16x16x32_bf16 v[204:207], a[200:203], a[56:59], v[204:207]
    v_mfma_f32_16x16x32_bf16 v[204:207], a[204:207], a[60:63], v[204:207]
    s_waitcnt lgkmcnt(2)
    v_mfma_f32_16x16x32_bf16 v[208:211], a[208:211], a[32:35], v[208:211]
    ds_read_b128 a[168:171], v233 offset:2048
    v_mfma_f32_16x16x32_bf16 v[208:211], a[212:215], a[36:39], v[208:211]
    buffer_load_dwordx4 v231, s[24:27], s56 offen offset:2048 sc1 lds
    v_mfma_f32_16x16x32_bf16 v[212:215], a[208:211], a[40:43], v[212:215]
    v_mfma_f32_16x16x32_bf16 v[212:215], a[212:215], a[44:47], v[212:215]
    v_mfma_f32_16x16x32_bf16 v[216:219], a[208:211], a[48:51], v[216:219]
    ds_read_b128 a[172:175], v233 offset:3072
    v_mfma_f32_16x16x32_bf16 v[216:219], a[212:215], a[52:55], v[216:219]
    v_mfma_f32_16x16x32_bf16 v[220:223], a[208:211], a[56:59], v[220:223]
    v_mfma_f32_16x16x32_bf16 v[220:223], a[212:215], a[60:63], v[220:223]
    s_waitcnt lgkmcnt(2)
    buffer_load_dwordx4 v231, s[24:27], s56 offen offset:3072 sc1 lds
    v_mfma_f32_16x16x32_bf16 v[0:3], a[160:163], a[64:67], v[0:3]
    ds_read_b128 a[176:179], v233 offset:4096
    v_mfma_f32_16x16x32_bf16 v[0:3], a[164:167], a[68:71], v[0:3]
    v_mfma_f32_16x16x32_bf16 v[4:7], a[160:163], a[72:75], v[4:7]
    v_mfma_f32_16x16x32_bf16 v[4:7], a[164:167], a[76:79], v[4:7]
    v_mfma_f32_16x16x32_bf16 v[8:11], a[160:163], a[80:83], v[8:11]
    s_add_u32 s57, s49, 8192
    ds_read_b128 a[180:183], v233 offset:5120
    v_mfma_f32_16x16x32_bf16 v[8:11], a[164:167], a[84:87], v[8:11]
    buffer_load_dwordx4 a[128:131], v231, s[28:31], s57 offen offset:0 sc1
    v_mfma_f32_16x16x32_bf16 v[12:15], a[160:163], a[88:91], v[12:15]
    v_mfma_f32_16x16x32_bf16 v[12:15], a[164:167], a[92:95], v[12:15]
    s_waitcnt lgkmcnt(2)
    v_mfma_f32_16x16x32_bf16 v[16:19], a[168:171], a[64:67], v[16:19]
    ds_read_b128 a[184:187], v233 offset:6144
    v_mfma_f32_16x16x32_bf16 v[16:19], a[172:175], a[68:71], v[16:19]
    v_mfma_f32_16x16x32_bf16 v[20:23], a[168:171], a[72:75], v[20:23]
    v_mfma_f32_16x16x32_bf16 v[20:23], a[172:175], a[76:79], v[20:23]
    buffer_load_dwordx4 a[132:135], v231, s[28:31], s57 offen offset:1024 sc1
    v_mfma_f32_16x16x32_bf16 v[24:27], a[168:171], a[80:83], v[24:27]
    ds_read_b128 a[188:191], v233 offset:7168
    v_mfma_f32_16x16x32_bf16 v[24:27], a[172:175], a[84:87], v[24:27]
    v_mfma_f32_16x16x32_bf16 v[28:31], a[168:171], a[88:91], v[28:31]
    v_mfma_f32_16x16x32_bf16 v[28:31], a[172:175], a[92:95], v[28:31]
L_stub_12:
    s_cbranch_execz L_stub_15
    s_waitcnt lgkmcnt(2)
    v_mfma_f32_16x16x32_bf16 v[32:35], a[176:179], a[64:67], v[32:35]
    s_add_u32 s57, s49, 40960
    ds_read_b128 a[192:195], v233 offset:8192
    v_mfma_f32_16x16x32_bf16 v[32:35], a[180:183], a[68:71], v[32:35]
    buffer_load_dwordx4 a[136:139], v231, s[28:31], s57 offen offset:0 sc1
    v_mfma_f32_16x16x32_bf16 v[36:39], a[176:179], a[72:75], v[36:39]
    v_mfma_f32_16x16x32_bf16 v[36:39], a[180:183], a[76:79], v[36:39]
    v_mfma_f32_16x16x32_bf16 v[40:43], a[176:179], a[80:83], v[40:43]
    ds_read_b128 a[196:199], v233 offset:9216
    v_mfma_f32_16x16x32_bf16 v[40:43], a[180:183], a[84:87], v[40:43]
    v_mfma_f32_16x16x32_bf16 v[44:47], a[176:179], a[88:91], v[44:47]
    v_mfma_f32_16x16x32_bf16 v[44:47], a[180:183], a[92:95], v[44:47]
    s_waitcnt lgkmcnt(2)
    buffer_load_dwordx4 a[140:143], v231, s[28:31], s57 offen offset:1024 sc1
    v_mfma_f32_16x16x32_bf16 v[48:51], a[184:187], a[64:67], v[48:51]
    ds_read_b128 a[200:203], v233 offset:10240
    v_mfma_f32_16x16x32_bf16 v[48:51], a[188:191], a[68:71], v[48:51]
    buffer_store_dwordx4 a[224:227], v231, s[64:67], s101 offen offset:2048 sc1
    v_mfma_f32_16x16x32_bf16 v[52:55], a[184:187], a[72:75], v[52:55]
    v_mfma_f32_16x16x32_bf16 v[52:55], a[188:191], a[76:79], v[52:55]
    v_mfma_f32_16x16x32_bf16 v[56:59], a[184:187], a[80:83], v[56:59]
    s_add_u32 s56, s52, 118784
    ds_read_b128 a[204:207], v233 offset:11264
    s_add_u32 m0, s53, 118784
    v_mfma_f32_16x16x32_bf16 v[56:59], a[188:191], a[84:87], v[56:59]
    buffer_load_dwordx4 v231, s[24:27], s56 offen offset:0 sc1 lds
    v_mfma_f32_16x16x32_bf16 v[60:63], a[184:187], a[88:91], v[60:63]
    v_mfma_f32_16x16x32_bf16 v[60:63], a[188:191], a[92:95], v[60:63]
    s_waitcnt lgkmcnt(2)
    v_mfma_f32_16x16x32_bf16 v[64:67], a[192:195], a[64:67], v[64:67]
    ds_read_b128 a[208:211], v233 offset:12288
    v_mfma_f32_16x16x32_bf16 v[64:67], a[196:199], a[68:71], v[64:67]
    buffer_load_dwordx4 v231, s[24:27], s56 offen offset:1024 sc1 lds
    v_mfma_f32_16x16x32_bf16 v[68:71], a[192:195], a[72:75], v[68:71]
    v_mfma_f32_16x16x32_bf16 v[68:71], a[196:199], a[76:79], v[68:71]
    v_mfma_f32_16x16x32_bf16 v[72:75], a[192:195], a[80:83], v[72:75]
    ds_read_b128 a[212:215], v233 offset:13312
    v_mfma_f32_16x16x32_bf16 v[72:75], a[196:199], a[84:87], v[72:75]
    v_mfma_f32_16x16x32_bf16 v[76:79], a[192:195], a[88:91], v[76:79]
    v_mfma_f32_16x16x32_bf16 v[76:79], a[196:199], a[92:95], v[76:79]
    s_waitcnt lgkmcnt(2)
    buffer_load_dwordx4 v231, s[24:27], s56 offen offset:2048 sc1 lds
    v_mfma_f32_16x16x32_bf16 v[80:83], a[200:203], a[64:67], v[80:83]
    ds_read_b128 a[160:163], v233 offset:14336
    v_mfma_f32_16x16x32_bf16 v[80:83], a[204:207], a[68:71], v[80:83]
    v_mfma_f32_16x16x32_bf16 v[84:87], a[200:203], a[72:75], v[84:87]
    v_mfma_f32_16x16x32_bf16 v[84:87], a[204:207], a[76:79], v[84:87]
    v_mfma_f32_16x16x32_bf16 v[88:91], a[200:203], a[80:83], v[88:91]
    s_add_u32 s57, s49, 73728
    ds_read_b128 a[164:167], v233 offset:15360
    v_mfma_f32_16x16x32_bf16 v[88:91], a[204:207], a[84:87], v[88:91]
    buffer_load_dwordx4 a[144:147], v231, s[28:31], s57 offen offset:0 sc1
    v_mfma_f32_16x16x32_bf16 v[92:95], a[200:203], a[88:91], v[92:95]
    v_mfma_f32_16x16x32_bf16 v[92:95], a[204:207], a[92:95], v[92:95]
    s_waitcnt lgkmcnt(2)
    v_mfma_f32_16x16x32_bf16 v[96:99], a[208:211], a[64:67], v[96:99]
    ds_read_b128 a[168:171], v233 offset:16384
    v_mfma_f32_16x16x32_bf16 v[96:99], a[212:215], a[68:71], v[96:99]
    v_mfma_f32_16x16x32_bf16 v[100:103], a[208:211], a[72:75], v[100:103]
    v_mfma_f32_16x16x32_bf16 v[100:103], a[212:215], a[76:79], v[100:103]
    buffer_load_dwordx4 a[148:151], v231, s[28:31], s57 offen offset:1024 sc1
    v_mfma_f32_16x16x32_bf16 v[104:107], a[208:211], a[80:83], v[104:107]
    ds_read_b128 a[172:175], v233 offset:17408
    v_mfma_f32_16x16x32_bf16 v[104:107], a[212:215], a[84:87], v[104:107]
    v_mfma_f32_16x16x32_bf16 v[108:111], a[208:211], a[88:91], v[108:111]
    v_mfma_f32_16x16x32_bf16 v[108:111], a[212:215], a[92:95], v[108:111]
    s_waitcnt lgkmcnt(2)
    v_mfma_f32_16x16x32_bf16 v[112:115], a[160:163], a[64:67], v[112:115]
    s_add_u32 s57, s49, 106496
    ds_read_b128 a[176:179], v233 offset:18432
    v_mfma_f32_16x16x32_bf16 v[112:115], a[164:167], a[68:71], v[112:115]
    buffer_load_dwordx4 a[152:155], v231, s[28:31], s57 offen offset:0 sc1
    v_mfma_f32_16x16x32_bf16 v[116:119], a[160:163], a[72:75], v[116:119]
    v_mfma_f32_16x16x32_bf16 v[116:119], a[164:167], a[76:79], v[116:119]
    v_mfma_f32_16x16x32_bf16 v[120:123], a[160:163], a[80:83], v[120:123]
    ds_read_b128 a[180:183], v233 offset:19456
    v_mfma_f32_16x16x32_bf16 v[120:123], a[164:167], a[84:87], v[120:123]
    v_mfma_f32_16x16x32_bf16 v[124:127], a[160:163], a[88:91], v[124:127]
    v_mfma_f32_16x16x32_bf16 v[124:127], a[164:167], a[92:95], v[124:127]
    s_waitcnt lgkmcnt(2)
    buffer_load_dwordx4 a[156:159], v231, s[28:31], s57 offen offset:1024 sc1
    v_mfma_f32_16x16x32_bf16 v[128:131], a[168:171], a[64:67], v[128:131]
    ds_read_b128 a[184:187], v233 offset:20480
    v_mfma_f32_16x16x32_bf16 v[128:131], a[172:175], a[68:71], v[128:131]
    v_mfma_f32_16x16x32_bf16 v[132:135], a[168:171], a[72:75], v[132:135]
    buffer_store_dwordx4 a[228:231], v231, s[64:67], s101 offen offset:3072 sc1
    v_mfma_f32_16x16x32_bf16 v[132:135], a[172:175], a[76:79], v[132:135]
    v_mfma_f32_16x16x32_bf16 v[136:139], a[168:171], a[80:83], v[136:139]
    s_add_u32 s56, s52, 143360
    ds_read_b128 a[188:191], v233 offset:21504
    s_add_u32 m0, s53, 0
    v_mfma_f32_16x16x32_bf16 v[136:139], a[172:175], a[84:87], v[136:139]
    buffer_load_dwordx4 v231, s[24:27], s56 offen offset:0 sc1 lds
    v_mfma_f32_16x16x32_bf16 v[140:143], a[168:171], a[88:91], v[140:143]
    v_mfma_f32_16x16x32_bf16 v[140:143], a[172:175], a[92:95], v[140:143]
    s_waitcnt lgkmcnt(2)
    v_mfma_f32_16x16x32_bf16 v[144:147], a[176:179], a[64:67], v[144:147]
    ds_read_b128 a[192:195], v233 offset:22528
    v_mfma_f32_16x16x32_bf16 v[144:147], a[180:183], a[68:71], v[144:147]
    v_mfma_f32_16x16x32_bf16 v[148:151], a[176:179], a[72:75], v[148:151]
    v_mfma_f32_16x16x32_bf16 v[148:151], a[180:183], a[76:79], v[148:151]
    buffer_load_dwordx4 v231, s[24:27], s56 offen offset:1024 sc1 lds
    v_mfma_f32_16x16x32_bf16 v[152:155], a[176:179], a[80:83], v[152:155]
    ds_read_b128 a[196:199], v233 offset:23552
    v_mfma_f32_16x16x32_bf16 v[152:155], a[180:183], a[84:87], v[152:155]
    v_mfma_f32_16x16x32_bf16 v[156:159], a[176:179], a[88:91], v[156:159]
    v_mfma_f32_16x16x32_bf16 v[156:159], a[180:183], a[92:95], v[156:159]
    s_waitcnt lgkmcnt(2)
    v_mfma_f32_16x16x32_bf16 v[160:163], a[184:187], a[64:67], v[160:163]
    ds_read_b128 a[200:203], v233 offset:24576
    v_mfma_f32_16x16x32_bf16 v[160:163], a[188:191], a[68:71], v[160:163]
    buffer_load_dwordx4 v231, s[24:27], s56 offen offset:2048 sc1 lds
    v_mfma_f32_16x16x32_bf16 v[164:167], a[184:187], a[72:75], v[164:167]
    v_mfma_f32_16x16x32_bf16 v[164:167], a[188:191], a[76:79], v[164:167]
    v_mfma_f32_16x16x32_bf16 v[168:171], a[184:187], a[80:83], v[168:171]
    ds_read_b128 a[204:207], v233 offset:25600
    v_mfma_f32_16x16x32_bf16 v[168:171], a[188:191], a[84:87], v[168:171]
    v_mfma_f32_16x16x32_bf16 v[172:175], a[184:187], a[88:91], v[172:175]
    v_mfma_f32_16x16x32_bf16 v[172:175], a[188:191], a[92:95], v[172:175]
    s_waitcnt lgkmcnt(2)
    buffer_load_dwordx4 v231, s[24:27], s56 offen offset:3072 sc1 lds
    v_mfma_f32_16x16x32_bf16 v[176:179], a[192:195], a[64:67], v[176:179]
    ds_read_b128 a[208:211], v233 offset:26624
    v_mfma_f32_16x16x32_bf16 v[176:179], a[196:199], a[68:71], v[176:179]
    v_mfma_f32_16x16x32_bf16 v[180:183], a[192:195], a[72:75], v[180:183]
    v_mfma_f32_16x16x32_bf16 v[180:183], a[196:199], a[76:79], v[180:183]
    v_mfma_f32_16x16x32_bf16 v[184:187], a[192:195], a[80:83], v[184:187]
    s_add_u32 s57, s49, 10240
    ds_read_b128 a[212:215], v233 offset:27648
    v_mfma_f32_16x16x32_bf16 v[184:187], a[196:199], a[84:87], v[184:187]
    buffer_load_dwordx4 a[0:3], v231, s[28:31], s57 offen offset:0 sc1
    v_mfma_f32_16x16x32_bf16 v[188:191], a[192:195], a[88:91], v[188:191]
    v_mfma_f32_16x16x32_bf16 v[188:191], a[196:199], a[92:95], v[188:191]
    s_waitcnt lgkmcnt(2)
    s_waitcnt vmcnt(23)
    s_barrier
    v_mfma_f32_16x16x32_bf16 v[192:195], a[200:203], a[64:67], v[192:195]
    ds_read_b128 a[160:163], v233 offset:28672
    v_mfma_f32_16x16x32_bf16 v[192:195], a[204:207], a[68:71], v[192:195]
    v_mfma_f32_16x16x32_bf16 v[196:199], a[200:203], a[72:75], v[196:199]
    v_mfma_f32_16x16x32_bf16 v[196:199], a[204:207], a[76:79], v[196:199]
    buffer_load_dwordx4 a[4:7], v231, s[28:31], s57 offen offset:1024 sc1
    v_mfma_f32_16x16x32_bf16 v[200:203], a[200:203], a[80:83], v[200:203]
    ds_read_b128 a[164:167], v233 offset:29696
    v_mfma_f32_16x16x32_bf16 v[200:203], a[204:207], a[84:87], v[200:203]
    v_mfma_f32_16x16x32_bf16 v[204:207], a[200:203], a[88:91], v[204:207]
    v_mfma_f32_16x16x32_bf16 v[204:207], a[204:207], a[92:95], v[204:207]
    s_waitcnt lgkmcnt(2)
    v_mfma_f32_16x16x32_bf16 v[208:211], a[208:211], a[64:67], v[208:211]
    s_add_u32 s57, s49, 43008
    ds_read_b128 a[168:171], v233 offset:30720
    v_mfma_f32_16x16x32_bf16 v[208:211], a[212:215], a[68:71], v[208:211]
    buffer_load_dwordx4 a[8:11], v231, s[28:31], s57 offen offset:0 sc1
    v_mfma_f32_16x16x32_bf16 v[212:215], a[208:211], a[72:75], v[212:215]
    buffer_store_dwordx4 a[232:235], v231, s[64:67], s70 offen offset:0 sc1
    v_mfma_f32_16x16x32_bf16 v[212:215], a[212:215], a[76:79], v[212:215]
    v_mfma_f32_16x16x32_bf16 v[216:219], a[208:211], a[80:83], v[216:219]
    ds_read_b128 a[172:175], v233 offset:31744
    v_mfma_f32_16x16x32_bf16 v[216:219], a[212:215], a[84:87], v[216:219]
    v_mfma_f32_16x16x32_bf16 v[220:223], a[208:211], a[88:91], v[220:223]
    v_mfma_f32_16x16x32_bf16 v[220:223], a[212:215], a[92:95], v[220:223]
    s_waitcnt lgkmcnt(2)
    buffer_load_dwordx4 a[12:15], v231, s[28:31], s57 offen offset:1024 sc1
    v_mfma_f32_16x16x32_bf16 v[0:3], a[160:163], a[96:99], v[0:3]
    ds_read_b128 a[176:179], v233 offset:32768
    v_mfma_f32_16x16x32_bf16 v[0:3], a[164:167], a[100:103], v[0:3]
    v_mfma_f32_16x16x32_bf16 v[4:7], a[160:163], a[104:107], v[4:7]
    v_mfma_f32_16x16x32_bf16 v[4:7], a[164:167], a[108:111], v[4:7]
    v_mfma_f32_16x16x32_bf16 v[8:11], a[160:163], a[112:115], v[8:11]
    s_add_u32 s56, s52, 147456
    ds_read_b128 a[180:183], v233 offset:33792
    s_add_u32 m0, s53, 4096
    v_mfma_f32_16x16x32_bf16 v[8:11], a[164:167], a[116:119], v[8:11]
    buffer_load_dwordx4 v231, s[24:27], s56 offen offset:0 sc1 lds
    v_mfma_f32_16x16x32_bf16 v[12:15], a[160:163], a[120:123], v[12:15]
    v_mfma_f32_16x16x32_bf16 v[12:15], a[164:167], a[124:127], v[12:15]
    s_waitcnt lgkmcnt(2)
    v_mfma_f32_16x16x32_bf16 v[16:19], a[168:171], a[96:99], v[16:19]
    ds_read_b128 a[184:187], v233 offset:34816
    v_mfma_f32_16x16x32_bf16 v[16:19], a[172:175], a[100:103], v[16:19]
    v_mfma_f32_16x16x32_bf16 v[20:23], a[168:171], a[104:107], v[20:23]
    v_mfma_f32_16x16x32_bf16 v[20:23], a[172:175], a[108:111], v[20:23]
    buffer_load_dwordx4 v231, s[24:27], s56 offen offset:1024 sc1 lds
    v_mfma_f32_16x16x32_bf16 v[24:27], a[168:171], a[112:115], v[24:27]
    ds_read_b128 a[188:191], v233 offset:35840
    v_mfma_f32_16x16x32_bf16 v[24:27], a[172:175], a[116:119], v[24:27]
    v_mfma_f32_16x16x32_bf16 v[28:31], a[168:171], a[120:123], v[28:31]
    v_mfma_f32_16x16x32_bf16 v[28:31], a[172:175], a[124:127], v[28:31]
    s_waitcnt lgkmcnt(2)
    v_mfma_f32_16x16x32_bf16 v[32:35], a[176:179], a[96:99], v[32:35]
    ds_read_b128 a[192:195], v233 offset:36864
    v_mfma_f32_16x16x32_bf16 v[32:35], a[180:183], a[100:103], v[32:35]
    buffer_load_dwordx4 v231, s[24:27], s56 offen offset:2048 sc1 lds
    v_mfma_f32_16x16x32_bf16 v[36:39], a[176:179], a[104:107], v[36:39]
    v_mfma_f32_16x16x32_bf16 v[36:39], a[180:183], a[108:111], v[36:39]
    v_mfma_f32_16x16x32_bf16 v[40:43], a[176:179], a[112:115], v[40:43]
    ds_read_b128 a[196:199], v233 offset:37888
    v_mfma_f32_16x16x32_bf16 v[40:43], a[180:183], a[116:119], v[40:43]
    v_mfma_f32_16x16x32_bf16 v[44:47], a[176:179], a[120:123], v[44:47]
    s_add_u32 s57, s49, 75776
    v_mfma_f32_16x16x32_bf16 v[44:47], a[180:183], a[124:127], v[44:47]
    s_waitcnt lgkmcnt(2)
    buffer_load_dwordx4 a[16:19], v231, s[28:31], s57 offen offset:0 sc1
    v_mfma_f32_16x16x32_bf16 v[48:51], a[184:187], a[96:99], v[48:51]
    ds_read_b128 a[200:203], v233 offset:38912
    v_mfma_f32_16x16x32_bf16 v[48:51], a[188:191], a[100:103], v[48:51]
    v_mfma_f32_16x16x32_bf16 v[52:55], a[184:187], a[104:107], v[52:55]
    v_mfma_f32_16x16x32_bf16 v[52:55], a[188:191], a[108:111], v[52:55]
    v_mfma_f32_16x16x32_bf16 v[56:59], a[184:187], a[112:115], v[56:59]
    ds_read_b128 a[204:207], v233 offset:39936
    v_mfma_f32_16x16x32_bf16 v[56:59], a[188:191], a[116:119], v[56:59]
    buffer_load_dwordx4 a[20:23], v231, s[28:31], s57 offen offset:1024 sc1
    v_mfma_f32_16x16x32_bf16 v[60:63], a[184:187], a[120:123], v[60:63]
    v_mfma_f32_16x16x32_bf16 v[60:63], a[188:191], a[124:127], v[60:63]
    s_waitcnt lgkmcnt(2)
    v_mfma_f32_16x16x32_bf16 v[64:67], a[192:195], a[96:99], v[64:67]
    ds_read_b128 a[208:211], v233 offset:40960
    v_mfma_f32_16x16x32_bf16 v[64:67], a[196:199], a[100:103], v[64:67]
    v_mfma_f32_16x16x32_bf16 v[68:71], a[192:195], a[104:107], v[68:71]
    s_add_u32 s57, s49, 108544
    v_mfma_f32_16x16x32_bf16 v[68:71], a[196:199], a[108:111], v[68:71]
    buffer_load_dwordx4 a[24:27], v231, s[28:31], s57 offen offset:0 sc1
    v_mfma_f32_16x16x32_bf16 v[72:75], a[192:195], a[112:115], v[72:75]
    ds_read_b128 a[212:215], v233 offset:41984
    v_mfma_f32_16x16x32_bf16 v[72:75], a[196:199], a[116:119], v[72:75]
    buffer_store_dwordx4 a[236:239], v231, s[64:67], s70 offen offset:1024 sc1
    v_mfma_f32_16x16x32_bf16 v[76:79], a[192:195], a[120:123], v[76:79]
    v_mfma_f32_16x16x32_bf16 v[76:79], a[196:199], a[124:127], v[76:79]
    s_waitcnt lgkmcnt(2)
    v_mfma_f32_16x16x32_bf16 v[80:83], a[200:203], a[96:99], v[80:83]
    ds_read_b128 a[160:163], v233 offset:43008
    v_mfma_f32_16x16x32_bf16 v[80:83], a[204:207], a[100:103], v[80:83]
    buffer_load_dwordx4 a[28:31], v231, s[28:31], s57 offen offset:1024 sc1
    v_mfma_f32_16x16x32_bf16 v[84:87], a[200:203], a[104:107], v[84:87]
    v_mfma_f32_16x16x32_bf16 v[84:87], a[204:207], a[108:111], v[84:87]
    v_mfma_f32_16x16x32_bf16 v[88:91], a[200:203], a[112:115], v[88:91]
    ds_read_b128 a[164:167], v233 offset:44032
    v_mfma_f32_16x16x32_bf16 v[88:91], a[204:207], a[116:119], v[88:91]
    v_mfma_f32_16x16x32_bf16 v[92:95], a[200:203], a[120:123], v[92:95]
    s_add_u32 s56, s52, 172032
    s_add_u32 m0, s53, 28672
    v_mfma_f32_16x16x32_bf16 v[92:95], a[204:207], a[124:127], v[92:95]
    s_waitcnt lgkmcnt(2)
    buffer_load_dwordx4 v231, s[24:27], s56 offen offset:0 sc1 lds
    v_mfma_f32_16x16x32_bf16 v[96:99], a[208:211], a[96:99], v[96:99]
    ds_read_b128 a[168:171], v233 offset:45056
    v_mfma_f32_16x16x32_bf16 v[96:99], a[212:215], a[100:103], v[96:99]
    v_mfma_f32_16x16x32_bf16 v[100:103], a[208:211], a[104:107], v[100:103]
    v_mfma_f32_16x16x32_bf16 v[100:103], a[212:215], a[108:111], v[100:103]
    v_mfma_f32_16x16x32_bf16 v[104:107], a[208:211], a[112:115], v[104:107]
    ds_read_b128 a[172:175], v233 offset:46080
    v_mfma_f32_16x16x32_bf16 v[104:107], a[212:215], a[116:119], v[104:107]
    buffer_load_dwordx4 v231, s[24:27], s56 offen offset:1024 sc1 lds
    v_mfma_f32_16x16x32_bf16 v[108:111], a[208:211], a[120:123], v[108:111]
    v_mfma_f32_16x16x32_bf16 v[108:111], a[212:215], a[124:127], v[108:111]
    s_waitcnt lgkmcnt(2)
    v_mfma_f32_16x16x32_bf16 v[112:115], a[160:163], a[96:99], v[112:115]
    ds_read_b128 a[176:179], v233 offset:47104
    v_mfma_f32_16x16x32_bf16 v[112:115], a[164:167], a[100:103], v[112:115]
    v_mfma_f32_16x16x32_bf16 v[116:119], a[160:163], a[104:107], v[116:119]
    v_mfma_f32_16x16x32_bf16 v[116:119], a[164:167], a[108:111], v[116:119]
    buffer_load_dwordx4 v231, s[24:27], s56 offen offset:2048 sc1 lds
    v_mfma_f32_16x16x32_bf16 v[120:123], a[160:163], a[112:115], v[120:123]
    ds_read_b128 a[180:183], v233 offset:48128
    v_mfma_f32_16x16x32_bf16 v[120:123], a[164:167], a[116:119], v[120:123]
    v_mfma_f32_16x16x32_bf16 v[124:127], a[160:163], a[120:123], v[124:127]
    v_mfma_f32_16x16x32_bf16 v[124:127], a[164:167], a[124:127], v[124:127]
    s_waitcnt lgkmcnt(2)
    v_mfma_f32_16x16x32_bf16 v[128:131], a[168:171], a[96:99], v[128:131]
    ds_read_b128 a[184:187], v233 offset:49152
    v_mfma_f32_16x16x32_bf16 v[128:131], a[172:175], a[100:103], v[128:131]
    buffer_load_dwordx4 v231, s[24:27], s56 offen offset:3072 sc1 lds
    v_mfma_f32_16x16x32_bf16 v[132:135], a[168:171], a[104:107], v[132:135]
    v_mfma_f32_16x16x32_bf16 v[132:135], a[172:175], a[108:111], v[132:135]
    v_mfma_f32_16x16x32_bf16 v[136:139], a[168:171], a[112:115], v[136:139]
    ds_read_b128 a[188:191], v233 offset:50176
    v_mfma_f32_16x16x32_bf16 v[136:139], a[172:175], a[116:119], v[136:139]
    v_mfma_f32_16x16x32_bf16 v[140:143], a[168:171], a[120:123], v[140:143]
    s_add_u32 s57, s49, 12288
    v_mfma_f32_16x16x32_bf16 v[140:143], a[172:175], a[124:127], v[140:143]
    s_waitcnt lgkmcnt(2)
    buffer_load_dwordx4 a[32:35], v231, s[28:31], s57 offen offset:0 sc1
    v_mfma_f32_16x16x32_bf16 v[144:147], a[176:179], a[96:99], v[144:147]
    ds_read_b128 a[192:195], v233 offset:51200
    v_mfma_f32_16x16x32_bf16 v[144:147], a[180:183], a[100:103], v[144:147]
    v_mfma_f32_16x16x32_bf16 v[148:151], a[176:179], a[104:107], v[148:151]
    v_mfma_f32_16x16x32_bf16 v[148:151], a[180:183], a[108:111], v[148:151]
    v_mfma_f32_16x16x32_bf16 v[152:155], a[176:179], a[112:115], v[152:155]
    ds_read_b128 a[196:199], v233 offset:52224
    v_mfma_f32_16x16x32_bf16 v[152:155], a[180:183], a[116:119], v[152:155]
    buffer_load_dwordx4 a[36:39], v231, s[28:31], s57 offen offset:1024 sc1
    v_mfma_f32_16x16x32_bf16 v[156:159], a[176:179], a[120:123], v[156:159]
    buffer_store_dwordx4 a[240:243], v231, s[64:67], s70 offen offset:2048 sc1
    v_mfma_f32_16x16x32_bf16 v[156:159], a[180:183], a[124:127], v[156:159]
    s_waitcnt lgkmcnt(2)
    v_mfma_f32_16x16x32_bf16 v[160:163], a[184:187], a[96:99], v[160:163]
    ds_read_b128 a[200:203], v233 offset:53248
    v_mfma_f32_16x16x32_bf16 v[160:163], a[188:191], a[100:103], v[160:163]
    v_mfma_f32_16x16x32_bf16 v[164:167], a[184:187], a[104:107], v[164:167]
    s_add_u32 s57, s49, 45056
    v_mfma_f32_16x16x32_bf16 v[164:167], a[188:191], a[108:111], v[164:167]
    buffer_load_dwordx4 a[40:43], v231, s[28:31], s57 offen offset:0 sc1
    v_mfma_f32_16x16x32_bf16 v[168:171], a[184:187], a[112:115], v[168:171]
    ds_read_b128 a[204:207], v233 offset:54272
    v_mfma_f32_16x16x32_bf16 v[168:171], a[188:191], a[116:119], v[168:171]
    v_mfma_f32_16x16x32_bf16 v[172:175], a[184:187], a[120:123], v[172:175]
    v_mfma_f32_16x16x32_bf16 v[172:175], a[188:191], a[124:127], v[172:175]
    s_waitcnt lgkmcnt(2)
    v_mfma_f32_16x16x32_bf16 v[176:179], a[192:195], a[96:99], v[176:179]
    ds_read_b128 a[208:211], v233 offset:55296
    v_mfma_f32_16x16x32_bf16 v[176:179], a[196:199], a[100:103], v[176:179]
    buffer_load_dwordx4 a[44:47], v231, s[28:31], s57 offen offset:1024 sc1
    v_mfma_f32_16x16x32_bf16 v[180:183], a[192:195], a[104:107], v[180:183]
    v_mfma_f32_16x16x32_bf16 v[180:183], a[196:199], a[108:111], v[180:183]
    v_mfma_f32_16x16x32_bf16 v[184:187], a[192:195], a[112:115], v[184:187]
    ds_read_b128 a[212:215], v233 offset:56320
    v_mfma_f32_16x16x32_bf16 v[184:187], a[196:199], a[116:119], v[184:187]
    v_mfma_f32_16x16x32_bf16 v[188:191], a[192:195], a[120:123], v[188:191]
    v_mfma_f32_16x16x32_bf16 v[188:191], a[196:199], a[124:127], v[188:191]
    s_waitcnt lgkmcnt(2)
    s_waitcnt vmcnt(27)
    s_barrier
    v_mfma_f32_16x16x32_bf16 v[192:195], a[200:203], a[96:99], v[192:195]
    s_add_u32 s56, s52, 176128
    ds_read_b128 a[160:163], v234 offset:0
    s_add_u32 m0, s53, 32768
    v_mfma_f32_16x16x32_bf16 v[192:195], a[204:207], a[100:103], v[192:195]
    buffer_load_dwordx4 v231, s[24:27], s56 offen offset:0 sc1 lds
    v_mfma_f32_16x16x32_bf16 v[196:199], a[200:203], a[104:107], v[196:199]
    buffer_atomic_add v253, v249, s[88:91], s72 offen sc1
    v_mfma_f32_16x16x32_bf16 v[196:199], a[204:207], a[108:111], v[196:199]
    v_mfma_f32_16x16x32_bf16 v[200:203], a[200:203], a[112:115], v[200:203]
    ds_read_b128 a[164:167], v234 offset:1024
    v_mfma_f32_16x16x32_bf16 v[200:203], a[204:207], a[116:119], v[200:203]
    buffer_load_dwordx4 v231, s[24:27], s56 offen offset:1024 sc1 lds
    v_mfma_f32_16x16x32_bf16 v[204:207], a[200:203], a[120:123], v[204:207]
    v_mfma_f32_16x16x32_bf16 v[204:207], a[204:207], a[124:127], v[204:207]
    s_waitcnt lgkmcnt(2)
    v_mfma_f32_16x16x32_bf16 v[208:211], a[208:211], a[96:99], v[208:211]
    ds_read_b128 a[168:171], v234 offset:2048
    v_mfma_f32_16x16x32_bf16 v[208:211], a[212:215], a[100:103], v[208:211]
    v_mfma_f32_16x16x32_bf16 v[212:215], a[208:211], a[104:107], v[212:215]
    v_mfma_f32_16x16x32_bf16 v[212:215], a[212:215], a[108:111], v[212:215]
    buffer_load_dwordx4 v231, s[24:27], s56 offen offset:2048 sc1 lds
    v_mfma_f32_16x16x32_bf16 v[216:219], a[208:211], a[112:115], v[216:219]
    ds_read_b128 a[172:175], v234 offset:3072
    v_mfma_f32_16x16x32_bf16 v[216:219], a[212:215], a[116:119], v[216:219]
    v_mfma_f32_16x16x32_bf16 v[220:223], a[208:211], a[120:123], v[220:223]
    v_mfma_f32_16x16x32_bf16 v[220:223], a[212:215], a[124:127], v[220:223]
    s_waitcnt lgkmcnt(2)
    v_mfma_f32_16x16x32_bf16 v[0:3], a[160:163], a[128:131], v[0:3]
    s_add_u32 s57, s49, 77824
    ds_read_b128 a[176:179], v234 offset:4096
    v_mfma_f32_16x16x32_bf16 v[0:3], a[164:167], a[132:135], v[0:3]
    buffer_load_dwordx4 a[48:51], v231, s[28:31], s57 offen offset:0 sc1
    v_mfma_f32_16x16x32_bf16 v[4:7], a[160:163], a[136:139], v[4:7]
    v_mfma_f32_16x16x32_bf16 v[4:7], a[164:167], a[140:143], v[4:7]
    v_mfma_f32_16x16x32_bf16 v[8:11], a[160:163], a[144:147], v[8:11]
    ds_read_b128 a[180:183], v234 offset:5120
    v_mfma_f32_16x16x32_bf16 v[8:11], a[164:167], a[148:151], v[8:11]
    buffer_store_dwordx4 a[244:247], v231, s[64:67], s70 offen offset:3072 sc1
    v_mfma_f32_16x16x32_bf16 v[12:15], a[160:163], a[152:155], v[12:15]
    v_mfma_f32_16x16x32_bf16 v[12:15], a[164:167], a[156:159], v[12:15]
    s_waitcnt lgkmcnt(2)
    buffer_load_dwordx4 a[52:55], v231, s[28:31], s57 offen offset:1024 sc1
    v_mfma_f32_16x16x32_bf16 v[16:19], a[168:171], a[128:131], v[16:19]
    ds_read_b128 a[184:187], v234 offset:6144
    v_mfma_f32_16x16x32_bf16 v[16:19], a[172:175], a[132:135], v[16:19]
    v_mfma_f32_16x16x32_bf16 v[20:23], a[168:171], a[136:139], v[20:23]
    v_mfma_f32_16x16x32_bf16 v[20:23], a[172:175], a[140:143], v[20:23]
    v_mfma_f32_16x16x32_bf16 v[24:27], a[168:171], a[144:147], v[24:27]
    s_add_u32 s57, s49, 110592
    ds_read_b128 a[188:191], v234 offset:7168
    v_mfma_f32_16x16x32_bf16 v[24:27], a[172:175], a[148:151], v[24:27]
    buffer_load_dwordx4 a[56:59], v231, s[28:31], s57 offen offset:0 sc1
    v_mfma_f32_16x16x32_bf16 v[28:31], a[168:171], a[152:155], v[28:31]
    v_mfma_f32_16x16x32_bf16 v[28:31], a[172:175], a[156:159], v[28:31]
    s_waitcnt lgkmcnt(2)
    v_mfma_f32_16x16x32_bf16 v[32:35], a[176:179], a[128:131], v[32:35]
    ds_read_b128 a[192:195], v234 offset:8192
    v_mfma_f32_16x16x32_bf16 v[32:35], a[180:183], a[132:135], v[32:35]
    v_mfma_f32_16x16x32_bf16 v[36:39], a[176:179], a[136:139], v[36:39]
    v_mfma_f32_16x16x32_bf16 v[36:39], a[180:183], a[140:143], v[36:39]
    buffer_load_dwordx4 a[60:63], v231, s[28:31], s57 offen offset:1024 sc1
    v_mfma_f32_16x16x32_bf16 v[40:43], a[176:179], a[144:147], v[40:43]
    ds_read_b128 a[196:199], v234 offset:9216
    v_mfma_f32_16x16x32_bf16 v[40:43], a[180:183], a[148:151], v[40:43]
    v_mfma_f32_16x16x32_bf16 v[44:47], a[176:179], a[152:155], v[44:47]
    v_mfma_f32_16x16x32_bf16 v[44:47], a[180:183], a[156:159], v[44:47]
    s_waitcnt lgkmcnt(2)
    v_mfma_f32_16x16x32_bf16 v[48:51], a[184:187], a[128:131], v[48:51]
    s_add_u32 s56, s52, 200704
    ds_read_b128 a[200:203], v234 offset:10240
    s_add_u32 m0, s53, 57344
    v_mfma_f32_16x16x32_bf16 v[48:51], a[188:191], a[132:135], v[48:51]
    buffer_load_dwordx4 v231, s[24:27], s56 offen offset:0 sc1 lds
    v_mfma_f32_16x16x32_bf16 v[52:55], a[184:187], a[136:139], v[52:55]
    v_mfma_f32_16x16x32_bf16 v[52:55], a[188:191], a[140:143], v[52:55]
    v_mfma_f32_16x16x32_bf16 v[56:59], a[184:187], a[144:147], v[56:59]
    ds_read_b128 a[204:207], v234 offset:11264
    v_mfma_f32_16x16x32_bf16 v[56:59], a[188:191], a[148:151], v[56:59]
    v_mfma_f32_16x16x32_bf16 v[60:63], a[184:187], a[152:155], v[60:63]
    v_mfma_f32_16x16x32_bf16 v[60:63], a[188:191], a[156:159], v[60:63]
    s_waitcnt lgkmcnt(2)
    buffer_load_dwordx4 v231, s[24:27], s56 offen offset:1024 sc1 lds
    v_mfma_f32_16x16x32_bf16 v[64:67], a[192:195], a[128:131], v[64:67]
    ds_read_b128 a[208:211], v234 offset:12288
    v_mfma_f32_16x16x32_bf16 v[64:67], a[196:199], a[132:135], v[64:67]
    global_load_dword v252, v[250:251], off
    v_mfma_f32_16x16x32_bf16 v[68:71], a[192:195], a[136:139], v[68:71]
    v_mfma_f32_16x16x32_bf16 v[68:71], a[196:199], a[140:143], v[68:71]
    v_mfma_f32_16x16x32_bf16 v[72:75], a[192:195], a[144:147], v[72:75]
    ds_read_b128 a[212:215], v234 offset:13312
    v_mfma_f32_16x16x32_bf16 v[72:75], a[196:199], a[148:151], v[72:75]
    buffer_load_dwordx4 v231, s[24:27], s56 offen offset:2048 sc1 lds
    v_mfma_f32_16x16x32_bf16 v[76:79], a[192:195], a[152:155], v[76:79]
    v_mfma_f32_16x16x32_bf16 v[76:79], a[196:199], a[156:159], v[76:79]
    s_waitcnt lgkmcnt(2)
    v_mfma_f32_16x16x32_bf16 v[80:83], a[200:203], a[128:131], v[80:83]
    ds_read_b128 a[160:163], v234 offset:14336
    v_mfma_f32_16x16x32_bf16 v[80:83], a[204:207], a[132:135], v[80:83]
    v_mfma_f32_16x16x32_bf16 v[84:87], a[200:203], a[136:139], v[84:87]
    v_mfma_f32_16x16x32_bf16 v[84:87], a[204:207], a[140:143], v[84:87]
    buffer_load_dwordx4 v231, s[24:27], s56 offen offset:3072 sc1 lds
    v_mfma_f32_16x16x32_bf16 v[88:91], a[200:203], a[144:147], v[88:91]
    ds_read_b128 a[164:167], v234 offset:15360
    v_mfma_f32_16x16x32_bf16 v[88:91], a[204:207], a[148:151], v[88:91]
    buffer_store_dwordx4 a[248:251], v232, s[64:67], s100 offen offset:0 sc1
    v_mfma_f32_16x16x32_bf16 v[92:95], a[200:203], a[152:155], v[92:95]
    v_mfma_f32_16x16x32_bf16 v[92:95], a[204:207], a[156:159], v[92:95]
    s_waitcnt lgkmcnt(2)
    v_mfma_f32_16x16x32_bf16 v[96:99], a[208:211], a[128:131], v[96:99]
    s_add_u32 s57, s49, 14336
    ds_read_b128 a[168:171], v234 offset:16384
    v_mfma_f32_16x16x32_bf16 v[96:99], a[212:215], a[132:135], v[96:99]
    buffer_load_dwordx4 a[64:67], v231, s[28:31], s57 offen offset:0 sc1
    v_mfma_f32_16x16x32_bf16 v[100:103], a[208:211], a[136:139], v[100:103]
    v_mfma_f32_16x16x32_bf16 v[100:103], a[212:215], a[140:143], v[100:103]
    v_mfma_f32_16x16x32_bf16 v[104:107], a[208:211], a[144:147], v[104:107]
    ds_read_b128 a[172:175], v234 offset:17408
    v_mfma_f32_16x16x32_bf16 v[104:107], a[212:215], a[148:151], v[104:107]
    v_mfma_f32_16x16x32_bf16 v[108:111], a[208:211], a[152:155], v[108:111]
    v_mfma_f32_16x16x32_bf16 v[108:111], a[212:215], a[156:159], v[108:111]
    s_waitcnt lgkmcnt(2)
    buffer_load_dwordx4 a[68:71], v231, s[28:31], s57 offen offset:1024 sc1
    v_mfma_f32_16x16x32_bf16 v[112:115], a[160:163], a[128:131], v[112:115]
    ds_read_b128 a[176:179], v234 offset:18432
    v_mfma_f32_16x16x32_bf16 v[112:115], a[164:167], a[132:135], v[112:115]
    v_mfma_f32_16x16x32_bf16 v[116:119], a[160:163], a[136:139], v[116:119]
    v_mfma_f32_16x16x32_bf16 v[116:119], a[164:167], a[140:143], v[116:119]
    v_mfma_f32_16x16x32_bf16 v[120:123], a[160:163], a[144:147], v[120:123]
    s_add_u32 s57, s49, 47104
    ds_read_b128 a[180:183], v234 offset:19456
    v_mfma_f32_16x16x32_bf16 v[120:123], a[164:167], a[148:151], v[120:123]
    buffer_load_dwordx4 a[72:75], v231, s[28:31], s57 offen offset:0 sc1
    v_mfma_f32_16x16x32_bf16 v[124:127], a[160:163], a[152:155], v[124:127]
    v_mfma_f32_16x16x32_bf16 v[124:127], a[164:167], a[156:159], v[124:127]
    s_waitcnt lgkmcnt(2)
    v_mfma_f32_16x16x32_bf16 v[128:131], a[168:171], a[128:131], v[128:131]
    ds_read_b128 a[184:187], v234 offset:20480
    v_mfma_f32_16x16x32_bf16 v[128:131], a[172:175], a[132:135], v[128:131]
    v_mfma_f32_16x16x32_bf16 v[132:135], a[168:171], a[136:139], v[132:135]
    v_mfma_f32_16x16x32_bf16 v[132:135], a[172:175], a[140:143], v[132:135]
    buffer_load_dwordx4 a[76:79], v231, s[28:31], s57 offen offset:1024 sc1
    v_mfma_f32_16x16x32_bf16 v[136:139], a[168:171], a[144:147], v[136:139]
    ds_read_b128 a[188:191], v234 offset:21504
    v_mfma_f32_16x16x32_bf16 v[136:139], a[172:175], a[148:151], v[136:139]
    v_mfma_f32_16x16x32_bf16 v[140:143], a[168:171], a[152:155], v[140:143]
    v_mfma_f32_16x16x32_bf16 v[140:143], a[172:175], a[156:159], v[140:143]
    s_waitcnt lgkmcnt(2)
    v_mfma_f32_16x16x32_bf16 v[144:147], a[176:179], a[128:131], v[144:147]
    s_add_u32 s56, s52, 204800
    ds_read_b128 a[192:195], v234 offset:22528
    s_add_u32 m0, s53, 61440
    v_mfma_f32_16x16x32_bf16 v[144:147], a[180:183], a[132:135], v[144:147]
    buffer_load_dwordx4 v231, s[24:27], s56 offen offset:0 sc1 lds
    v_mfma_f32_16x16x32_bf16 v[148:151], a[176:179], a[136:139], v[148:151]
    v_mfma_f32_16x16x32_bf16 v[148:151], a[180:183], a[140:143], v[148:151]
    v_mfma_f32_16x16x32_bf16 v[152:155], a[176:179], a[144:147], v[152:155]
    ds_read_b128 a[196:199], v234 offset:23552
    v_mfma_f32_16x16x32_bf16 v[152:155], a[180:183], a[148:151], v[152:155]
    v_mfma_f32_16x16x32_bf16 v[156:159], a[176:179], a[152:155], v[156:159]
    v_mfma_f32_16x16x32_bf16 v[156:159], a[180:183], a[156:159], v[156:159]
    s_waitcnt lgkmcnt(2)
    buffer_load_dwordx4 v231, s[24:27], s56 offen offset:1024 sc1 lds
    v_mfma_f32_16x16x32_bf16 v[160:163], a[184:187], a[128:131], v[160:163]
    ds_read_b128 a[200:203], v234 offset:24576
    v_mfma_f32_16x16x32_bf16 v[160:163], a[188:191], a[132:135], v[160:163]
    v_mfma_f32_16x16x32_bf16 v[164:167], a[184:187], a[136:139], v[164:167]
    v_mfma_f32_16x16x32_bf16 v[164:167], a[188:191], a[140:143], v[164:167]
    v_mfma_f32_16x16x32_bf16 v[168:171], a[184:187], a[144:147], v[168:171]
    ds_read_b128 a[204:207], v234 offset:25600
    v_mfma_f32_16x16x32_bf16 v[168:171], a[188:191], a[148:151], v[168:171]
    buffer_load_dwordx4 v231, s[24:27], s56 offen offset:2048 sc1 lds
    v_mfma_f32_16x16x32_bf16 v[172:175], a[184:187], a[152:155], v[172:175]
    buffer_store_dwordx4 a[248:251], v232, s[64:67], s100 offen offset:1024 sc1
    v_mfma_f32_16x16x32_bf16 v[172:175], a[188:191], a[156:159], v[172:175]
    s_waitcnt lgkmcnt(2)
    v_mfma_f32_16x16x32_bf16 v[176:179], a[192:195], a[128:131], v[176:179]
    ds_read_b128 a[208:211], v234 offset:26624
    v_mfma_f32_16x16x32_bf16 v[176:179], a[196:199], a[132:135], v[176:179]
    v_mfma_f32_16x16x32_bf16 v[180:183], a[192:195], a[136:139], v[180:183]
    s_add_u32 s57, s49, 79872
    v_mfma_f32_16x16x32_bf16 v[180:183], a[196:199], a[140:143], v[180:183]
    buffer_load_dwordx4 a[80:83], v231, s[28:31], s57 offen offset:0 sc1
    v_mfma_f32_16x16x32_bf16 v[184:187], a[192:195], a[144:147], v[184:187]
    ds_read_b128 a[212:215], v234 offset:27648
    v_mfma_f32_16x16x32_bf16 v[184:187], a[196:199], a[148:151], v[184:187]
    v_mfma_f32_16x16x32_bf16 v[188:191], a[192:195], a[152:155], v[188:191]
    v_mfma_f32_16x16x32_bf16 v[188:191], a[196:199], a[156:159], v[188:191]
    s_waitcnt lgkmcnt(2)
    s_waitcnt vmcnt(33)
    s_barrier
    v_mfma_f32_16x16x32_bf16 v[192:195], a[200:203], a[128:131], v[192:195]
    ds_read_b128 a[160:163], v232 offset:0
    v_mfma_f32_16x16x32_bf16 v[192:195], a[204:207], a[132:135], v[192:195]
    buffer_load_dwordx4 a[84:87], v231, s[28:31], s57 offen offset:1024 sc1
    v_mfma_f32_16x16x32_bf16 v[196:199], a[200:203], a[136:139], v[196:199]
    v_mfma_f32_16x16x32_bf16 v[196:199], a[204:207], a[140:143], v[196:199]
    v_mfma_f32_16x16x32_bf16 v[200:203], a[200:203], a[144:147], v[200:203]
    ds_read_b128 a[164:167], v232 offset:1024
    v_mfma_f32_16x16x32_bf16 v[200:203], a[204:207], a[148:151], v[200:203]
    v_mfma_f32_16x16x32_bf16 v[204:207], a[200:203], a[152:155], v[204:207]
    s_add_u32 s57, s49, 112640
    v_mfma_f32_16x16x32_bf16 v[204:207], a[204:207], a[156:159], v[204:207]
    s_waitcnt lgkmcnt(2)
    buffer_load_dwordx4 a[88:91], v231, s[28:31], s57 offen offset:0 sc1
    v_mfma_f32_16x16x32_bf16 v[208:211], a[208:211], a[128:131], v[208:211]
    ds_read_b128 a[168:171], v232 offset:2048
    v_mfma_f32_16x16x32_bf16 v[208:211], a[212:215], a[132:135], v[208:211]
    v_mfma_f32_16x16x32_bf16 v[212:215], a[208:211], a[136:139], v[212:215]
    v_mfma_f32_16x16x32_bf16 v[212:215], a[212:215], a[140:143], v[212:215]
    v_mfma_f32_16x16x32_bf16 v[216:219], a[208:211], a[144:147], v[216:219]
    ds_read_b128 a[172:175], v232 offset:3072
L_stub_13:
    s_cbranch_execz L_stub_16
    v_mfma_f32_16x16x32_bf16 v[216:219], a[212:215], a[148:151], v[216:219]
    buffer_load_dwordx4 a[92:95], v231, s[28:31], s57 offen offset:1024 sc1
    v_mfma_f32_16x16x32_bf16 v[220:223], a[208:211], a[152:155], v[220:223]
    v_mfma_f32_16x16x32_bf16 v[220:223], a[212:215], a[156:159], v[220:223]
    s_waitcnt lgkmcnt(2)
    v_mfma_f32_16x16x32_bf16 v[0:3], a[160:163], a[0:3], v[0:3]
    ds_read_b128 a[176:179], v232 offset:4096
    v_mfma_f32_16x16x32_bf16 v[0:3], a[164:167], a[4:7], v[0:3]
    v_mfma_f32_16x16x32_bf16 v[4:7], a[160:163], a[8:11], v[4:7]
    s_add_u32 s56, s52, 229376
    s_add_u32 m0, s53, 86016
    v_mfma_f32_16x16x32_bf16 v[4:7], a[164:167], a[12:15], v[4:7]
    buffer_load_dwordx4 v231, s[24:27], s56 offen offset:0 sc1 lds
    v_mfma_f32_16x16x32_bf16 v[8:11], a[160:163], a[16:19], v[8:11]
    ds_read_b128 a[180:183], v232 offset:5120
    v_mfma_f32_16x16x32_bf16 v[8:11], a[164:167], a[20:23], v[8:11]
    v_mfma_f32_16x16x32_bf16 v[12:15], a[160:163], a[24:27], v[12:15]
    v_mfma_f32_16x16x32_bf16 v[12:15], a[164:167], a[28:31], v[12:15]
    s_waitcnt lgkmcnt(2)
    v_mfma_f32_16x16x32_bf16 v[16:19], a[168:171], a[0:3], v[16:19]
    ds_read_b128 a[184:187], v232 offset:6144
    v_mfma_f32_16x16x32_bf16 v[16:19], a[172:175], a[4:7], v[16:19]
    buffer_load_dwordx4 v231, s[24:27], s56 offen offset:1024 sc1 lds
    v_mfma_f32_16x16x32_bf16 v[20:23], a[168:171], a[8:11], v[20:23]
    v_mfma_f32_16x16x32_bf16 v[20:23], a[172:175], a[12:15], v[20:23]
    v_mfma_f32_16x16x32_bf16 v[24:27], a[168:171], a[16:19], v[24:27]
    ds_read_b128 a[188:191], v232 offset:7168
    v_mfma_f32_16x16x32_bf16 v[24:27], a[172:175], a[20:23], v[24:27]
    v_mfma_f32_16x16x32_bf16 v[28:31], a[168:171], a[24:27], v[28:31]
    v_mfma_f32_16x16x32_bf16 v[28:31], a[172:175], a[28:31], v[28:31]
    s_waitcnt lgkmcnt(2)
    buffer_load_dwordx4 v231, s[24:27], s56 offen offset:2048 sc1 lds
    v_mfma_f32_16x16x32_bf16 v[32:35], a[176:179], a[0:3], v[32:35]
    ds_read_b128 a[192:195], v232 offset:8192
    v_mfma_f32_16x16x32_bf16 v[32:35], a[180:183], a[4:7], v[32:35]
    buffer_store_dwordx4 a[248:251], v232, s[64:67], s100 offen offset:2048 sc1
    v_mfma_f32_16x16x32_bf16 v[36:39], a[176:179], a[8:11], v[36:39]
    v_mfma_f32_16x16x32_bf16 v[36:39], a[180:183], a[12:15], v[36:39]
    v_mfma_f32_16x16x32_bf16 v[40:43], a[176:179], a[16:19], v[40:43]
    ds_read_b128 a[196:199], v232 offset:9216
    v_mfma_f32_16x16x32_bf16 v[40:43], a[180:183], a[20:23], v[40:43]
    buffer_load_dwordx4 v231, s[24:27], s56 offen offset:3072 sc1 lds
    v_mfma_f32_16x16x32_bf16 v[44:47], a[176:179], a[24:27], v[44:47]
    v_mfma_f32_16x16x32_bf16 v[44:47], a[180:183], a[28:31], v[44:47]
    s_waitcnt lgkmcnt(2)
    v_mfma_f32_16x16x32_bf16 v[48:51], a[184:187], a[0:3], v[48:51]
    ds_read_b128 a[200:203], v232 offset:10240
    v_mfma_f32_16x16x32_bf16 v[48:51], a[188:191], a[4:7], v[48:51]
    v_mfma_f32_16x16x32_bf16 v[52:55], a[184:187], a[8:11], v[52:55]
    s_add_u32 s56, s52, 233472
    s_add_u32 m0, s53, 90112
    v_mfma_f32_16x16x32_bf16 v[52:55], a[188:191], a[12:15], v[52:55]
    buffer_load_dwordx4 v231, s[24:27], s56 offen offset:0 sc1 lds
    v_mfma_f32_16x16x32_bf16 v[56:59], a[184:187], a[16:19], v[56:59]
    ds_read_b128 a[204:207], v232 offset:11264
    v_mfma_f32_16x16x32_bf16 v[56:59], a[188:191], a[20:23], v[56:59]
    v_mfma_f32_16x16x32_bf16 v[60:63], a[184:187], a[24:27], v[60:63]
    v_mfma_f32_16x16x32_bf16 v[60:63], a[188:191], a[28:31], v[60:63]
    s_waitcnt lgkmcnt(2)
    v_mfma_f32_16x16x32_bf16 v[64:67], a[192:195], a[0:3], v[64:67]
    ds_read_b128 a[208:211], v232 offset:12288
    v_mfma_f32_16x16x32_bf16 v[64:67], a[196:199], a[4:7], v[64:67]
    buffer_load_dwordx4 v231, s[24:27], s56 offen offset:1024 sc1 lds
    v_mfma_f32_16x16x32_bf16 v[68:71], a[192:195], a[8:11], v[68:71]
    v_mfma_f32_16x16x32_bf16 v[68:71], a[196:199], a[12:15], v[68:71]
    v_mfma_f32_16x16x32_bf16 v[72:75], a[192:195], a[16:19], v[72:75]
    ds_read_b128 a[212:215], v232 offset:13312
    v_mfma_f32_16x16x32_bf16 v[72:75], a[196:199], a[20:23], v[72:75]
    v_mfma_f32_16x16x32_bf16 v[76:79], a[192:195], a[24:27], v[76:79]
    v_mfma_f32_16x16x32_bf16 v[76:79], a[196:199], a[28:31], v[76:79]
    s_waitcnt lgkmcnt(2)
    buffer_load_dwordx4 v231, s[24:27], s56 offen offset:2048 sc1 lds
    v_mfma_f32_16x16x32_bf16 v[80:83], a[200:203], a[0:3], v[80:83]
    ds_read_b128 a[160:163], v232 offset:14336
    v_mfma_f32_16x16x32_bf16 v[80:83], a[204:207], a[4:7], v[80:83]
    v_mfma_f32_16x16x32_bf16 v[84:87], a[200:203], a[8:11], v[84:87]
    v_mfma_f32_16x16x32_bf16 v[84:87], a[204:207], a[12:15], v[84:87]
    v_mfma_f32_16x16x32_bf16 v[88:91], a[200:203], a[16:19], v[88:91]
    s_add_u32 s57, s49, 16384
    ds_read_b128 a[164:167], v232 offset:15360
    v_mfma_f32_16x16x32_bf16 v[88:91], a[204:207], a[20:23], v[88:91]
    buffer_load_dwordx4 a[96:99], v231, s[28:31], s57 offen offset:0 sc1
    v_mfma_f32_16x16x32_bf16 v[92:95], a[200:203], a[24:27], v[92:95]
    v_mfma_f32_16x16x32_bf16 v[92:95], a[204:207], a[28:31], v[92:95]
    s_waitcnt lgkmcnt(2)
    v_mfma_f32_16x16x32_bf16 v[96:99], a[208:211], a[0:3], v[96:99]
    ds_read_b128 a[168:171], v232 offset:16384
    v_mfma_f32_16x16x32_bf16 v[96:99], a[212:215], a[4:7], v[96:99]
    v_mfma_f32_16x16x32_bf16 v[100:103], a[208:211], a[8:11], v[100:103]
    v_mfma_f32_16x16x32_bf16 v[100:103], a[212:215], a[12:15], v[100:103]
    buffer_load_dwordx4 a[100:103], v231, s[28:31], s57 offen offset:1024 sc1
    v_mfma_f32_16x16x32_bf16 v[104:107], a[208:211], a[16:19], v[104:107]
    ds_read_b128 a[172:175], v232 offset:17408
    v_mfma_f32_16x16x32_bf16 v[104:107], a[212:215], a[20:23], v[104:107]
    v_mfma_f32_16x16x32_bf16 v[108:111], a[208:211], a[24:27], v[108:111]
    v_mfma_f32_16x16x32_bf16 v[108:111], a[212:215], a[28:31], v[108:111]
    s_waitcnt lgkmcnt(2)
    v_mfma_f32_16x16x32_bf16 v[112:115], a[160:163], a[0:3], v[112:115]
    s_add_u32 s57, s49, 49152
    ds_read_b128 a[176:179], v232 offset:18432
    v_mfma_f32_16x16x32_bf16 v[112:115], a[164:167], a[4:7], v[112:115]
    buffer_load_dwordx4 a[104:107], v231, s[28:31], s57 offen offset:0 sc1
    v_mfma_f32_16x16x32_bf16 v[116:119], a[160:163], a[8:11], v[116:119]
    buffer_store_dwordx4 a[248:251], v232, s[64:67], s100 offen offset:3072 sc1
    v_mfma_f32_16x16x32_bf16 v[116:119], a[164:167], a[12:15], v[116:119]
    v_mfma_f32_16x16x32_bf16 v[120:123], a[160:163], a[16:19], v[120:123]
    ds_read_b128 a[180:183], v232 offset:19456
    v_mfma_f32_16x16x32_bf16 v[120:123], a[164:167], a[20:23], v[120:123]
    v_mfma_f32_16x16x32_bf16 v[124:127], a[160:163], a[24:27], v[124:127]
    v_mfma_f32_16x16x32_bf16 v[124:127], a[164:167], a[28:31], v[124:127]
    s_waitcnt lgkmcnt(2)
    buffer_load_dwordx4 a[108:111], v231, s[28:31], s57 offen offset:1024 sc1
    v_mfma_f32_16x16x32_bf16 v[128:131], a[168:171], a[0:3], v[128:131]
    ds_read_b128 a[184:187], v232 offset:20480
    v_mfma_f32_16x16x32_bf16 v[128:131], a[172:175], a[4:7], v[128:131]
    v_mfma_f32_16x16x32_bf16 v[132:135], a[168:171], a[8:11], v[132:135]
    v_mfma_f32_16x16x32_bf16 v[132:135], a[172:175], a[12:15], v[132:135]
    v_mfma_f32_16x16x32_bf16 v[136:139], a[168:171], a[16:19], v[136:139]
    s_add_u32 s57, s49, 81920
    ds_read_b128 a[188:191], v232 offset:21504
    v_mfma_f32_16x16x32_bf16 v[136:139], a[172:175], a[20:23], v[136:139]
    buffer_load_dwordx4 a[112:115], v231, s[28:31], s57 offen offset:0 sc1
    v_mfma_f32_16x16x32_bf16 v[140:143], a[168:171], a[24:27], v[140:143]
    v_mfma_f32_16x16x32_bf16 v[140:143], a[172:175], a[28:31], v[140:143]
    s_waitcnt lgkmcnt(2)
    v_mfma_f32_16x16x32_bf16 v[144:147], a[176:179], a[0:3], v[144:147]
    ds_read_b128 a[192:195], v232 offset:22528
    v_mfma_f32_16x16x32_bf16 v[144:147], a[180:183], a[4:7], v[144:147]
    v_mfma_f32_16x16x32_bf16 v[148:151], a[176:179], a[8:11], v[148:151]
    v_mfma_f32_16x16x32_bf16 v[148:151], a[180:183], a[12:15], v[148:151]
    buffer_load_dwordx4 a[116:119], v231, s[28:31], s57 offen offset:1024 sc1
    v_mfma_f32_16x16x32_bf16 v[152:155], a[176:179], a[16:19], v[152:155]
    ds_read_b128 a[196:199], v232 offset:23552
    v_mfma_f32_16x16x32_bf16 v[152:155], a[180:183], a[20:23], v[152:155]
    v_mfma_f32_16x16x32_bf16 v[156:159], a[176:179], a[24:27], v[156:159]
    v_mfma_f32_16x16x32_bf16 v[156:159], a[180:183], a[28:31], v[156:159]
    s_waitcnt lgkmcnt(2)
    v_mfma_f32_16x16x32_bf16 v[160:163], a[184:187], a[0:3], v[160:163]
    s_add_u32 s57, s49, 114688
    ds_read_b128 a[200:203], v232 offset:24576
    v_mfma_f32_16x16x32_bf16 v[160:163], a[188:191], a[4:7], v[160:163]
    buffer_load_dwordx4 a[120:123], v231, s[28:31], s57 offen offset:0 sc1
    v_mfma_f32_16x16x32_bf16 v[164:167], a[184:187], a[8:11], v[164:167]
    ds_read_b128 a[204:207], v232 offset:25600
    v_mfma_f32_16x16x32_bf16 v[164:167], a[188:191], a[12:15], v[164:167]
    v_mfma_f32_16x16x32_bf16 v[168:171], a[184:187], a[16:19], v[168:171]
    ds_read_b128 a[208:211], v232 offset:26624
    v_mfma_f32_16x16x32_bf16 v[168:171], a[188:191], a[20:23], v[168:171]
    v_mfma_f32_16x16x32_bf16 v[172:175], a[184:187], a[24:27], v[172:175]
    ds_read_b128 a[212:215], v232 offset:27648
    v_mfma_f32_16x16x32_bf16 v[172:175], a[188:191], a[28:31], v[172:175]
    s_waitcnt lgkmcnt(4)
    buffer_load_dwordx4 a[124:127], v231, s[28:31], s57 offen offset:1024 sc1
    v_mfma_f32_16x16x32_bf16 v[176:179], a[192:195], a[0:3], v[176:179]
    v_mfma_f32_16x16x32_bf16 v[176:179], a[196:199], a[4:7], v[176:179]
    v_mfma_f32_16x16x32_bf16 v[180:183], a[192:195], a[8:11], v[180:183]
    v_mfma_f32_16x16x32_bf16 v[180:183], a[196:199], a[12:15], v[180:183]
    v_mfma_f32_16x16x32_bf16 v[184:187], a[192:195], a[16:19], v[184:187]
    v_mfma_f32_16x16x32_bf16 v[184:187], a[196:199], a[20:23], v[184:187]
    v_mfma_f32_16x16x32_bf16 v[188:191], a[192:195], a[24:27], v[188:191]
    s_waitcnt lgkmcnt(0)
    v_mfma_f32_16x16x32_bf16 v[188:191], a[196:199], a[28:31], v[188:191]
    s_waitcnt vmcnt(35)
    s_barrier
    v_mfma_f32_16x16x32_bf16 v[192:195], a[200:203], a[0:3], v[192:195]
    s_add_u32 s56, s52, 258048
    ds_read_b128 a[160:163], v232 offset:28672
    s_add_u32 m0, s53, 114688
    v_mfma_f32_16x16x32_bf16 v[192:195], a[204:207], a[4:7], v[192:195]
    buffer_load_dwordx4 v231, s[24:27], s56 offen offset:0 sc1 lds
    v_mfma_f32_16x16x32_bf16 v[196:199], a[200:203], a[8:11], v[196:199]
    v_mfma_f32_16x16x32_bf16 v[196:199], a[204:207], a[12:15], v[196:199]
    v_mfma_f32_16x16x32_bf16 v[200:203], a[200:203], a[16:19], v[200:203]
    ds_read_b128 a[164:167], v232 offset:29696
    v_mfma_f32_16x16x32_bf16 v[200:203], a[204:207], a[20:23], v[200:203]
    buffer_load_dwordx4 v231, s[24:27], s56 offen offset:1024 sc1 lds
    v_mfma_f32_16x16x32_bf16 v[204:207], a[200:203], a[24:27], v[204:207]
    v_mfma_f32_16x16x32_bf16 v[204:207], a[204:207], a[28:31], v[204:207]
    v_mfma_f32_16x16x32_bf16 v[208:211], a[208:211], a[0:3], v[208:211]
    ds_read_b128 a[168:171], v232 offset:30720
    v_mfma_f32_16x16x32_bf16 v[208:211], a[212:215], a[4:7], v[208:211]
    buffer_load_dwordx4 v231, s[24:27], s56 offen offset:2048 sc1 lds
    v_mfma_f32_16x16x32_bf16 v[212:215], a[208:211], a[8:11], v[212:215]
    v_mfma_f32_16x16x32_bf16 v[212:215], a[212:215], a[12:15], v[212:215]
    v_mfma_f32_16x16x32_bf16 v[216:219], a[208:211], a[16:19], v[216:219]
    ds_read_b128 a[172:175], v232 offset:31744
    v_mfma_f32_16x16x32_bf16 v[216:219], a[212:215], a[20:23], v[216:219]
    v_mfma_f32_16x16x32_bf16 v[220:223], a[208:211], a[24:27], v[220:223]
    v_mfma_f32_16x16x32_bf16 v[220:223], a[212:215], a[28:31], v[220:223]
    s_waitcnt lgkmcnt(2)
    buffer_load_dwordx4 v231, s[24:27], s56 offen offset:3072 sc1 lds
    v_mfma_f32_16x16x32_bf16 v[0:3], a[160:163], a[32:35], v[0:3]
    ds_read_b128 a[176:179], v232 offset:32768
    v_mfma_f32_16x16x32_bf16 v[0:3], a[164:167], a[36:39], v[0:3]
    v_mfma_f32_16x16x32_bf16 v[4:7], a[160:163], a[40:43], v[4:7]
    v_mfma_f32_16x16x32_bf16 v[4:7], a[164:167], a[44:47], v[4:7]
    v_mfma_f32_16x16x32_bf16 v[8:11], a[160:163], a[48:51], v[8:11]
    s_add_u32 s56, s52, 262144
    ds_read_b128 a[180:183], v232 offset:33792
    s_add_u32 m0, s53, 118784
    v_mfma_f32_16x16x32_bf16 v[8:11], a[164:167], a[52:55], v[8:11]
    buffer_load_dwordx4 v231, s[24:27], s56 offen offset:0 sc1 lds
    v_mfma_f32_16x16x32_bf16 v[12:15], a[160:163], a[56:59], v[12:15]
    v_mfma_f32_16x16x32_bf16 v[12:15], a[164:167], a[60:63], v[12:15]
    s_waitcnt lgkmcnt(2)
    v_cmp_lt_u32 vcc, 27, v235
    v_mfma_f32_16x16x32_bf16 v[16:19], a[168:171], a[32:35], v[16:19]
    ds_read_b128 a[184:187], v232 offset:34816
    v_mfma_f32_16x16x32_bf16 v[16:19], a[172:175], a[36:39], v[16:19]
    v_mfma_f32_16x16x32_bf16 v[20:23], a[168:171], a[40:43], v[20:23]
    v_mfma_f32_16x16x32_bf16 v[20:23], a[172:175], a[44:47], v[20:23]
    buffer_load_dwordx4 v231, s[24:27], s56 offen offset:1024 sc1 lds
    v_mfma_f32_16x16x32_bf16 v[24:27], a[168:171], a[48:51], v[24:27]
    ds_read_b128 a[188:191], v232 offset:35840
    v_mfma_f32_16x16x32_bf16 v[24:27], a[172:175], a[52:55], v[24:27]
    v_mfma_f32_16x16x32_bf16 v[28:31], a[168:171], a[56:59], v[28:31]
    v_mfma_f32_16x16x32_bf16 v[28:31], a[172:175], a[60:63], v[28:31]
    s_waitcnt lgkmcnt(2)
    v_mfma_f32_16x16x32_bf16 v[32:35], a[176:179], a[32:35], v[32:35]
    ds_read_b128 a[192:195], v232 offset:36864
    v_mfma_f32_16x16x32_bf16 v[32:35], a[180:183], a[36:39], v[32:35]
    buffer_load_dwordx4 v231, s[24:27], s56 offen offset:2048 sc1 lds
    v_mfma_f32_16x16x32_bf16 v[36:39], a[176:179], a[40:43], v[36:39]
    v_mfma_f32_16x16x32_bf16 v[36:39], a[180:183], a[44:47], v[36:39]
    v_mfma_f32_16x16x32_bf16 v[40:43], a[176:179], a[48:51], v[40:43]
    ds_read_b128 a[196:199], v232 offset:37888
    v_mfma_f32_16x16x32_bf16 v[40:43], a[180:183], a[52:55], v[40:43]
    v_mfma_f32_16x16x32_bf16 v[44:47], a[176:179], a[56:59], v[44:47]
    s_add_u32 s57, s49, 18432
    v_mov_b32 v246, 13888
    v_mfma_f32_16x16x32_bf16 v[44:47], a[180:183], a[60:63], v[44:47]
    s_waitcnt lgkmcnt(2)
    buffer_load_dwordx4 a[128:131], v231, s[28:31], s57 offen offset:0 sc1
    v_mfma_f32_16x16x32_bf16 v[48:51], a[184:187], a[32:35], v[48:51]
    ds_read_b128 a[200:203], v232 offset:38912
    v_mfma_f32_16x16x32_bf16 v[48:51], a[188:191], a[36:39], v[48:51]
    v_mfma_f32_16x16x32_bf16 v[52:55], a[184:187], a[40:43], v[52:55]
    v_mfma_f32_16x16x32_bf16 v[52:55], a[188:191], a[44:47], v[52:55]
    v_mfma_f32_16x16x32_bf16 v[56:59], a[184:187], a[48:51], v[56:59]
    ds_read_b128 a[204:207], v232 offset:39936
    v_mfma_f32_16x16x32_bf16 v[56:59], a[188:191], a[52:55], v[56:59]
    buffer_load_dwordx4 a[132:135], v231, s[28:31], s57 offen offset:1024 sc1
    v_mfma_f32_16x16x32_bf16 v[60:63], a[184:187], a[56:59], v[60:63]
    v_mfma_f32_16x16x32_bf16 v[60:63], a[188:191], a[60:63], v[60:63]
    s_waitcnt lgkmcnt(2)
    v_mfma_f32_16x16x32_bf16 v[64:67], a[192:195], a[32:35], v[64:67]
    ds_read_b128 a[208:211], v232 offset:40960
    v_mfma_f32_16x16x32_bf16 v[64:67], a[196:199], a[36:39], v[64:67]
    v_mfma_f32_16x16x32_bf16 v[68:71], a[192:195], a[40:43], v[68:71]
    s_add_u32 s57, s49, 51200
    v_mfma_f32_16x16x32_bf16 v[68:71], a[196:199], a[44:47], v[68:71]
    buffer_load_dwordx4 a[136:139], v231, s[28:31], s57 offen offset:0 sc1
    v_mfma_f32_16x16x32_bf16 v[72:75], a[192:195], a[48:51], v[72:75]
    ds_read_b128 a[212:215], v232 offset:41984
    v_mfma_f32_16x16x32_bf16 v[72:75], a[196:199], a[52:55], v[72:75]
    v_mfma_f32_16x16x32_bf16 v[76:79], a[192:195], a[56:59], v[76:79]
    v_and_b32 v247, 15, v235
    v_mfma_f32_16x16x32_bf16 v[76:79], a[196:199], a[60:63], v[76:79]
    s_waitcnt lgkmcnt(2)
    v_mfma_f32_16x16x32_bf16 v[80:83], a[200:203], a[32:35], v[80:83]
    ds_read_b128 a[160:163], v232 offset:43008
    v_mfma_f32_16x16x32_bf16 v[80:83], a[204:207], a[36:39], v[80:83]
    buffer_load_dwordx4 a[140:143], v231, s[28:31], s57 offen offset:1024 sc1
    v_mfma_f32_16x16x32_bf16 v[84:87], a[200:203], a[40:43], v[84:87]
    v_mfma_f32_16x16x32_bf16 v[84:87], a[204:207], a[44:47], v[84:87]
    v_mfma_f32_16x16x32_bf16 v[88:91], a[200:203], a[48:51], v[88:91]
    ds_read_b128 a[164:167], v232 offset:44032
    v_mfma_f32_16x16x32_bf16 v[88:91], a[204:207], a[52:55], v[88:91]
    v_mfma_f32_16x16x32_bf16 v[92:95], a[200:203], a[56:59], v[92:95]
    s_add_u32 s57, s49, 83968
    v_mfma_f32_16x16x32_bf16 v[92:95], a[204:207], a[60:63], v[92:95]
    s_waitcnt lgkmcnt(2)
    buffer_load_dwordx4 a[144:147], v231, s[28:31], s57 offen offset:0 sc1
    v_mfma_f32_16x16x32_bf16 v[96:99], a[208:211], a[32:35], v[96:99]
    ds_read_b128 a[168:171], v232 offset:45056
    v_mfma_f32_16x16x32_bf16 v[96:99], a[212:215], a[36:39], v[96:99]
    v_mfma_f32_16x16x32_bf16 v[100:103], a[208:211], a[40:43], v[100:103]
    v_mfma_f32_16x16x32_bf16 v[100:103], a[212:215], a[44:47], v[100:103]
    v_mfma_f32_16x16x32_bf16 v[104:107], a[208:211], a[48:51], v[104:107]
    ds_read_b128 a[172:175], v232 offset:46080
    v_mfma_f32_16x16x32_bf16 v[104:107], a[212:215], a[52:55], v[104:107]
    buffer_load_dwordx4 a[148:151], v231, s[28:31], s57 offen offset:1024 sc1
    v_cndmask_b32 v246, 0, v246, vcc
    v_mfma_f32_16x16x32_bf16 v[108:111], a[208:211], a[56:59], v[108:111]
    v_mfma_f32_16x16x32_bf16 v[108:111], a[212:215], a[60:63], v[108:111]
    s_waitcnt lgkmcnt(2)
    v_mfma_f32_16x16x32_bf16 v[112:115], a[160:163], a[32:35], v[112:115]
    ds_read_b128 a[176:179], v232 offset:47104
    v_mfma_f32_16x16x32_bf16 v[112:115], a[164:167], a[36:39], v[112:115]
    v_mfma_f32_16x16x32_bf16 v[116:119], a[160:163], a[40:43], v[116:119]
    s_add_u32 s57, s49, 116736
    v_mfma_f32_16x16x32_bf16 v[116:119], a[164:167], a[44:47], v[116:119]
    buffer_load_dwordx4 a[152:155], v231, s[28:31], s57 offen offset:0 sc1
    v_mfma_f32_16x16x32_bf16 v[120:123], a[160:163], a[48:51], v[120:123]
    ds_read_b128 a[180:183], v232 offset:48128
    v_mfma_f32_16x16x32_bf16 v[120:123], a[164:167], a[52:55], v[120:123]
    v_mfma_f32_16x16x32_bf16 v[124:127], a[160:163], a[56:59], v[124:127]
    v_mfma_f32_16x16x32_bf16 v[124:127], a[164:167], a[60:63], v[124:127]
    s_waitcnt lgkmcnt(2)
    v_mfma_f32_16x16x32_bf16 v[128:131], a[168:171], a[32:35], v[128:131]
    ds_read_b128 a[184:187], v232 offset:49152
    v_mfma_f32_16x16x32_bf16 v[128:131], a[172:175], a[36:39], v[128:131]
    buffer_load_dwordx4 a[156:159], v231, s[28:31], s57 offen offset:1024 sc1
    v_mfma_f32_16x16x32_bf16 v[132:135], a[168:171], a[40:43], v[132:135]
    v_mfma_f32_16x16x32_bf16 v[132:135], a[172:175], a[44:47], v[132:135]
    v_mfma_f32_16x16x32_bf16 v[136:139], a[168:171], a[48:51], v[136:139]
    ds_read_b128 a[188:191], v232 offset:50176
    v_lshl_add_u32 v246, v235, 4, v246
    v_mfma_f32_16x16x32_bf16 v[136:139], a[172:175], a[52:55], v[136:139]
    v_mfma_f32_16x16x32_bf16 v[140:143], a[168:171], a[56:59], v[140:143]
    s_add_u32 s56, s52, 286720
    s_add_u32 m0, s53, 0
    v_mfma_f32_16x16x32_bf16 v[140:143], a[172:175], a[60:63], v[140:143]
    s_waitcnt lgkmcnt(2)
    buffer_load_dwordx4 v231, s[24:27], s56 offen offset:0 sc1 lds
    v_mfma_f32_16x16x32_bf16 v[144:147], a[176:179], a[32:35], v[144:147]
    ds_read_b128 a[192:195], v232 offset:51200
    v_mfma_f32_16x16x32_bf16 v[144:147], a[180:183], a[36:39], v[144:147]
    v_mfma_f32_16x16x32_bf16 v[148:151], a[176:179], a[40:43], v[148:151]
    v_mfma_f32_16x16x32_bf16 v[148:151], a[180:183], a[44:47], v[148:151]
    v_mfma_f32_16x16x32_bf16 v[152:155], a[176:179], a[48:51], v[152:155]
    ds_read_b128 a[196:199], v232 offset:52224
    v_mfma_f32_16x16x32_bf16 v[152:155], a[180:183], a[52:55], v[152:155]
    buffer_load_dwordx4 v231, s[24:27], s56 offen offset:1024 sc1 lds
    v_mfma_f32_16x16x32_bf16 v[156:159], a[176:179], a[56:59], v[156:159]
    v_mfma_f32_16x16x32_bf16 v[156:159], a[180:183], a[60:63], v[156:159]
    s_waitcnt lgkmcnt(2)
    v_mfma_f32_16x16x32_bf16 v[160:163], a[184:187], a[32:35], v[160:163]
    ds_read_b128 a[200:203], v232 offset:53248
    v_mfma_f32_16x16x32_bf16 v[160:163], a[188:191], a[36:39], v[160:163]
    v_mfma_f32_16x16x32_bf16 v[164:167], a[184:187], a[40:43], v[164:167]
    ds_read_b128 a[204:207], v232 offset:54272
    v_mfma_f32_16x16x32_bf16 v[164:167], a[188:191], a[44:47], v[164:167]
    buffer_load_dwordx4 v231, s[24:27], s56 offen offset:2048 sc1 lds
    v_mfma_f32_16x16x32_bf16 v[168:171], a[184:187], a[48:51], v[168:171]
    ds_read_b128 a[208:211], v232 offset:55296
    v_mfma_f32_16x16x32_bf16 v[168:171], a[188:191], a[52:55], v[168:171]
    v_lshlrev_b32 v247, 3, v247
    v_mfma_f32_16x16x32_bf16 v[172:175], a[184:187], a[56:59], v[172:175]
    ds_read_b128 a[212:215], v232 offset:56320
    v_mfma_f32_16x16x32_bf16 v[172:175], a[188:191], a[60:63], v[172:175]
    s_waitcnt lgkmcnt(4)
    v_mfma_f32_16x16x32_bf16 v[176:179], a[192:195], a[32:35], v[176:179]
    v_mfma_f32_16x16x32_bf16 v[176:179], a[196:199], a[36:39], v[176:179]
    buffer_load_dwordx4 v231, s[24:27], s56 offen offset:3072 sc1 lds
    v_mfma_f32_16x16x32_bf16 v[180:183], a[192:195], a[40:43], v[180:183]
    v_mfma_f32_16x16x32_bf16 v[180:183], a[196:199], a[44:47], v[180:183]
    v_mfma_f32_16x16x32_bf16 v[184:187], a[192:195], a[48:51], v[184:187]
    v_mfma_f32_16x16x32_bf16 v[184:187], a[196:199], a[52:55], v[184:187]
    v_mfma_f32_16x16x32_bf16 v[188:191], a[192:195], a[56:59], v[188:191]
    s_waitcnt lgkmcnt(0)
    v_mfma_f32_16x16x32_bf16 v[188:191], a[196:199], a[60:63], v[188:191]
    s_waitcnt vmcnt(24)
    s_barrier
    v_mfma_f32_16x16x32_bf16 v[192:195], a[200:203], a[32:35], v[192:195]
    s_add_u32 s56, s52, 290816
    ds_read_b128 a[160:163], v233 offset:0
    s_add_u32 m0, s53, 4096
    v_mfma_f32_16x16x32_bf16 v[192:195], a[204:207], a[36:39], v[192:195]
    buffer_load_dwordx4 v231, s[24:27], s56 offen offset:0 sc1 lds
    v_mfma_f32_16x16x32_bf16 v[196:199], a[200:203], a[40:43], v[196:199]
    buffer_atomic_add v253, v249, s[88:91], s71 offen sc1
    v_mfma_f32_16x16x32_bf16 v[196:199], a[204:207], a[44:47], v[196:199]
    v_mfma_f32_16x16x32_bf16 v[200:203], a[200:203], a[48:51], v[200:203]
    ds_read_b128 a[164:167], v233 offset:1024
    v_mfma_f32_16x16x32_bf16 v[200:203], a[204:207], a[52:55], v[200:203]
    buffer_load_dwordx4 v231, s[24:27], s56 offen offset:1024 sc1 lds
    v_mfma_f32_16x16x32_bf16 v[204:207], a[200:203], a[56:59], v[204:207]
    v_and_b32 v244, 15, v235
    v_mfma_f32_16x16x32_bf16 v[204:207], a[204:207], a[60:63], v[204:207]
    v_mfma_f32_16x16x32_bf16 v[208:211], a[208:211], a[32:35], v[208:211]
    ds_read_b128 a[168:171], v233 offset:2048
    v_mfma_f32_16x16x32_bf16 v[208:211], a[212:215], a[36:39], v[208:211]
    buffer_load_dwordx4 v231, s[24:27], s56 offen offset:2048 sc1 lds
    v_mfma_f32_16x16x32_bf16 v[212:215], a[208:211], a[40:43], v[212:215]
    v_lshlrev_b32 v244, 10, v244
    v_mfma_f32_16x16x32_bf16 v[212:215], a[212:215], a[44:47], v[212:215]
    v_mfma_f32_16x16x32_bf16 v[216:219], a[208:211], a[48:51], v[216:219]
    ds_read_b128 a[172:175], v233 offset:3072
    v_mfma_f32_16x16x32_bf16 v[216:219], a[212:215], a[52:55], v[216:219]
    v_mfma_f32_16x16x32_bf16 v[220:223], a[208:211], a[56:59], v[220:223]
    s_add_u32 s57, s49, 20480
    s_mov_b32 s73, 65536
    v_mfma_f32_16x16x32_bf16 v[220:223], a[212:215], a[60:63], v[220:223]
    s_waitcnt lgkmcnt(2)
    buffer_load_dwordx4 a[0:3], v231, s[28:31], s57 offen offset:0 sc1
    v_mfma_f32_16x16x32_bf16 v[0:3], a[160:163], a[64:67], v[0:3]
    ds_read_b128 a[176:179], v233 offset:4096
    v_mfma_f32_16x16x32_bf16 v[0:3], a[164:167], a[68:71], v[0:3]
    buffer_load_dword v245, v244, s[88:91], s73 offen sc1
    v_mfma_f32_16x16x32_bf16 v[4:7], a[160:163], a[72:75], v[4:7]
    v_mfma_f32_16x16x32_bf16 v[4:7], a[164:167], a[76:79], v[4:7]
    v_mfma_f32_16x16x32_bf16 v[8:11], a[160:163], a[80:83], v[8:11]
    ds_read_b128 a[180:183], v233 offset:5120
    v_mfma_f32_16x16x32_bf16 v[8:11], a[164:167], a[84:87], v[8:11]
    buffer_load_dwordx4 a[4:7], v231, s[28:31], s57 offen offset:1024 sc1
    v_mfma_f32_16x16x32_bf16 v[12:15], a[160:163], a[88:91], v[12:15]
    v_mfma_f32_16x16x32_bf16 v[12:15], a[164:167], a[92:95], v[12:15]
    s_waitcnt lgkmcnt(2)
    v_mfma_f32_16x16x32_bf16 v[16:19], a[168:171], a[64:67], v[16:19]
    ds_read_b128 a[184:187], v233 offset:6144
    v_mfma_f32_16x16x32_bf16 v[16:19], a[172:175], a[68:71], v[16:19]
    v_mfma_f32_16x16x32_bf16 v[20:23], a[168:171], a[72:75], v[20:23]
    s_add_u32 s57, s49, 53248
    v_mfma_f32_16x16x32_bf16 v[20:23], a[172:175], a[76:79], v[20:23]
    buffer_load_dwordx4 a[8:11], v231, s[28:31], s57 offen offset:0 sc1
    v_mfma_f32_16x16x32_bf16 v[24:27], a[168:171], a[80:83], v[24:27]
    ds_read_b128 a[188:191], v233 offset:7168
    v_mfma_f32_16x16x32_bf16 v[24:27], a[172:175], a[84:87], v[24:27]
    v_mfma_f32_16x16x32_bf16 v[28:31], a[168:171], a[88:91], v[28:31]
    v_mfma_f32_16x16x32_bf16 v[28:31], a[172:175], a[92:95], v[28:31]
    s_waitcnt lgkmcnt(2)
    v_mfma_f32_16x16x32_bf16 v[32:35], a[176:179], a[64:67], v[32:35]
    ds_read_b128 a[192:195], v233 offset:8192
    v_mfma_f32_16x16x32_bf16 v[32:35], a[180:183], a[68:71], v[32:35]
    buffer_load_dwordx4 a[12:15], v231, s[28:31], s57 offen offset:1024 sc1
    v_mfma_f32_16x16x32_bf16 v[36:39], a[176:179], a[72:75], v[36:39]
    v_mfma_f32_16x16x32_bf16 v[36:39], a[180:183], a[76:79], v[36:39]
    v_mfma_f32_16x16x32_bf16 v[40:43], a[176:179], a[80:83], v[40:43]
    ds_read_b128 a[196:199], v233 offset:9216
    v_mfma_f32_16x16x32_bf16 v[40:43], a[180:183], a[84:87], v[40:43]
    v_mfma_f32_16x16x32_bf16 v[44:47], a[176:179], a[88:91], v[44:47]
    s_add_u32 s57, s49, 86016
    v_mfma_f32_16x16x32_bf16 v[44:47], a[180:183], a[92:95], v[44:47]
    s_waitcnt lgkmcnt(2)
    buffer_load_dwordx4 a[16:19], v231, s[28:31], s57 offen offset:0 sc1
    v_mfma_f32_16x16x32_bf16 v[48:51], a[184:187], a[64:67], v[48:51]
    ds_read_b128 a[200:203], v233 offset:10240
    v_mfma_f32_16x16x32_bf16 v[48:51], a[188:191], a[68:71], v[48:51]
    v_mfma_f32_16x16x32_bf16 v[52:55], a[184:187], a[72:75], v[52:55]
    v_mfma_f32_16x16x32_bf16 v[52:55], a[188:191], a[76:79], v[52:55]
    v_mfma_f32_16x16x32_bf16 v[56:59], a[184:187], a[80:83], v[56:59]
    ds_read_b128 a[204:207], v233 offset:11264
    v_mfma_f32_16x16x32_bf16 v[56:59], a[188:191], a[84:87], v[56:59]
    buffer_load_dwordx4 a[20:23], v231, s[28:31], s57 offen offset:1024 sc1
    v_mfma_f32_16x16x32_bf16 v[60:63], a[184:187], a[88:91], v[60:63]
    v_mfma_f32_16x16x32_bf16 v[60:63], a[188:191], a[92:95], v[60:63]
    s_waitcnt lgkmcnt(2)
    v_mfma_f32_16x16x32_bf16 v[64:67], a[192:195], a[64:67], v[64:67]
    ds_read_b128 a[208:211], v233 offset:12288
    v_mfma_f32_16x16x32_bf16 v[64:67], a[196:199], a[68:71], v[64:67]
    v_mfma_f32_16x16x32_bf16 v[68:71], a[192:195], a[72:75], v[68:71]
    s_add_u32 s57, s49, 118784
    v_mfma_f32_16x16x32_bf16 v[68:71], a[196:199], a[76:79], v[68:71]
    buffer_load_dwordx4 a[24:27], v231, s[28:31], s57 offen offset:0 sc1
    v_mfma_f32_16x16x32_bf16 v[72:75], a[192:195], a[80:83], v[72:75]
    ds_read_b128 a[212:215], v233 offset:13312
    v_mfma_f32_16x16x32_bf16 v[72:75], a[196:199], a[84:87], v[72:75]
    v_mfma_f32_16x16x32_bf16 v[76:79], a[192:195], a[88:91], v[76:79]
    v_mfma_f32_16x16x32_bf16 v[76:79], a[196:199], a[92:95], v[76:79]
    s_waitcnt lgkmcnt(2)
    v_mfma_f32_16x16x32_bf16 v[80:83], a[200:203], a[64:67], v[80:83]
    ds_read_b128 a[160:163], v233 offset:14336
    v_mfma_f32_16x16x32_bf16 v[80:83], a[204:207], a[68:71], v[80:83]
    buffer_load_dwordx4 a[28:31], v231, s[28:31], s57 offen offset:1024 sc1
    v_mfma_f32_16x16x32_bf16 v[84:87], a[200:203], a[72:75], v[84:87]
    v_mfma_f32_16x16x32_bf16 v[84:87], a[204:207], a[76:79], v[84:87]
    v_mfma_f32_16x16x32_bf16 v[88:91], a[200:203], a[80:83], v[88:91]
    ds_read_b128 a[164:167], v233 offset:15360
    v_mfma_f32_16x16x32_bf16 v[88:91], a[204:207], a[84:87], v[88:91]
    v_mfma_f32_16x16x32_bf16 v[92:95], a[200:203], a[88:91], v[92:95]
    s_add_u32 s56, s52, 315392
    s_add_u32 m0, s53, 28672
    v_mfma_f32_16x16x32_bf16 v[92:95], a[204:207], a[92:95], v[92:95]
    s_waitcnt lgkmcnt(2)
    buffer_load_dwordx4 v231, s[24:27], s56 offen offset:0 sc1 lds
    v_mfma_f32_16x16x32_bf16 v[96:99], a[208:211], a[64:67], v[96:99]
    ds_read_b128 a[168:171], v233 offset:16384
    v_mfma_f32_16x16x32_bf16 v[96:99], a[212:215], a[68:71], v[96:99]
    v_mfma_f32_16x16x32_bf16 v[100:103], a[208:211], a[72:75], v[100:103]
    v_mfma_f32_16x16x32_bf16 v[100:103], a[212:215], a[76:79], v[100:103]
    v_mfma_f32_16x16x32_bf16 v[104:107], a[208:211], a[80:83], v[104:107]
    ds_read_b128 a[172:175], v233 offset:17408
    v_mfma_f32_16x16x32_bf16 v[104:107], a[212:215], a[84:87], v[104:107]
    buffer_load_dwordx4 v231, s[24:27], s56 offen offset:1024 sc1 lds
    v_mfma_f32_16x16x32_bf16 v[108:111], a[208:211], a[88:91], v[108:111]
    v_mfma_f32_16x16x32_bf16 v[108:111], a[212:215], a[92:95], v[108:111]
    s_waitcnt lgkmcnt(2)
    v_mfma_f32_16x16x32_bf16 v[112:115], a[160:163], a[64:67], v[112:115]
    ds_read_b128 a[176:179], v233 offset:18432
    v_mfma_f32_16x16x32_bf16 v[112:115], a[164:167], a[68:71], v[112:115]
    v_mfma_f32_16x16x32_bf16 v[116:119], a[160:163], a[72:75], v[116:119]
    v_mfma_f32_16x16x32_bf16 v[116:119], a[164:167], a[76:79], v[116:119]
    buffer_load_dwordx4 v231, s[24:27], s56 offen offset:2048 sc1 lds
    v_mfma_f32_16x16x32_bf16 v[120:123], a[160:163], a[80:83], v[120:123]
    ds_read_b128 a[180:183], v233 offset:19456
    v_mfma_f32_16x16x32_bf16 v[120:123], a[164:167], a[84:87], v[120:123]
    v_mfma_f32_16x16x32_bf16 v[124:127], a[160:163], a[88:91], v[124:127]
    v_mfma_f32_16x16x32_bf16 v[124:127], a[164:167], a[92:95], v[124:127]
    s_waitcnt lgkmcnt(2)
    v_mfma_f32_16x16x32_bf16 v[128:131], a[168:171], a[64:67], v[128:131]
    ds_read_b128 a[184:187], v233 offset:20480
    v_mfma_f32_16x16x32_bf16 v[128:131], a[172:175], a[68:71], v[128:131]
    buffer_load_dwordx4 v231, s[24:27], s56 offen offset:3072 sc1 lds
    v_mfma_f32_16x16x32_bf16 v[132:135], a[168:171], a[72:75], v[132:135]
    v_mfma_f32_16x16x32_bf16 v[132:135], a[172:175], a[76:79], v[132:135]
    v_mfma_f32_16x16x32_bf16 v[136:139], a[168:171], a[80:83], v[136:139]
    ds_read_b128 a[188:191], v233 offset:21504
    v_mfma_f32_16x16x32_bf16 v[136:139], a[172:175], a[84:87], v[136:139]
    v_mfma_f32_16x16x32_bf16 v[140:143], a[168:171], a[88:91], v[140:143]
    s_add_u32 s56, s52, 319488
    s_add_u32 m0, s53, 32768
    v_mfma_f32_16x16x32_bf16 v[140:143], a[172:175], a[92:95], v[140:143]
    s_waitcnt lgkmcnt(2)
    buffer_load_dwordx4 v231, s[24:27], s56 offen offset:0 sc1 lds
    v_mfma_f32_16x16x32_bf16 v[144:147], a[176:179], a[64:67], v[144:147]
    ds_read_b128 a[192:195], v233 offset:22528
    v_mfma_f32_16x16x32_bf16 v[144:147], a[180:183], a[68:71], v[144:147]
    v_mfma_f32_16x16x32_bf16 v[148:151], a[176:179], a[72:75], v[148:151]
    v_mfma_f32_16x16x32_bf16 v[148:151], a[180:183], a[76:79], v[148:151]
    v_mfma_f32_16x16x32_bf16 v[152:155], a[176:179], a[80:83], v[152:155]
    ds_read_b128 a[196:199], v233 offset:23552
    v_mfma_f32_16x16x32_bf16 v[152:155], a[180:183], a[84:87], v[152:155]
    buffer_load_dwordx4 v231, s[24:27], s56 offen offset:1024 sc1 lds
    v_mfma_f32_16x16x32_bf16 v[156:159], a[176:179], a[88:91], v[156:159]
    v_mfma_f32_16x16x32_bf16 v[156:159], a[180:183], a[92:95], v[156:159]
    s_waitcnt lgkmcnt(2)
    v_mfma_f32_16x16x32_bf16 v[160:163], a[184:187], a[64:67], v[160:163]
    ds_read_b128 a[200:203], v233 offset:24576
    v_mfma_f32_16x16x32_bf16 v[160:163], a[188:191], a[68:71], v[160:163]
    v_mfma_f32_16x16x32_bf16 v[164:167], a[184:187], a[72:75], v[164:167]
    ds_read_b128 a[204:207], v233 offset:25600
    v_mfma_f32_16x16x32_bf16 v[164:167], a[188:191], a[76:79], v[164:167]
    buffer_load_dwordx4 v231, s[24:27], s56 offen offset:2048 sc1 lds
    v_mfma_f32_16x16x32_bf16 v[168:171], a[184:187], a[80:83], v[168:171]
    ds_read_b128 a[208:211], v233 offset:26624
    v_mfma_f32_16x16x32_bf16 v[168:171], a[188:191], a[84:87], v[168:171]
    v_mfma_f32_16x16x32_bf16 v[172:175], a[184:187], a[88:91], v[172:175]
    ds_read_b128 a[212:215], v233 offset:27648
    v_mfma_f32_16x16x32_bf16 v[172:175], a[188:191], a[92:95], v[172:175]
    s_waitcnt lgkmcnt(4)
    v_mfma_f32_16x16x32_bf16 v[176:179], a[192:195], a[64:67], v[176:179]
    s_add_u32 s57, s49, 22528
    v_mfma_f32_16x16x32_bf16 v[176:179], a[196:199], a[68:71], v[176:179]
    buffer_load_dwordx4 a[32:35], v231, s[28:31], s57 offen offset:0 sc1
    v_mfma_f32_16x16x32_bf16 v[180:183], a[192:195], a[72:75], v[180:183]
L_stub_14:
    s_cbranch_execz L_stub_17
    v_mfma_f32_16x16x32_bf16 v[180:183], a[196:199], a[76:79], v[180:183]
    v_mfma_f32_16x16x32_bf16 v[184:187], a[192:195], a[80:83], v[184:187]
    v_mfma_f32_16x16x32_bf16 v[184:187], a[196:199], a[84:87], v[184:187]
    v_mfma_f32_16x16x32_bf16 v[188:191], a[192:195], a[88:91], v[188:191]
    s_waitcnt lgkmcnt(0)
    v_mfma_f32_16x16x32_bf16 v[188:191], a[196:199], a[92:95], v[188:191]
    s_waitcnt vmcnt(40)
    s_barrier
    v_mfma_f32_16x16x32_bf16 v[192:195], a[200:203], a[64:67], v[192:195]
    ds_read_b128 a[160:163], v233 offset:28672
    v_mfma_f32_16x16x32_bf16 v[192:195], a[204:207], a[68:71], v[192:195]
    buffer_load_dwordx4 a[36:39], v231, s[28:31], s57 offen offset:1024 sc1
    v_mfma_f32_16x16x32_bf16 v[196:199], a[200:203], a[72:75], v[196:199]
    v_mfma_f32_16x16x32_bf16 v[196:199], a[204:207], a[76:79], v[196:199]
    v_mfma_f32_16x16x32_bf16 v[200:203], a[200:203], a[80:83], v[200:203]
    s_add_u32 s57, s49, 55296
    ds_read_b128 a[164:167], v233 offset:29696
    v_mfma_f32_16x16x32_bf16 v[200:203], a[204:207], a[84:87], v[200:203]
    buffer_load_dwordx4 a[40:43], v231, s[28:31], s57 offen offset:0 sc1
    v_mfma_f32_16x16x32_bf16 v[204:207], a[200:203], a[88:91], v[204:207]
    v_mfma_f32_16x16x32_bf16 v[204:207], a[204:207], a[92:95], v[204:207]
    v_mfma_f32_16x16x32_bf16 v[208:211], a[208:211], a[64:67], v[208:211]
    ds_read_b128 a[168:171], v233 offset:30720
    v_mfma_f32_16x16x32_bf16 v[208:211], a[212:215], a[68:71], v[208:211]
    v_mfma_f32_16x16x32_bf16 v[212:215], a[208:211], a[72:75], v[212:215]
    v_mfma_f32_16x16x32_bf16 v[212:215], a[212:215], a[76:79], v[212:215]
    buffer_load_dwordx4 a[44:47], v231, s[28:31], s57 offen offset:1024 sc1
    v_mfma_f32_16x16x32_bf16 v[216:219], a[208:211], a[80:83], v[216:219]
    ds_read_b128 a[172:175], v233 offset:31744
    v_mfma_f32_16x16x32_bf16 v[216:219], a[212:215], a[84:87], v[216:219]
    v_mfma_f32_16x16x32_bf16 v[220:223], a[208:211], a[88:91], v[220:223]
    v_mfma_f32_16x16x32_bf16 v[220:223], a[212:215], a[92:95], v[220:223]
    s_waitcnt lgkmcnt(2)
    v_mfma_f32_16x16x32_bf16 v[0:3], a[160:163], a[96:99], v[0:3]
    s_add_u32 s57, s49, 88064
    ds_read_b128 a[176:179], v233 offset:32768
    s_waitcnt vmcnt(18)
    v_cmp_gt_u32 vcc, 16, v245
    v_mfma_f32_16x16x32_bf16 v[0:3], a[164:167], a[100:103], v[0:3]
    buffer_load_dwordx4 a[48:51], v231, s[28:31], s57 offen offset:0 sc1
    v_mfma_f32_16x16x32_bf16 v[4:7], a[160:163], a[104:107], v[4:7]
    v_mfma_f32_16x16x32_bf16 v[4:7], a[164:167], a[108:111], v[4:7]
    v_mfma_f32_16x16x32_bf16 v[8:11], a[160:163], a[112:115], v[8:11]
    s_cbranch_vccnz L_sequential_preLN__softmax_full_mha__glu_gated_swiglu__prompt_kernel_gspin_21
L_sequential_preLN__softmax_full_mha__glu_gated_swiglu__prompt_kernel_gspin_21_r:
    ds_read_b128 a[180:183], v233 offset:33792
    v_mfma_f32_16x16x32_bf16 v[8:11], a[164:167], a[116:119], v[8:11]
    v_mfma_f32_16x16x32_bf16 v[12:15], a[160:163], a[120:123], v[12:15]
    v_mfma_f32_16x16x32_bf16 v[12:15], a[164:167], a[124:127], v[12:15]
    s_waitcnt lgkmcnt(2)
    buffer_load_dwordx4 a[52:55], v231, s[28:31], s57 offen offset:1024 sc1
    v_mfma_f32_16x16x32_bf16 v[16:19], a[168:171], a[96:99], v[16:19]
    ds_read_b128 a[184:187], v233 offset:34816
    v_mfma_f32_16x16x32_bf16 v[16:19], a[172:175], a[100:103], v[16:19]
    buffer_load_dwordx2 v[236:237], v247, s[36:39], s63 offen offset:0 sc1
    v_mfma_f32_16x16x32_bf16 v[20:23], a[168:171], a[104:107], v[20:23]
    buffer_load_dwordx2 v[238:239], v247, s[36:39], s63 offen offset:128 sc1
    v_mfma_f32_16x16x32_bf16 v[20:23], a[172:175], a[108:111], v[20:23]
    buffer_load_dwordx2 v[240:241], v247, s[36:39], s63 offen offset:256 sc1
    v_mfma_f32_16x16x32_bf16 v[24:27], a[168:171], a[112:115], v[24:27]
    s_add_u32 s57, s49, 120832
    ds_read_b128 a[188:191], v233 offset:35840
    v_mfma_f32_16x16x32_bf16 v[24:27], a[172:175], a[116:119], v[24:27]
    buffer_load_dwordx4 a[56:59], v231, s[28:31], s57 offen offset:0 sc1
    v_mfma_f32_16x16x32_bf16 v[28:31], a[168:171], a[120:123], v[28:31]
    buffer_load_dwordx2 v[242:243], v247, s[36:39], s63 offen offset:384 sc1
    v_mfma_f32_16x16x32_bf16 v[28:31], a[172:175], a[124:127], v[28:31]
    s_waitcnt lgkmcnt(2)
    v_mfma_f32_16x16x32_bf16 v[32:35], a[176:179], a[96:99], v[32:35]
    ds_read_b128 a[192:195], v233 offset:36864
    v_mfma_f32_16x16x32_bf16 v[32:35], a[180:183], a[100:103], v[32:35]
    v_mfma_f32_16x16x32_bf16 v[36:39], a[176:179], a[104:107], v[36:39]
    v_mfma_f32_16x16x32_bf16 v[36:39], a[180:183], a[108:111], v[36:39]
    buffer_load_dwordx4 a[60:63], v231, s[28:31], s57 offen offset:1024 sc1
    v_mfma_f32_16x16x32_bf16 v[40:43], a[176:179], a[112:115], v[40:43]
    ds_read_b128 a[196:199], v233 offset:37888
    v_mfma_f32_16x16x32_bf16 v[40:43], a[180:183], a[116:119], v[40:43]
    v_mfma_f32_16x16x32_bf16 v[44:47], a[176:179], a[120:123], v[44:47]
    s_mov_b32 m0, s55
    v_mfma_f32_16x16x32_bf16 v[44:47], a[180:183], a[124:127], v[44:47]
    s_waitcnt lgkmcnt(2)
    buffer_load_dwordx4 v246, s[40:43], s58 offen sc1 lds
    v_mfma_f32_16x16x32_bf16 v[48:51], a[184:187], a[96:99], v[48:51]
    s_add_u32 s56, s52, 344064
    ds_read_b128 a[200:203], v233 offset:38912
    s_add_u32 m0, s53, 57344
    v_mfma_f32_16x16x32_bf16 v[48:51], a[188:191], a[100:103], v[48:51]
    buffer_load_dwordx4 v231, s[24:27], s56 offen offset:0 sc1 lds
    v_mfma_f32_16x16x32_bf16 v[52:55], a[184:187], a[104:107], v[52:55]
    v_mfma_f32_16x16x32_bf16 v[52:55], a[188:191], a[108:111], v[52:55]
    v_mfma_f32_16x16x32_bf16 v[56:59], a[184:187], a[112:115], v[56:59]
    ds_read_b128 a[204:207], v233 offset:39936
    v_mfma_f32_16x16x32_bf16 v[56:59], a[188:191], a[116:119], v[56:59]
    v_mfma_f32_16x16x32_bf16 v[60:63], a[184:187], a[120:123], v[60:63]
    v_mfma_f32_16x16x32_bf16 v[60:63], a[188:191], a[124:127], v[60:63]
    s_waitcnt lgkmcnt(2)
    buffer_load_dwordx4 v231, s[24:27], s56 offen offset:1024 sc1 lds
    v_mfma_f32_16x16x32_bf16 v[64:67], a[192:195], a[96:99], v[64:67]
    ds_read_b128 a[208:211], v233 offset:40960
    v_mfma_f32_16x16x32_bf16 v[64:67], a[196:199], a[100:103], v[64:67]
    v_mfma_f32_16x16x32_bf16 v[68:71], a[192:195], a[104:107], v[68:71]
    v_mfma_f32_16x16x32_bf16 v[68:71], a[196:199], a[108:111], v[68:71]
    v_mfma_f32_16x16x32_bf16 v[72:75], a[192:195], a[112:115], v[72:75]
    ds_read_b128 a[212:215], v233 offset:41984
    v_mfma_f32_16x16x32_bf16 v[72:75], a[196:199], a[116:119], v[72:75]
    buffer_load_dwordx4 v231, s[24:27], s56 offen offset:2048 sc1 lds
    v_mfma_f32_16x16x32_bf16 v[76:79], a[192:195], a[120:123], v[76:79]
    v_mfma_f32_16x16x32_bf16 v[76:79], a[196:199], a[124:127], v[76:79]
    s_waitcnt lgkmcnt(2)
    v_mfma_f32_16x16x32_bf16 v[80:83], a[200:203], a[96:99], v[80:83]
    ds_read_b128 a[160:163], v233 offset:43008
    v_mfma_f32_16x16x32_bf16 v[80:83], a[204:207], a[100:103], v[80:83]
    v_mfma_f32_16x16x32_bf16 v[84:87], a[200:203], a[104:107], v[84:87]
    v_mfma_f32_16x16x32_bf16 v[84:87], a[204:207], a[108:111], v[84:87]
    buffer_load_dwordx4 v231, s[24:27], s56 offen offset:3072 sc1 lds
    v_mfma_f32_16x16x32_bf16 v[88:91], a[200:203], a[112:115], v[88:91]
    ds_read_b128 a[164:167], v233 offset:44032
    v_mfma_f32_16x16x32_bf16 v[88:91], a[204:207], a[116:119], v[88:91]
    v_mfma_f32_16x16x32_bf16 v[92:95], a[200:203], a[120:123], v[92:95]
    v_mfma_f32_16x16x32_bf16 v[92:95], a[204:207], a[124:127], v[92:95]
    s_waitcnt lgkmcnt(2)
    v_mfma_f32_16x16x32_bf16 v[96:99], a[208:211], a[96:99], v[96:99]
    s_add_u32 s56, s52, 348160
    ds_read_b128 a[168:171], v233 offset:45056
    s_add_u32 m0, s53, 61440
    v_mfma_f32_16x16x32_bf16 v[96:99], a[212:215], a[100:103], v[96:99]
    buffer_load_dwordx4 v231, s[24:27], s56 offen offset:0 sc1 lds
    v_mfma_f32_16x16x32_bf16 v[100:103], a[208:211], a[104:107], v[100:103]
    v_mfma_f32_16x16x32_bf16 v[100:103], a[212:215], a[108:111], v[100:103]
    v_mfma_f32_16x16x32_bf16 v[104:107], a[208:211], a[112:115], v[104:107]
    ds_read_b128 a[172:175], v233 offset:46080
    v_mfma_f32_16x16x32_bf16 v[104:107], a[212:215], a[116:119], v[104:107]
    v_mfma_f32_16x16x32_bf16 v[108:111], a[208:211], a[120:123], v[108:111]
    v_mfma_f32_16x16x32_bf16 v[108:111], a[212:215], a[124:127], v[108:111]
    s_waitcnt lgkmcnt(2)
    buffer_load_dwordx4 v231, s[24:27], s56 offen offset:1024 sc1 lds
    v_mfma_f32_16x16x32_bf16 v[112:115], a[160:163], a[96:99], v[112:115]
    ds_read_b128 a[176:179], v233 offset:47104
    v_mfma_f32_16x16x32_bf16 v[112:115], a[164:167], a[100:103], v[112:115]
    v_mfma_f32_16x16x32_bf16 v[116:119], a[160:163], a[104:107], v[116:119]
    v_mfma_f32_16x16x32_bf16 v[116:119], a[164:167], a[108:111], v[116:119]
    v_mfma_f32_16x16x32_bf16 v[120:123], a[160:163], a[112:115], v[120:123]
    ds_read_b128 a[180:183], v233 offset:48128
    v_mfma_f32_16x16x32_bf16 v[120:123], a[164:167], a[116:119], v[120:123]
    buffer_load_dwordx4 v231, s[24:27], s56 offen offset:2048 sc1 lds
    v_mfma_f32_16x16x32_bf16 v[124:127], a[160:163], a[120:123], v[124:127]
    v_mfma_f32_16x16x32_bf16 v[124:127], a[164:167], a[124:127], v[124:127]
    s_waitcnt lgkmcnt(2)
    v_mfma_f32_16x16x32_bf16 v[128:131], a[168:171], a[96:99], v[128:131]
    ds_read_b128 a[184:187], v233 offset:49152
    v_mfma_f32_16x16x32_bf16 v[128:131], a[172:175], a[100:103], v[128:131]
    v_mfma_f32_16x16x32_bf16 v[132:135], a[168:171], a[104:107], v[132:135]
    s_add_u32 s57, s49, 24576
    v_mfma_f32_16x16x32_bf16 v[132:135], a[172:175], a[108:111], v[132:135]
    buffer_load_dwordx4 a[64:67], v231, s[28:31], s57 offen offset:0 sc1
    v_mfma_f32_16x16x32_bf16 v[136:139], a[168:171], a[112:115], v[136:139]
    ds_read_b128 a[188:191], v233 offset:50176
    v_mfma_f32_16x16x32_bf16 v[136:139], a[172:175], a[116:119], v[136:139]
    v_mfma_f32_16x16x32_bf16 v[140:143], a[168:171], a[120:123], v[140:143]
    v_mfma_f32_16x16x32_bf16 v[140:143], a[172:175], a[124:127], v[140:143]
    s_waitcnt lgkmcnt(2)
    v_mfma_f32_16x16x32_bf16 v[144:147], a[176:179], a[96:99], v[144:147]
    ds_read_b128 a[192:195], v233 offset:51200
    v_mfma_f32_16x16x32_bf16 v[144:147], a[180:183], a[100:103], v[144:147]
    buffer_load_dwordx4 a[68:71], v231, s[28:31], s57 offen offset:1024 sc1
    v_mfma_f32_16x16x32_bf16 v[148:151], a[176:179], a[104:107], v[148:151]
    v_mfma_f32_16x16x32_bf16 v[148:151], a[180:183], a[108:111], v[148:151]
    v_mfma_f32_16x16x32_bf16 v[152:155], a[176:179], a[112:115], v[152:155]
    ds_read_b128 a[196:199], v233 offset:52224
    v_mfma_f32_16x16x32_bf16 v[152:155], a[180:183], a[116:119], v[152:155]
    v_mfma_f32_16x16x32_bf16 v[156:159], a[176:179], a[120:123], v[156:159]
    s_add_u32 s57, s49, 57344
    v_mfma_f32_16x16x32_bf16 v[156:159], a[180:183], a[124:127], v[156:159]
    s_waitcnt lgkmcnt(2)
    buffer_load_dwordx4 a[72:75], v231, s[28:31], s57 offen offset:0 sc1
    v_mfma_f32_16x16x32_bf16 v[160:163], a[184:187], a[96:99], v[160:163]
    ds_read_b128 a[200:203], v233 offset:53248
    v_mfma_f32_16x16x32_bf16 v[160:163], a[188:191], a[100:103], v[160:163]
    v_mfma_f32_16x16x32_bf16 v[164:167], a[184:187], a[104:107], v[164:167]
    ds_read_b128 a[204:207], v233 offset:54272
    v_mfma_f32_16x16x32_bf16 v[164:167], a[188:191], a[108:111], v[164:167]
    v_mfma_f32_16x16x32_bf16 v[168:171], a[184:187], a[112:115], v[168:171]
    ds_read_b128 a[208:211], v233 offset:55296
    v_mfma_f32_16x16x32_bf16 v[168:171], a[188:191], a[116:119], v[168:171]
    buffer_load_dwordx4 a[76:79], v231, s[28:31], s57 offen offset:1024 sc1
    v_mfma_f32_16x16x32_bf16 v[172:175], a[184:187], a[120:123], v[172:175]
    ds_read_b128 a[212:215], v233 offset:56320
    v_mfma_f32_16x16x32_bf16 v[172:175], a[188:191], a[124:127], v[172:175]
    s_waitcnt lgkmcnt(4)
    v_mfma_f32_16x16x32_bf16 v[176:179], a[192:195], a[96:99], v[176:179]
    v_mfma_f32_16x16x32_bf16 v[176:179], a[196:199], a[100:103], v[176:179]
    v_mfma_f32_16x16x32_bf16 v[180:183], a[192:195], a[104:107], v[180:183]
    s_add_u32 s57, s49, 90112
    v_mfma_f32_16x16x32_bf16 v[180:183], a[196:199], a[108:111], v[180:183]
    buffer_load_dwordx4 a[80:83], v231, s[28:31], s57 offen offset:0 sc1
    v_mfma_f32_16x16x32_bf16 v[184:187], a[192:195], a[112:115], v[184:187]
    v_mfma_f32_16x16x32_bf16 v[184:187], a[196:199], a[116:119], v[184:187]
    v_mfma_f32_16x16x32_bf16 v[188:191], a[192:195], a[120:123], v[188:191]
    s_waitcnt lgkmcnt(0)
    v_mfma_f32_16x16x32_bf16 v[188:191], a[196:199], a[124:127], v[188:191]
    s_barrier
    v_mfma_f32_16x16x32_bf16 v[192:195], a[200:203], a[96:99], v[192:195]
    ds_read_b128 a[160:163], v234 offset:0
    v_mfma_f32_16x16x32_bf16 v[192:195], a[204:207], a[100:103], v[192:195]
    buffer_load_dwordx4 a[84:87], v231, s[28:31], s57 offen offset:1024 sc1
    v_mfma_f32_16x16x32_bf16 v[196:199], a[200:203], a[104:107], v[196:199]
    v_mfma_f32_16x16x32_bf16 v[196:199], a[204:207], a[108:111], v[196:199]
    v_mfma_f32_16x16x32_bf16 v[200:203], a[200:203], a[112:115], v[200:203]
    ds_read_b128 a[164:167], v234 offset:1024
    v_mfma_f32_16x16x32_bf16 v[200:203], a[204:207], a[116:119], v[200:203]
    v_mfma_f32_16x16x32_bf16 v[204:207], a[200:203], a[120:123], v[204:207]
    s_add_u32 s57, s49, 122880
    v_mfma_f32_16x16x32_bf16 v[204:207], a[204:207], a[124:127], v[204:207]
    buffer_load_dwordx4 a[88:91], v231, s[28:31], s57 offen offset:0 sc1
    v_mfma_f32_16x16x32_bf16 v[208:211], a[208:211], a[96:99], v[208:211]
    ds_read_b128 a[168:171], v234 offset:2048
    v_mfma_f32_16x16x32_bf16 v[208:211], a[212:215], a[100:103], v[208:211]
    v_mfma_f32_16x16x32_bf16 v[212:215], a[208:211], a[104:107], v[212:215]
    v_mfma_f32_16x16x32_bf16 v[212:215], a[212:215], a[108:111], v[212:215]
    v_mfma_f32_16x16x32_bf16 v[216:219], a[208:211], a[112:115], v[216:219]
    ds_read_b128 a[172:175], v234 offset:3072
    v_mfma_f32_16x16x32_bf16 v[216:219], a[212:215], a[116:119], v[216:219]
    buffer_load_dwordx4 a[92:95], v231, s[28:31], s57 offen offset:1024 sc1
    v_mfma_f32_16x16x32_bf16 v[220:223], a[208:211], a[120:123], v[220:223]
    v_mfma_f32_16x16x32_bf16 v[220:223], a[212:215], a[124:127], v[220:223]
    s_waitcnt lgkmcnt(2)
    v_mfma_f32_16x16x32_bf16 v[0:3], a[160:163], a[128:131], v[0:3]
    ds_read_b128 a[176:179], v234 offset:4096
    v_mfma_f32_16x16x32_bf16 v[0:3], a[164:167], a[132:135], v[0:3]
    v_mfma_f32_16x16x32_bf16 v[4:7], a[160:163], a[136:139], v[4:7]
    s_add_u32 s56, s52, 372736
    s_add_u32 m0, s53, 86016
    v_mfma_f32_16x16x32_bf16 v[4:7], a[164:167], a[140:143], v[4:7]
    buffer_load_dwordx4 v231, s[24:27], s56 offen offset:0 sc1 lds
    v_mfma_f32_16x16x32_bf16 v[8:11], a[160:163], a[144:147], v[8:11]
    ds_read_b128 a[180:183], v234 offset:5120
    v_mfma_f32_16x16x32_bf16 v[8:11], a[164:167], a[148:151], v[8:11]
    v_mfma_f32_16x16x32_bf16 v[12:15], a[160:163], a[152:155], v[12:15]
    v_mfma_f32_16x16x32_bf16 v[12:15], a[164:167], a[156:159], v[12:15]
    s_waitcnt lgkmcnt(2)
    v_mfma_f32_16x16x32_bf16 v[16:19], a[168:171], a[128:131], v[16:19]
    ds_read_b128 a[184:187], v234 offset:6144
    v_mfma_f32_16x16x32_bf16 v[16:19], a[172:175], a[132:135], v[16:19]
    buffer_load_dwordx4 v231, s[24:27], s56 offen offset:1024 sc1 lds
    v_mfma_f32_16x16x32_bf16 v[20:23], a[168:171], a[136:139], v[20:23]
    v_mfma_f32_16x16x32_bf16 v[20:23], a[172:175], a[140:143], v[20:23]
    v_mfma_f32_16x16x32_bf16 v[24:27], a[168:171], a[144:147], v[24:27]
    ds_read_b128 a[188:191], v234 offset:7168
    v_mfma_f32_16x16x32_bf16 v[24:27], a[172:175], a[148:151], v[24:27]
    v_mfma_f32_16x16x32_bf16 v[28:31], a[168:171], a[152:155], v[28:31]
    v_mfma_f32_16x16x32_bf16 v[28:31], a[172:175], a[156:159], v[28:31]
    s_waitcnt lgkmcnt(2)
    buffer_load_dwordx4 v231, s[24:27], s56 offen offset:2048 sc1 lds
    v_mfma_f32_16x16x32_bf16 v[32:35], a[176:179], a[128:131], v[32:35]
    ds_read_b128 a[192:195], v234 offset:8192
    v_mfma_f32_16x16x32_bf16 v[32:35], a[180:183], a[132:135], v[32:35]
    v_mfma_f32_16x16x32_bf16 v[36:39], a[176:179], a[136:139], v[36:39]
    v_mfma_f32_16x16x32_bf16 v[36:39], a[180:183], a[140:143], v[36:39]
    v_mfma_f32_16x16x32_bf16 v[40:43], a[176:179], a[144:147], v[40:43]
    ds_read_b128 a[196:199], v234 offset:9216
    v_mfma_f32_16x16x32_bf16 v[40:43], a[180:183], a[148:151], v[40:43]
    buffer_load_dwordx4 v231, s[24:27], s56 offen offset:3072 sc1 lds
    v_mfma_f32_16x16x32_bf16 v[44:47], a[176:179], a[152:155], v[44:47]
    v_mfma_f32_16x16x32_bf16 v[44:47], a[180:183], a[156:159], v[44:47]
    s_waitcnt lgkmcnt(2)
    v_mfma_f32_16x16x32_bf16 v[48:51], a[184:187], a[128:131], v[48:51]
    ds_read_b128 a[200:203], v234 offset:10240
    v_mfma_f32_16x16x32_bf16 v[48:51], a[188:191], a[132:135], v[48:51]
    v_mfma_f32_16x16x32_bf16 v[52:55], a[184:187], a[136:139], v[52:55]
    s_add_u32 s56, s52, 376832
    s_add_u32 m0, s53, 90112
    v_mfma_f32_16x16x32_bf16 v[52:55], a[188:191], a[140:143], v[52:55]
    buffer_load_dwordx4 v231, s[24:27], s56 offen offset:0 sc1 lds
    v_mfma_f32_16x16x32_bf16 v[56:59], a[184:187], a[144:147], v[56:59]
    ds_read_b128 a[204:207], v234 offset:11264
    v_mfma_f32_16x16x32_bf16 v[56:59], a[188:191], a[148:151], v[56:59]
    v_mfma_f32_16x16x32_bf16 v[60:63], a[184:187], a[152:155], v[60:63]
    v_mfma_f32_16x16x32_bf16 v[60:63], a[188:191], a[156:159], v[60:63]
    s_waitcnt lgkmcnt(2)
    v_mfma_f32_16x16x32_bf16 v[64:67], a[192:195], a[128:131], v[64:67]
    ds_read_b128 a[208:211], v234 offset:12288
    v_mfma_f32_16x16x32_bf16 v[64:67], a[196:199], a[132:135], v[64:67]
    buffer_load_dwordx4 v231, s[24:27], s56 offen offset:1024 sc1 lds
    v_mfma_f32_16x16x32_bf16 v[68:71], a[192:195], a[136:139], v[68:71]
    global_load_dword v252, v[250:251], off
    v_mfma_f32_16x16x32_bf16 v[68:71], a[196:199], a[140:143], v[68:71]
    v_mfma_f32_16x16x32_bf16 v[72:75], a[192:195], a[144:147], v[72:75]
    ds_read_b128 a[212:215], v234 offset:13312
    v_mfma_f32_16x16x32_bf16 v[72:75], a[196:199], a[148:151], v[72:75]
    v_mfma_f32_16x16x32_bf16 v[76:79], a[192:195], a[152:155], v[76:79]
    v_mfma_f32_16x16x32_bf16 v[76:79], a[196:199], a[156:159], v[76:79]
    s_waitcnt lgkmcnt(2)
    buffer_load_dwordx4 v231, s[24:27], s56 offen offset:2048 sc1 lds
    v_mfma_f32_16x16x32_bf16 v[80:83], a[200:203], a[128:131], v[80:83]
    ds_read_b128 a[160:163], v234 offset:14336
    v_mfma_f32_16x16x32_bf16 v[80:83], a[204:207], a[132:135], v[80:83]
    s_waitcnt vmcnt(23)
    v_mfma_f32_16x16x32_bf16 v[84:87], a[200:203], a[136:139], v[84:87]
    v_mfma_f32_16x16x32_bf16 v[84:87], a[204:207], a[140:143], v[84:87]
    v_mul_f32 v236, 0xba800000, v236
    v_mfma_f32_16x16x32_bf16 v[88:91], a[200:203], a[144:147], v[88:91]
    s_add_u32 s57, s49, 26624
    ds_read_b128 a[164:167], v234 offset:15360
    v_mfma_f32_16x16x32_bf16 v[88:91], a[204:207], a[148:151], v[88:91]
    buffer_load_dwordx4 a[96:99], v231, s[28:31], s57 offen offset:0 sc1
    v_mfma_f32_16x16x32_bf16 v[92:95], a[200:203], a[152:155], v[92:95]
    v_mul_f32 v237, 0x3a800000, v237
    v_mfma_f32_16x16x32_bf16 v[92:95], a[204:207], a[156:159], v[92:95]
    s_waitcnt lgkmcnt(2)
    v_mfma_f32_16x16x32_bf16 v[96:99], a[208:211], a[128:131], v[96:99]
    ds_read_b128 a[168:171], v234 offset:16384
    v_mfma_f32_16x16x32_bf16 v[96:99], a[212:215], a[132:135], v[96:99]
    v_fma_f32 v237, -v236, v236, v237
    v_mfma_f32_16x16x32_bf16 v[100:103], a[208:211], a[136:139], v[100:103]
    v_mfma_f32_16x16x32_bf16 v[100:103], a[212:215], a[140:143], v[100:103]
    buffer_load_dwordx4 a[100:103], v231, s[28:31], s57 offen offset:1024 sc1
    v_max_f32 v237, 0, v237
    v_mfma_f32_16x16x32_bf16 v[104:107], a[208:211], a[144:147], v[104:107]
    ds_read_b128 a[172:175], v234 offset:17408
    v_mfma_f32_16x16x32_bf16 v[104:107], a[212:215], a[148:151], v[104:107]
    v_mfma_f32_16x16x32_bf16 v[108:111], a[208:211], a[152:155], v[108:111]
    v_add_f32 v237, 0x3727c5ac, v237
    v_mfma_f32_16x16x32_bf16 v[108:111], a[212:215], a[156:159], v[108:111]
    s_waitcnt lgkmcnt(2)
    v_mfma_f32_16x16x32_bf16 v[112:115], a[160:163], a[128:131], v[112:115]
    s_add_u32 s57, s49, 59392
    ds_read_b128 a[176:179], v234 offset:18432
    v_mfma_f32_16x16x32_bf16 v[112:115], a[164:167], a[132:135], v[112:115]
    buffer_load_dwordx4 a[104:107], v231, s[28:31], s57 offen offset:0 sc1
    v_mul_f32 v238, 0xba800000, v238
    v_mfma_f32_16x16x32_bf16 v[116:119], a[160:163], a[136:139], v[116:119]
    v_mfma_f32_16x16x32_bf16 v[116:119], a[164:167], a[140:143], v[116:119]
    v_mul_f32 v239, 0x3a800000, v239
    v_mfma_f32_16x16x32_bf16 v[120:123], a[160:163], a[144:147], v[120:123]
    ds_read_b128 a[180:183], v234 offset:19456
    v_mfma_f32_16x16x32_bf16 v[120:123], a[164:167], a[148:151], v[120:123]
    v_mfma_f32_16x16x32_bf16 v[124:127], a[160:163], a[152:155], v[124:127]
    v_fma_f32 v239, -v238, v238, v239
    v_mfma_f32_16x16x32_bf16 v[124:127], a[164:167], a[156:159], v[124:127]
    s_waitcnt lgkmcnt(2)
    buffer_load_dwordx4 a[108:111], v231, s[28:31], s57 offen offset:1024 sc1
    v_mfma_f32_16x16x32_bf16 v[128:131], a[168:171], a[128:131], v[128:131]
    ds_read_b128 a[184:187], v234 offset:20480
    v_mfma_f32_16x16x32_bf16 v[128:131], a[172:175], a[132:135], v[128:131]
    v_max_f32 v239, 0, v239
    v_mfma_f32_16x16x32_bf16 v[132:135], a[168:171], a[136:139], v[132:135]
    v_mfma_f32_16x16x32_bf16 v[132:135], a[172:175], a[140:143], v[132:135]
    v_add_f32 v239, 0x3727c5ac, v239
    v_mfma_f32_16x16x32_bf16 v[136:139], a[168:171], a[144:147], v[136:139]
    s_add_u32 s57, s49, 92160
    ds_read_b128 a[188:191], v234 offset:21504
    v_mfma_f32_16x16x32_bf16 v[136:139], a[172:175], a[148:151], v[136:139]
    buffer_load_dwordx4 a[112:115], v231, s[28:31], s57 offen offset:0 sc1
    v_mfma_f32_16x16x32_bf16 v[140:143], a[168:171], a[152:155], v[140:143]
    v_mul_f32 v240, 0xba800000, v240
    v_mfma_f32_16x16x32_bf16 v[140:143], a[172:175], a[156:159], v[140:143]
    s_waitcnt lgkmcnt(2)
    v_mfma_f32_16x16x32_bf16 v[144:147], a[176:179], a[128:131], v[144:147]
    ds_read_b128 a[192:195], v234 offset:22528
    v_mfma_f32_16x16x32_bf16 v[144:147], a[180:183], a[132:135], v[144:147]
    v_mul_f32 v241, 0x3a800000, v241
    v_mfma_f32_16x16x32_bf16 v[148:151], a[176:179], a[136:139], v[148:151]
    v_mfma_f32_16x16x32_bf16 v[148:151], a[180:183], a[140:143], v[148:151]
    buffer_load_dwordx4 a[116:119], v231, s[28:31], s57 offen offset:1024 sc1
    v_fma_f32 v241, -v240, v240, v241
    v_mfma_f32_16x16x32_bf16 v[152:155], a[176:179], a[144:147], v[152:155]
    ds_read_b128 a[196:199], v234 offset:23552
    v_mfma_f32_16x16x32_bf16 v[152:155], a[180:183], a[148:151], v[152:155]
    v_mfma_f32_16x16x32_bf16 v[156:159], a[176:179], a[152:155], v[156:159]
    v_max_f32 v241, 0, v241
    v_mfma_f32_16x16x32_bf16 v[156:159], a[180:183], a[156:159], v[156:159]
    s_waitcnt lgkmcnt(2)
    v_mfma_f32_16x16x32_bf16 v[160:163], a[184:187], a[128:131], v[160:163]
    s_add_u32 s57, s49, 124928
    ds_read_b128 a[200:203], v234 offset:24576
    v_add_f32 v241, 0x3727c5ac, v241
    v_mfma_f32_16x16x32_bf16 v[160:163], a[188:191], a[132:135], v[160:163]
    buffer_load_dwordx4 a[120:123], v231, s[28:31], s57 offen offset:0 sc1
    v_mfma_f32_16x16x32_bf16 v[164:167], a[184:187], a[136:139], v[164:167]
    ds_read_b128 a[204:207], v234 offset:25600
    v_mfma_f32_16x16x32_bf16 v[164:167], a[188:191], a[140:143], v[164:167]
    v_mul_f32 v242, 0xba800000, v242
    v_mfma_f32_16x16x32_bf16 v[168:171], a[184:187], a[144:147], v[168:171]
    ds_read_b128 a[208:211], v234 offset:26624
    v_mfma_f32_16x16x32_bf16 v[168:171], a[188:191], a[148:151], v[168:171]
    v_mfma_f32_16x16x32_bf16 v[172:175], a[184:187], a[152:155], v[172:175]
    ds_read_b128 a[212:215], v234 offset:27648
    v_mfma_f32_16x16x32_bf16 v[172:175], a[188:191], a[156:159], v[172:175]
    s_waitcnt lgkmcnt(4)
    buffer_load_dwordx4 a[124:127], v231, s[28:31], s57 offen offset:1024 sc1
    v_mul_f32 v243, 0x3a800000, v243
    v_mfma_f32_16x16x32_bf16 v[176:179], a[192:195], a[128:131], v[176:179]
    v_mfma_f32_16x16x32_bf16 v[176:179], a[196:199], a[132:135], v[176:179]
    v_fma_f32 v243, -v242, v242, v243
    v_mfma_f32_16x16x32_bf16 v[180:183], a[192:195], a[136:139], v[180:183]
    v_mfma_f32_16x16x32_bf16 v[180:183], a[196:199], a[140:143], v[180:183]
    v_max_f32 v243, 0, v243
    v_mfma_f32_16x16x32_bf16 v[184:187], a[192:195], a[144:147], v[184:187]
    v_mfma_f32_16x16x32_bf16 v[184:187], a[196:199], a[148:151], v[184:187]
    v_add_f32 v243, 0x3727c5ac, v243
    v_mfma_f32_16x16x32_bf16 v[188:191], a[192:195], a[152:155], v[188:191]
    s_waitcnt lgkmcnt(0)
    v_mfma_f32_16x16x32_bf16 v[188:191], a[196:199], a[156:159], v[188:191]
    s_barrier
    v_mfma_f32_16x16x32_bf16 v[192:195], a[200:203], a[128:131], v[192:195]
    s_add_u32 s56, s52, 401408
    ds_read_b128 a[160:163], v232 offset:0
    s_add_u32 m0, s53, 114688
    v_mfma_f32_16x16x32_bf16 v[192:195], a[204:207], a[132:135], v[192:195]
    buffer_load_dwordx4 v231, s[24:27], s56 offen offset:0 sc1 lds
    v_lshrrev_b32 v248, 4, v235
    v_mfma_f32_16x16x32_bf16 v[196:199], a[200:203], a[136:139], v[196:199]
    v_mfma_f32_16x16x32_bf16 v[196:199], a[204:207], a[140:143], v[196:199]
    v_lshl_add_u32 v248, v248, 4, s55
    v_mfma_f32_16x16x32_bf16 v[200:203], a[200:203], a[144:147], v[200:203]
    ds_read_b128 a[164:167], v232 offset:1024
    v_mfma_f32_16x16x32_bf16 v[200:203], a[204:207], a[148:151], v[200:203]
    buffer_load_dwordx4 v231, s[24:27], s56 offen offset:1024 sc1 lds
    v_mfma_f32_16x16x32_bf16 v[204:207], a[200:203], a[152:155], v[204:207]
    v_mfma_f32_16x16x32_bf16 v[204:207], a[204:207], a[156:159], v[204:207]
    v_mfma_f32_16x16x32_bf16 v[208:211], a[208:211], a[128:131], v[208:211]
    ds_read_b128 a[168:171], v232 offset:2048
    v_mfma_f32_16x16x32_bf16 v[208:211], a[212:215], a[132:135], v[208:211]
    buffer_load_dwordx4 v231, s[24:27], s56 offen offset:2048 sc1 lds
    v_mfma_f32_16x16x32_bf16 v[212:215], a[208:211], a[136:139], v[212:215]
    v_mfma_f32_16x16x32_bf16 v[212:215], a[212:215], a[140:143], v[212:215]
    v_mfma_f32_16x16x32_bf16 v[216:219], a[208:211], a[144:147], v[216:219]
    ds_read_b128 a[172:175], v232 offset:3072
    v_mfma_f32_16x16x32_bf16 v[216:219], a[212:215], a[148:151], v[216:219]
    v_mfma_f32_16x16x32_bf16 v[220:223], a[208:211], a[152:155], v[220:223]
    v_mfma_f32_16x16x32_bf16 v[220:223], a[212:215], a[156:159], v[220:223]
    s_waitcnt lgkmcnt(2)
    buffer_load_dwordx4 v231, s[24:27], s56 offen offset:3072 sc1 lds
    ds_read_b128 v[244:247], v248 offset:448
    v_mfma_f32_16x16x32_bf16 v[0:3], a[160:163], a[0:3], v[0:3]
    ds_read_b128 a[176:179], v232 offset:4096
    v_mfma_f32_16x16x32_bf16 v[0:3], a[164:167], a[4:7], v[0:3]
    v_mfma_f32_16x16x32_bf16 v[4:7], a[160:163], a[8:11], v[4:7]
    v_mfma_f32_16x16x32_bf16 v[4:7], a[164:167], a[12:15], v[4:7]
    v_mfma_f32_16x16x32_bf16 v[8:11], a[160:163], a[16:19], v[8:11]
    s_add_u32 s56, s52, 405504
    ds_read_b128 a[180:183], v232 offset:5120
    s_add_u32 m0, s53, 118784
    v_mfma_f32_16x16x32_bf16 v[8:11], a[164:167], a[20:23], v[8:11]
    buffer_load_dwordx4 v231, s[24:27], s56 offen offset:0 sc1 lds
    s_waitcnt lgkmcnt(2)
    v_fmac_f32 v112, v244, v236
    v_mfma_f32_16x16x32_bf16 v[12:15], a[160:163], a[24:27], v[12:15]
    v_fmac_f32 v113, v245, v236
    v_fmac_f32 v114, v246, v236
    v_mfma_f32_16x16x32_bf16 v[12:15], a[164:167], a[28:31], v[12:15]
    v_fmac_f32 v115, v247, v236
    v_fmac_f32 v116, v244, v238
    v_mfma_f32_16x16x32_bf16 v[16:19], a[168:171], a[0:3], v[16:19]
    ds_read_b128 a[184:187], v232 offset:6144
    v_fmac_f32 v117, v245, v238
    v_mfma_f32_16x16x32_bf16 v[16:19], a[172:175], a[4:7], v[16:19]
    v_fmac_f32 v118, v246, v238
    v_fmac_f32 v119, v247, v238
    v_mfma_f32_16x16x32_bf16 v[20:23], a[168:171], a[8:11], v[20:23]
    v_fmac_f32 v120, v244, v240
    v_fmac_f32 v121, v245, v240
    v_mfma_f32_16x16x32_bf16 v[20:23], a[172:175], a[12:15], v[20:23]
    buffer_load_dwordx4 v231, s[24:27], s56 offen offset:1024 sc1 lds
    v_fmac_f32 v122, v246, v240
    v_mfma_f32_16x16x32_bf16 v[24:27], a[168:171], a[16:19], v[24:27]
    ds_read_b128 a[188:191], v232 offset:7168
    v_fmac_f32 v123, v247, v240
    v_mfma_f32_16x16x32_bf16 v[24:27], a[172:175], a[20:23], v[24:27]
    v_fmac_f32 v124, v244, v242
    v_fmac_f32 v125, v245, v242
    v_mfma_f32_16x16x32_bf16 v[28:31], a[168:171], a[24:27], v[28:31]
    v_fmac_f32 v126, v246, v242
    v_fmac_f32 v127, v247, v242
    v_mfma_f32_16x16x32_bf16 v[28:31], a[172:175], a[28:31], v[28:31]
    s_waitcnt lgkmcnt(2)
    ds_read_b128 v[244:247], v248 offset:576
    v_mfma_f32_16x16x32_bf16 v[32:35], a[176:179], a[0:3], v[32:35]
    ds_read_b128 a[192:195], v232 offset:8192
    v_mfma_f32_16x16x32_bf16 v[32:35], a[180:183], a[4:7], v[32:35]
    buffer_load_dwordx4 v231, s[24:27], s56 offen offset:2048 sc1 lds
    v_mfma_f32_16x16x32_bf16 v[36:39], a[176:179], a[8:11], v[36:39]
    v_mfma_f32_16x16x32_bf16 v[36:39], a[180:183], a[12:15], v[36:39]
    v_mfma_f32_16x16x32_bf16 v[40:43], a[176:179], a[16:19], v[40:43]
    ds_read_b128 a[196:199], v232 offset:9216
    s_waitcnt lgkmcnt(2)
    v_fmac_f32 v144, v244, v236
    v_mfma_f32_16x16x32_bf16 v[40:43], a[180:183], a[20:23], v[40:43]
    v_fmac_f32 v145, v245, v236
    v_fmac_f32 v146, v246, v236
    v_mfma_f32_16x16x32_bf16 v[44:47], a[176:179], a[24:27], v[44:47]
    s_add_u32 s57, s49, 28672
    v_fmac_f32 v147, v247, v236
    v_fmac_f32 v148, v244, v238
    v_mfma_f32_16x16x32_bf16 v[44:47], a[180:183], a[28:31], v[44:47]
    buffer_load_dwordx4 a[128:131], v231, s[28:31], s57 offen offset:0 sc1
    v_fmac_f32 v149, v245, v238
    v_mfma_f32_16x16x32_bf16 v[48:51], a[184:187], a[0:3], v[48:51]
    ds_read_b128 a[200:203], v232 offset:10240
    v_fmac_f32 v150, v246, v238
    v_mfma_f32_16x16x32_bf16 v[48:51], a[188:191], a[4:7], v[48:51]
    v_fmac_f32 v151, v247, v238
    v_mfma_f32_16x16x32_bf16 v[52:55], a[184:187], a[8:11], v[52:55]
    v_fmac_f32 v152, v244, v240
    v_fmac_f32 v153, v245, v240
    v_mfma_f32_16x16x32_bf16 v[52:55], a[188:191], a[12:15], v[52:55]
    v_fmac_f32 v154, v246, v240
    v_fmac_f32 v155, v247, v240
    v_mfma_f32_16x16x32_bf16 v[56:59], a[184:187], a[16:19], v[56:59]
    ds_read_b128 a[204:207], v232 offset:11264
    v_fmac_f32 v156, v244, v242
    v_mfma_f32_16x16x32_bf16 v[56:59], a[188:191], a[20:23], v[56:59]
    buffer_load_dwordx4 a[132:135], v231, s[28:31], s57 offen offset:1024 sc1
    v_fmac_f32 v157, v245, v242
    v_mfma_f32_16x16x32_bf16 v[60:63], a[184:187], a[24:27], v[60:63]
    v_fmac_f32 v158, v246, v242
    v_fmac_f32 v159, v247, v242
    v_mfma_f32_16x16x32_bf16 v[60:63], a[188:191], a[28:31], v[60:63]
    s_waitcnt lgkmcnt(2)
    ds_read_b128 v[244:247], v248 offset:704
    v_mfma_f32_16x16x32_bf16 v[64:67], a[192:195], a[0:3], v[64:67]
    ds_read_b128 a[208:211], v232 offset:12288
    v_mfma_f32_16x16x32_bf16 v[64:67], a[196:199], a[4:7], v[64:67]
    v_mfma_f32_16x16x32_bf16 v[68:71], a[192:195], a[8:11], v[68:71]
    s_add_u32 s57, s49, 61440
    v_mfma_f32_16x16x32_bf16 v[68:71], a[196:199], a[12:15], v[68:71]
    buffer_load_dwordx4 a[136:139], v231, s[28:31], s57 offen offset:0 sc1
    v_mfma_f32_16x16x32_bf16 v[72:75], a[192:195], a[16:19], v[72:75]
    ds_read_b128 a[212:215], v232 offset:13312
    s_waitcnt lgkmcnt(2)
    v_fmac_f32 v176, v244, v236
    v_mfma_f32_16x16x32_bf16 v[72:75], a[196:199], a[20:23], v[72:75]
    v_fmac_f32 v177, v245, v236
    v_fmac_f32 v178, v246, v236
    v_mfma_f32_16x16x32_bf16 v[76:79], a[192:195], a[24:27], v[76:79]
    v_fmac_f32 v179, v247, v236
    v_mfma_f32_16x16x32_bf16 v[76:79], a[196:199], a[28:31], v[76:79]
    v_fmac_f32 v180, v244, v238
    v_fmac_f32 v181, v245, v238
    v_mfma_f32_16x16x32_bf16 v[80:83], a[200:203], a[0:3], v[80:83]
    ds_read_b128 a[160:163], v232 offset:14336
    v_fmac_f32 v182, v246, v238
    v_mfma_f32_16x16x32_bf16 v[80:83], a[204:207], a[4:7], v[80:83]
    buffer_load_dwordx4 a[140:143], v231, s[28:31], s57 offen offset:1024 sc1
    v_fmac_f32 v183, v247, v238
    v_mfma_f32_16x16x32_bf16 v[84:87], a[200:203], a[8:11], v[84:87]
    v_fmac_f32 v184, v244, v240
    v_fmac_f32 v185, v245, v240
    v_mfma_f32_16x16x32_bf16 v[84:87], a[204:207], a[12:15], v[84:87]
    v_fmac_f32 v186, v246, v240
    v_fmac_f32 v187, v247, v240
    v_mfma_f32_16x16x32_bf16 v[88:91], a[200:203], a[16:19], v[88:91]
    ds_read_b128 a[164:167], v232 offset:15360
    v_mfma_f32_16x16x32_bf16 v[88:91], a[204:207], a[20:23], v[88:91]
    v_fmac_f32 v188, v244, v242
    v_fmac_f32 v189, v245, v242
    v_mfma_f32_16x16x32_bf16 v[92:95], a[200:203], a[24:27], v[92:95]
    s_add_u32 s57, s49, 94208
    v_fmac_f32 v190, v246, v242
    v_fmac_f32 v191, v247, v242
L_stub_15:
    s_cbranch_execz L_stub_18
    v_mfma_f32_16x16x32_bf16 v[92:95], a[204:207], a[28:31], v[92:95]
    s_waitcnt lgkmcnt(2)
    buffer_load_dwordx4 a[144:147], v231, s[28:31], s57 offen offset:0 sc1
    ds_read_b128 v[244:247], v248 offset:832
    v_mfma_f32_16x16x32_bf16 v[96:99], a[208:211], a[0:3], v[96:99]
    ds_read_b128 a[168:171], v232 offset:16384
    v_mfma_f32_16x16x32_bf16 v[96:99], a[212:215], a[4:7], v[96:99]
    v_mfma_f32_16x16x32_bf16 v[100:103], a[208:211], a[8:11], v[100:103]
    v_mfma_f32_16x16x32_bf16 v[100:103], a[212:215], a[12:15], v[100:103]
    v_mfma_f32_16x16x32_bf16 v[104:107], a[208:211], a[16:19], v[104:107]
    ds_read_b128 a[172:175], v232 offset:17408
    s_waitcnt lgkmcnt(2)
    v_fmac_f32 v208, v244, v236
    v_mfma_f32_16x16x32_bf16 v[104:107], a[212:215], a[20:23], v[104:107]
    buffer_load_dwordx4 a[148:151], v231, s[28:31], s57 offen offset:1024 sc1
    v_fmac_f32 v209, v245, v236
    v_mfma_f32_16x16x32_bf16 v[108:111], a[208:211], a[24:27], v[108:111]
    v_fmac_f32 v210, v246, v236
    v_fmac_f32 v211, v247, v236
    v_mfma_f32_16x16x32_bf16 v[108:111], a[212:215], a[28:31], v[108:111]
    v_fmac_f32 v212, v244, v238
    v_fmac_f32 v213, v245, v238
    v_mfma_f32_16x16x32_bf16 v[112:115], a[160:163], a[0:3], v[112:115]
    ds_read_b128 a[176:179], v232 offset:18432
    v_fmac_f32 v214, v246, v238
    v_mfma_f32_16x16x32_bf16 v[112:115], a[164:167], a[4:7], v[112:115]
    v_fmac_f32 v215, v247, v238
    v_mfma_f32_16x16x32_bf16 v[116:119], a[160:163], a[8:11], v[116:119]
    s_add_u32 s57, s49, 126976
    v_fmac_f32 v216, v244, v240
    v_fmac_f32 v217, v245, v240
    v_mfma_f32_16x16x32_bf16 v[116:119], a[164:167], a[12:15], v[116:119]
    buffer_load_dwordx4 a[152:155], v231, s[28:31], s57 offen offset:0 sc1
    v_fmac_f32 v218, v246, v240
    v_mfma_f32_16x16x32_bf16 v[120:123], a[160:163], a[16:19], v[120:123]
    ds_read_b128 a[180:183], v232 offset:19456
    v_fmac_f32 v219, v247, v240
    v_mfma_f32_16x16x32_bf16 v[120:123], a[164:167], a[20:23], v[120:123]
    v_fmac_f32 v220, v244, v242
    v_fmac_f32 v221, v245, v242
    v_mfma_f32_16x16x32_bf16 v[124:127], a[160:163], a[24:27], v[124:127]
    v_fmac_f32 v222, v246, v242
    v_fmac_f32 v223, v247, v242
    v_mfma_f32_16x16x32_bf16 v[124:127], a[164:167], a[28:31], v[124:127]
    s_waitcnt lgkmcnt(2)
    ds_read_b128 v[244:247], v248 offset:64
    v_mfma_f32_16x16x32_bf16 v[128:131], a[168:171], a[0:3], v[128:131]
    ds_read_b128 a[184:187], v232 offset:20480
    v_mfma_f32_16x16x32_bf16 v[128:131], a[172:175], a[4:7], v[128:131]
    buffer_load_dwordx4 a[156:159], v231, s[28:31], s57 offen offset:1024 sc1
    v_mfma_f32_16x16x32_bf16 v[132:135], a[168:171], a[8:11], v[132:135]
    v_mfma_f32_16x16x32_bf16 v[132:135], a[172:175], a[12:15], v[132:135]
    v_mfma_f32_16x16x32_bf16 v[136:139], a[168:171], a[16:19], v[136:139]
    ds_read_b128 a[188:191], v232 offset:21504
    s_waitcnt lgkmcnt(2)
    v_fmac_f32 v16, v244, v236
    v_mfma_f32_16x16x32_bf16 v[136:139], a[172:175], a[20:23], v[136:139]
    v_fmac_f32 v17, v245, v236
    v_fmac_f32 v18, v246, v236
    v_mfma_f32_16x16x32_bf16 v[140:143], a[168:171], a[24:27], v[140:143]
    v_fmac_f32 v19, v247, v236
    v_mfma_f32_16x16x32_bf16 v[140:143], a[172:175], a[28:31], v[140:143]
    v_fmac_f32 v20, v244, v238
    v_fmac_f32 v21, v245, v238
    v_mfma_f32_16x16x32_bf16 v[144:147], a[176:179], a[0:3], v[144:147]
    ds_read_b128 a[192:195], v232 offset:22528
    v_fmac_f32 v22, v246, v238
    v_mfma_f32_16x16x32_bf16 v[144:147], a[180:183], a[4:7], v[144:147]
    v_fmac_f32 v23, v247, v238
    v_mfma_f32_16x16x32_bf16 v[148:151], a[176:179], a[8:11], v[148:151]
    v_fmac_f32 v24, v244, v240
    v_fmac_f32 v25, v245, v240
    v_mfma_f32_16x16x32_bf16 v[148:151], a[180:183], a[12:15], v[148:151]
    v_fmac_f32 v26, v246, v240
    v_fmac_f32 v27, v247, v240
    v_mfma_f32_16x16x32_bf16 v[152:155], a[176:179], a[16:19], v[152:155]
    ds_read_b128 a[196:199], v232 offset:23552
    v_fmac_f32 v28, v244, v242
    v_mfma_f32_16x16x32_bf16 v[152:155], a[180:183], a[20:23], v[152:155]
    v_fmac_f32 v29, v245, v242
    v_mfma_f32_16x16x32_bf16 v[156:159], a[176:179], a[24:27], v[156:159]
    v_fmac_f32 v30, v246, v242
    v_fmac_f32 v31, v247, v242
    v_mfma_f32_16x16x32_bf16 v[156:159], a[180:183], a[28:31], v[156:159]
    s_waitcnt lgkmcnt(2)
    ds_read_b128 v[244:247], v248 offset:192
    v_mfma_f32_16x16x32_bf16 v[160:163], a[184:187], a[0:3], v[160:163]
    ds_read_b128 a[200:203], v232 offset:24576
    v_mfma_f32_16x16x32_bf16 v[160:163], a[188:191], a[4:7], v[160:163]
    v_mfma_f32_16x16x32_bf16 v[164:167], a[184:187], a[8:11], v[164:167]
    ds_read_b128 a[204:207], v232 offset:25600
    v_mfma_f32_16x16x32_bf16 v[164:167], a[188:191], a[12:15], v[164:167]
    v_mfma_f32_16x16x32_bf16 v[168:171], a[184:187], a[16:19], v[168:171]
    ds_read_b128 a[208:211], v232 offset:26624
    s_waitcnt lgkmcnt(3)
    v_fmac_f32 v48, v244, v236
    v_mfma_f32_16x16x32_bf16 v[168:171], a[188:191], a[20:23], v[168:171]
    v_fmac_f32 v49, v245, v236
    v_mfma_f32_16x16x32_bf16 v[172:175], a[184:187], a[24:27], v[172:175]
    ds_read_b128 a[212:215], v232 offset:27648
    v_fmac_f32 v50, v246, v236
    v_mfma_f32_16x16x32_bf16 v[172:175], a[188:191], a[28:31], v[172:175]
    v_fmac_f32 v51, v247, v236
    v_fmac_f32 v52, v244, v238
    v_mfma_f32_16x16x32_bf16 v[176:179], a[192:195], a[0:3], v[176:179]
    v_fmac_f32 v53, v245, v238
    v_mfma_f32_16x16x32_bf16 v[176:179], a[196:199], a[4:7], v[176:179]
    v_fmac_f32 v54, v246, v238
    v_fmac_f32 v55, v247, v238
    v_mfma_f32_16x16x32_bf16 v[180:183], a[192:195], a[8:11], v[180:183]
    v_fmac_f32 v56, v244, v240
    v_fmac_f32 v57, v245, v240
    v_mfma_f32_16x16x32_bf16 v[180:183], a[196:199], a[12:15], v[180:183]
    v_fmac_f32 v58, v246, v240
    v_mfma_f32_16x16x32_bf16 v[184:187], a[192:195], a[16:19], v[184:187]
    v_fmac_f32 v59, v247, v240
    v_fmac_f32 v60, v244, v242
    v_mfma_f32_16x16x32_bf16 v[184:187], a[196:199], a[20:23], v[184:187]
    v_fmac_f32 v61, v245, v242
    v_mfma_f32_16x16x32_bf16 v[188:191], a[192:195], a[24:27], v[188:191]
    s_waitcnt lgkmcnt(0)
    v_fmac_f32 v62, v246, v242
    v_fmac_f32 v63, v247, v242
    v_mfma_f32_16x16x32_bf16 v[188:191], a[196:199], a[28:31], v[188:191]
    s_barrier
    ds_read_b128 v[244:247], v248 offset:320
    v_mfma_f32_16x16x32_bf16 v[192:195], a[200:203], a[0:3], v[192:195]
    s_add_u32 s56, s52, 430080
    ds_read_b128 a[160:163], v232 offset:28672
    s_add_u32 m0, s53, 0
    v_mfma_f32_16x16x32_bf16 v[192:195], a[204:207], a[4:7], v[192:195]
    buffer_load_dwordx4 v231, s[24:27], s56 offen offset:0 sc1 lds
    v_mfma_f32_16x16x32_bf16 v[196:199], a[200:203], a[8:11], v[196:199]
    v_mfma_f32_16x16x32_bf16 v[196:199], a[204:207], a[12:15], v[196:199]
    v_mfma_f32_16x16x32_bf16 v[200:203], a[200:203], a[16:19], v[200:203]
    ds_read_b128 a[164:167], v232 offset:29696
    s_waitcnt lgkmcnt(2)
    v_fmac_f32 v80, v244, v236
    v_mfma_f32_16x16x32_bf16 v[200:203], a[204:207], a[20:23], v[200:203]
    buffer_load_dwordx4 v231, s[24:27], s56 offen offset:1024 sc1 lds
    v_fmac_f32 v81, v245, v236
    v_mfma_f32_16x16x32_bf16 v[204:207], a[200:203], a[24:27], v[204:207]
    v_fmac_f32 v82, v246, v236
    v_fmac_f32 v83, v247, v236
    v_mfma_f32_16x16x32_bf16 v[204:207], a[204:207], a[28:31], v[204:207]
    v_fmac_f32 v84, v244, v238
    v_fmac_f32 v85, v245, v238
    v_mfma_f32_16x16x32_bf16 v[208:211], a[208:211], a[0:3], v[208:211]
    ds_read_b128 a[168:171], v232 offset:30720
    v_fmac_f32 v86, v246, v238
    v_mfma_f32_16x16x32_bf16 v[208:211], a[212:215], a[4:7], v[208:211]
    buffer_load_dwordx4 v231, s[24:27], s56 offen offset:2048 sc1 lds
    v_fmac_f32 v87, v247, v238
    v_mfma_f32_16x16x32_bf16 v[212:215], a[208:211], a[8:11], v[212:215]
    v_fmac_f32 v88, v244, v240
    v_fmac_f32 v89, v245, v240
    v_mfma_f32_16x16x32_bf16 v[212:215], a[212:215], a[12:15], v[212:215]
    v_fmac_f32 v90, v246, v240
    v_fmac_f32 v91, v247, v240
    v_mfma_f32_16x16x32_bf16 v[216:219], a[208:211], a[16:19], v[216:219]
    ds_read_b128 a[172:175], v232 offset:31744
    v_fmac_f32 v92, v244, v242
    v_mfma_f32_16x16x32_bf16 v[216:219], a[212:215], a[20:23], v[216:219]
    buffer_load_dwordx4 v231, s[24:27], s56 offen offset:3072 sc1 lds
    v_fmac_f32 v93, v245, v242
    v_mfma_f32_16x16x32_bf16 v[220:223], a[208:211], a[24:27], v[220:223]
    v_fmac_f32 v94, v246, v242
    v_fmac_f32 v95, v247, v242
    v_mfma_f32_16x16x32_bf16 v[220:223], a[212:215], a[28:31], v[220:223]
    s_waitcnt lgkmcnt(2)
    ds_read_b128 v[244:247], v248 offset:512
    v_mfma_f32_16x16x32_bf16 v[0:3], a[160:163], a[32:35], v[0:3]
    s_add_u32 s56, s52, 434176
    ds_read_b128 a[176:179], v232 offset:32768
    s_add_u32 m0, s53, 4096
    v_mfma_f32_16x16x32_bf16 v[0:3], a[164:167], a[36:39], v[0:3]
    buffer_load_dwordx4 v231, s[24:27], s56 offen offset:0 sc1 lds
    v_mfma_f32_16x16x32_bf16 v[4:7], a[160:163], a[40:43], v[4:7]
    v_mfma_f32_16x16x32_bf16 v[4:7], a[164:167], a[44:47], v[4:7]
    v_mfma_f32_16x16x32_bf16 v[8:11], a[160:163], a[48:51], v[8:11]
    ds_read_b128 a[180:183], v232 offset:33792
    s_waitcnt lgkmcnt(2)
    v_fmac_f32 v128, v244, v236
    v_mfma_f32_16x16x32_bf16 v[8:11], a[164:167], a[52:55], v[8:11]
    buffer_load_dwordx4 v231, s[24:27], s56 offen offset:1024 sc1 lds
    v_fmac_f32 v129, v245, v236
    v_mfma_f32_16x16x32_bf16 v[12:15], a[160:163], a[56:59], v[12:15]
    v_fmac_f32 v130, v246, v236
    v_fmac_f32 v131, v247, v236
    v_mfma_f32_16x16x32_bf16 v[12:15], a[164:167], a[60:63], v[12:15]
    v_fmac_f32 v132, v244, v238
    v_fmac_f32 v133, v245, v238
    v_mfma_f32_16x16x32_bf16 v[16:19], a[168:171], a[32:35], v[16:19]
    ds_read_b128 a[184:187], v232 offset:34816
    v_fmac_f32 v134, v246, v238
    v_mfma_f32_16x16x32_bf16 v[16:19], a[172:175], a[36:39], v[16:19]
    buffer_load_dwordx4 v231, s[24:27], s56 offen offset:2048 sc1 lds
    v_fmac_f32 v135, v247, v238
    v_mfma_f32_16x16x32_bf16 v[20:23], a[168:171], a[40:43], v[20:23]
    v_fmac_f32 v136, v244, v240
    v_fmac_f32 v137, v245, v240
    v_mfma_f32_16x16x32_bf16 v[20:23], a[172:175], a[44:47], v[20:23]
    v_fmac_f32 v138, v246, v240
    v_fmac_f32 v139, v247, v240
    v_mfma_f32_16x16x32_bf16 v[24:27], a[168:171], a[48:51], v[24:27]
    s_add_u32 s57, s49, 30720
    ds_read_b128 a[188:191], v232 offset:35840
    v_fmac_f32 v140, v244, v242
    v_mfma_f32_16x16x32_bf16 v[24:27], a[172:175], a[52:55], v[24:27]
    buffer_load_dwordx4 a[0:3], v231, s[28:31], s57 offen offset:0 sc1
    v_fmac_f32 v141, v245, v242
    v_mfma_f32_16x16x32_bf16 v[28:31], a[168:171], a[56:59], v[28:31]
    v_fmac_f32 v142, v246, v242
    v_fmac_f32 v143, v247, v242
    v_mfma_f32_16x16x32_bf16 v[28:31], a[172:175], a[60:63], v[28:31]
    s_waitcnt lgkmcnt(2)
    ds_read_b128 v[244:247], v248 offset:640
    v_mfma_f32_16x16x32_bf16 v[32:35], a[176:179], a[32:35], v[32:35]
    ds_read_b128 a[192:195], v232 offset:36864
    v_mfma_f32_16x16x32_bf16 v[32:35], a[180:183], a[36:39], v[32:35]
    buffer_load_dwordx4 a[4:7], v231, s[28:31], s57 offen offset:1024 sc1
    v_mfma_f32_16x16x32_bf16 v[36:39], a[176:179], a[40:43], v[36:39]
    v_mfma_f32_16x16x32_bf16 v[36:39], a[180:183], a[44:47], v[36:39]
    v_mfma_f32_16x16x32_bf16 v[40:43], a[176:179], a[48:51], v[40:43]
    s_add_u32 s57, s49, 63488
    ds_read_b128 a[196:199], v232 offset:37888
    s_waitcnt lgkmcnt(2)
    v_fmac_f32 v160, v244, v236
    v_mfma_f32_16x16x32_bf16 v[40:43], a[180:183], a[52:55], v[40:43]
    buffer_load_dwordx4 a[8:11], v231, s[28:31], s57 offen offset:0 sc1
    v_fmac_f32 v161, v245, v236
    v_mfma_f32_16x16x32_bf16 v[44:47], a[176:179], a[56:59], v[44:47]
    v_fmac_f32 v162, v246, v236
    v_fmac_f32 v163, v247, v236
    v_mfma_f32_16x16x32_bf16 v[44:47], a[180:183], a[60:63], v[44:47]
    v_fmac_f32 v164, v244, v238
    v_fmac_f32 v165, v245, v238
    v_mfma_f32_16x16x32_bf16 v[48:51], a[184:187], a[32:35], v[48:51]
    ds_read_b128 a[200:203], v232 offset:38912
    v_fmac_f32 v166, v246, v238
    v_mfma_f32_16x16x32_bf16 v[48:51], a[188:191], a[36:39], v[48:51]
    buffer_load_dwordx4 a[12:15], v231, s[28:31], s57 offen offset:1024 sc1
    v_fmac_f32 v167, v247, v238
    v_mfma_f32_16x16x32_bf16 v[52:55], a[184:187], a[40:43], v[52:55]
    v_fmac_f32 v168, v244, v240
    v_fmac_f32 v169, v245, v240
    v_mfma_f32_16x16x32_bf16 v[52:55], a[188:191], a[44:47], v[52:55]
    v_fmac_f32 v170, v246, v240
    v_fmac_f32 v171, v247, v240
    v_mfma_f32_16x16x32_bf16 v[56:59], a[184:187], a[48:51], v[56:59]
    s_add_u32 s57, s49, 96256
    ds_read_b128 a[204:207], v232 offset:39936
    v_fmac_f32 v172, v244, v242
    v_mfma_f32_16x16x32_bf16 v[56:59], a[188:191], a[52:55], v[56:59]
    buffer_load_dwordx4 a[16:19], v231, s[28:31], s57 offen offset:0 sc1
    v_fmac_f32 v173, v245, v242
    v_mfma_f32_16x16x32_bf16 v[60:63], a[184:187], a[56:59], v[60:63]
    v_fmac_f32 v174, v246, v242
    v_fmac_f32 v175, v247, v242
    v_mfma_f32_16x16x32_bf16 v[60:63], a[188:191], a[60:63], v[60:63]
    s_waitcnt lgkmcnt(2)
    ds_read_b128 v[244:247], v248 offset:768
    v_mfma_f32_16x16x32_bf16 v[64:67], a[192:195], a[32:35], v[64:67]
    ds_read_b128 a[208:211], v232 offset:40960
    v_mfma_f32_16x16x32_bf16 v[64:67], a[196:199], a[36:39], v[64:67]
    buffer_load_dwordx4 a[20:23], v231, s[28:31], s57 offen offset:1024 sc1
    v_mfma_f32_16x16x32_bf16 v[68:71], a[192:195], a[40:43], v[68:71]
    v_and_b32 v226, 15, v235
    v_mfma_f32_16x16x32_bf16 v[68:71], a[196:199], a[44:47], v[68:71]
    v_mfma_f32_16x16x32_bf16 v[72:75], a[192:195], a[48:51], v[72:75]
    s_add_u32 s57, s49, 129024
    ds_read_b128 a[212:215], v232 offset:41984
    s_waitcnt lgkmcnt(2)
    v_fmac_f32 v192, v244, v236
    v_mfma_f32_16x16x32_bf16 v[72:75], a[196:199], a[52:55], v[72:75]
    buffer_load_dwordx4 a[24:27], v231, s[28:31], s57 offen offset:0 sc1
    v_fmac_f32 v193, v245, v236
    v_mfma_f32_16x16x32_bf16 v[76:79], a[192:195], a[56:59], v[76:79]
    v_lshlrev_b32 v226, 10, v226
    v_fmac_f32 v194, v246, v236
    v_mfma_f32_16x16x32_bf16 v[76:79], a[196:199], a[60:63], v[76:79]
    v_fmac_f32 v195, v247, v236
    v_fmac_f32 v196, v244, v238
    v_mfma_f32_16x16x32_bf16 v[80:83], a[200:203], a[32:35], v[80:83]
    ds_read_b128 a[160:163], v232 offset:43008
    v_fmac_f32 v197, v245, v238
    v_mfma_f32_16x16x32_bf16 v[80:83], a[204:207], a[36:39], v[80:83]
    v_fmac_f32 v198, v246, v238
    v_fmac_f32 v199, v247, v238
    v_fmac_f32 v200, v244, v240
    v_mfma_f32_16x16x32_bf16 v[84:87], a[200:203], a[40:43], v[84:87]
    s_mov_b32 s73, 81920
    v_fmac_f32 v201, v245, v240
    v_fmac_f32 v202, v246, v240
    v_mfma_f32_16x16x32_bf16 v[84:87], a[204:207], a[44:47], v[84:87]
    buffer_load_dwordx4 a[28:31], v231, s[28:31], s57 offen offset:1024 sc1
    v_fmac_f32 v203, v247, v240
    v_mfma_f32_16x16x32_bf16 v[88:91], a[200:203], a[48:51], v[88:91]
    ds_read_b128 a[164:167], v232 offset:44032
    v_fmac_f32 v204, v244, v242
    v_mfma_f32_16x16x32_bf16 v[88:91], a[204:207], a[52:55], v[88:91]
    buffer_load_dword v227, v226, s[88:91], s73 offen sc1
    v_fmac_f32 v205, v245, v242
    v_mfma_f32_16x16x32_bf16 v[92:95], a[200:203], a[56:59], v[92:95]
    v_fmac_f32 v206, v246, v242
    v_fmac_f32 v207, v247, v242
    v_mfma_f32_16x16x32_bf16 v[92:95], a[204:207], a[60:63], v[92:95]
    s_waitcnt lgkmcnt(2)
    ds_read_b128 v[244:247], v248 offset:0
    v_mfma_f32_16x16x32_bf16 v[96:99], a[208:211], a[32:35], v[96:99]
    ds_read_b128 a[168:171], v232 offset:45056
    v_mfma_f32_16x16x32_bf16 v[96:99], a[212:215], a[36:39], v[96:99]
    v_mfma_f32_16x16x32_bf16 v[100:103], a[208:211], a[40:43], v[100:103]
    v_mfma_f32_16x16x32_bf16 v[100:103], a[212:215], a[44:47], v[100:103]
    v_mfma_f32_16x16x32_bf16 v[104:107], a[208:211], a[48:51], v[104:107]
    ds_read_b128 a[172:175], v232 offset:46080
    s_waitcnt lgkmcnt(2)
    v_fmac_f32 v0, v244, v236
    v_mfma_f32_16x16x32_bf16 v[104:107], a[212:215], a[52:55], v[104:107]
    v_fmac_f32 v1, v245, v236
    v_fmac_f32 v2, v246, v236
    v_mfma_f32_16x16x32_bf16 v[108:111], a[208:211], a[56:59], v[108:111]
    v_fmac_f32 v3, v247, v236
    v_mfma_f32_16x16x32_bf16 v[108:111], a[212:215], a[60:63], v[108:111]
    v_fmac_f32 v4, v244, v238
    v_fmac_f32 v5, v245, v238
    v_mfma_f32_16x16x32_bf16 v[112:115], a[160:163], a[32:35], v[112:115]
    ds_read_b128 a[176:179], v232 offset:47104
    v_fmac_f32 v6, v246, v238
    v_mfma_f32_16x16x32_bf16 v[112:115], a[164:167], a[36:39], v[112:115]
    v_fmac_f32 v7, v247, v238
    v_mfma_f32_16x16x32_bf16 v[116:119], a[160:163], a[40:43], v[116:119]
    v_fmac_f32 v8, v244, v240
    v_fmac_f32 v9, v245, v240
    v_mfma_f32_16x16x32_bf16 v[116:119], a[164:167], a[44:47], v[116:119]
    v_fmac_f32 v10, v246, v240
    v_fmac_f32 v11, v247, v240
    v_mfma_f32_16x16x32_bf16 v[120:123], a[160:163], a[48:51], v[120:123]
    ds_read_b128 a[180:183], v232 offset:48128
    v_fmac_f32 v12, v244, v242
    v_mfma_f32_16x16x32_bf16 v[120:123], a[164:167], a[52:55], v[120:123]
    v_fmac_f32 v13, v245, v242
    v_mfma_f32_16x16x32_bf16 v[124:127], a[160:163], a[56:59], v[124:127]
    v_fmac_f32 v14, v246, v242
    v_fmac_f32 v15, v247, v242
    v_mfma_f32_16x16x32_bf16 v[124:127], a[164:167], a[60:63], v[124:127]
    s_waitcnt lgkmcnt(2)
    ds_read_b128 v[244:247], v248 offset:128
    v_mfma_f32_16x16x32_bf16 v[128:131], a[168:171], a[32:35], v[128:131]
    ds_read_b128 a[184:187], v232 offset:49152
    v_mfma_f32_16x16x32_bf16 v[128:131], a[172:175], a[36:39], v[128:131]
    v_mfma_f32_16x16x32_bf16 v[132:135], a[168:171], a[40:43], v[132:135]
    v_mfma_f32_16x16x32_bf16 v[132:135], a[172:175], a[44:47], v[132:135]
    v_mfma_f32_16x16x32_bf16 v[136:139], a[168:171], a[48:51], v[136:139]
    ds_read_b128 a[188:191], v232 offset:50176
    s_waitcnt lgkmcnt(2)
    v_fmac_f32 v32, v244, v236
    v_mfma_f32_16x16x32_bf16 v[136:139], a[172:175], a[52:55], v[136:139]
    v_fmac_f32 v33, v245, v236
    v_fmac_f32 v34, v246, v236
    v_mfma_f32_16x16x32_bf16 v[140:143], a[168:171], a[56:59], v[140:143]
    v_fmac_f32 v35, v247, v236
    v_mfma_f32_16x16x32_bf16 v[140:143], a[172:175], a[60:63], v[140:143]
    v_fmac_f32 v36, v244, v238
    v_fmac_f32 v37, v245, v238
    v_mfma_f32_16x16x32_bf16 v[144:147], a[176:179], a[32:35], v[144:147]
    ds_read_b128 a[192:195], v232 offset:51200
    v_fmac_f32 v38, v246, v238
    v_mfma_f32_16x16x32_bf16 v[144:147], a[180:183], a[36:39], v[144:147]
    v_fmac_f32 v39, v247, v238
    v_mfma_f32_16x16x32_bf16 v[148:151], a[176:179], a[40:43], v[148:151]
    v_fmac_f32 v40, v244, v240
    v_fmac_f32 v41, v245, v240
    v_mfma_f32_16x16x32_bf16 v[148:151], a[180:183], a[44:47], v[148:151]
    v_fmac_f32 v42, v246, v240
    v_fmac_f32 v43, v247, v240
    v_mfma_f32_16x16x32_bf16 v[152:155], a[176:179], a[48:51], v[152:155]
    ds_read_b128 a[196:199], v232 offset:52224
    v_fmac_f32 v44, v244, v242
    v_mfma_f32_16x16x32_bf16 v[152:155], a[180:183], a[52:55], v[152:155]
    v_fmac_f32 v45, v245, v242
    v_mfma_f32_16x16x32_bf16 v[156:159], a[176:179], a[56:59], v[156:159]
    v_fmac_f32 v46, v246, v242
    v_fmac_f32 v47, v247, v242
    v_mfma_f32_16x16x32_bf16 v[156:159], a[180:183], a[60:63], v[156:159]
    s_waitcnt lgkmcnt(2)
    ds_read_b128 v[244:247], v248 offset:256
    v_mfma_f32_16x16x32_bf16 v[160:163], a[184:187], a[32:35], v[160:163]
    ds_read_b128 a[200:203], v232 offset:53248
    v_mfma_f32_16x16x32_bf16 v[160:163], a[188:191], a[36:39], v[160:163]
    v_mfma_f32_16x16x32_bf16 v[164:167], a[184:187], a[40:43], v[164:167]
    ds_read_b128 a[204:207], v232 offset:54272
    v_mfma_f32_16x16x32_bf16 v[164:167], a[188:191], a[44:47], v[164:167]
    v_mfma_f32_16x16x32_bf16 v[168:171], a[184:187], a[48:51], v[168:171]
    ds_read_b128 a[208:211], v232 offset:55296
    s_waitcnt lgkmcnt(3)
    v_fmac_f32 v64, v244, v236
    v_mfma_f32_16x16x32_bf16 v[168:171], a[188:191], a[52:55], v[168:171]
    v_fmac_f32 v65, v245, v236
    v_mfma_f32_16x16x32_bf16 v[172:175], a[184:187], a[56:59], v[172:175]
    ds_read_b128 a[212:215], v232 offset:56320
    v_fmac_f32 v66, v246, v236
    v_mfma_f32_16x16x32_bf16 v[172:175], a[188:191], a[60:63], v[172:175]
    v_fmac_f32 v67, v247, v236
    v_fmac_f32 v68, v244, v238
    v_mfma_f32_16x16x32_bf16 v[176:179], a[192:195], a[32:35], v[176:179]
    v_fmac_f32 v69, v245, v238
    v_mfma_f32_16x16x32_bf16 v[176:179], a[196:199], a[36:39], v[176:179]
    v_fmac_f32 v70, v246, v238
    v_fmac_f32 v71, v247, v238
    v_mfma_f32_16x16x32_bf16 v[180:183], a[192:195], a[40:43], v[180:183]
    v_fmac_f32 v72, v244, v240
    v_fmac_f32 v73, v245, v240
    v_mfma_f32_16x16x32_bf16 v[180:183], a[196:199], a[44:47], v[180:183]
    v_fmac_f32 v74, v246, v240
    v_mfma_f32_16x16x32_bf16 v[184:187], a[192:195], a[48:51], v[184:187]
    v_fmac_f32 v75, v247, v240
    v_fmac_f32 v76, v244, v242
    v_mfma_f32_16x16x32_bf16 v[184:187], a[196:199], a[52:55], v[184:187]
    v_fmac_f32 v77, v245, v242
    v_mfma_f32_16x16x32_bf16 v[188:191], a[192:195], a[56:59], v[188:191]
    s_waitcnt lgkmcnt(0)
    v_fmac_f32 v78, v246, v242
    v_fmac_f32 v79, v247, v242
    v_mfma_f32_16x16x32_bf16 v[188:191], a[196:199], a[60:63], v[188:191]
    s_waitcnt vmcnt(1)
    s_barrier
    ds_read_b128 v[244:247], v248 offset:384
    v_mfma_f32_16x16x32_bf16 v[192:195], a[200:203], a[32:35], v[192:195]
    ds_read_b128 a[160:163], v233 offset:0
    v_mfma_f32_16x16x32_bf16 v[192:195], a[204:207], a[36:39], v[192:195]
    v_mfma_f32_16x16x32_bf16 v[196:199], a[200:203], a[40:43], v[196:199]
    v_mfma_f32_16x16x32_bf16 v[196:199], a[204:207], a[44:47], v[196:199]
    v_mfma_f32_16x16x32_bf16 v[200:203], a[200:203], a[48:51], v[200:203]
    ds_read_b128 a[164:167], v233 offset:1024
    s_waitcnt lgkmcnt(2)
    v_fmac_f32 v96, v244, v236
    v_mfma_f32_16x16x32_bf16 v[200:203], a[204:207], a[52:55], v[200:203]
    v_fmac_f32 v97, v245, v236
    v_fmac_f32 v98, v246, v236
    v_mfma_f32_16x16x32_bf16 v[204:207], a[200:203], a[56:59], v[204:207]
    v_fmac_f32 v99, v247, v236
    v_mfma_f32_16x16x32_bf16 v[204:207], a[204:207], a[60:63], v[204:207]
    v_fmac_f32 v100, v244, v238
    v_fmac_f32 v101, v245, v238
    v_mfma_f32_16x16x32_bf16 v[208:211], a[208:211], a[32:35], v[208:211]
    ds_read_b128 a[168:171], v233 offset:28672
    v_fmac_f32 v102, v246, v238
    v_mfma_f32_16x16x32_bf16 v[208:211], a[212:215], a[36:39], v[208:211]
    v_fmac_f32 v103, v247, v238
    v_mfma_f32_16x16x32_bf16 v[212:215], a[208:211], a[40:43], v[212:215]
    v_fmac_f32 v104, v244, v240
    v_fmac_f32 v105, v245, v240
    v_mfma_f32_16x16x32_bf16 v[212:215], a[212:215], a[44:47], v[212:215]
    v_fmac_f32 v106, v246, v240
    v_fmac_f32 v107, v247, v240
    v_mfma_f32_16x16x32_bf16 v[216:219], a[208:211], a[48:51], v[216:219]
    ds_read_b128 a[172:175], v233 offset:29696
    v_fmac_f32 v108, v244, v242
    v_mfma_f32_16x16x32_bf16 v[216:219], a[212:215], a[52:55], v[216:219]
    v_fmac_f32 v109, v245, v242
    v_mfma_f32_16x16x32_bf16 v[220:223], a[208:211], a[56:59], v[220:223]
    v_fmac_f32 v110, v246, v242
    v_fmac_f32 v111, v247, v242
    v_mfma_f32_16x16x32_bf16 v[220:223], a[212:215], a[60:63], v[220:223]
    s_waitcnt lgkmcnt(2)
    v_mfma_f32_16x16x32_bf16 v[0:3], a[160:163], a[64:67], v[0:3]
    ds_read_b128 a[176:179], v234 offset:0
    v_mfma_f32_16x16x32_bf16 v[0:3], a[164:167], a[68:71], v[0:3]
    v_mfma_f32_16x16x32_bf16 v[4:7], a[160:163], a[72:75], v[4:7]
    v_rsq_f32 v236, v237
    v_mfma_f32_16x16x32_bf16 v[4:7], a[164:167], a[76:79], v[4:7]
    s_bfe_u32 s54, s44, 0x10000
    v_mfma_f32_16x16x32_bf16 v[8:11], a[160:163], a[80:83], v[8:11]
    s_xor_b32 s54, s54, 0
    ds_read_b128 a[180:183], v234 offset:1024
    v_mfma_f32_16x16x32_bf16 v[8:11], a[164:167], a[84:87], v[8:11]
    v_rsq_f32 v238, v239
    v_mfma_f32_16x16x32_bf16 v[12:15], a[160:163], a[88:91], v[12:15]
    s_bfe_u32 s46, s44, 0x10001
    s_xor_b32 s46, s46, 0
    v_mfma_f32_16x16x32_bf16 v[12:15], a[164:167], a[92:95], v[12:15]
    s_waitcnt lgkmcnt(2)
    s_lshl_b32 s46, s46, 3
    v_mfma_f32_16x16x32_bf16 v[0:3], a[168:171], a[96:99], v[0:3]
    s_and_b32 s47, s45, 7
    ds_read_b128 a[184:187], v232 offset:0
    v_mfma_f32_16x16x32_bf16 v[0:3], a[172:175], a[100:103], v[0:3]
    v_rsq_f32 v240, v241
    v_mfma_f32_16x16x32_bf16 v[4:7], a[168:171], a[104:107], v[4:7]
    s_add_u32 s46, s46, s47
    v_mfma_f32_16x16x32_bf16 v[4:7], a[172:175], a[108:111], v[4:7]
    s_bfe_u32 s47, s44, 0x10002
    v_mfma_f32_16x16x32_bf16 v[8:11], a[168:171], a[112:115], v[8:11]
    s_lshl_b32 s47, s47, 2
    ds_read_b128 a[188:191], v232 offset:1024
    v_mfma_f32_16x16x32_bf16 v[8:11], a[172:175], a[116:119], v[8:11]
    v_rsq_f32 v242, v243
    v_mfma_f32_16x16x32_bf16 v[12:15], a[168:171], a[120:123], v[12:15]
    s_lshr_b32 s48, s45, 3
    s_add_u32 s47, s47, s48
    v_mfma_f32_16x16x32_bf16 v[12:15], a[172:175], a[124:127], v[12:15]
    s_waitcnt lgkmcnt(2)
    v_and_b32 v244, 31, v235
    v_mfma_f32_16x16x32_bf16 v[0:3], a[176:179], a[128:131], v[0:3]
    ds_read_b128 a[192:195], v233 offset:14336
    v_lshlrev_b32 v224, 4, v235
    v_mfma_f32_16x16x32_bf16 v[0:3], a[180:183], a[132:135], v[0:3]
    v_lshlrev_b32 v244, 4, v244
    v_lshlrev_b32 v231, 4, v235
    v_mfma_f32_16x16x32_bf16 v[4:7], a[176:179], a[136:139], v[4:7]
    v_bfe_u32 v245, v244, 7, 2
    v_mfma_f32_16x16x32_bf16 v[4:7], a[180:183], a[140:143], v[4:7]
    s_lshl_b32 s93, s47, 1
    s_add_u32 s93, s93, s54
    v_mfma_f32_16x16x32_bf16 v[8:11], a[176:179], a[144:147], v[8:11]
    s_lshl_b32 s53, s3, 11
    ds_read_b128 a[196:199], v233 offset:15360
    v_mfma_f32_16x16x32_bf16 v[8:11], a[180:183], a[148:151], v[8:11]
    v_add_u32 v245, 1, v245
    v_mfma_f32_16x16x32_bf16 v[12:15], a[176:179], a[152:155], v[12:15]
    s_mul_i32 s51, s54, 229376
    v_lshrrev_b32 v245, 2, v245
    v_mfma_f32_16x16x32_bf16 v[12:15], a[180:183], a[156:159], v[12:15]
    s_waitcnt lgkmcnt(2)
    s_add_u32 s51, s51, s53
    v_mfma_f32_16x16x32_bf16 v[0:3], a[184:187], a[0:3], v[0:3]
    ds_read_b128 a[200:203], v233 offset:43008
    v_mul_u32_u24 v245, 16776832, v245
    v_mfma_f32_16x16x32_bf16 v[0:3], a[188:191], a[4:7], v[0:3]
    s_mul_i32 s52, s93, 458752
    s_add_u32 s52, s52, s51
    v_mfma_f32_16x16x32_bf16 v[4:7], a[184:187], a[8:11], v[4:7]
    v_add_u32 v244, v244, v245
    v_mfma_f32_16x16x32_bf16 v[4:7], a[188:191], a[12:15], v[4:7]
    s_xor_b32 s55, s93, 1
    v_lshrrev_b32 v245, 5, v235
    v_mfma_f32_16x16x32_bf16 v[8:11], a[184:187], a[16:19], v[8:11]
    s_mul_i32 s55, s55, 458752
    ds_read_b128 a[204:207], v233 offset:44032
    v_mfma_f32_16x16x32_bf16 v[8:11], a[188:191], a[20:23], v[8:11]
    s_add_u32 s55, s55, s51
    v_mul_u32_u24 v245, 114688, v245
    v_mfma_f32_16x16x32_bf16 v[12:15], a[184:187], a[24:27], v[12:15]
    v_bfe_u32 v225, v224, 7, 2
    v_mfma_f32_16x16x32_bf16 v[12:15], a[188:191], a[28:31], v[12:15]
    s_waitcnt lgkmcnt(2)
    v_add_u32 v244, v244, v245
    v_add_u32 v225, 1, v225
    v_mfma_f32_16x16x32_bf16 v[112:115], a[192:195], a[64:67], v[112:115]
    ds_read_b128 a[208:211], v234 offset:14336
    v_mfma_f32_16x16x32_bf16 v[112:115], a[196:199], a[68:71], v[112:115]
    v_mul_f32 v236, 0xbfb8aa3b, v236
    v_lshrrev_b32 v225, 2, v225
    v_mfma_f32_16x16x32_bf16 v[116:119], a[192:195], a[72:75], v[116:119]
    s_waitcnt vmcnt(0)
    v_cmp_gt_u32 vcc, 16, v227
    v_mul_u32_u24 v225, 16776832, v225
    v_mfma_f32_16x16x32_bf16 v[116:119], a[196:199], a[76:79], v[116:119]
    v_mul_f32 v238, 0xbfb8aa3b, v238
    v_mfma_f32_16x16x32_bf16 v[120:123], a[192:195], a[80:83], v[120:123]
    ds_read_b128 a[212:215], v234 offset:15360
    v_add_u32 v224, v224, v225
    v_mfma_f32_16x16x32_bf16 v[120:123], a[196:199], a[84:87], v[120:123]
    v_mul_f32 v240, 0xbfb8aa3b, v240
    v_mfma_f32_16x16x32_bf16 v[124:127], a[192:195], a[88:91], v[124:127]
    s_cbranch_vccnz L_sequential_preLN__softmax_full_mha__glu_gated_swiglu__prompt_kernel_gspin_22
L_sequential_preLN__softmax_full_mha__glu_gated_swiglu__prompt_kernel_gspin_22_r:
    s_add_u32 s24, s22, 39845888
    s_addc_u32 s25, s23, 0
    v_mfma_f32_16x16x32_bf16 v[124:127], a[196:199], a[92:95], v[124:127]
    s_waitcnt lgkmcnt(2)
    s_mov_b32 s26, 24117248
    v_mul_f32 v242, 0xbfb8aa3b, v242
    v_mfma_f32_16x16x32_bf16 v[112:115], a[200:203], a[96:99], v[112:115]
    ds_read_b128 a[160:163], v232 offset:14336
    v_mfma_f32_16x16x32_bf16 v[112:115], a[204:207], a[100:103], v[112:115]
    v_mfma_f32_16x16x32_bf16 v[116:119], a[200:203], a[104:107], v[116:119]
    v_mfma_f32_16x16x32_bf16 v[116:119], a[204:207], a[108:111], v[116:119]
    v_mfma_f32_16x16x32_bf16 v[120:123], a[200:203], a[112:115], v[120:123]
    ds_read_b128 a[164:167], v232 offset:15360
    v_mfma_f32_16x16x32_bf16 v[120:123], a[204:207], a[116:119], v[120:123]
    v_mfma_f32_16x16x32_bf16 v[124:127], a[200:203], a[120:123], v[124:127]
    v_mfma_f32_16x16x32_bf16 v[124:127], a[204:207], a[124:127], v[124:127]
    s_waitcnt lgkmcnt(2)
    s_add_u32 s56, s52, 0
    v_mfma_f32_16x16x32_bf16 v[112:115], a[208:211], a[128:131], v[112:115]
    s_add_u32 m0, s53, 32768
    ds_read_b128 a[168:171], v233 offset:2048
    v_mfma_f32_16x16x32_bf16 v[112:115], a[212:215], a[132:135], v[112:115]
    buffer_load_dwordx4 v224, s[24:27], s56 offen offset:0 sc1 lds
    v_mfma_f32_16x16x32_bf16 v[116:119], a[208:211], a[136:139], v[116:119]
    v_mfma_f32_16x16x32_bf16 v[116:119], a[212:215], a[140:143], v[116:119]
    v_mfma_f32_16x16x32_bf16 v[120:123], a[208:211], a[144:147], v[120:123]
    ds_read_b128 a[172:175], v233 offset:3072
    v_mfma_f32_16x16x32_bf16 v[120:123], a[212:215], a[148:151], v[120:123]
    buffer_load_dwordx4 v224, s[24:27], s56 offen offset:1024 sc1 lds
    v_mfma_f32_16x16x32_bf16 v[124:127], a[208:211], a[152:155], v[124:127]
    v_mfma_f32_16x16x32_bf16 v[124:127], a[212:215], a[156:159], v[124:127]
    s_waitcnt lgkmcnt(2)
    s_add_u32 s56, s55, 0
    v_mfma_f32_16x16x32_bf16 v[112:115], a[160:163], a[0:3], v[112:115]
    s_add_u32 m0, s53, 40960
    ds_read_b128 a[176:179], v233 offset:30720
    v_mfma_f32_16x16x32_bf16 v[112:115], a[164:167], a[4:7], v[112:115]
    buffer_load_dwordx4 v224, s[24:27], s56 offen offset:0 sc1 lds
    v_mfma_f32_16x16x32_bf16 v[116:119], a[160:163], a[8:11], v[116:119]
    v_mfma_f32_16x16x32_bf16 v[116:119], a[164:167], a[12:15], v[116:119]
    v_mfma_f32_16x16x32_bf16 v[120:123], a[160:163], a[16:19], v[120:123]
    ds_read_b128 a[180:183], v233 offset:31744
    v_mfma_f32_16x16x32_bf16 v[120:123], a[164:167], a[20:23], v[120:123]
    buffer_load_dwordx4 v224, s[24:27], s56 offen offset:1024 sc1 lds
    v_mfma_f32_16x16x32_bf16 v[124:127], a[160:163], a[24:27], v[124:127]
    v_mfma_f32_16x16x32_bf16 v[124:127], a[164:167], a[28:31], v[124:127]
    s_waitcnt lgkmcnt(2)
    s_add_u32 s56, s52, 8192
    v_mfma_f32_16x16x32_bf16 v[16:19], a[168:171], a[64:67], v[16:19]
    s_add_u32 m0, s53, 49152
    ds_read_b128 a[184:187], v234 offset:2048
    v_mfma_f32_16x16x32_bf16 v[16:19], a[172:175], a[68:71], v[16:19]
    buffer_load_dwordx4 v224, s[24:27], s56 offen offset:0 sc1 lds
    v_mfma_f32_16x16x32_bf16 v[20:23], a[168:171], a[72:75], v[20:23]
    v_mul_f32 v112, v112, v0
    v_mul_f32 v113, v113, v1
    v_mul_f32 v114, v114, v2
    v_mfma_f32_16x16x32_bf16 v[20:23], a[172:175], a[76:79], v[20:23]
    v_mul_f32 v115, v115, v3
    v_mul_f32 v0, v0, v236
    v_mfma_f32_16x16x32_bf16 v[24:27], a[168:171], a[80:83], v[24:27]
    ds_read_b128 a[188:191], v234 offset:3072
    v_mul_f32 v1, v1, v236
    v_mul_f32 v2, v2, v236
    v_mfma_f32_16x16x32_bf16 v[24:27], a[172:175], a[84:87], v[24:27]
    buffer_load_dwordx4 v224, s[24:27], s56 offen offset:1024 sc1 lds
    v_mul_f32 v3, v3, v236
    v_mul_f32 v116, v116, v4
    v_mfma_f32_16x16x32_bf16 v[28:31], a[168:171], a[88:91], v[28:31]
    v_mul_f32 v117, v117, v5
    v_mul_f32 v118, v118, v6
    v_mfma_f32_16x16x32_bf16 v[28:31], a[172:175], a[92:95], v[28:31]
    s_waitcnt lgkmcnt(2)
    s_add_u32 s56, s55, 8192
    v_mul_f32 v119, v119, v7
    v_mul_f32 v4, v4, v238
    v_mul_f32 v5, v5, v238
L_stub_16:
    s_cbranch_execz L_warm_w20_ret
    v_mfma_f32_16x16x32_bf16 v[16:19], a[176:179], a[96:99], v[16:19]
    s_add_u32 m0, s53, 147456
    ds_read_b128 a[192:195], v232 offset:2048
    v_mul_f32 v6, v6, v238
    v_mul_f32 v7, v7, v238
    v_mfma_f32_16x16x32_bf16 v[16:19], a[180:183], a[100:103], v[16:19]
    buffer_load_dwordx4 v224, s[24:27], s56 offen offset:0 sc1 lds
    v_exp_f32 v0, v0
    v_mfma_f32_16x16x32_bf16 v[20:23], a[176:179], a[104:107], v[20:23]
    v_mul_f32 v120, v120, v8
    v_mfma_f32_16x16x32_bf16 v[20:23], a[180:183], a[108:111], v[20:23]
    v_exp_f32 v1, v1
    v_mul_f32 v121, v121, v9
    v_mfma_f32_16x16x32_bf16 v[24:27], a[176:179], a[112:115], v[24:27]
    ds_read_b128 a[196:199], v232 offset:3072
    v_exp_f32 v2, v2
    v_mfma_f32_16x16x32_bf16 v[24:27], a[180:183], a[116:119], v[24:27]
    buffer_load_dwordx4 v224, s[24:27], s56 offen offset:1024 sc1 lds
    v_mul_f32 v122, v122, v10
    v_mfma_f32_16x16x32_bf16 v[28:31], a[176:179], a[120:123], v[28:31]
    v_exp_f32 v3, v3
    v_mul_f32 v123, v123, v11
    v_mfma_f32_16x16x32_bf16 v[28:31], a[180:183], a[124:127], v[28:31]
    s_waitcnt lgkmcnt(2)
    s_add_u32 s56, s52, 16384
    v_exp_f32 v4, v4
    v_mul_f32 v8, v8, v240
    v_mfma_f32_16x16x32_bf16 v[16:19], a[184:187], a[128:131], v[16:19]
    s_add_u32 m0, s53, 155648
    ds_read_b128 a[200:203], v233 offset:16384
    v_exp_f32 v5, v5
    v_mfma_f32_16x16x32_bf16 v[16:19], a[188:191], a[132:135], v[16:19]
    buffer_load_dwordx4 v224, s[24:27], s56 offen offset:0 sc1 lds
    v_mul_f32 v9, v9, v240
    v_mfma_f32_16x16x32_bf16 v[20:23], a[184:187], a[136:139], v[20:23]
    v_exp_f32 v6, v6
    v_mul_f32 v10, v10, v240
    v_mfma_f32_16x16x32_bf16 v[20:23], a[188:191], a[140:143], v[20:23]
    v_exp_f32 v7, v7
    v_mul_f32 v11, v11, v240
    v_mfma_f32_16x16x32_bf16 v[24:27], a[184:187], a[144:147], v[24:27]
    ds_read_b128 a[204:207], v233 offset:17408
    v_fma_f32 v0, v0, v237, v237
    v_mfma_f32_16x16x32_bf16 v[24:27], a[188:191], a[148:151], v[24:27]
    buffer_load_dwordx4 v224, s[24:27], s56 offen offset:1024 sc1 lds
    v_fma_f32 v1, v1, v237, v237
    v_fma_f32 v2, v2, v237, v237
    v_mfma_f32_16x16x32_bf16 v[28:31], a[184:187], a[152:155], v[28:31]
    v_fma_f32 v3, v3, v237, v237
    v_fma_f32 v4, v4, v239, v239
    v_fma_f32 v5, v5, v239, v239
    v_mfma_f32_16x16x32_bf16 v[28:31], a[188:191], a[156:159], v[28:31]
    s_waitcnt lgkmcnt(2)
    v_fma_f32 v6, v6, v239, v239
    v_fma_f32 v7, v7, v239, v239
    v_mfma_f32_16x16x32_bf16 v[16:19], a[192:195], a[0:3], v[16:19]
    ds_read_b128 a[208:211], v233 offset:45056
    v_rcp_f32 v0, v0
    v_mfma_f32_16x16x32_bf16 v[16:19], a[196:199], a[4:7], v[16:19]
    v_mul_f32 v124, v124, v12
    v_rcp_f32 v1, v1
    v_mfma_f32_16x16x32_bf16 v[20:23], a[192:195], a[8:11], v[20:23]
    v_mul_f32 v125, v125, v13
    v_rcp_f32 v2, v2
    v_mfma_f32_16x16x32_bf16 v[20:23], a[196:199], a[12:15], v[20:23]
    v_mul_f32 v126, v126, v14
    v_mfma_f32_16x16x32_bf16 v[24:27], a[192:195], a[16:19], v[24:27]
    ds_read_b128 a[212:215], v233 offset:46080
    v_rcp_f32 v3, v3
    v_mfma_f32_16x16x32_bf16 v[24:27], a[196:199], a[20:23], v[24:27]
    v_mul_f32 v127, v127, v15
    v_rcp_f32 v4, v4
    v_mfma_f32_16x16x32_bf16 v[28:31], a[192:195], a[24:27], v[28:31]
    v_mul_f32 v12, v12, v242
    v_rcp_f32 v5, v5
    v_mfma_f32_16x16x32_bf16 v[28:31], a[196:199], a[28:31], v[28:31]
    s_waitcnt lgkmcnt(2)
    v_mul_f32 v13, v13, v242
    v_rcp_f32 v6, v6
    v_mfma_f32_16x16x32_bf16 v[128:131], a[200:203], a[64:67], v[128:131]
    ds_read_b128 a[160:163], v234 offset:16384
    v_mul_f32 v14, v14, v242
    v_mfma_f32_16x16x32_bf16 v[128:131], a[204:207], a[68:71], v[128:131]
    v_rcp_f32 v7, v7
    v_mul_f32 v15, v15, v242
    v_mfma_f32_16x16x32_bf16 v[132:135], a[200:203], a[72:75], v[132:135]
    v_exp_f32 v8, v8
    v_mfma_f32_16x16x32_bf16 v[132:135], a[204:207], a[76:79], v[132:135]
    v_mul_f32 v112, v112, v0
    v_exp_f32 v9, v9
    v_mfma_f32_16x16x32_bf16 v[136:139], a[200:203], a[80:83], v[136:139]
    ds_read_b128 a[164:167], v234 offset:17408
    v_mul_f32 v113, v113, v1
    v_mfma_f32_16x16x32_bf16 v[136:139], a[204:207], a[84:87], v[136:139]
    v_exp_f32 v10, v10
    v_mul_f32 v114, v114, v2
    v_mfma_f32_16x16x32_bf16 v[140:143], a[200:203], a[88:91], v[140:143]
    v_exp_f32 v11, v11
    v_mul_f32 v115, v115, v3
    v_mfma_f32_16x16x32_bf16 v[140:143], a[204:207], a[92:95], v[140:143]
    s_waitcnt lgkmcnt(2)
    v_exp_f32 v12, v12
    v_mul_f32 v116, v116, v4
    v_mfma_f32_16x16x32_bf16 v[128:131], a[208:211], a[96:99], v[128:131]
    ds_read_b128 a[168:171], v232 offset:16384
    v_exp_f32 v13, v13
    v_mfma_f32_16x16x32_bf16 v[128:131], a[212:215], a[100:103], v[128:131]
    v_mul_f32 v117, v117, v5
    v_mfma_f32_16x16x32_bf16 v[132:135], a[208:211], a[104:107], v[132:135]
    v_exp_f32 v14, v14
    v_mul_f32 v118, v118, v6
    v_mfma_f32_16x16x32_bf16 v[132:135], a[212:215], a[108:111], v[132:135]
    v_exp_f32 v15, v15
    v_mul_f32 v119, v119, v7
    v_mfma_f32_16x16x32_bf16 v[136:139], a[208:211], a[112:115], v[136:139]
    ds_read_b128 a[172:175], v232 offset:17408
    v_fma_f32 v8, v8, v241, v241
    v_fma_f32 v9, v9, v241, v241
    v_mfma_f32_16x16x32_bf16 v[136:139], a[212:215], a[116:119], v[136:139]
    v_fma_f32 v10, v10, v241, v241
    v_fma_f32 v11, v11, v241, v241
    v_mfma_f32_16x16x32_bf16 v[140:143], a[208:211], a[120:123], v[140:143]
    v_fma_f32 v12, v12, v243, v243
    v_fma_f32 v13, v13, v243, v243
    v_fma_f32 v14, v14, v243, v243
    v_mfma_f32_16x16x32_bf16 v[140:143], a[212:215], a[124:127], v[140:143]
    s_waitcnt lgkmcnt(2)
    v_fma_f32 v15, v15, v243, v243
    v_rcp_f32 v8, v8
    v_mfma_f32_16x16x32_bf16 v[128:131], a[160:163], a[128:131], v[128:131]
    ds_read_b128 a[176:179], v233 offset:4096
    v_cvt_pk_bf16_f32 v0, v112, v113
    v_mfma_f32_16x16x32_bf16 v[128:131], a[164:167], a[132:135], v[128:131]
    v_rcp_f32 v9, v9
    v_cvt_pk_bf16_f32 v2, v116, v117
    v_mfma_f32_16x16x32_bf16 v[132:135], a[160:163], a[136:139], v[132:135]
    v_rcp_f32 v10, v10
    v_cvt_pk_bf16_f32 v1, v114, v115
    v_mfma_f32_16x16x32_bf16 v[132:135], a[164:167], a[140:143], v[132:135]
    v_rcp_f32 v11, v11
    v_mfma_f32_16x16x32_bf16 v[136:139], a[160:163], a[144:147], v[136:139]
    ds_read_b128 a[180:183], v233 offset:5120
    v_cvt_pk_bf16_f32 v3, v118, v119
    v_mfma_f32_16x16x32_bf16 v[136:139], a[164:167], a[148:151], v[136:139]
    v_rcp_f32 v12, v12
    v_permlane32_swap_b32 v0, v2
    v_mfma_f32_16x16x32_bf16 v[140:143], a[160:163], a[152:155], v[140:143]
    v_rcp_f32 v13, v13
    s_nop 0
    v_mfma_f32_16x16x32_bf16 v[140:143], a[164:167], a[156:159], v[140:143]
    s_waitcnt lgkmcnt(2)
    v_rcp_f32 v14, v14
    v_permlane32_swap_b32 v1, v3
    v_mfma_f32_16x16x32_bf16 v[128:131], a[168:171], a[0:3], v[128:131]
    ds_read_b128 a[184:187], v233 offset:32768
    v_rcp_f32 v15, v15
    v_mfma_f32_16x16x32_bf16 v[128:131], a[172:175], a[4:7], v[128:131]
    buffer_store_dwordx4 v[0:3], v244, s[32:35], s60 offen offset:0 sc1
    v_mul_f32 v120, v120, v8
    v_mfma_f32_16x16x32_bf16 v[132:135], a[168:171], a[8:11], v[132:135]
    v_mul_f32 v121, v121, v9
    v_mul_f32 v122, v122, v10
    v_mul_f32 v123, v123, v11
    v_mfma_f32_16x16x32_bf16 v[132:135], a[172:175], a[12:15], v[132:135]
    v_mul_f32 v124, v124, v12
    v_mul_f32 v125, v125, v13
    v_mfma_f32_16x16x32_bf16 v[136:139], a[168:171], a[16:19], v[136:139]
    ds_read_b128 a[188:191], v233 offset:33792
    v_mul_f32 v126, v126, v14
    v_mul_f32 v127, v127, v15
    v_mfma_f32_16x16x32_bf16 v[136:139], a[172:175], a[20:23], v[136:139]
    v_cvt_pk_bf16_f32 v8, v120, v121
    v_cvt_pk_bf16_f32 v10, v124, v125
    v_cvt_pk_bf16_f32 v9, v122, v123
    v_mfma_f32_16x16x32_bf16 v[140:143], a[168:171], a[24:27], v[140:143]
    v_cvt_pk_bf16_f32 v11, v126, v127
    v_permlane32_swap_b32 v8, v10
    v_mfma_f32_16x16x32_bf16 v[140:143], a[172:175], a[28:31], v[140:143]
    s_waitcnt lgkmcnt(2)
    s_nop 0
    v_permlane32_swap_b32 v9, v11
    buffer_store_dwordx4 v[8:11], v244, s[32:35], s61 offen offset:0 sc1
    v_mfma_f32_16x16x32_bf16 v[32:35], a[176:179], a[64:67], v[32:35]
    ds_read_b128 a[192:195], v234 offset:4096
    v_mfma_f32_16x16x32_bf16 v[32:35], a[180:183], a[68:71], v[32:35]
    v_mfma_f32_16x16x32_bf16 v[36:39], a[176:179], a[72:75], v[36:39]
    v_mul_f32 v128, v128, v16
    v_mul_f32 v129, v129, v17
    v_mul_f32 v130, v130, v18
    v_mfma_f32_16x16x32_bf16 v[36:39], a[180:183], a[76:79], v[36:39]
    v_mul_f32 v131, v131, v19
    v_mul_f32 v16, v16, v236
    v_mfma_f32_16x16x32_bf16 v[40:43], a[176:179], a[80:83], v[40:43]
    ds_read_b128 a[196:199], v234 offset:5120
    v_mul_f32 v17, v17, v236
    v_mul_f32 v18, v18, v236
    v_mfma_f32_16x16x32_bf16 v[40:43], a[180:183], a[84:87], v[40:43]
    v_mul_f32 v19, v19, v236
    v_mul_f32 v132, v132, v20
    v_mfma_f32_16x16x32_bf16 v[44:47], a[176:179], a[88:91], v[44:47]
    v_mul_f32 v133, v133, v21
    v_mul_f32 v134, v134, v22
    v_mul_f32 v135, v135, v23
    v_mfma_f32_16x16x32_bf16 v[44:47], a[180:183], a[92:95], v[44:47]
    s_waitcnt lgkmcnt(2)
    v_mul_f32 v20, v20, v238
    v_mul_f32 v21, v21, v238
    v_mfma_f32_16x16x32_bf16 v[32:35], a[184:187], a[96:99], v[32:35]
    ds_read_b128 a[200:203], v232 offset:4096
    v_mul_f32 v22, v22, v238
    v_mul_f32 v23, v23, v238
    v_mfma_f32_16x16x32_bf16 v[32:35], a[188:191], a[100:103], v[32:35]
    v_exp_f32 v16, v16
    v_mul_f32 v136, v136, v24
    v_mfma_f32_16x16x32_bf16 v[36:39], a[184:187], a[104:107], v[36:39]
    v_exp_f32 v17, v17
    v_mfma_f32_16x16x32_bf16 v[36:39], a[188:191], a[108:111], v[36:39]
    v_mul_f32 v137, v137, v25
    v_exp_f32 v18, v18
    v_mfma_f32_16x16x32_bf16 v[40:43], a[184:187], a[112:115], v[40:43]
    ds_read_b128 a[204:207], v232 offset:5120
    v_mul_f32 v138, v138, v26
    v_mfma_f32_16x16x32_bf16 v[40:43], a[188:191], a[116:119], v[40:43]
    v_exp_f32 v19, v19
    v_mul_f32 v139, v139, v27
    v_mfma_f32_16x16x32_bf16 v[44:47], a[184:187], a[120:123], v[44:47]
    v_exp_f32 v20, v20
    v_mfma_f32_16x16x32_bf16 v[44:47], a[188:191], a[124:127], v[44:47]
    s_waitcnt lgkmcnt(2)
    v_mul_f32 v24, v24, v240
    v_exp_f32 v21, v21
    v_mfma_f32_16x16x32_bf16 v[32:35], a[192:195], a[128:131], v[32:35]
    ds_read_b128 a[208:211], v233 offset:18432
    v_mul_f32 v25, v25, v240
    v_mfma_f32_16x16x32_bf16 v[32:35], a[196:199], a[132:135], v[32:35]
    v_exp_f32 v22, v22
    v_mul_f32 v26, v26, v240
    v_mfma_f32_16x16x32_bf16 v[36:39], a[192:195], a[136:139], v[36:39]
    v_exp_f32 v23, v23
    v_mul_f32 v27, v27, v240
    v_mfma_f32_16x16x32_bf16 v[36:39], a[196:199], a[140:143], v[36:39]
    v_fma_f32 v16, v16, v237, v237
    v_fma_f32 v17, v17, v237, v237
    v_mfma_f32_16x16x32_bf16 v[40:43], a[192:195], a[144:147], v[40:43]
    ds_read_b128 a[212:215], v233 offset:19456
    v_fma_f32 v18, v18, v237, v237
    v_fma_f32 v19, v19, v237, v237
    v_mfma_f32_16x16x32_bf16 v[40:43], a[196:199], a[148:151], v[40:43]
    v_fma_f32 v20, v20, v239, v239
    v_fma_f32 v21, v21, v239, v239
    v_mfma_f32_16x16x32_bf16 v[44:47], a[192:195], a[152:155], v[44:47]
    v_fma_f32 v22, v22, v239, v239
    v_fma_f32 v23, v23, v239, v239
    v_mfma_f32_16x16x32_bf16 v[44:47], a[196:199], a[156:159], v[44:47]
    s_waitcnt lgkmcnt(2)
    v_rcp_f32 v16, v16
    v_mul_f32 v140, v140, v28
    v_mfma_f32_16x16x32_bf16 v[32:35], a[200:203], a[0:3], v[32:35]
    ds_read_b128 a[160:163], v233 offset:47104
    v_rcp_f32 v17, v17
    v_mfma_f32_16x16x32_bf16 v[32:35], a[204:207], a[4:7], v[32:35]
    v_mul_f32 v141, v141, v29
    v_rcp_f32 v18, v18
    v_mfma_f32_16x16x32_bf16 v[36:39], a[200:203], a[8:11], v[36:39]
    v_mul_f32 v142, v142, v30
    v_rcp_f32 v19, v19
    v_mfma_f32_16x16x32_bf16 v[36:39], a[204:207], a[12:15], v[36:39]
    v_mul_f32 v143, v143, v31
    v_mfma_f32_16x16x32_bf16 v[40:43], a[200:203], a[16:19], v[40:43]
    ds_read_b128 a[164:167], v233 offset:48128
    v_rcp_f32 v20, v20
    v_mfma_f32_16x16x32_bf16 v[40:43], a[204:207], a[20:23], v[40:43]
    v_mul_f32 v28, v28, v242
    v_rcp_f32 v21, v21
    v_mfma_f32_16x16x32_bf16 v[44:47], a[200:203], a[24:27], v[44:47]
    v_mul_f32 v29, v29, v242
    v_rcp_f32 v22, v22
    v_mfma_f32_16x16x32_bf16 v[44:47], a[204:207], a[28:31], v[44:47]
    s_waitcnt lgkmcnt(2)
    v_mul_f32 v30, v30, v242
    v_mfma_f32_16x16x32_bf16 v[144:147], a[208:211], a[64:67], v[144:147]
    ds_read_b128 a[168:171], v234 offset:18432
    v_rcp_f32 v23, v23
    v_mfma_f32_16x16x32_bf16 v[144:147], a[212:215], a[68:71], v[144:147]
    v_mul_f32 v31, v31, v242
    v_exp_f32 v24, v24
    v_mfma_f32_16x16x32_bf16 v[148:151], a[208:211], a[72:75], v[148:151]
    v_mul_f32 v128, v128, v16
    v_exp_f32 v25, v25
    v_mfma_f32_16x16x32_bf16 v[148:151], a[212:215], a[76:79], v[148:151]
    v_mul_f32 v129, v129, v17
    v_exp_f32 v26, v26
    v_mfma_f32_16x16x32_bf16 v[152:155], a[208:211], a[80:83], v[152:155]
    ds_read_b128 a[172:175], v234 offset:19456
    v_mul_f32 v130, v130, v18
    v_mfma_f32_16x16x32_bf16 v[152:155], a[212:215], a[84:87], v[152:155]
    v_exp_f32 v27, v27
    v_mfma_f32_16x16x32_bf16 v[156:159], a[208:211], a[88:91], v[156:159]
    v_mul_f32 v131, v131, v19
    v_exp_f32 v28, v28
    v_mfma_f32_16x16x32_bf16 v[156:159], a[212:215], a[92:95], v[156:159]
    s_waitcnt lgkmcnt(2)
    v_mul_f32 v132, v132, v20
    v_exp_f32 v29, v29
    v_mfma_f32_16x16x32_bf16 v[144:147], a[160:163], a[96:99], v[144:147]
    ds_read_b128 a[176:179], v232 offset:18432
    v_mul_f32 v133, v133, v21
    v_mfma_f32_16x16x32_bf16 v[144:147], a[164:167], a[100:103], v[144:147]
    v_exp_f32 v30, v30
    v_mul_f32 v134, v134, v22
    v_mfma_f32_16x16x32_bf16 v[148:151], a[160:163], a[104:107], v[148:151]
    v_exp_f32 v31, v31
    v_mfma_f32_16x16x32_bf16 v[148:151], a[164:167], a[108:111], v[148:151]
    v_mul_f32 v135, v135, v23
    v_fma_f32 v24, v24, v241, v241
    v_fma_f32 v25, v25, v241, v241
    v_mfma_f32_16x16x32_bf16 v[152:155], a[160:163], a[112:115], v[152:155]
    ds_read_b128 a[180:183], v232 offset:19456
    v_fma_f32 v26, v26, v241, v241
    v_mfma_f32_16x16x32_bf16 v[152:155], a[164:167], a[116:119], v[152:155]
    v_fma_f32 v27, v27, v241, v241
    v_fma_f32 v28, v28, v243, v243
    v_fma_f32 v29, v29, v243, v243
    v_mfma_f32_16x16x32_bf16 v[156:159], a[160:163], a[120:123], v[156:159]
    v_fma_f32 v30, v30, v243, v243
    v_fma_f32 v31, v31, v243, v243
    v_mfma_f32_16x16x32_bf16 v[156:159], a[164:167], a[124:127], v[156:159]
    s_waitcnt lgkmcnt(2)
    v_rcp_f32 v24, v24
    v_cvt_pk_bf16_f32 v16, v128, v129
    v_mfma_f32_16x16x32_bf16 v[144:147], a[168:171], a[128:131], v[144:147]
    ds_read_b128 a[184:187], v233 offset:6144
    v_rcp_f32 v25, v25
    v_mfma_f32_16x16x32_bf16 v[144:147], a[172:175], a[132:135], v[144:147]
    v_cvt_pk_bf16_f32 v18, v132, v133
    v_rcp_f32 v26, v26
    v_mfma_f32_16x16x32_bf16 v[148:151], a[168:171], a[136:139], v[148:151]
    v_cvt_pk_bf16_f32 v17, v130, v131
    v_mfma_f32_16x16x32_bf16 v[148:151], a[172:175], a[140:143], v[148:151]
    v_rcp_f32 v27, v27
    v_cvt_pk_bf16_f32 v19, v134, v135
    v_mfma_f32_16x16x32_bf16 v[152:155], a[168:171], a[144:147], v[152:155]
    ds_read_b128 a[188:191], v233 offset:7168
    v_rcp_f32 v28, v28
    v_mfma_f32_16x16x32_bf16 v[152:155], a[172:175], a[148:151], v[152:155]
    v_permlane32_swap_b32 v16, v18
    v_rcp_f32 v29, v29
    v_mfma_f32_16x16x32_bf16 v[156:159], a[168:171], a[152:155], v[156:159]
    s_nop 0
    v_mfma_f32_16x16x32_bf16 v[156:159], a[172:175], a[156:159], v[156:159]
    s_waitcnt lgkmcnt(2)
    v_rcp_f32 v30, v30
    v_permlane32_swap_b32 v17, v19
    v_mfma_f32_16x16x32_bf16 v[144:147], a[176:179], a[0:3], v[144:147]
    ds_read_b128 a[192:195], v233 offset:34816
    v_rcp_f32 v31, v31
    v_mfma_f32_16x16x32_bf16 v[144:147], a[180:183], a[4:7], v[144:147]
    buffer_store_dwordx4 v[16:19], v244, s[32:35], s60 offen offset:512 sc1
    v_mul_f32 v136, v136, v24
    v_mul_f32 v137, v137, v25
    v_mfma_f32_16x16x32_bf16 v[148:151], a[176:179], a[8:11], v[148:151]
    v_mul_f32 v138, v138, v26
    v_mul_f32 v139, v139, v27
    v_mfma_f32_16x16x32_bf16 v[148:151], a[180:183], a[12:15], v[148:151]
    v_mul_f32 v140, v140, v28
    v_mul_f32 v141, v141, v29
    v_mul_f32 v142, v142, v30
    v_mfma_f32_16x16x32_bf16 v[152:155], a[176:179], a[16:19], v[152:155]
    ds_read_b128 a[196:199], v233 offset:35840
    v_mul_f32 v143, v143, v31
    v_mfma_f32_16x16x32_bf16 v[152:155], a[180:183], a[20:23], v[152:155]
    v_cvt_pk_bf16_f32 v24, v136, v137
    v_cvt_pk_bf16_f32 v26, v140, v141
    v_cvt_pk_bf16_f32 v25, v138, v139
    v_mfma_f32_16x16x32_bf16 v[156:159], a[176:179], a[24:27], v[156:159]
    v_cvt_pk_bf16_f32 v27, v142, v143
    v_permlane32_swap_b32 v24, v26
    v_mfma_f32_16x16x32_bf16 v[156:159], a[180:183], a[28:31], v[156:159]
    s_waitcnt lgkmcnt(2)
    s_nop 0
    v_permlane32_swap_b32 v25, v27
    buffer_store_dwordx4 v[24:27], v244, s[32:35], s61 offen offset:512 sc1
    v_mfma_f32_16x16x32_bf16 v[48:51], a[184:187], a[64:67], v[48:51]
    ds_read_b128 a[200:203], v234 offset:6144
    v_mfma_f32_16x16x32_bf16 v[48:51], a[188:191], a[68:71], v[48:51]
    v_mfma_f32_16x16x32_bf16 v[52:55], a[184:187], a[72:75], v[52:55]
    v_mul_f32 v144, v144, v32
    v_mul_f32 v145, v145, v33
    v_mul_f32 v146, v146, v34
    v_mfma_f32_16x16x32_bf16 v[52:55], a[188:191], a[76:79], v[52:55]
    v_mul_f32 v147, v147, v35
    v_mul_f32 v32, v32, v236
    v_mfma_f32_16x16x32_bf16 v[56:59], a[184:187], a[80:83], v[56:59]
    ds_read_b128 a[204:207], v234 offset:7168
    v_mul_f32 v33, v33, v236
    v_mul_f32 v34, v34, v236
    v_mfma_f32_16x16x32_bf16 v[56:59], a[188:191], a[84:87], v[56:59]
    v_mul_f32 v35, v35, v236
    v_mul_f32 v148, v148, v36
    v_mfma_f32_16x16x32_bf16 v[60:63], a[184:187], a[88:91], v[60:63]
    v_mul_f32 v149, v149, v37
    v_mul_f32 v150, v150, v38
    v_mul_f32 v151, v151, v39
    v_mfma_f32_16x16x32_bf16 v[60:63], a[188:191], a[92:95], v[60:63]
    s_waitcnt lgkmcnt(2)
    v_mul_f32 v36, v36, v238
    v_mul_f32 v37, v37, v238
    v_mfma_f32_16x16x32_bf16 v[48:51], a[192:195], a[96:99], v[48:51]
    ds_read_b128 a[208:211], v232 offset:6144
    v_mul_f32 v38, v38, v238
    v_mul_f32 v39, v39, v238
    v_mfma_f32_16x16x32_bf16 v[48:51], a[196:199], a[100:103], v[48:51]
    v_exp_f32 v32, v32
    v_mul_f32 v152, v152, v40
    v_mfma_f32_16x16x32_bf16 v[52:55], a[192:195], a[104:107], v[52:55]
    v_exp_f32 v33, v33
    v_mfma_f32_16x16x32_bf16 v[52:55], a[196:199], a[108:111], v[52:55]
    v_mul_f32 v153, v153, v41
    v_exp_f32 v34, v34
    v_mfma_f32_16x16x32_bf16 v[56:59], a[192:195], a[112:115], v[56:59]
    ds_read_b128 a[212:215], v232 offset:7168
    v_mul_f32 v154, v154, v42
    v_mfma_f32_16x16x32_bf16 v[56:59], a[196:199], a[116:119], v[56:59]
    v_exp_f32 v35, v35
    v_mul_f32 v155, v155, v43
    v_mfma_f32_16x16x32_bf16 v[60:63], a[192:195], a[120:123], v[60:63]
    v_exp_f32 v36, v36
    v_mfma_f32_16x16x32_bf16 v[60:63], a[196:199], a[124:127], v[60:63]
    s_waitcnt lgkmcnt(2)
    v_mul_f32 v40, v40, v240
    v_exp_f32 v37, v37
    v_mfma_f32_16x16x32_bf16 v[48:51], a[200:203], a[128:131], v[48:51]
    ds_read_b128 a[160:163], v233 offset:20480
    v_mul_f32 v41, v41, v240
    v_mfma_f32_16x16x32_bf16 v[48:51], a[204:207], a[132:135], v[48:51]
    v_exp_f32 v38, v38
    v_mul_f32 v42, v42, v240
    v_mfma_f32_16x16x32_bf16 v[52:55], a[200:203], a[136:139], v[52:55]
    v_exp_f32 v39, v39
    v_mul_f32 v43, v43, v240
    v_mfma_f32_16x16x32_bf16 v[52:55], a[204:207], a[140:143], v[52:55]
    v_fma_f32 v32, v32, v237, v237
    v_fma_f32 v33, v33, v237, v237
    v_mfma_f32_16x16x32_bf16 v[56:59], a[200:203], a[144:147], v[56:59]
    ds_read_b128 a[164:167], v233 offset:21504
    v_fma_f32 v34, v34, v237, v237
    v_fma_f32 v35, v35, v237, v237
    v_mfma_f32_16x16x32_bf16 v[56:59], a[204:207], a[148:151], v[56:59]
    v_fma_f32 v36, v36, v239, v239
    v_fma_f32 v37, v37, v239, v239
    v_mfma_f32_16x16x32_bf16 v[60:63], a[200:203], a[152:155], v[60:63]
    v_fma_f32 v38, v38, v239, v239
    v_fma_f32 v39, v39, v239, v239
    v_mfma_f32_16x16x32_bf16 v[60:63], a[204:207], a[156:159], v[60:63]
    s_waitcnt lgkmcnt(2)
    v_rcp_f32 v32, v32
    v_mul_f32 v156, v156, v44
    v_mfma_f32_16x16x32_bf16 v[48:51], a[208:211], a[0:3], v[48:51]
    ds_read_b128 a[168:171], v233 offset:49152
    v_rcp_f32 v33, v33
    v_mfma_f32_16x16x32_bf16 v[48:51], a[212:215], a[4:7], v[48:51]
    v_mul_f32 v157, v157, v45
    v_rcp_f32 v34, v34
    v_mfma_f32_16x16x32_bf16 v[52:55], a[208:211], a[8:11], v[52:55]
    v_mul_f32 v158, v158, v46
    v_rcp_f32 v35, v35
    v_mfma_f32_16x16x32_bf16 v[52:55], a[212:215], a[12:15], v[52:55]
    v_mul_f32 v159, v159, v47
    v_mfma_f32_16x16x32_bf16 v[56:59], a[208:211], a[16:19], v[56:59]
    ds_read_b128 a[172:175], v233 offset:50176
    v_rcp_f32 v36, v36
    v_mfma_f32_16x16x32_bf16 v[56:59], a[212:215], a[20:23], v[56:59]
    v_mul_f32 v44, v44, v242
    v_rcp_f32 v37, v37
    v_mfma_f32_16x16x32_bf16 v[60:63], a[208:211], a[24:27], v[60:63]
    v_mul_f32 v45, v45, v242
    v_rcp_f32 v38, v38
    v_mfma_f32_16x16x32_bf16 v[60:63], a[212:215], a[28:31], v[60:63]
    s_waitcnt lgkmcnt(2)
    v_mul_f32 v46, v46, v242
    v_mfma_f32_16x16x32_bf16 v[160:163], a[160:163], a[64:67], v[160:163]
    ds_read_b128 a[176:179], v234 offset:20480
    v_rcp_f32 v39, v39
    v_mfma_f32_16x16x32_bf16 v[160:163], a[164:167], a[68:71], v[160:163]
    v_mul_f32 v47, v47, v242
    v_exp_f32 v40, v40
    v_mfma_f32_16x16x32_bf16 v[164:167], a[160:163], a[72:75], v[164:167]
    v_mul_f32 v144, v144, v32
    v_exp_f32 v41, v41
    v_mfma_f32_16x16x32_bf16 v[164:167], a[164:167], a[76:79], v[164:167]
    v_mul_f32 v145, v145, v33
    v_exp_f32 v42, v42
    v_mfma_f32_16x16x32_bf16 v[168:171], a[160:163], a[80:83], v[168:171]
    ds_read_b128 a[180:183], v234 offset:21504
    v_mul_f32 v146, v146, v34
    v_mfma_f32_16x16x32_bf16 v[168:171], a[164:167], a[84:87], v[168:171]
    v_exp_f32 v43, v43
    v_mfma_f32_16x16x32_bf16 v[172:175], a[160:163], a[88:91], v[172:175]
    v_mul_f32 v147, v147, v35
    v_exp_f32 v44, v44
    v_mfma_f32_16x16x32_bf16 v[172:175], a[164:167], a[92:95], v[172:175]
    s_waitcnt lgkmcnt(2)
    v_mul_f32 v148, v148, v36
    v_exp_f32 v45, v45
    v_mfma_f32_16x16x32_bf16 v[160:163], a[168:171], a[96:99], v[160:163]
    ds_read_b128 a[184:187], v232 offset:20480
    v_mul_f32 v149, v149, v37
    v_mfma_f32_16x16x32_bf16 v[160:163], a[172:175], a[100:103], v[160:163]
    v_exp_f32 v46, v46
    v_mul_f32 v150, v150, v38
    v_mfma_f32_16x16x32_bf16 v[164:167], a[168:171], a[104:107], v[164:167]
    v_exp_f32 v47, v47
    v_mfma_f32_16x16x32_bf16 v[164:167], a[172:175], a[108:111], v[164:167]
    v_mul_f32 v151, v151, v39
    v_fma_f32 v40, v40, v241, v241
    v_fma_f32 v41, v41, v241, v241
    v_mfma_f32_16x16x32_bf16 v[168:171], a[168:171], a[112:115], v[168:171]
    ds_read_b128 a[188:191], v232 offset:21504
    v_fma_f32 v42, v42, v241, v241
    v_mfma_f32_16x16x32_bf16 v[168:171], a[172:175], a[116:119], v[168:171]
    v_fma_f32 v43, v43, v241, v241
    v_fma_f32 v44, v44, v243, v243
    v_fma_f32 v45, v45, v243, v243
    v_mfma_f32_16x16x32_bf16 v[172:175], a[168:171], a[120:123], v[172:175]
    v_fma_f32 v46, v46, v243, v243
    v_fma_f32 v47, v47, v243, v243
    v_mfma_f32_16x16x32_bf16 v[172:175], a[172:175], a[124:127], v[172:175]
    s_waitcnt lgkmcnt(2)
    v_rcp_f32 v40, v40
    v_cvt_pk_bf16_f32 v32, v144, v145
    v_mfma_f32_16x16x32_bf16 v[160:163], a[176:179], a[128:131], v[160:163]
    ds_read_b128 a[192:195], v233 offset:8192
    v_rcp_f32 v41, v41
    v_mfma_f32_16x16x32_bf16 v[160:163], a[180:183], a[132:135], v[160:163]
    v_cvt_pk_bf16_f32 v34, v148, v149
    v_rcp_f32 v42, v42
    v_mfma_f32_16x16x32_bf16 v[164:167], a[176:179], a[136:139], v[164:167]
    v_cvt_pk_bf16_f32 v33, v146, v147
    v_mfma_f32_16x16x32_bf16 v[164:167], a[180:183], a[140:143], v[164:167]
    v_rcp_f32 v43, v43
    v_cvt_pk_bf16_f32 v35, v150, v151
    v_mfma_f32_16x16x32_bf16 v[168:171], a[176:179], a[144:147], v[168:171]
    ds_read_b128 a[196:199], v233 offset:9216
    v_rcp_f32 v44, v44
    v_mfma_f32_16x16x32_bf16 v[168:171], a[180:183], a[148:151], v[168:171]
    v_permlane32_swap_b32 v32, v34
    v_rcp_f32 v45, v45
    v_mfma_f32_16x16x32_bf16 v[172:175], a[176:179], a[152:155], v[172:175]
    s_nop 0
    v_mfma_f32_16x16x32_bf16 v[172:175], a[180:183], a[156:159], v[172:175]
    s_waitcnt lgkmcnt(2)
    v_rcp_f32 v46, v46
    v_permlane32_swap_b32 v33, v35
    v_mfma_f32_16x16x32_bf16 v[160:163], a[184:187], a[0:3], v[160:163]
    ds_read_b128 a[200:203], v233 offset:36864
    v_rcp_f32 v47, v47
    v_mfma_f32_16x16x32_bf16 v[160:163], a[188:191], a[4:7], v[160:163]
    buffer_store_dwordx4 v[32:35], v244, s[32:35], s60 offen offset:1024 sc1
    v_mul_f32 v152, v152, v40
    v_mul_f32 v153, v153, v41
    v_mfma_f32_16x16x32_bf16 v[164:167], a[184:187], a[8:11], v[164:167]
    v_mul_f32 v154, v154, v42
    v_mul_f32 v155, v155, v43
    v_mfma_f32_16x16x32_bf16 v[164:167], a[188:191], a[12:15], v[164:167]
    v_mul_f32 v156, v156, v44
    v_mul_f32 v157, v157, v45
    v_mul_f32 v158, v158, v46
    v_mfma_f32_16x16x32_bf16 v[168:171], a[184:187], a[16:19], v[168:171]
    ds_read_b128 a[204:207], v233 offset:37888
    v_mul_f32 v159, v159, v47
    v_mfma_f32_16x16x32_bf16 v[168:171], a[188:191], a[20:23], v[168:171]
    v_cvt_pk_bf16_f32 v40, v152, v153
    v_cvt_pk_bf16_f32 v42, v156, v157
    v_cvt_pk_bf16_f32 v41, v154, v155
    v_mfma_f32_16x16x32_bf16 v[172:175], a[184:187], a[24:27], v[172:175]
    v_cvt_pk_bf16_f32 v43, v158, v159
    v_permlane32_swap_b32 v40, v42
    v_mfma_f32_16x16x32_bf16 v[172:175], a[188:191], a[28:31], v[172:175]
    s_waitcnt lgkmcnt(2)
    s_nop 0
    v_permlane32_swap_b32 v41, v43
    buffer_store_dwordx4 v[40:43], v244, s[32:35], s61 offen offset:1024 sc1
    v_mfma_f32_16x16x32_bf16 v[64:67], a[192:195], a[64:67], v[64:67]
    ds_read_b128 a[208:211], v234 offset:8192
    v_mfma_f32_16x16x32_bf16 v[64:67], a[196:199], a[68:71], v[64:67]
    v_mfma_f32_16x16x32_bf16 v[68:71], a[192:195], a[72:75], v[68:71]
    v_mul_f32 v160, v160, v48
    v_mul_f32 v161, v161, v49
    v_mul_f32 v162, v162, v50
    v_mfma_f32_16x16x32_bf16 v[68:71], a[196:199], a[76:79], v[68:71]
    v_mul_f32 v163, v163, v51
    v_mul_f32 v48, v48, v236
    v_mfma_f32_16x16x32_bf16 v[72:75], a[192:195], a[80:83], v[72:75]
    ds_read_b128 a[212:215], v234 offset:9216
    v_mul_f32 v49, v49, v236
    v_mul_f32 v50, v50, v236
    v_mfma_f32_16x16x32_bf16 v[72:75], a[196:199], a[84:87], v[72:75]
    v_mul_f32 v51, v51, v236
    v_mul_f32 v164, v164, v52
    v_mfma_f32_16x16x32_bf16 v[76:79], a[192:195], a[88:91], v[76:79]
    v_mul_f32 v165, v165, v53
    v_mul_f32 v166, v166, v54
    v_mul_f32 v167, v167, v55
    v_mfma_f32_16x16x32_bf16 v[76:79], a[196:199], a[92:95], v[76:79]
    s_waitcnt lgkmcnt(2)
    v_mul_f32 v52, v52, v238
    v_mul_f32 v53, v53, v238
    v_mfma_f32_16x16x32_bf16 v[64:67], a[200:203], a[96:99], v[64:67]
    ds_read_b128 a[160:163], v232 offset:8192
    v_mul_f32 v54, v54, v238
    v_mul_f32 v55, v55, v238
    v_mfma_f32_16x16x32_bf16 v[64:67], a[204:207], a[100:103], v[64:67]
    v_exp_f32 v48, v48
    v_mul_f32 v168, v168, v56
    v_mfma_f32_16x16x32_bf16 v[68:71], a[200:203], a[104:107], v[68:71]
    v_exp_f32 v49, v49
    v_mfma_f32_16x16x32_bf16 v[68:71], a[204:207], a[108:111], v[68:71]
    v_mul_f32 v169, v169, v57
    v_exp_f32 v50, v50
    v_mfma_f32_16x16x32_bf16 v[72:75], a[200:203], a[112:115], v[72:75]
    ds_read_b128 a[164:167], v232 offset:9216
    v_mul_f32 v170, v170, v58
    v_mfma_f32_16x16x32_bf16 v[72:75], a[204:207], a[116:119], v[72:75]
    v_exp_f32 v51, v51
    v_mul_f32 v171, v171, v59
    v_mfma_f32_16x16x32_bf16 v[76:79], a[200:203], a[120:123], v[76:79]
    v_exp_f32 v52, v52
    v_mfma_f32_16x16x32_bf16 v[76:79], a[204:207], a[124:127], v[76:79]
    s_waitcnt lgkmcnt(2)
    v_mul_f32 v56, v56, v240
    v_exp_f32 v53, v53
    v_mfma_f32_16x16x32_bf16 v[64:67], a[208:211], a[128:131], v[64:67]
    ds_read_b128 a[168:171], v233 offset:22528
    v_mul_f32 v57, v57, v240
    v_mfma_f32_16x16x32_bf16 v[64:67], a[212:215], a[132:135], v[64:67]
    v_exp_f32 v54, v54
    v_mul_f32 v58, v58, v240
    v_mfma_f32_16x16x32_bf16 v[68:71], a[208:211], a[136:139], v[68:71]
    v_exp_f32 v55, v55
    v_mul_f32 v59, v59, v240
    v_mfma_f32_16x16x32_bf16 v[68:71], a[212:215], a[140:143], v[68:71]
    v_fma_f32 v48, v48, v237, v237
    v_fma_f32 v49, v49, v237, v237
    v_mfma_f32_16x16x32_bf16 v[72:75], a[208:211], a[144:147], v[72:75]
    ds_read_b128 a[172:175], v233 offset:23552
    v_fma_f32 v50, v50, v237, v237
    v_fma_f32 v51, v51, v237, v237
    v_mfma_f32_16x16x32_bf16 v[72:75], a[212:215], a[148:151], v[72:75]
    v_fma_f32 v52, v52, v239, v239
    v_fma_f32 v53, v53, v239, v239
    v_mfma_f32_16x16x32_bf16 v[76:79], a[208:211], a[152:155], v[76:79]
    v_fma_f32 v54, v54, v239, v239
    v_fma_f32 v55, v55, v239, v239
    v_mfma_f32_16x16x32_bf16 v[76:79], a[212:215], a[156:159], v[76:79]
    s_waitcnt lgkmcnt(2)
    v_rcp_f32 v48, v48
    v_mul_f32 v172, v172, v60
    v_mfma_f32_16x16x32_bf16 v[64:67], a[160:163], a[0:3], v[64:67]
    ds_read_b128 a[176:179], v233 offset:51200
    v_rcp_f32 v49, v49
    v_mfma_f32_16x16x32_bf16 v[64:67], a[164:167], a[4:7], v[64:67]
    v_mul_f32 v173, v173, v61
    v_rcp_f32 v50, v50
    v_mfma_f32_16x16x32_bf16 v[68:71], a[160:163], a[8:11], v[68:71]
    v_mul_f32 v174, v174, v62
    v_rcp_f32 v51, v51
L_stub_17:
    s_cbranch_execz L_warm_w20_ret
    v_mfma_f32_16x16x32_bf16 v[68:71], a[164:167], a[12:15], v[68:71]
    v_mul_f32 v175, v175, v63
    v_mfma_f32_16x16x32_bf16 v[72:75], a[160:163], a[16:19], v[72:75]
    ds_read_b128 a[180:183], v233 offset:52224
    v_rcp_f32 v52, v52
    v_mfma_f32_16x16x32_bf16 v[72:75], a[164:167], a[20:23], v[72:75]
    v_mul_f32 v60, v60, v242
    v_rcp_f32 v53, v53
    v_mfma_f32_16x16x32_bf16 v[76:79], a[160:163], a[24:27], v[76:79]
    v_mul_f32 v61, v61, v242
    v_rcp_f32 v54, v54
    v_mfma_f32_16x16x32_bf16 v[76:79], a[164:167], a[28:31], v[76:79]
    s_waitcnt lgkmcnt(2)
    v_mul_f32 v62, v62, v242
    v_mfma_f32_16x16x32_bf16 v[176:179], a[168:171], a[64:67], v[176:179]
    ds_read_b128 a[184:187], v234 offset:22528
    v_rcp_f32 v55, v55
    v_mfma_f32_16x16x32_bf16 v[176:179], a[172:175], a[68:71], v[176:179]
    v_mul_f32 v63, v63, v242
    v_exp_f32 v56, v56
    v_mfma_f32_16x16x32_bf16 v[180:183], a[168:171], a[72:75], v[180:183]
    v_mul_f32 v160, v160, v48
    v_exp_f32 v57, v57
    v_mfma_f32_16x16x32_bf16 v[180:183], a[172:175], a[76:79], v[180:183]
    v_mul_f32 v161, v161, v49
    v_exp_f32 v58, v58
    v_mfma_f32_16x16x32_bf16 v[184:187], a[168:171], a[80:83], v[184:187]
    ds_read_b128 a[188:191], v234 offset:23552
    v_mul_f32 v162, v162, v50
    v_mfma_f32_16x16x32_bf16 v[184:187], a[172:175], a[84:87], v[184:187]
    v_exp_f32 v59, v59
    v_mfma_f32_16x16x32_bf16 v[188:191], a[168:171], a[88:91], v[188:191]
    v_mul_f32 v163, v163, v51
    v_exp_f32 v60, v60
    v_mfma_f32_16x16x32_bf16 v[188:191], a[172:175], a[92:95], v[188:191]
    s_waitcnt lgkmcnt(2)
    v_mul_f32 v164, v164, v52
    v_exp_f32 v61, v61
    v_mfma_f32_16x16x32_bf16 v[176:179], a[176:179], a[96:99], v[176:179]
    ds_read_b128 a[192:195], v232 offset:22528
    v_mul_f32 v165, v165, v53
    v_mfma_f32_16x16x32_bf16 v[176:179], a[180:183], a[100:103], v[176:179]
    v_exp_f32 v62, v62
    v_mul_f32 v166, v166, v54
    v_mfma_f32_16x16x32_bf16 v[180:183], a[176:179], a[104:107], v[180:183]
    v_exp_f32 v63, v63
    v_mfma_f32_16x16x32_bf16 v[180:183], a[180:183], a[108:111], v[180:183]
    v_mul_f32 v167, v167, v55
    v_fma_f32 v56, v56, v241, v241
    v_fma_f32 v57, v57, v241, v241
    v_mfma_f32_16x16x32_bf16 v[184:187], a[176:179], a[112:115], v[184:187]
    ds_read_b128 a[196:199], v232 offset:23552
    v_fma_f32 v58, v58, v241, v241
    v_mfma_f32_16x16x32_bf16 v[184:187], a[180:183], a[116:119], v[184:187]
    v_fma_f32 v59, v59, v241, v241
    v_fma_f32 v60, v60, v243, v243
    v_fma_f32 v61, v61, v243, v243
    v_mfma_f32_16x16x32_bf16 v[188:191], a[176:179], a[120:123], v[188:191]
    v_fma_f32 v62, v62, v243, v243
    v_fma_f32 v63, v63, v243, v243
    v_mfma_f32_16x16x32_bf16 v[188:191], a[180:183], a[124:127], v[188:191]
    s_waitcnt lgkmcnt(2)
    v_rcp_f32 v56, v56
    v_cvt_pk_bf16_f32 v48, v160, v161
    v_mfma_f32_16x16x32_bf16 v[176:179], a[184:187], a[128:131], v[176:179]
    ds_read_b128 a[200:203], v233 offset:10240
    v_rcp_f32 v57, v57
    v_mfma_f32_16x16x32_bf16 v[176:179], a[188:191], a[132:135], v[176:179]
    v_cvt_pk_bf16_f32 v50, v164, v165
    v_rcp_f32 v58, v58
    v_mfma_f32_16x16x32_bf16 v[180:183], a[184:187], a[136:139], v[180:183]
    v_cvt_pk_bf16_f32 v49, v162, v163
    v_mfma_f32_16x16x32_bf16 v[180:183], a[188:191], a[140:143], v[180:183]
    v_rcp_f32 v59, v59
    v_cvt_pk_bf16_f32 v51, v166, v167
    v_mfma_f32_16x16x32_bf16 v[184:187], a[184:187], a[144:147], v[184:187]
    ds_read_b128 a[204:207], v233 offset:11264
    v_rcp_f32 v60, v60
    v_mfma_f32_16x16x32_bf16 v[184:187], a[188:191], a[148:151], v[184:187]
    v_permlane32_swap_b32 v48, v50
    v_rcp_f32 v61, v61
    v_mfma_f32_16x16x32_bf16 v[188:191], a[184:187], a[152:155], v[188:191]
    s_nop 0
    v_mfma_f32_16x16x32_bf16 v[188:191], a[188:191], a[156:159], v[188:191]
    s_waitcnt lgkmcnt(2)
    v_rcp_f32 v62, v62
    v_permlane32_swap_b32 v49, v51
    v_mfma_f32_16x16x32_bf16 v[176:179], a[192:195], a[0:3], v[176:179]
    ds_read_b128 a[208:211], v233 offset:38912
    v_rcp_f32 v63, v63
    v_mfma_f32_16x16x32_bf16 v[176:179], a[196:199], a[4:7], v[176:179]
    buffer_store_dwordx4 v[48:51], v244, s[32:35], s60 offen offset:1536 sc1
    v_mul_f32 v168, v168, v56
    v_mul_f32 v169, v169, v57
    v_mfma_f32_16x16x32_bf16 v[180:183], a[192:195], a[8:11], v[180:183]
    v_mul_f32 v170, v170, v58
    v_mul_f32 v171, v171, v59
    v_mfma_f32_16x16x32_bf16 v[180:183], a[196:199], a[12:15], v[180:183]
    v_mul_f32 v172, v172, v60
    v_mul_f32 v173, v173, v61
    v_mul_f32 v174, v174, v62
    v_mfma_f32_16x16x32_bf16 v[184:187], a[192:195], a[16:19], v[184:187]
    ds_read_b128 a[212:215], v233 offset:39936
    v_mul_f32 v175, v175, v63
    v_mfma_f32_16x16x32_bf16 v[184:187], a[196:199], a[20:23], v[184:187]
    v_cvt_pk_bf16_f32 v56, v168, v169
    v_cvt_pk_bf16_f32 v58, v172, v173
    v_cvt_pk_bf16_f32 v57, v170, v171
    v_mfma_f32_16x16x32_bf16 v[188:191], a[192:195], a[24:27], v[188:191]
    v_cvt_pk_bf16_f32 v59, v174, v175
    v_permlane32_swap_b32 v56, v58
    v_mfma_f32_16x16x32_bf16 v[188:191], a[196:199], a[28:31], v[188:191]
    s_waitcnt lgkmcnt(2)
    s_nop 0
    v_permlane32_swap_b32 v57, v59
    buffer_store_dwordx4 v[56:59], v244, s[32:35], s61 offen offset:1536 sc1
    v_mfma_f32_16x16x32_bf16 v[80:83], a[200:203], a[64:67], v[80:83]
    ds_read_b128 a[160:163], v234 offset:10240
    v_mfma_f32_16x16x32_bf16 v[80:83], a[204:207], a[68:71], v[80:83]
    v_mfma_f32_16x16x32_bf16 v[84:87], a[200:203], a[72:75], v[84:87]
    v_mul_f32 v176, v176, v64
    v_mul_f32 v177, v177, v65
    v_mul_f32 v178, v178, v66
    v_mfma_f32_16x16x32_bf16 v[84:87], a[204:207], a[76:79], v[84:87]
    v_mul_f32 v179, v179, v67
    v_mul_f32 v64, v64, v236
    v_mfma_f32_16x16x32_bf16 v[88:91], a[200:203], a[80:83], v[88:91]
    ds_read_b128 a[164:167], v234 offset:11264
    v_mul_f32 v65, v65, v236
    v_mul_f32 v66, v66, v236
    v_mfma_f32_16x16x32_bf16 v[88:91], a[204:207], a[84:87], v[88:91]
    v_mul_f32 v67, v67, v236
    v_mul_f32 v180, v180, v68
    v_mfma_f32_16x16x32_bf16 v[92:95], a[200:203], a[88:91], v[92:95]
    v_mul_f32 v181, v181, v69
    v_mul_f32 v182, v182, v70
    v_mul_f32 v183, v183, v71
    v_mfma_f32_16x16x32_bf16 v[92:95], a[204:207], a[92:95], v[92:95]
    s_waitcnt lgkmcnt(2)
    v_mul_f32 v68, v68, v238
    v_mul_f32 v69, v69, v238
    v_mfma_f32_16x16x32_bf16 v[80:83], a[208:211], a[96:99], v[80:83]
    ds_read_b128 a[168:171], v232 offset:10240
    v_mul_f32 v70, v70, v238
    v_mul_f32 v71, v71, v238
    v_mfma_f32_16x16x32_bf16 v[80:83], a[212:215], a[100:103], v[80:83]
    v_exp_f32 v64, v64
    v_mul_f32 v184, v184, v72
    v_mfma_f32_16x16x32_bf16 v[84:87], a[208:211], a[104:107], v[84:87]
    v_exp_f32 v65, v65
    v_mfma_f32_16x16x32_bf16 v[84:87], a[212:215], a[108:111], v[84:87]
    v_mul_f32 v185, v185, v73
    v_exp_f32 v66, v66
    v_mfma_f32_16x16x32_bf16 v[88:91], a[208:211], a[112:115], v[88:91]
    ds_read_b128 a[172:175], v232 offset:11264
    v_mul_f32 v186, v186, v74
    v_mfma_f32_16x16x32_bf16 v[88:91], a[212:215], a[116:119], v[88:91]
    v_exp_f32 v67, v67
    v_mul_f32 v187, v187, v75
    v_mfma_f32_16x16x32_bf16 v[92:95], a[208:211], a[120:123], v[92:95]
    v_exp_f32 v68, v68
    v_mfma_f32_16x16x32_bf16 v[92:95], a[212:215], a[124:127], v[92:95]
    s_waitcnt lgkmcnt(2)
    v_mul_f32 v72, v72, v240
    v_exp_f32 v69, v69
    v_mfma_f32_16x16x32_bf16 v[80:83], a[160:163], a[128:131], v[80:83]
    ds_read_b128 a[176:179], v233 offset:24576
    v_mul_f32 v73, v73, v240
    v_mfma_f32_16x16x32_bf16 v[80:83], a[164:167], a[132:135], v[80:83]
    v_exp_f32 v70, v70
    v_mul_f32 v74, v74, v240
    v_mfma_f32_16x16x32_bf16 v[84:87], a[160:163], a[136:139], v[84:87]
    v_exp_f32 v71, v71
    v_mul_f32 v75, v75, v240
    v_mfma_f32_16x16x32_bf16 v[84:87], a[164:167], a[140:143], v[84:87]
    v_fma_f32 v64, v64, v237, v237
    v_fma_f32 v65, v65, v237, v237
    v_mfma_f32_16x16x32_bf16 v[88:91], a[160:163], a[144:147], v[88:91]
    ds_read_b128 a[180:183], v233 offset:25600
    v_fma_f32 v66, v66, v237, v237
    v_fma_f32 v67, v67, v237, v237
    v_mfma_f32_16x16x32_bf16 v[88:91], a[164:167], a[148:151], v[88:91]
    v_fma_f32 v68, v68, v239, v239
    v_fma_f32 v69, v69, v239, v239
    v_mfma_f32_16x16x32_bf16 v[92:95], a[160:163], a[152:155], v[92:95]
    v_fma_f32 v70, v70, v239, v239
    v_fma_f32 v71, v71, v239, v239
    v_mfma_f32_16x16x32_bf16 v[92:95], a[164:167], a[156:159], v[92:95]
    s_waitcnt lgkmcnt(2)
    v_rcp_f32 v64, v64
    v_mul_f32 v188, v188, v76
    v_mfma_f32_16x16x32_bf16 v[80:83], a[168:171], a[0:3], v[80:83]
    ds_read_b128 a[184:187], v233 offset:53248
    v_rcp_f32 v65, v65
    v_mfma_f32_16x16x32_bf16 v[80:83], a[172:175], a[4:7], v[80:83]
    v_mul_f32 v189, v189, v77
    v_rcp_f32 v66, v66
    v_mfma_f32_16x16x32_bf16 v[84:87], a[168:171], a[8:11], v[84:87]
    v_mul_f32 v190, v190, v78
    v_rcp_f32 v67, v67
    v_mfma_f32_16x16x32_bf16 v[84:87], a[172:175], a[12:15], v[84:87]
    v_mul_f32 v191, v191, v79
    v_mfma_f32_16x16x32_bf16 v[88:91], a[168:171], a[16:19], v[88:91]
    ds_read_b128 a[188:191], v233 offset:54272
    v_rcp_f32 v68, v68
    v_mfma_f32_16x16x32_bf16 v[88:91], a[172:175], a[20:23], v[88:91]
    v_mul_f32 v76, v76, v242
    v_rcp_f32 v69, v69
    v_mfma_f32_16x16x32_bf16 v[92:95], a[168:171], a[24:27], v[92:95]
    v_mul_f32 v77, v77, v242
    v_rcp_f32 v70, v70
    v_mfma_f32_16x16x32_bf16 v[92:95], a[172:175], a[28:31], v[92:95]
    s_waitcnt lgkmcnt(2)
    v_mul_f32 v78, v78, v242
    v_mfma_f32_16x16x32_bf16 v[192:195], a[176:179], a[64:67], v[192:195]
    ds_read_b128 a[192:195], v234 offset:24576
    v_rcp_f32 v71, v71
    v_mfma_f32_16x16x32_bf16 v[192:195], a[180:183], a[68:71], v[192:195]
    v_mul_f32 v79, v79, v242
    v_exp_f32 v72, v72
    v_mfma_f32_16x16x32_bf16 v[196:199], a[176:179], a[72:75], v[196:199]
    v_mul_f32 v176, v176, v64
    v_exp_f32 v73, v73
    v_mfma_f32_16x16x32_bf16 v[196:199], a[180:183], a[76:79], v[196:199]
    v_mul_f32 v177, v177, v65
    v_exp_f32 v74, v74
    v_mfma_f32_16x16x32_bf16 v[200:203], a[176:179], a[80:83], v[200:203]
    ds_read_b128 a[196:199], v234 offset:25600
    v_mul_f32 v178, v178, v66
    v_mfma_f32_16x16x32_bf16 v[200:203], a[180:183], a[84:87], v[200:203]
    v_exp_f32 v75, v75
    v_mfma_f32_16x16x32_bf16 v[204:207], a[176:179], a[88:91], v[204:207]
    v_mul_f32 v179, v179, v67
    v_exp_f32 v76, v76
    v_mfma_f32_16x16x32_bf16 v[204:207], a[180:183], a[92:95], v[204:207]
    s_waitcnt lgkmcnt(2)
    v_mul_f32 v180, v180, v68
    v_exp_f32 v77, v77
    v_mfma_f32_16x16x32_bf16 v[192:195], a[184:187], a[96:99], v[192:195]
    ds_read_b128 a[200:203], v232 offset:24576
    v_mul_f32 v181, v181, v69
    v_mfma_f32_16x16x32_bf16 v[192:195], a[188:191], a[100:103], v[192:195]
    v_exp_f32 v78, v78
    v_mul_f32 v182, v182, v70
    v_mfma_f32_16x16x32_bf16 v[196:199], a[184:187], a[104:107], v[196:199]
    v_exp_f32 v79, v79
    v_mfma_f32_16x16x32_bf16 v[196:199], a[188:191], a[108:111], v[196:199]
    v_mul_f32 v183, v183, v71
    v_fma_f32 v72, v72, v241, v241
    v_fma_f32 v73, v73, v241, v241
    v_mfma_f32_16x16x32_bf16 v[200:203], a[184:187], a[112:115], v[200:203]
    ds_read_b128 a[204:207], v232 offset:25600
    v_fma_f32 v74, v74, v241, v241
    v_mfma_f32_16x16x32_bf16 v[200:203], a[188:191], a[116:119], v[200:203]
    v_fma_f32 v75, v75, v241, v241
    v_fma_f32 v76, v76, v243, v243
    v_fma_f32 v77, v77, v243, v243
    v_mfma_f32_16x16x32_bf16 v[204:207], a[184:187], a[120:123], v[204:207]
    v_fma_f32 v78, v78, v243, v243
    v_fma_f32 v79, v79, v243, v243
    v_mfma_f32_16x16x32_bf16 v[204:207], a[188:191], a[124:127], v[204:207]
    s_waitcnt lgkmcnt(2)
    v_rcp_f32 v72, v72
    v_cvt_pk_bf16_f32 v64, v176, v177
    v_mfma_f32_16x16x32_bf16 v[192:195], a[192:195], a[128:131], v[192:195]
    ds_read_b128 a[208:211], v233 offset:12288
    v_rcp_f32 v73, v73
    v_mfma_f32_16x16x32_bf16 v[192:195], a[196:199], a[132:135], v[192:195]
    v_cvt_pk_bf16_f32 v66, v180, v181
    v_rcp_f32 v74, v74
    v_mfma_f32_16x16x32_bf16 v[196:199], a[192:195], a[136:139], v[196:199]
    v_cvt_pk_bf16_f32 v65, v178, v179
    v_mfma_f32_16x16x32_bf16 v[196:199], a[196:199], a[140:143], v[196:199]
    v_rcp_f32 v75, v75
    v_cvt_pk_bf16_f32 v67, v182, v183
    v_mfma_f32_16x16x32_bf16 v[200:203], a[192:195], a[144:147], v[200:203]
    ds_read_b128 a[212:215], v233 offset:13312
    v_rcp_f32 v76, v76
    v_mfma_f32_16x16x32_bf16 v[200:203], a[196:199], a[148:151], v[200:203]
    v_permlane32_swap_b32 v64, v66
    v_rcp_f32 v77, v77
    v_mfma_f32_16x16x32_bf16 v[204:207], a[192:195], a[152:155], v[204:207]
    s_nop 0
    v_mfma_f32_16x16x32_bf16 v[204:207], a[196:199], a[156:159], v[204:207]
    s_waitcnt lgkmcnt(2)
    v_rcp_f32 v78, v78
    v_permlane32_swap_b32 v65, v67
    v_mfma_f32_16x16x32_bf16 v[192:195], a[200:203], a[0:3], v[192:195]
    ds_read_b128 a[160:163], v233 offset:40960
    v_rcp_f32 v79, v79
    v_mfma_f32_16x16x32_bf16 v[192:195], a[204:207], a[4:7], v[192:195]
    buffer_store_dwordx4 v[64:67], v244, s[32:35], s60 offen offset:2048 sc1
    v_mul_f32 v184, v184, v72
    v_mul_f32 v185, v185, v73
    v_mfma_f32_16x16x32_bf16 v[196:199], a[200:203], a[8:11], v[196:199]
    v_mul_f32 v186, v186, v74
    v_mul_f32 v187, v187, v75
    v_mfma_f32_16x16x32_bf16 v[196:199], a[204:207], a[12:15], v[196:199]
    v_mul_f32 v188, v188, v76
    v_mul_f32 v189, v189, v77
    v_mul_f32 v190, v190, v78
    v_mfma_f32_16x16x32_bf16 v[200:203], a[200:203], a[16:19], v[200:203]
    ds_read_b128 a[164:167], v233 offset:41984
    v_mul_f32 v191, v191, v79
    v_mfma_f32_16x16x32_bf16 v[200:203], a[204:207], a[20:23], v[200:203]
    v_cvt_pk_bf16_f32 v72, v184, v185
    v_cvt_pk_bf16_f32 v74, v188, v189
    v_cvt_pk_bf16_f32 v73, v186, v187
    v_mfma_f32_16x16x32_bf16 v[204:207], a[200:203], a[24:27], v[204:207]
    v_cvt_pk_bf16_f32 v75, v190, v191
    v_permlane32_swap_b32 v72, v74
    v_mfma_f32_16x16x32_bf16 v[204:207], a[204:207], a[28:31], v[204:207]
    s_waitcnt lgkmcnt(2)
    s_nop 0
    v_permlane32_swap_b32 v73, v75
    buffer_store_dwordx4 v[72:75], v244, s[32:35], s61 offen offset:2048 sc1
    v_mfma_f32_16x16x32_bf16 v[96:99], a[208:211], a[64:67], v[96:99]
    ds_read_b128 a[168:171], v234 offset:12288
    v_mfma_f32_16x16x32_bf16 v[96:99], a[212:215], a[68:71], v[96:99]
    v_mfma_f32_16x16x32_bf16 v[100:103], a[208:211], a[72:75], v[100:103]
    v_mul_f32 v192, v192, v80
    v_mul_f32 v193, v193, v81
    v_mul_f32 v194, v194, v82
    v_mfma_f32_16x16x32_bf16 v[100:103], a[212:215], a[76:79], v[100:103]
    v_mul_f32 v195, v195, v83
    v_mul_f32 v80, v80, v236
    v_mfma_f32_16x16x32_bf16 v[104:107], a[208:211], a[80:83], v[104:107]
    ds_read_b128 a[172:175], v234 offset:13312
    v_mul_f32 v81, v81, v236
    v_mul_f32 v82, v82, v236
    v_mfma_f32_16x16x32_bf16 v[104:107], a[212:215], a[84:87], v[104:107]
    v_mul_f32 v83, v83, v236
    v_mul_f32 v196, v196, v84
    v_mfma_f32_16x16x32_bf16 v[108:111], a[208:211], a[88:91], v[108:111]
    v_mul_f32 v197, v197, v85
    v_mul_f32 v198, v198, v86
    v_mul_f32 v199, v199, v87
    v_mfma_f32_16x16x32_bf16 v[108:111], a[212:215], a[92:95], v[108:111]
    s_waitcnt lgkmcnt(2)
    v_mul_f32 v84, v84, v238
    v_mul_f32 v85, v85, v238
    v_mfma_f32_16x16x32_bf16 v[96:99], a[160:163], a[96:99], v[96:99]
    ds_read_b128 a[176:179], v232 offset:12288
    v_mul_f32 v86, v86, v238
    v_mul_f32 v87, v87, v238
    v_mfma_f32_16x16x32_bf16 v[96:99], a[164:167], a[100:103], v[96:99]
    v_exp_f32 v80, v80
    v_mfma_f32_16x16x32_bf16 v[100:103], a[160:163], a[104:107], v[100:103]
    v_mul_f32 v200, v200, v88
    v_exp_f32 v81, v81
    v_mfma_f32_16x16x32_bf16 v[100:103], a[164:167], a[108:111], v[100:103]
    v_mul_f32 v201, v201, v89
    v_exp_f32 v82, v82
    v_mfma_f32_16x16x32_bf16 v[104:107], a[160:163], a[112:115], v[104:107]
    ds_read_b128 a[180:183], v232 offset:13312
    v_mul_f32 v202, v202, v90
    v_mfma_f32_16x16x32_bf16 v[104:107], a[164:167], a[116:119], v[104:107]
    v_exp_f32 v83, v83
    v_mfma_f32_16x16x32_bf16 v[108:111], a[160:163], a[120:123], v[108:111]
    v_mul_f32 v203, v203, v91
    v_exp_f32 v84, v84
    v_mfma_f32_16x16x32_bf16 v[108:111], a[164:167], a[124:127], v[108:111]
    s_waitcnt lgkmcnt(2)
    v_mul_f32 v88, v88, v240
    v_exp_f32 v85, v85
    v_mfma_f32_16x16x32_bf16 v[96:99], a[168:171], a[128:131], v[96:99]
    ds_read_b128 a[184:187], v233 offset:26624
    v_mul_f32 v89, v89, v240
    v_mfma_f32_16x16x32_bf16 v[96:99], a[172:175], a[132:135], v[96:99]
    v_exp_f32 v86, v86
    v_mfma_f32_16x16x32_bf16 v[100:103], a[168:171], a[136:139], v[100:103]
    v_mul_f32 v90, v90, v240
    v_exp_f32 v87, v87
    v_mfma_f32_16x16x32_bf16 v[100:103], a[172:175], a[140:143], v[100:103]
    v_mul_f32 v91, v91, v240
    v_fma_f32 v80, v80, v237, v237
    v_mfma_f32_16x16x32_bf16 v[104:107], a[168:171], a[144:147], v[104:107]
    ds_read_b128 a[188:191], v233 offset:27648
    v_fma_f32 v81, v81, v237, v237
    v_fma_f32 v82, v82, v237, v237
    v_mfma_f32_16x16x32_bf16 v[104:107], a[172:175], a[148:151], v[104:107]
    v_fma_f32 v83, v83, v237, v237
    v_fma_f32 v84, v84, v239, v239
    v_mfma_f32_16x16x32_bf16 v[108:111], a[168:171], a[152:155], v[108:111]
    v_fma_f32 v85, v85, v239, v239
    v_fma_f32 v86, v86, v239, v239
    v_fma_f32 v87, v87, v239, v239
    v_mfma_f32_16x16x32_bf16 v[108:111], a[172:175], a[156:159], v[108:111]
    s_waitcnt lgkmcnt(2)
    v_rcp_f32 v80, v80
    v_mfma_f32_16x16x32_bf16 v[96:99], a[176:179], a[0:3], v[96:99]
    ds_read_b128 a[192:195], v233 offset:55296
    v_mul_f32 v204, v204, v92
    v_mfma_f32_16x16x32_bf16 v[96:99], a[180:183], a[4:7], v[96:99]
    v_rcp_f32 v81, v81
    v_mul_f32 v205, v205, v93
    v_mfma_f32_16x16x32_bf16 v[100:103], a[176:179], a[8:11], v[100:103]
    v_rcp_f32 v82, v82
    v_mul_f32 v206, v206, v94
    v_mfma_f32_16x16x32_bf16 v[100:103], a[180:183], a[12:15], v[100:103]
    v_rcp_f32 v83, v83
    v_mfma_f32_16x16x32_bf16 v[104:107], a[176:179], a[16:19], v[104:107]
    ds_read_b128 a[196:199], v233 offset:56320
    v_mul_f32 v207, v207, v95
    v_mfma_f32_16x16x32_bf16 v[104:107], a[180:183], a[20:23], v[104:107]
    v_rcp_f32 v84, v84
    v_mul_f32 v92, v92, v242
    v_mfma_f32_16x16x32_bf16 v[108:111], a[176:179], a[24:27], v[108:111]
    v_rcp_f32 v85, v85
    v_mul_f32 v93, v93, v242
    v_mfma_f32_16x16x32_bf16 v[108:111], a[180:183], a[28:31], v[108:111]
    s_waitcnt lgkmcnt(2)
    v_rcp_f32 v86, v86
    v_mfma_f32_16x16x32_bf16 v[208:211], a[184:187], a[64:67], v[208:211]
    ds_read_b128 a[200:203], v234 offset:26624
    v_mul_f32 v94, v94, v242
    v_mfma_f32_16x16x32_bf16 v[208:211], a[188:191], a[68:71], v[208:211]
    v_rcp_f32 v87, v87
    v_mul_f32 v95, v95, v242
    v_mfma_f32_16x16x32_bf16 v[212:215], a[184:187], a[72:75], v[212:215]
    v_exp_f32 v88, v88
    v_mul_f32 v192, v192, v80
    v_mfma_f32_16x16x32_bf16 v[212:215], a[188:191], a[76:79], v[212:215]
    v_exp_f32 v89, v89
    v_mfma_f32_16x16x32_bf16 v[216:219], a[184:187], a[80:83], v[216:219]
    ds_read_b128 a[204:207], v234 offset:27648
    v_mul_f32 v193, v193, v81
    v_mfma_f32_16x16x32_bf16 v[216:219], a[188:191], a[84:87], v[216:219]
    v_exp_f32 v90, v90
    v_mul_f32 v194, v194, v82
    v_mfma_f32_16x16x32_bf16 v[220:223], a[184:187], a[88:91], v[220:223]
    v_exp_f32 v91, v91
    v_mul_f32 v195, v195, v83
    v_mfma_f32_16x16x32_bf16 v[220:223], a[188:191], a[92:95], v[220:223]
    s_waitcnt lgkmcnt(2)
    v_exp_f32 v92, v92
    v_mfma_f32_16x16x32_bf16 v[208:211], a[192:195], a[96:99], v[208:211]
    ds_read_b128 a[208:211], v232 offset:26624
    v_mul_f32 v196, v196, v84
    v_mfma_f32_16x16x32_bf16 v[208:211], a[196:199], a[100:103], v[208:211]
    v_exp_f32 v93, v93
    v_mul_f32 v197, v197, v85
    v_mfma_f32_16x16x32_bf16 v[212:215], a[192:195], a[104:107], v[212:215]
    v_exp_f32 v94, v94
    v_mul_f32 v198, v198, v86
    v_mfma_f32_16x16x32_bf16 v[212:215], a[196:199], a[108:111], v[212:215]
    v_exp_f32 v95, v95
    v_mfma_f32_16x16x32_bf16 v[216:219], a[192:195], a[112:115], v[216:219]
    ds_read_b128 a[212:215], v232 offset:27648
    v_mul_f32 v199, v199, v87
    v_fma_f32 v88, v88, v241, v241
    v_mfma_f32_16x16x32_bf16 v[216:219], a[196:199], a[116:119], v[216:219]
    v_fma_f32 v89, v89, v241, v241
    v_fma_f32 v90, v90, v241, v241
    v_mfma_f32_16x16x32_bf16 v[220:223], a[192:195], a[120:123], v[220:223]
    v_fma_f32 v91, v91, v241, v241
    v_fma_f32 v92, v92, v243, v243
    v_fma_f32 v93, v93, v243, v243
    v_mfma_f32_16x16x32_bf16 v[220:223], a[196:199], a[124:127], v[220:223]
    s_waitcnt lgkmcnt(2)
    v_fma_f32 v94, v94, v243, v243
    v_fma_f32 v95, v95, v243, v243
    v_mfma_f32_16x16x32_bf16 v[208:211], a[200:203], a[128:131], v[208:211]
    v_rcp_f32 v88, v88
    v_cvt_pk_bf16_f32 v80, v192, v193
    v_mfma_f32_16x16x32_bf16 v[208:211], a[204:207], a[132:135], v[208:211]
    v_rcp_f32 v89, v89
    v_mfma_f32_16x16x32_bf16 v[212:215], a[200:203], a[136:139], v[212:215]
    v_cvt_pk_bf16_f32 v82, v196, v197
    v_rcp_f32 v90, v90
    v_mfma_f32_16x16x32_bf16 v[212:215], a[204:207], a[140:143], v[212:215]
    v_cvt_pk_bf16_f32 v81, v194, v195
    v_rcp_f32 v91, v91
    v_mfma_f32_16x16x32_bf16 v[216:219], a[200:203], a[144:147], v[216:219]
    v_cvt_pk_bf16_f32 v83, v198, v199
    v_mfma_f32_16x16x32_bf16 v[216:219], a[204:207], a[148:151], v[216:219]
    v_rcp_f32 v92, v92
    v_permlane32_swap_b32 v80, v82
    v_mfma_f32_16x16x32_bf16 v[220:223], a[200:203], a[152:155], v[220:223]
    v_rcp_f32 v93, v93
    s_nop 0
    v_mfma_f32_16x16x32_bf16 v[220:223], a[204:207], a[156:159], v[220:223]
    s_waitcnt lgkmcnt(0)
    v_rcp_f32 v94, v94
    v_mfma_f32_16x16x32_bf16 v[208:211], a[208:211], a[0:3], v[208:211]
    v_permlane32_swap_b32 v81, v83
    v_rcp_f32 v95, v95
    v_mfma_f32_16x16x32_bf16 v[208:211], a[212:215], a[4:7], v[208:211]
    buffer_store_dwordx4 v[80:83], v244, s[32:35], s60 offen offset:2560 sc1
    v_mul_f32 v200, v200, v88
    v_mfma_f32_16x16x32_bf16 v[212:215], a[208:211], a[8:11], v[212:215]
    v_mul_f32 v201, v201, v89
    v_mul_f32 v202, v202, v90
    v_mul_f32 v203, v203, v91
    v_mfma_f32_16x16x32_bf16 v[212:215], a[212:215], a[12:15], v[212:215]
    v_mul_f32 v204, v204, v92
    v_mul_f32 v205, v205, v93
    v_mfma_f32_16x16x32_bf16 v[216:219], a[208:211], a[16:19], v[216:219]
    v_mul_f32 v206, v206, v94
    v_mul_f32 v207, v207, v95
    v_cvt_pk_bf16_f32 v88, v200, v201
    v_mfma_f32_16x16x32_bf16 v[216:219], a[212:215], a[20:23], v[216:219]
    v_cvt_pk_bf16_f32 v90, v204, v205
    v_cvt_pk_bf16_f32 v89, v202, v203
    v_mfma_f32_16x16x32_bf16 v[220:223], a[208:211], a[24:27], v[220:223]
    v_cvt_pk_bf16_f32 v91, v206, v207
    v_permlane32_swap_b32 v88, v90
    s_nop 0
    v_mfma_f32_16x16x32_bf16 v[220:223], a[212:215], a[28:31], v[220:223]
    v_permlane32_swap_b32 v89, v91
    buffer_store_dwordx4 v[88:91], v244, s[32:35], s61 offen offset:2560 sc1
    s_barrier
    s_nop 5
    v_pk_mul_f32 v[208:209], v[208:209], v[96:97] op_sel:[0,0] op_sel_hi:[1,1]
    v_pk_mul_f32 v[210:211], v[210:211], v[98:99] op_sel:[0,0] op_sel_hi:[1,1]
    v_pk_mul_f32 v[96:97], v[96:97], v[236:237] op_sel:[0,0] op_sel_hi:[1,0]
    v_pk_mul_f32 v[98:99], v[98:99], v[236:237] op_sel:[0,0] op_sel_hi:[1,0]
    v_pk_mul_f32 v[212:213], v[212:213], v[100:101] op_sel:[0,0] op_sel_hi:[1,1]
    v_pk_mul_f32 v[214:215], v[214:215], v[102:103] op_sel:[0,0] op_sel_hi:[1,1]
    v_pk_mul_f32 v[100:101], v[100:101], v[238:239] op_sel:[0,0] op_sel_hi:[1,0]
    v_pk_mul_f32 v[102:103], v[102:103], v[238:239] op_sel:[0,0] op_sel_hi:[1,0]
    v_exp_f32 v96, v96
    v_exp_f32 v97, v97
    v_exp_f32 v98, v98
    v_exp_f32 v99, v99
    v_exp_f32 v100, v100
    v_exp_f32 v101, v101
    v_exp_f32 v102, v102
    v_exp_f32 v103, v103
    v_pk_fma_f32 v[96:97], v[96:97], v[236:237], v[236:237] op_sel:[0,1,1] op_sel_hi:[1,1,1]
    v_pk_fma_f32 v[98:99], v[98:99], v[236:237], v[236:237] op_sel:[0,1,1] op_sel_hi:[1,1,1]
    v_pk_fma_f32 v[100:101], v[100:101], v[238:239], v[238:239] op_sel:[0,1,1] op_sel_hi:[1,1,1]
    v_pk_fma_f32 v[102:103], v[102:103], v[238:239], v[238:239] op_sel:[0,1,1] op_sel_hi:[1,1,1]
    v_rcp_f32 v96, v96
    v_rcp_f32 v97, v97
    v_rcp_f32 v98, v98
    v_rcp_f32 v99, v99
    v_rcp_f32 v100, v100
    v_rcp_f32 v101, v101
    v_rcp_f32 v102, v102
    v_rcp_f32 v103, v103
    v_pk_mul_f32 v[208:209], v[208:209], v[96:97] op_sel:[0,0] op_sel_hi:[1,1]
    v_pk_mul_f32 v[210:211], v[210:211], v[98:99] op_sel:[0,0] op_sel_hi:[1,1]
    v_pk_mul_f32 v[212:213], v[212:213], v[100:101] op_sel:[0,0] op_sel_hi:[1,1]
    v_pk_mul_f32 v[214:215], v[214:215], v[102:103] op_sel:[0,0] op_sel_hi:[1,1]
    v_cvt_pk_bf16_f32 v96, v208, v209
    v_cvt_pk_bf16_f32 v98, v212, v213
    v_cvt_pk_bf16_f32 v97, v210, v211
    v_cvt_pk_bf16_f32 v99, v214, v215
    v_permlane32_swap_b32 v96, v98
    s_nop 0
    v_permlane32_swap_b32 v97, v99
    buffer_store_dwordx4 v[96:99], v244, s[32:35], s60 offen offset:3072 sc1
    v_pk_mul_f32 v[216:217], v[216:217], v[104:105] op_sel:[0,0] op_sel_hi:[1,1]
    v_pk_mul_f32 v[218:219], v[218:219], v[106:107] op_sel:[0,0] op_sel_hi:[1,1]
    v_pk_mul_f32 v[104:105], v[104:105], v[240:241] op_sel:[0,0] op_sel_hi:[1,0]
    v_pk_mul_f32 v[106:107], v[106:107], v[240:241] op_sel:[0,0] op_sel_hi:[1,0]
    v_pk_mul_f32 v[220:221], v[220:221], v[108:109] op_sel:[0,0] op_sel_hi:[1,1]
    v_pk_mul_f32 v[222:223], v[222:223], v[110:111] op_sel:[0,0] op_sel_hi:[1,1]
    v_pk_mul_f32 v[108:109], v[108:109], v[242:243] op_sel:[0,0] op_sel_hi:[1,0]
    v_pk_mul_f32 v[110:111], v[110:111], v[242:243] op_sel:[0,0] op_sel_hi:[1,0]
    v_exp_f32 v104, v104
    v_exp_f32 v105, v105
    v_exp_f32 v106, v106
    v_exp_f32 v107, v107
    v_exp_f32 v108, v108
    v_exp_f32 v109, v109
    v_exp_f32 v110, v110
    v_exp_f32 v111, v111
    v_pk_fma_f32 v[104:105], v[104:105], v[240:241], v[240:241] op_sel:[0,1,1] op_sel_hi:[1,1,1]
    v_pk_fma_f32 v[106:107], v[106:107], v[240:241], v[240:241] op_sel:[0,1,1] op_sel_hi:[1,1,1]
    v_pk_fma_f32 v[108:109], v[108:109], v[242:243], v[242:243] op_sel:[0,1,1] op_sel_hi:[1,1,1]
    v_pk_fma_f32 v[110:111], v[110:111], v[242:243], v[242:243] op_sel:[0,1,1] op_sel_hi:[1,1,1]
    v_rcp_f32 v104, v104
    v_rcp_f32 v105, v105
    v_rcp_f32 v106, v106
    v_rcp_f32 v107, v107
    v_rcp_f32 v108, v108
    v_rcp_f32 v109, v109
    v_rcp_f32 v110, v110
    v_rcp_f32 v111, v111
    v_pk_mul_f32 v[216:217], v[216:217], v[104:105] op_sel:[0,0] op_sel_hi:[1,1]
    v_pk_mul_f32 v[218:219], v[218:219], v[106:107] op_sel:[0,0] op_sel_hi:[1,1]
    v_pk_mul_f32 v[220:221], v[220:221], v[108:109] op_sel:[0,0] op_sel_hi:[1,1]
    v_pk_mul_f32 v[222:223], v[222:223], v[110:111] op_sel:[0,0] op_sel_hi:[1,1]
    v_cvt_pk_bf16_f32 v104, v216, v217
    v_cvt_pk_bf16_f32 v106, v220, v221
    v_cvt_pk_bf16_f32 v105, v218, v219
    v_cvt_pk_bf16_f32 v107, v222, v223
    v_permlane32_swap_b32 v104, v106
    s_nop 0
    v_permlane32_swap_b32 v105, v107
    buffer_store_dwordx4 v[104:107], v244, s[32:35], s61 offen offset:3072 sc1
    s_add_u32 s56, s55, 16384
    s_add_u32 m0, s53, 0
    s_nop 0
    buffer_load_dwordx4 v224, s[24:27], s56 offen offset:0 sc1 lds
    buffer_load_dwordx4 v224, s[24:27], s56 offen offset:1024 sc1 lds
    s_add_u32 s56, s52, 24576
    s_add_u32 m0, s53, 8192
    s_nop 0
    buffer_load_dwordx4 v224, s[24:27], s56 offen offset:0 sc1 lds
    buffer_load_dwordx4 v224, s[24:27], s56 offen offset:1024 sc1 lds
    s_add_u32 s56, s55, 24576
    s_add_u32 m0, s53, 16384
    s_nop 0
    buffer_load_dwordx4 v224, s[24:27], s56 offen offset:0 sc1 lds
    buffer_load_dwordx4 v224, s[24:27], s56 offen offset:1024 sc1 lds
    s_add_u32 s56, s52, 32768
    s_add_u32 m0, s53, 24576
    s_nop 0
    buffer_load_dwordx4 v224, s[24:27], s56 offen offset:0 sc1 lds
    buffer_load_dwordx4 v224, s[24:27], s56 offen offset:1024 sc1 lds
    s_xor_b32 s63, s2, 1
    s_lshl_b32 s48, s46, 3
    s_lshl_b32 s49, s3, 1
    s_add_u32 s48, s48, s49
    s_mul_i32 s49, s48, 114688
    s_mul_i32 s51, s54, 57344
    s_add_u32 s49, s49, s51
    v_mov_b32 v128, v231
    v_add_u32 v129, 0x10000, v231
    v_add_u32 v130, 0x20000, v231
    s_lshl_b32 s60, s48, 15
    s_lshl_b32 s61, s93, 11
    s_add_u32 s60, s60, s61
    s_add_u32 s58, s60, 32768
    s_lshr_b32 s62, s46, 1
    s_lshl_b32 s62, s62, 1
    s_add_u32 s62, s62, s54
    s_lshl_b32 s62, s62, 10
    s_add_u32 s62, s62, 49152
    s_and_b32 s51, s47, 3
    s_lshl_b32 s51, s51, 7
    s_add_u32 s62, s62, s51
    s_waitcnt vmcnt(8)
    s_barrier
    s_lshl_b32 s61, s3, 20
    s_add_u32 s61, s61, s94
    buffer_atomic_add v253, v249, s[88:91], s61 offen sc1
    buffer_load_dwordx4 v[160:163], v224, s[28:31], s60 offen offset:0 sc1
    buffer_load_dwordx4 v[164:167], v224, s[28:31], s60 offen offset:1024 sc1
    buffer_load_dwordx4 v[168:171], v224, s[28:31], s58 offen offset:0 sc1
    buffer_load_dwordx4 v[172:175], v224, s[28:31], s58 offen offset:1024 sc1
    s_add_u32 s56, s55, 32768
    s_add_u32 m0, s53, 57344
    s_nop 0
    buffer_load_dwordx4 v224, s[24:27], s56 offen offset:0 sc1 lds
    buffer_load_dwordx4 v224, s[24:27], s56 offen offset:1024 sc1 lds
    s_add_u32 s56, s52, 40960
    s_add_u32 m0, s53, 65536
    s_nop 0
    buffer_load_dwordx4 v224, s[24:27], s56 offen offset:0 sc1 lds
    buffer_load_dwordx4 v224, s[24:27], s56 offen offset:1024 sc1 lds
    s_add_u32 s56, s55, 40960
    s_add_u32 m0, s53, 73728
    s_nop 0
    buffer_load_dwordx4 v224, s[24:27], s56 offen offset:0 sc1 lds
    buffer_load_dwordx4 v224, s[24:27], s56 offen offset:1024 sc1 lds
    s_getpc_b64 s[76:77]
L_sequential_preLN__softmax_full_mha__glu_gated_swiglu__prompt_kernel_pc_24:
    s_add_u32 s76, s76, L_sequential_preLN__softmax_full_mha__glu_gated_swiglu__prompt_kernel_code5_23-L_sequential_preLN__softmax_full_mha__glu_gated_swiglu__prompt_kernel_pc_24
    s_addc_u32 s77, s77, (L_sequential_preLN__softmax_full_mha__glu_gated_swiglu__prompt_kernel_code5_23-L_sequential_preLN__softmax_full_mha__glu_gated_swiglu__prompt_kernel_pc_24)>>32
    s_lshl_b32 s78, s45, 2
    s_add_u32 s78, s78, s3
    s_lshl_b32 s78, s78, 9
    v_and_b32 v250, 3, v235
    v_lshl_add_u32 v250, v250, 7, s78
    v_min_u32 v250, L_sequential_preLN__softmax_full_mha__glu_gated_swiglu__prompt_kernel_end-L_sequential_preLN__softmax_full_mha__glu_gated_swiglu__prompt_kernel_code5_23, v250
L_stub_18:
    s_cbranch_execz L_warm_w20_ret
    v_mov_b32 v251, s77
    v_add_co_u32 v250, vcc, s76, v250
    s_nop 1
    v_addc_co_u32 v251, vcc, 0, v251, vcc
    global_load_dword v252, v[250:251], off
    s_cmp_eq_u32 s3, 0
    s_cbranch_scc1 L_sequential_preLN__softmax_full_mha__glu_gated_swiglu__prompt_kernel_poller_26
    s_mov_b64 exec, 0
    s_cmp_eq_u32 s3, 1
    s_cbranch_scc1 L_stub_19
    s_cmp_eq_u32 s3, 2
    s_cbranch_scc1 L_stub_20
    s_branch L_stub_21
L_warm_w28_ret:
    s_mov_b64 exec, -1
    s_branch L_sequential_preLN__softmax_full_mha__glu_gated_swiglu__prompt_kernel_pdone_25
L_sequential_preLN__softmax_full_mha__glu_gated_swiglu__prompt_kernel_poller_26:
    s_mov_b32 s50, 262144
    s_mov_b64 exec, 1
L_sequential_preLN__softmax_full_mha__glu_gated_swiglu__prompt_kernel_poll_27:
    v_mov_b32 v155, 0
    s_sub_u32 s50, s50, 1
    s_cbranch_scc1 L_sequential_preLN__softmax_full_mha__glu_gated_swiglu__prompt_kernel_pend_28
    buffer_atomic_add v155, v249, s[88:91], s62 offen sc0 sc1
    s_waitcnt vmcnt(0)
    v_cmp_gt_u32 vcc, 16, v155
    s_nop 4
    s_cbranch_vccnz L_sequential_preLN__softmax_full_mha__glu_gated_swiglu__prompt_kernel_poll_27
L_sequential_preLN__softmax_full_mha__glu_gated_swiglu__prompt_kernel_pend_28:
    s_mov_b64 exec, -1
L_sequential_preLN__softmax_full_mha__glu_gated_swiglu__prompt_kernel_pdone_25:
    s_waitcnt vmcnt(0)
    s_barrier
L_sequential_preLN__softmax_full_mha__glu_gated_swiglu__prompt_kernel_code5_23:
    s_add_u32 s57, s49, 0
    buffer_load_dwordx4 a[0:3], v224, s[32:35], s57 offen offset:0 sc1
    buffer_load_dwordx4 a[4:7], v224, s[32:35], s57 offen offset:1024 sc1
    s_add_u32 s57, s49, 114688
    buffer_load_dwordx4 a[8:11], v224, s[32:35], s57 offen offset:0 sc1
    buffer_load_dwordx4 a[12:15], v224, s[32:35], s57 offen offset:1024 sc1
    ds_read_b128 v[64:67], v128 offset:32768
    ds_read_b128 v[68:71], v128 offset:36864
    ds_read_b128 v[72:75], v128 offset:33792
    ds_read_b128 v[76:79], v128 offset:37888
    ds_read_b128 v[80:83], v128 offset:34816
    ds_read_b128 v[84:87], v128 offset:38912
    s_add_u32 s57, s49, 2048
    buffer_load_dwordx4 a[16:19], v224, s[32:35], s57 offen offset:0 sc1
    buffer_load_dwordx4 a[20:23], v224, s[32:35], s57 offen offset:1024 sc1
    s_add_u32 s57, s49, 116736
    buffer_load_dwordx4 a[24:27], v224, s[32:35], s57 offen offset:0 sc1
    buffer_load_dwordx4 a[28:31], v224, s[32:35], s57 offen offset:1024 sc1
    s_add_u32 s57, s49, 4096
    buffer_load_dwordx4 a[32:35], v224, s[32:35], s57 offen offset:0 sc1
    buffer_load_dwordx4 a[36:39], v224, s[32:35], s57 offen offset:1024 sc1
    s_add_u32 s57, s49, 118784
    buffer_load_dwordx4 a[40:43], v224, s[32:35], s57 offen offset:0 sc1
    buffer_load_dwordx4 a[44:47], v224, s[32:35], s57 offen offset:1024 sc1
    v_lshlrev_b32 v0, 16, v160
    v_and_b32 v1, 0xffff0000, v160
    v_lshlrev_b32 v2, 16, v161
    v_and_b32 v3, 0xffff0000, v161
    v_lshlrev_b32 v8, 16, v162
    v_and_b32 v9, 0xffff0000, v162
    v_lshlrev_b32 v10, 16, v163
    v_and_b32 v11, 0xffff0000, v163
    v_lshlrev_b32 v16, 16, v164
    v_and_b32 v17, 0xffff0000, v164
    v_lshlrev_b32 v18, 16, v165
    v_and_b32 v19, 0xffff0000, v165
    v_lshlrev_b32 v24, 16, v166
    v_and_b32 v25, 0xffff0000, v166
    v_lshlrev_b32 v26, 16, v167
    v_and_b32 v27, 0xffff0000, v167
    v_lshlrev_b32 v4, 16, v168
    v_and_b32 v5, 0xffff0000, v168
    v_lshlrev_b32 v6, 16, v169
    v_and_b32 v7, 0xffff0000, v169
    v_lshlrev_b32 v12, 16, v170
    v_and_b32 v13, 0xffff0000, v170
    v_lshlrev_b32 v14, 16, v171
    v_and_b32 v15, 0xffff0000, v171
    v_lshlrev_b32 v20, 16, v172
    v_and_b32 v21, 0xffff0000, v172
    v_lshlrev_b32 v22, 16, v173
    v_and_b32 v23, 0xffff0000, v173
    v_lshlrev_b32 v28, 16, v174
    v_and_b32 v29, 0xffff0000, v174
    v_lshlrev_b32 v30, 16, v175
    v_and_b32 v31, 0xffff0000, v175
    s_nop 0
    s_waitcnt vmcnt(8)
    s_waitcnt lgkmcnt(4)
    v_mfma_f32_16x16x32_bf16 v[0:3], v[64:67], a[0:3], v[0:3]
    s_add_u32 s57, s49, 6144
    ds_read_b128 v[88:91], v128 offset:35840
    v_mfma_f32_16x16x32_bf16 v[0:3], v[68:71], a[4:7], v[0:3]
    buffer_load_dwordx4 a[48:51], v224, s[32:35], s57 offen offset:0 sc1
    v_mfma_f32_16x16x32_bf16 v[4:7], v[64:67], a[8:11], v[4:7]
    ds_read_b128 v[92:95], v128 offset:39936
    v_mfma_f32_16x16x32_bf16 v[4:7], v[68:71], a[12:15], v[4:7]
    s_waitcnt lgkmcnt(4)
    v_mfma_f32_16x16x32_bf16 v[8:11], v[72:75], a[0:3], v[8:11]
    ds_read_b128 v[64:67], v128 offset:40960
    v_mfma_f32_16x16x32_bf16 v[8:11], v[76:79], a[4:7], v[8:11]
    buffer_load_dwordx4 a[52:55], v224, s[32:35], s57 offen offset:1024 sc1
    v_mfma_f32_16x16x32_bf16 v[12:15], v[72:75], a[8:11], v[12:15]
    ds_read_b128 v[68:71], v128 offset:45056
    v_mfma_f32_16x16x32_bf16 v[12:15], v[76:79], a[12:15], v[12:15]
    s_waitcnt lgkmcnt(4)
    v_mfma_f32_16x16x32_bf16 v[16:19], v[80:83], a[0:3], v[16:19]
    s_add_u32 s57, s49, 120832
    ds_read_b128 v[72:75], v128 offset:41984
    v_mfma_f32_16x16x32_bf16 v[16:19], v[84:87], a[4:7], v[16:19]
    buffer_load_dwordx4 a[56:59], v224, s[32:35], s57 offen offset:0 sc1
    v_mfma_f32_16x16x32_bf16 v[20:23], v[80:83], a[8:11], v[20:23]
    ds_read_b128 v[76:79], v128 offset:46080
    v_mfma_f32_16x16x32_bf16 v[20:23], v[84:87], a[12:15], v[20:23]
    s_waitcnt lgkmcnt(4)
    v_mfma_f32_16x16x32_bf16 v[24:27], v[88:91], a[0:3], v[24:27]
    ds_read_b128 v[80:83], v128 offset:43008
    v_mfma_f32_16x16x32_bf16 v[24:27], v[92:95], a[4:7], v[24:27]
    buffer_load_dwordx4 a[60:63], v224, s[32:35], s57 offen offset:1024 sc1
    v_mfma_f32_16x16x32_bf16 v[28:31], v[88:91], a[8:11], v[28:31]
    ds_read_b128 v[84:87], v128 offset:47104
    v_mfma_f32_16x16x32_bf16 v[28:31], v[92:95], a[12:15], v[28:31]
    s_waitcnt lgkmcnt(4)
    v_mfma_f32_16x16x32_bf16 v[32:35], v[64:67], a[0:3], 0
    s_add_u32 s57, s49, 8192
    ds_read_b128 v[88:91], v128 offset:44032
    v_mfma_f32_16x16x32_bf16 v[32:35], v[68:71], a[4:7], v[32:35]
    buffer_load_dwordx4 a[64:67], v224, s[32:35], s57 offen offset:0 sc1
    v_mfma_f32_16x16x32_bf16 v[36:39], v[64:67], a[8:11], 0
    ds_read_b128 v[92:95], v128 offset:48128
    v_mfma_f32_16x16x32_bf16 v[36:39], v[68:71], a[12:15], v[36:39]
    s_waitcnt lgkmcnt(4)
    v_mfma_f32_16x16x32_bf16 v[40:43], v[72:75], a[0:3], 0
    ds_read_b128 v[64:67], v128 offset:49152
    v_mfma_f32_16x16x32_bf16 v[40:43], v[76:79], a[4:7], v[40:43]
    buffer_load_dwordx4 a[68:71], v224, s[32:35], s57 offen offset:1024 sc1
    v_mfma_f32_16x16x32_bf16 v[44:47], v[72:75], a[8:11], 0
    ds_read_b128 v[68:71], v128 offset:53248
    v_mfma_f32_16x16x32_bf16 v[44:47], v[76:79], a[12:15], v[44:47]
    s_waitcnt lgkmcnt(4)
    v_mfma_f32_16x16x32_bf16 v[48:51], v[80:83], a[0:3], 0
    s_add_u32 s57, s49, 122880
    ds_read_b128 v[72:75], v128 offset:50176
    v_mfma_f32_16x16x32_bf16 v[48:51], v[84:87], a[4:7], v[48:51]
    buffer_load_dwordx4 a[72:75], v224, s[32:35], s57 offen offset:0 sc1
    v_mfma_f32_16x16x32_bf16 v[52:55], v[80:83], a[8:11], 0
    ds_read_b128 v[76:79], v128 offset:54272
    v_mfma_f32_16x16x32_bf16 v[52:55], v[84:87], a[12:15], v[52:55]
    s_waitcnt lgkmcnt(4)
    v_mfma_f32_16x16x32_bf16 v[56:59], v[88:91], a[0:3], 0
    ds_read_b128 v[80:83], v128 offset:51200
    v_mfma_f32_16x16x32_bf16 v[56:59], v[92:95], a[4:7], v[56:59]
    buffer_load_dwordx4 a[76:79], v224, s[32:35], s57 offen offset:1024 sc1
    v_mfma_f32_16x16x32_bf16 v[60:63], v[88:91], a[8:11], 0
    s_waitcnt vmcnt(12)
    ds_read_b128 v[84:87], v128 offset:55296
    v_mfma_f32_16x16x32_bf16 v[60:63], v[92:95], a[12:15], v[60:63]
    s_waitcnt lgkmcnt(4)
    v_mfma_f32_16x16x32_bf16 v[0:3], v[64:67], a[16:19], v[0:3]
    s_add_u32 s57, s49, 10240
    ds_read_b128 v[88:91], v128 offset:52224
    v_mfma_f32_16x16x32_bf16 v[0:3], v[68:71], a[20:23], v[0:3]
    buffer_load_dwordx4 a[80:83], v224, s[32:35], s57 offen offset:0 sc1
    v_mfma_f32_16x16x32_bf16 v[4:7], v[64:67], a[24:27], v[4:7]
    ds_read_b128 v[92:95], v128 offset:56320
    v_mfma_f32_16x16x32_bf16 v[4:7], v[68:71], a[28:31], v[4:7]
    s_waitcnt lgkmcnt(4)
    v_mfma_f32_16x16x32_bf16 v[8:11], v[72:75], a[16:19], v[8:11]
    ds_read_b128 v[64:67], v130 offset:16384
    v_mfma_f32_16x16x32_bf16 v[8:11], v[76:79], a[20:23], v[8:11]
    buffer_load_dwordx4 a[84:87], v224, s[32:35], s57 offen offset:1024 sc1
    v_mfma_f32_16x16x32_bf16 v[12:15], v[72:75], a[24:27], v[12:15]
    ds_read_b128 v[68:71], v130 offset:20480
    v_mfma_f32_16x16x32_bf16 v[12:15], v[76:79], a[28:31], v[12:15]
    s_waitcnt lgkmcnt(4)
    v_mfma_f32_16x16x32_bf16 v[16:19], v[80:83], a[16:19], v[16:19]
    s_add_u32 s57, s49, 124928
    ds_read_b128 v[72:75], v130 offset:17408
    v_mfma_f32_16x16x32_bf16 v[16:19], v[84:87], a[20:23], v[16:19]
    buffer_load_dwordx4 a[88:91], v224, s[32:35], s57 offen offset:0 sc1
    v_mfma_f32_16x16x32_bf16 v[20:23], v[80:83], a[24:27], v[20:23]
    ds_read_b128 v[76:79], v130 offset:21504
    v_mfma_f32_16x16x32_bf16 v[20:23], v[84:87], a[28:31], v[20:23]
    s_waitcnt lgkmcnt(4)
    v_mfma_f32_16x16x32_bf16 v[24:27], v[88:91], a[16:19], v[24:27]
    ds_read_b128 v[80:83], v130 offset:18432
    v_mfma_f32_16x16x32_bf16 v[24:27], v[92:95], a[20:23], v[24:27]
    buffer_load_dwordx4 a[92:95], v224, s[32:35], s57 offen offset:1024 sc1
    v_mfma_f32_16x16x32_bf16 v[28:31], v[88:91], a[24:27], v[28:31]
    ds_read_b128 v[84:87], v130 offset:22528
    v_mfma_f32_16x16x32_bf16 v[28:31], v[92:95], a[28:31], v[28:31]
    s_waitcnt lgkmcnt(4)
    v_mfma_f32_16x16x32_bf16 v[32:35], v[64:67], a[16:19], v[32:35]
    s_add_u32 s56, s52, 49152
    ds_read_b128 v[88:91], v130 offset:19456
    s_add_u32 m0, s53, 81920
    v_mfma_f32_16x16x32_bf16 v[32:35], v[68:71], a[20:23], v[32:35]
    buffer_load_dwordx4 v224, s[24:27], s56 offen offset:0 sc1 lds
    v_mfma_f32_16x16x32_bf16 v[36:39], v[64:67], a[24:27], v[36:39]
    ds_read_b128 v[92:95], v130 offset:23552
    v_mfma_f32_16x16x32_bf16 v[36:39], v[68:71], a[28:31], v[36:39]
    s_waitcnt lgkmcnt(4)
    v_mfma_f32_16x16x32_bf16 v[40:43], v[72:75], a[16:19], v[40:43]
    ds_read_b128 v[64:67], v130 offset:24576
    v_mfma_f32_16x16x32_bf16 v[40:43], v[76:79], a[20:23], v[40:43]
    buffer_load_dwordx4 v224, s[24:27], s56 offen offset:1024 sc1 lds
    v_mfma_f32_16x16x32_bf16 v[44:47], v[72:75], a[24:27], v[44:47]
    ds_read_b128 v[68:71], v130 offset:28672
    v_mfma_f32_16x16x32_bf16 v[44:47], v[76:79], a[28:31], v[44:47]
    s_waitcnt lgkmcnt(4)
    v_mfma_f32_16x16x32_bf16 v[48:51], v[80:83], a[16:19], v[48:51]
    s_add_u32 s56, s55, 49152
    ds_read_b128 v[72:75], v130 offset:25600
    s_add_u32 m0, s53, 90112
    v_mfma_f32_16x16x32_bf16 v[48:51], v[84:87], a[20:23], v[48:51]
    buffer_load_dwordx4 v224, s[24:27], s56 offen offset:0 sc1 lds
    v_mfma_f32_16x16x32_bf16 v[52:55], v[80:83], a[24:27], v[52:55]
    ds_read_b128 v[76:79], v130 offset:29696
    v_mfma_f32_16x16x32_bf16 v[52:55], v[84:87], a[28:31], v[52:55]
    s_waitcnt lgkmcnt(4)
    v_mfma_f32_16x16x32_bf16 v[56:59], v[88:91], a[16:19], v[56:59]
    ds_read_b128 v[80:83], v130 offset:26624
    v_mfma_f32_16x16x32_bf16 v[56:59], v[92:95], a[20:23], v[56:59]
    buffer_load_dwordx4 v224, s[24:27], s56 offen offset:1024 sc1 lds
    v_mfma_f32_16x16x32_bf16 v[60:63], v[88:91], a[24:27], v[60:63]
    s_waitcnt vmcnt(16)
    ds_read_b128 v[84:87], v130 offset:30720
    v_mfma_f32_16x16x32_bf16 v[60:63], v[92:95], a[28:31], v[60:63]
    s_waitcnt lgkmcnt(4)
    v_mfma_f32_16x16x32_bf16 v[0:3], v[64:67], a[32:35], v[0:3]
    s_add_u32 s57, s49, 12288
    ds_read_b128 v[88:91], v130 offset:27648
    v_mfma_f32_16x16x32_bf16 v[0:3], v[68:71], a[36:39], v[0:3]
    buffer_load_dwordx4 a[96:99], v224, s[32:35], s57 offen offset:0 sc1
    v_mfma_f32_16x16x32_bf16 v[4:7], v[64:67], a[40:43], v[4:7]
    ds_read_b128 v[92:95], v130 offset:31744
    v_mfma_f32_16x16x32_bf16 v[4:7], v[68:71], a[44:47], v[4:7]
    s_waitcnt lgkmcnt(4)
    s_lshl_b32 s64, s2, 2
    v_mfma_f32_16x16x32_bf16 v[8:11], v[72:75], a[32:35], v[8:11]
    ds_read_b128 v[64:67], v128 offset:0
    v_mfma_f32_16x16x32_bf16 v[8:11], v[76:79], a[36:39], v[8:11]
    buffer_load_dwordx4 a[100:103], v224, s[32:35], s57 offen offset:1024 sc1
    v_mfma_f32_16x16x32_bf16 v[12:15], v[72:75], a[40:43], v[12:15]
    ds_read_b128 v[68:71], v128 offset:4096
    v_mfma_f32_16x16x32_bf16 v[12:15], v[76:79], a[44:47], v[12:15]
    s_waitcnt lgkmcnt(4)
    s_add_u32 s64, s64, s3
    v_mfma_f32_16x16x32_bf16 v[16:19], v[80:83], a[32:35], v[16:19]
    s_add_u32 s57, s49, 126976
    ds_read_b128 v[72:75], v128 offset:1024
    v_mfma_f32_16x16x32_bf16 v[16:19], v[84:87], a[36:39], v[16:19]
    buffer_load_dwordx4 a[104:107], v224, s[32:35], s57 offen offset:0 sc1
    v_mfma_f32_16x16x32_bf16 v[20:23], v[80:83], a[40:43], v[20:23]
    ds_read_b128 v[76:79], v128 offset:5120
    v_mfma_f32_16x16x32_bf16 v[20:23], v[84:87], a[44:47], v[20:23]
    s_waitcnt lgkmcnt(4)
    v_mfma_f32_16x16x32_bf16 v[24:27], v[88:91], a[32:35], v[24:27]
    s_lshl_b32 s65, s63, 2
    ds_read_b128 v[80:83], v128 offset:2048
    v_mfma_f32_16x16x32_bf16 v[24:27], v[92:95], a[36:39], v[24:27]
    buffer_load_dwordx4 a[108:111], v224, s[32:35], s57 offen offset:1024 sc1
    v_mfma_f32_16x16x32_bf16 v[28:31], v[88:91], a[40:43], v[28:31]
    ds_read_b128 v[84:87], v128 offset:6144
    v_mfma_f32_16x16x32_bf16 v[28:31], v[92:95], a[44:47], v[28:31]
    s_waitcnt lgkmcnt(4)
    v_mfma_f32_16x16x32_bf16 v[32:35], v[64:67], a[32:35], v[32:35]
    s_add_u32 s56, s52, 57344
    ds_read_b128 v[88:91], v128 offset:3072
    s_add_u32 m0, s53, 98304
    v_mfma_f32_16x16x32_bf16 v[32:35], v[68:71], a[36:39], v[32:35]
    buffer_load_dwordx4 v224, s[24:27], s56 offen offset:0 sc1 lds
    v_mfma_f32_16x16x32_bf16 v[36:39], v[64:67], a[40:43], v[36:39]
    ds_read_b128 v[92:95], v128 offset:7168
    v_mfma_f32_16x16x32_bf16 v[36:39], v[68:71], a[44:47], v[36:39]
    s_waitcnt lgkmcnt(4)
    s_add_u32 s65, s65, s3
    v_mfma_f32_16x16x32_bf16 v[40:43], v[72:75], a[32:35], v[40:43]
    ds_read_b128 v[64:67], v128 offset:8192
    v_mfma_f32_16x16x32_bf16 v[40:43], v[76:79], a[36:39], v[40:43]
    buffer_load_dwordx4 v224, s[24:27], s56 offen offset:1024 sc1 lds
    v_mfma_f32_16x16x32_bf16 v[44:47], v[72:75], a[40:43], v[44:47]
    ds_read_b128 v[68:71], v128 offset:12288
    v_mfma_f32_16x16x32_bf16 v[44:47], v[76:79], a[44:47], v[44:47]
    s_waitcnt lgkmcnt(4)
    s_lshl_b32 s66, s64, 12
    v_mfma_f32_16x16x32_bf16 v[48:51], v[80:83], a[32:35], v[48:51]
    s_add_u32 s56, s55, 57344
    ds_read_b128 v[72:75], v128 offset:9216
    s_add_u32 m0, s53, 106496
    v_mfma_f32_16x16x32_bf16 v[48:51], v[84:87], a[36:39], v[48:51]
    buffer_load_dwordx4 v224, s[24:27], s56 offen offset:0 sc1 lds
    v_mfma_f32_16x16x32_bf16 v[52:55], v[80:83], a[40:43], v[52:55]
    ds_read_b128 v[76:79], v128 offset:13312
    v_mfma_f32_16x16x32_bf16 v[52:55], v[84:87], a[44:47], v[52:55]
    s_waitcnt lgkmcnt(4)
    v_mfma_f32_16x16x32_bf16 v[56:59], v[88:91], a[32:35], v[56:59]
    ds_read_b128 v[80:83], v128 offset:10240
    v_mfma_f32_16x16x32_bf16 v[56:59], v[92:95], a[36:39], v[56:59]
    s_lshl_b32 s67, s65, 12
    buffer_load_dwordx4 v224, s[24:27], s56 offen offset:1024 sc1 lds
    v_mfma_f32_16x16x32_bf16 v[60:63], v[88:91], a[40:43], v[60:63]
    s_waitcnt vmcnt(20)
    ds_read_b128 v[84:87], v128 offset:14336
    v_mfma_f32_16x16x32_bf16 v[60:63], v[92:95], a[44:47], v[60:63]
    s_waitcnt lgkmcnt(4)
    v_mfma_f32_16x16x32_bf16 v[0:3], v[64:67], a[48:51], v[0:3]
    s_add_u32 s57, s49, 14336
    ds_read_b128 v[88:91], v128 offset:11264
    v_mfma_f32_16x16x32_bf16 v[0:3], v[68:71], a[52:55], v[0:3]
    buffer_load_dwordx4 a[112:115], v224, s[32:35], s57 offen offset:0 sc1
    v_mfma_f32_16x16x32_bf16 v[4:7], v[64:67], a[56:59], v[4:7]
    s_mov_b32 s42, 4194304
    ds_read_b128 v[92:95], v128 offset:15360
    v_mfma_f32_16x16x32_bf16 v[4:7], v[68:71], a[60:63], v[4:7]
    s_waitcnt lgkmcnt(4)
    v_mfma_f32_16x16x32_bf16 v[8:11], v[72:75], a[48:51], v[8:11]
    ds_read_b128 v[64:67], v128 offset:16384
    v_mfma_f32_16x16x32_bf16 v[8:11], v[76:79], a[52:55], v[8:11]
    buffer_load_dwordx4 a[116:119], v224, s[32:35], s57 offen offset:1024 sc1
    v_mfma_f32_16x16x32_bf16 v[12:15], v[72:75], a[56:59], v[12:15]
    ds_read_b128 v[68:71], v128 offset:20480
    v_mfma_f32_16x16x32_bf16 v[12:15], v[76:79], a[60:63], v[12:15]
    s_waitcnt lgkmcnt(4)
    s_mov_b32 s36, s18
    v_mfma_f32_16x16x32_bf16 v[16:19], v[80:83], a[48:51], v[16:19]
    s_add_u32 s57, s49, 129024
    ds_read_b128 v[72:75], v128 offset:17408
    v_mfma_f32_16x16x32_bf16 v[16:19], v[84:87], a[52:55], v[16:19]
    buffer_load_dwordx4 a[120:123], v224, s[32:35], s57 offen offset:0 sc1
    v_mfma_f32_16x16x32_bf16 v[20:23], v[80:83], a[56:59], v[20:23]
    ds_read_b128 v[76:79], v128 offset:21504
    v_mfma_f32_16x16x32_bf16 v[20:23], v[84:87], a[60:63], v[20:23]
    s_waitcnt lgkmcnt(4)
    v_mfma_f32_16x16x32_bf16 v[24:27], v[88:91], a[48:51], v[24:27]
    s_mov_b32 s37, s19
    ds_read_b128 v[80:83], v128 offset:18432
    v_mfma_f32_16x16x32_bf16 v[24:27], v[92:95], a[52:55], v[24:27]
    buffer_load_dwordx4 a[124:127], v224, s[32:35], s57 offen offset:1024 sc1
    v_mfma_f32_16x16x32_bf16 v[28:31], v[88:91], a[56:59], v[28:31]
    ds_read_b128 v[84:87], v128 offset:22528
    v_mfma_f32_16x16x32_bf16 v[28:31], v[92:95], a[60:63], v[28:31]
    s_waitcnt lgkmcnt(4)
    v_mfma_f32_16x16x32_bf16 v[32:35], v[64:67], a[48:51], v[32:35]
    s_add_u32 s56, s52, 65536
    ds_read_b128 v[88:91], v128 offset:19456
    s_add_u32 m0, s53, 114688
    v_mfma_f32_16x16x32_bf16 v[32:35], v[68:71], a[52:55], v[32:35]
    buffer_load_dwordx4 v224, s[24:27], s56 offen offset:0 sc1 lds
    v_mfma_f32_16x16x32_bf16 v[36:39], v[64:67], a[56:59], v[36:39]
    s_mov_b32 s38, 4194304
    ds_read_b128 v[92:95], v128 offset:23552
    v_mfma_f32_16x16x32_bf16 v[36:39], v[68:71], a[60:63], v[36:39]
    s_waitcnt lgkmcnt(4)
    v_mfma_f32_16x16x32_bf16 v[40:43], v[72:75], a[48:51], v[40:43]
    ds_read_b128 v[64:67], v128 offset:24576
    v_mfma_f32_16x16x32_bf16 v[40:43], v[76:79], a[52:55], v[40:43]
    buffer_load_dwordx4 v224, s[24:27], s56 offen offset:1024 sc1 lds
    v_mfma_f32_16x16x32_bf16 v[44:47], v[72:75], a[56:59], v[44:47]
    ds_read_b128 v[68:71], v128 offset:28672
    v_mfma_f32_16x16x32_bf16 v[44:47], v[76:79], a[60:63], v[44:47]
    s_waitcnt lgkmcnt(4)
    v_and_b32 v152, 15, v235
    v_mfma_f32_16x16x32_bf16 v[48:51], v[80:83], a[48:51], v[48:51]
    s_add_u32 s56, s55, 65536
    ds_read_b128 v[72:75], v128 offset:25600
    s_add_u32 m0, s53, 122880
    v_mfma_f32_16x16x32_bf16 v[48:51], v[84:87], a[52:55], v[48:51]
    buffer_load_dwordx4 v224, s[24:27], s56 offen offset:0 sc1 lds
    v_mfma_f32_16x16x32_bf16 v[52:55], v[80:83], a[56:59], v[52:55]
    ds_read_b128 v[76:79], v128 offset:29696
    v_mfma_f32_16x16x32_bf16 v[52:55], v[84:87], a[60:63], v[52:55]
    s_waitcnt lgkmcnt(4)
    v_mfma_f32_16x16x32_bf16 v[56:59], v[88:91], a[48:51], v[56:59]
    ds_read_b128 v[80:83], v128 offset:26624
    v_mfma_f32_16x16x32_bf16 v[56:59], v[92:95], a[52:55], v[56:59]
    buffer_load_dwordx4 v224, s[24:27], s56 offen offset:1024 sc1 lds
    v_lshrrev_b32 v153, 4, v235
    v_mfma_f32_16x16x32_bf16 v[60:63], v[88:91], a[56:59], v[60:63]
    s_waitcnt vmcnt(24)
    ds_read_b128 v[84:87], v128 offset:30720
    v_mfma_f32_16x16x32_bf16 v[60:63], v[92:95], a[60:63], v[60:63]
    s_waitcnt lgkmcnt(4)
    v_mfma_f32_16x16x32_bf16 v[0:3], v[64:67], a[64:67], v[0:3]
    s_add_u32 s57, s49, 16384
    ds_read_b128 v[88:91], v128 offset:27648
    v_mfma_f32_16x16x32_bf16 v[0:3], v[68:71], a[68:71], v[0:3]
    buffer_load_dwordx4 a[128:131], v224, s[32:35], s57 offen offset:0 sc1
    v_mfma_f32_16x16x32_bf16 v[4:7], v[64:67], a[72:75], v[4:7]
    ds_read_b128 v[92:95], v128 offset:31744
    v_and_b32 v154, 1, v153
    v_mfma_f32_16x16x32_bf16 v[4:7], v[68:71], a[76:79], v[4:7]
    s_waitcnt lgkmcnt(4)
    v_mfma_f32_16x16x32_bf16 v[8:11], v[72:75], a[64:67], v[8:11]
    ds_read_b128 v[64:67], v128 offset:57344
    v_mfma_f32_16x16x32_bf16 v[8:11], v[76:79], a[68:71], v[8:11]
    buffer_load_dwordx4 a[132:135], v224, s[32:35], s57 offen offset:1024 sc1
    v_mfma_f32_16x16x32_bf16 v[12:15], v[72:75], a[72:75], v[12:15]
    ds_read_b128 v[68:71], v128 offset:61440
    v_mfma_f32_16x16x32_bf16 v[12:15], v[76:79], a[76:79], v[12:15]
    s_waitcnt lgkmcnt(4)
    v_lshrrev_b32 v155, 1, v153
    v_mfma_f32_16x16x32_bf16 v[16:19], v[80:83], a[64:67], v[16:19]
    s_add_u32 s57, s49, 131072
    ds_read_b128 v[72:75], v128 offset:58368
    v_mfma_f32_16x16x32_bf16 v[16:19], v[84:87], a[68:71], v[16:19]
    buffer_load_dwordx4 a[136:139], v224, s[32:35], s57 offen offset:0 sc1
    v_mfma_f32_16x16x32_bf16 v[20:23], v[80:83], a[72:75], v[20:23]
    ds_read_b128 v[76:79], v128 offset:62464
    v_mfma_f32_16x16x32_bf16 v[20:23], v[84:87], a[76:79], v[20:23]
    s_waitcnt lgkmcnt(4)
    v_mfma_f32_16x16x32_bf16 v[24:27], v[88:91], a[64:67], v[24:27]
    ds_read_b128 v[80:83], v128 offset:59392
    v_lshlrev_b32 v154, 5, v154
    v_mfma_f32_16x16x32_bf16 v[24:27], v[92:95], a[68:71], v[24:27]
    buffer_load_dwordx4 a[140:143], v224, s[32:35], s57 offen offset:1024 sc1
    v_mfma_f32_16x16x32_bf16 v[28:31], v[88:91], a[72:75], v[28:31]
    ds_read_b128 v[84:87], v128 offset:63488
    v_mfma_f32_16x16x32_bf16 v[28:31], v[92:95], a[76:79], v[28:31]
    s_waitcnt lgkmcnt(4)
    v_mfma_f32_16x16x32_bf16 v[32:35], v[64:67], a[64:67], v[32:35]
    s_add_u32 s56, s52, 73728
    ds_read_b128 v[88:91], v128 offset:60416
    s_add_u32 m0, s53, 131072
    v_mfma_f32_16x16x32_bf16 v[32:35], v[68:71], a[68:71], v[32:35]
    buffer_load_dwordx4 v224, s[24:27], s56 offen offset:0 sc1 lds
    v_mfma_f32_16x16x32_bf16 v[36:39], v[64:67], a[72:75], v[36:39]
    ds_read_b128 v[92:95], v128 offset:64512
    v_lshl_add_u32 v154, v155, 4, v154
    v_mfma_f32_16x16x32_bf16 v[36:39], v[68:71], a[76:79], v[36:39]
    s_waitcnt lgkmcnt(4)
    v_mfma_f32_16x16x32_bf16 v[40:43], v[72:75], a[64:67], v[40:43]
    ds_read_b128 v[64:67], v129 offset:0
    v_mfma_f32_16x16x32_bf16 v[40:43], v[76:79], a[68:71], v[40:43]
    buffer_load_dwordx4 v224, s[24:27], s56 offen offset:1024 sc1 lds
    v_mfma_f32_16x16x32_bf16 v[44:47], v[72:75], a[72:75], v[44:47]
    ds_read_b128 v[68:71], v129 offset:4096
    v_mfma_f32_16x16x32_bf16 v[44:47], v[76:79], a[76:79], v[44:47]
    s_waitcnt lgkmcnt(4)
    v_lshl_add_u32 v154, v152, 11, v154
    v_mfma_f32_16x16x32_bf16 v[48:51], v[80:83], a[64:67], v[48:51]
    s_add_u32 s56, s55, 73728
    ds_read_b128 v[72:75], v129 offset:1024
    s_add_u32 m0, s53, 139264
    v_mfma_f32_16x16x32_bf16 v[48:51], v[84:87], a[68:71], v[48:51]
    buffer_load_dwordx4 v224, s[24:27], s56 offen offset:0 sc1 lds
    v_mfma_f32_16x16x32_bf16 v[52:55], v[80:83], a[72:75], v[52:55]
    ds_read_b128 v[76:79], v129 offset:5120
    v_mfma_f32_16x16x32_bf16 v[52:55], v[84:87], a[76:79], v[52:55]
    s_waitcnt lgkmcnt(4)
    v_mfma_f32_16x16x32_bf16 v[56:59], v[88:91], a[64:67], v[56:59]
    ds_read_b128 v[80:83], v129 offset:2048
    v_mfma_f32_16x16x32_bf16 v[56:59], v[92:95], a[68:71], v[56:59]
    s_lshl_b32 s60, s48, 15
    buffer_load_dwordx4 v224, s[24:27], s56 offen offset:1024 sc1 lds
    v_mfma_f32_16x16x32_bf16 v[60:63], v[88:91], a[72:75], v[60:63]
    s_waitcnt vmcnt(28)
    ds_read_b128 v[84:87], v129 offset:6144
    v_mfma_f32_16x16x32_bf16 v[60:63], v[92:95], a[76:79], v[60:63]
    s_waitcnt lgkmcnt(4)
    v_mfma_f32_16x16x32_bf16 v[0:3], v[64:67], a[80:83], v[0:3]
    s_add_u32 s57, s49, 18432
    ds_read_b128 v[88:91], v129 offset:3072
    v_mfma_f32_16x16x32_bf16 v[0:3], v[68:71], a[84:87], v[0:3]
    buffer_load_dwordx4 a[144:147], v224, s[32:35], s57 offen offset:0 sc1
    v_mfma_f32_16x16x32_bf16 v[4:7], v[64:67], a[88:91], v[4:7]
    s_lshl_b32 s61, s93, 7
    ds_read_b128 v[92:95], v129 offset:7168
    v_mfma_f32_16x16x32_bf16 v[4:7], v[68:71], a[92:95], v[4:7]
    s_waitcnt lgkmcnt(4)
    v_mfma_f32_16x16x32_bf16 v[8:11], v[72:75], a[80:83], v[8:11]
    ds_read_b128 v[64:67], v129 offset:8192
    v_mfma_f32_16x16x32_bf16 v[8:11], v[76:79], a[84:87], v[8:11]
    buffer_load_dwordx4 a[148:151], v224, s[32:35], s57 offen offset:1024 sc1
    v_mfma_f32_16x16x32_bf16 v[12:15], v[72:75], a[88:91], v[12:15]
    ds_read_b128 v[68:71], v129 offset:12288
    v_mfma_f32_16x16x32_bf16 v[12:15], v[76:79], a[92:95], v[12:15]
    s_waitcnt lgkmcnt(4)
    s_add_u32 s60, s60, s61
    v_mfma_f32_16x16x32_bf16 v[16:19], v[80:83], a[80:83], v[16:19]
    s_add_u32 s57, s49, 133120
    ds_read_b128 v[72:75], v129 offset:9216
    v_mfma_f32_16x16x32_bf16 v[16:19], v[84:87], a[84:87], v[16:19]
    buffer_load_dwordx4 a[152:155], v224, s[32:35], s57 offen offset:0 sc1
    v_mfma_f32_16x16x32_bf16 v[20:23], v[80:83], a[88:91], v[20:23]
    ds_read_b128 v[76:79], v129 offset:13312
    v_mfma_f32_16x16x32_bf16 v[20:23], v[84:87], a[92:95], v[20:23]
    s_waitcnt lgkmcnt(4)
    s_add_u32 s61, s60, 32768
    v_mfma_f32_16x16x32_bf16 v[24:27], v[88:91], a[80:83], v[24:27]
    ds_read_b128 v[80:83], v129 offset:10240
    v_mfma_f32_16x16x32_bf16 v[24:27], v[92:95], a[84:87], v[24:27]
    buffer_load_dwordx4 a[156:159], v224, s[32:35], s57 offen offset:1024 sc1
    v_mfma_f32_16x16x32_bf16 v[28:31], v[88:91], a[88:91], v[28:31]
    ds_read_b128 v[84:87], v129 offset:14336
    v_mfma_f32_16x16x32_bf16 v[28:31], v[92:95], a[92:95], v[28:31]
    s_waitcnt lgkmcnt(4)
    v_mfma_f32_16x16x32_bf16 v[32:35], v[64:67], a[80:83], v[32:35]
    ds_read_b128 v[88:91], v129 offset:11264
    v_mfma_f32_16x16x32_bf16 v[32:35], v[68:71], a[84:87], v[32:35]
    s_mov_b32 s69, 262144
    v_mfma_f32_16x16x32_bf16 v[36:39], v[64:67], a[88:91], v[36:39]
    s_waitcnt vmcnt(28)
    ds_read_b128 v[92:95], v129 offset:15360
    v_mfma_f32_16x16x32_bf16 v[36:39], v[68:71], a[92:95], v[36:39]
    s_waitcnt lgkmcnt(4)
    s_barrier
    v_mfma_f32_16x16x32_bf16 v[40:43], v[72:75], a[80:83], v[40:43]
    s_add_u32 s56, s52, 81920
    ds_read_b128 v[64:67], v129 offset:16384
    s_add_u32 m0, s53, 32768
    v_mfma_f32_16x16x32_bf16 v[40:43], v[76:79], a[84:87], v[40:43]
    buffer_load_dwordx4 v224, s[24:27], s56 offen offset:0 sc1 lds
    v_mfma_f32_16x16x32_bf16 v[44:47], v[72:75], a[88:91], v[44:47]
    ds_read_b128 v[68:71], v129 offset:20480
    v_mfma_f32_16x16x32_bf16 v[44:47], v[76:79], a[92:95], v[44:47]
    s_waitcnt lgkmcnt(4)
    buffer_load_dwordx4 v224, s[24:27], s56 offen offset:1024 sc1 lds
    v_mfma_f32_16x16x32_bf16 v[48:51], v[80:83], a[80:83], v[48:51]
    s_add_u32 s56, s55, 81920
    ds_read_b128 v[72:75], v129 offset:17408
    s_add_u32 m0, s53, 40960
    v_mfma_f32_16x16x32_bf16 v[48:51], v[84:87], a[84:87], v[48:51]
    buffer_load_dwordx4 v224, s[24:27], s56 offen offset:0 sc1 lds
    v_mfma_f32_16x16x32_bf16 v[52:55], v[80:83], a[88:91], v[52:55]
    ds_read_b128 v[76:79], v129 offset:21504
    v_mfma_f32_16x16x32_bf16 v[52:55], v[84:87], a[92:95], v[52:55]
    s_waitcnt lgkmcnt(4)
    s_add_u32 s40, s22, 100663296
    s_addc_u32 s41, s23, 0
    v_mfma_f32_16x16x32_bf16 v[56:59], v[88:91], a[80:83], v[56:59]
    ds_read_b128 v[80:83], v129 offset:18432
    v_mfma_f32_16x16x32_bf16 v[56:59], v[92:95], a[84:87], v[56:59]
    buffer_load_dwordx4 v224, s[24:27], s56 offen offset:1024 sc1 lds
    v_mfma_f32_16x16x32_bf16 v[60:63], v[88:91], a[88:91], v[60:63]
    s_waitcnt vmcnt(28)
    ds_read_b128 v[84:87], v129 offset:22528
    v_mfma_f32_16x16x32_bf16 v[60:63], v[92:95], a[92:95], v[60:63]
    s_waitcnt lgkmcnt(4)
    v_mfma_f32_16x16x32_bf16 v[0:3], v[64:67], a[96:99], v[0:3]
    s_add_u32 s57, s49, 20480
    ds_read_b128 v[88:91], v129 offset:19456
    v_mfma_f32_16x16x32_bf16 v[0:3], v[68:71], a[100:103], v[0:3]
    buffer_load_dwordx4 a[160:163], v224, s[32:35], s57 offen offset:0 sc1
    v_mfma_f32_16x16x32_bf16 v[4:7], v[64:67], a[104:107], v[4:7]
    ds_read_b128 v[92:95], v129 offset:23552
    v_mfma_f32_16x16x32_bf16 v[4:7], v[68:71], a[108:111], v[4:7]
    s_waitcnt lgkmcnt(4)
    v_mfma_f32_16x16x32_bf16 v[8:11], v[72:75], a[96:99], v[8:11]
    ds_read_b128 v[64:67], v129 offset:24576
    v_mfma_f32_16x16x32_bf16 v[8:11], v[76:79], a[100:103], v[8:11]
    buffer_load_dwordx4 a[164:167], v224, s[32:35], s57 offen offset:1024 sc1
    v_mfma_f32_16x16x32_bf16 v[12:15], v[72:75], a[104:107], v[12:15]
    ds_read_b128 v[68:71], v129 offset:28672
    v_mfma_f32_16x16x32_bf16 v[12:15], v[76:79], a[108:111], v[12:15]
    s_waitcnt lgkmcnt(4)
    v_mfma_f32_16x16x32_bf16 v[16:19], v[80:83], a[96:99], v[16:19]
    s_add_u32 s57, s49, 135168
    ds_read_b128 v[72:75], v129 offset:25600
    v_mfma_f32_16x16x32_bf16 v[16:19], v[84:87], a[100:103], v[16:19]
    buffer_load_dwordx4 a[168:171], v224, s[32:35], s57 offen offset:0 sc1
    v_mfma_f32_16x16x32_bf16 v[20:23], v[80:83], a[104:107], v[20:23]
    ds_read_b128 v[76:79], v129 offset:29696
    v_mfma_f32_16x16x32_bf16 v[20:23], v[84:87], a[108:111], v[20:23]
    s_waitcnt lgkmcnt(4)
    v_mfma_f32_16x16x32_bf16 v[24:27], v[88:91], a[96:99], v[24:27]
    ds_read_b128 v[80:83], v129 offset:26624
    v_mfma_f32_16x16x32_bf16 v[24:27], v[92:95], a[100:103], v[24:27]
    buffer_load_dwordx4 a[172:175], v224, s[32:35], s57 offen offset:1024 sc1
    v_mfma_f32_16x16x32_bf16 v[28:31], v[88:91], a[104:107], v[28:31]
    ds_read_b128 v[84:87], v129 offset:30720
    v_mfma_f32_16x16x32_bf16 v[28:31], v[92:95], a[108:111], v[28:31]
    s_waitcnt lgkmcnt(4)
    v_mfma_f32_16x16x32_bf16 v[32:35], v[64:67], a[96:99], v[32:35]
L_stub_19:
    s_cbranch_execz L_warm_w28_ret
    s_add_u32 s56, s52, 90112
    ds_read_b128 v[88:91], v129 offset:27648
    s_add_u32 m0, s53, 49152
    v_mfma_f32_16x16x32_bf16 v[32:35], v[68:71], a[100:103], v[32:35]
    buffer_load_dwordx4 v224, s[24:27], s56 offen offset:0 sc1 lds
    v_mfma_f32_16x16x32_bf16 v[36:39], v[64:67], a[104:107], v[36:39]
    s_waitcnt vmcnt(29)
    ds_read_b128 v[92:95], v129 offset:31744
    v_mfma_f32_16x16x32_bf16 v[36:39], v[68:71], a[108:111], v[36:39]
    s_waitcnt lgkmcnt(4)
    s_barrier
    v_mfma_f32_16x16x32_bf16 v[40:43], v[72:75], a[96:99], v[40:43]
    ds_read_b128 v[64:67], v129 offset:32768
    v_mfma_f32_16x16x32_bf16 v[40:43], v[76:79], a[100:103], v[40:43]
    buffer_load_dwordx4 v224, s[24:27], s56 offen offset:1024 sc1 lds
    v_mfma_f32_16x16x32_bf16 v[44:47], v[72:75], a[104:107], v[44:47]
    ds_read_b128 v[68:71], v129 offset:36864
    v_mfma_f32_16x16x32_bf16 v[44:47], v[76:79], a[108:111], v[44:47]
    s_waitcnt lgkmcnt(4)
    v_mfma_f32_16x16x32_bf16 v[48:51], v[80:83], a[96:99], v[48:51]
    s_add_u32 s56, s55, 90112
    ds_read_b128 v[72:75], v129 offset:33792
    s_add_u32 m0, s53, 147456
    v_mfma_f32_16x16x32_bf16 v[48:51], v[84:87], a[100:103], v[48:51]
    buffer_load_dwordx4 v224, s[24:27], s56 offen offset:0 sc1 lds
    v_mfma_f32_16x16x32_bf16 v[52:55], v[80:83], a[104:107], v[52:55]
    ds_read_b128 v[76:79], v129 offset:37888
    v_mfma_f32_16x16x32_bf16 v[52:55], v[84:87], a[108:111], v[52:55]
    s_waitcnt lgkmcnt(4)
    v_mfma_f32_16x16x32_bf16 v[56:59], v[88:91], a[96:99], v[56:59]
    ds_read_b128 v[80:83], v129 offset:34816
    v_mfma_f32_16x16x32_bf16 v[56:59], v[92:95], a[100:103], v[56:59]
    buffer_load_dwordx4 v224, s[24:27], s56 offen offset:1024 sc1 lds
    v_mfma_f32_16x16x32_bf16 v[60:63], v[88:91], a[104:107], v[60:63]
    s_waitcnt vmcnt(28)
    ds_read_b128 v[84:87], v129 offset:38912
    v_mfma_f32_16x16x32_bf16 v[60:63], v[92:95], a[108:111], v[60:63]
    s_waitcnt lgkmcnt(4)
    v_mfma_f32_16x16x32_bf16 v[0:3], v[64:67], a[112:115], v[0:3]
    s_add_u32 s57, s49, 22528
    ds_read_b128 v[88:91], v129 offset:35840
    v_mfma_f32_16x16x32_bf16 v[0:3], v[68:71], a[116:119], v[0:3]
    buffer_load_dwordx4 a[176:179], v224, s[32:35], s57 offen offset:0 sc1
    v_mfma_f32_16x16x32_bf16 v[4:7], v[64:67], a[120:123], v[4:7]
    ds_read_b128 v[92:95], v129 offset:39936
    v_mfma_f32_16x16x32_bf16 v[4:7], v[68:71], a[124:127], v[4:7]
    s_waitcnt lgkmcnt(4)
    v_mfma_f32_16x16x32_bf16 v[8:11], v[72:75], a[112:115], v[8:11]
    ds_read_b128 v[64:67], v129 offset:40960
    v_mfma_f32_16x16x32_bf16 v[8:11], v[76:79], a[116:119], v[8:11]
    buffer_load_dwordx4 a[180:183], v224, s[32:35], s57 offen offset:1024 sc1
    v_mfma_f32_16x16x32_bf16 v[12:15], v[72:75], a[120:123], v[12:15]
    ds_read_b128 v[68:71], v129 offset:45056
    v_mfma_f32_16x16x32_bf16 v[12:15], v[76:79], a[124:127], v[12:15]
    s_waitcnt lgkmcnt(4)
    v_mfma_f32_16x16x32_bf16 v[16:19], v[80:83], a[112:115], v[16:19]
    s_add_u32 s57, s49, 137216
    ds_read_b128 v[72:75], v129 offset:41984
    v_mfma_f32_16x16x32_bf16 v[16:19], v[84:87], a[116:119], v[16:19]
    buffer_load_dwordx4 a[184:187], v224, s[32:35], s57 offen offset:0 sc1
    v_mfma_f32_16x16x32_bf16 v[20:23], v[80:83], a[120:123], v[20:23]
    ds_read_b128 v[76:79], v129 offset:46080
    v_mfma_f32_16x16x32_bf16 v[20:23], v[84:87], a[124:127], v[20:23]
    s_waitcnt lgkmcnt(4)
    v_mfma_f32_16x16x32_bf16 v[24:27], v[88:91], a[112:115], v[24:27]
    ds_read_b128 v[80:83], v129 offset:43008
    v_mfma_f32_16x16x32_bf16 v[24:27], v[92:95], a[116:119], v[24:27]
    buffer_load_dwordx4 a[188:191], v224, s[32:35], s57 offen offset:1024 sc1
    v_mfma_f32_16x16x32_bf16 v[28:31], v[88:91], a[120:123], v[28:31]
    ds_read_b128 v[84:87], v129 offset:47104
    v_mfma_f32_16x16x32_bf16 v[28:31], v[92:95], a[124:127], v[28:31]
    s_waitcnt lgkmcnt(4)
    v_mfma_f32_16x16x32_bf16 v[32:35], v[64:67], a[112:115], v[32:35]
    s_add_u32 s56, s52, 98304
    ds_read_b128 v[88:91], v129 offset:44032
    s_add_u32 m0, s53, 155648
    v_mfma_f32_16x16x32_bf16 v[32:35], v[68:71], a[116:119], v[32:35]
    buffer_load_dwordx4 v224, s[24:27], s56 offen offset:0 sc1 lds
    v_mfma_f32_16x16x32_bf16 v[36:39], v[64:67], a[120:123], v[36:39]
    s_waitcnt vmcnt(29)
    ds_read_b128 v[92:95], v129 offset:48128
    v_mfma_f32_16x16x32_bf16 v[36:39], v[68:71], a[124:127], v[36:39]
    s_waitcnt lgkmcnt(4)
    s_barrier
    v_mfma_f32_16x16x32_bf16 v[40:43], v[72:75], a[112:115], v[40:43]
    ds_read_b128 v[64:67], v129 offset:49152
    v_mfma_f32_16x16x32_bf16 v[40:43], v[76:79], a[116:119], v[40:43]
    buffer_load_dwordx4 v224, s[24:27], s56 offen offset:1024 sc1 lds
    v_mfma_f32_16x16x32_bf16 v[44:47], v[72:75], a[120:123], v[44:47]
    ds_read_b128 v[68:71], v129 offset:53248
    v_mfma_f32_16x16x32_bf16 v[44:47], v[76:79], a[124:127], v[44:47]
    s_waitcnt lgkmcnt(4)
    v_mfma_f32_16x16x32_bf16 v[48:51], v[80:83], a[112:115], v[48:51]
    s_add_u32 s56, s55, 98304
    ds_read_b128 v[72:75], v129 offset:50176
    s_add_u32 m0, s53, 0
    v_mfma_f32_16x16x32_bf16 v[48:51], v[84:87], a[116:119], v[48:51]
    buffer_load_dwordx4 v224, s[24:27], s56 offen offset:0 sc1 lds
    v_mfma_f32_16x16x32_bf16 v[52:55], v[80:83], a[120:123], v[52:55]
    ds_read_b128 v[76:79], v129 offset:54272
    v_mfma_f32_16x16x32_bf16 v[52:55], v[84:87], a[124:127], v[52:55]
    s_waitcnt lgkmcnt(4)
    v_mfma_f32_16x16x32_bf16 v[56:59], v[88:91], a[112:115], v[56:59]
    ds_read_b128 v[80:83], v129 offset:51200
    v_mfma_f32_16x16x32_bf16 v[56:59], v[92:95], a[116:119], v[56:59]
    buffer_load_dwordx4 v224, s[24:27], s56 offen offset:1024 sc1 lds
    v_mfma_f32_16x16x32_bf16 v[60:63], v[88:91], a[120:123], v[60:63]
    s_waitcnt vmcnt(28)
    ds_read_b128 v[84:87], v129 offset:55296
    v_mfma_f32_16x16x32_bf16 v[60:63], v[92:95], a[124:127], v[60:63]
    s_waitcnt lgkmcnt(4)
    v_mfma_f32_16x16x32_bf16 v[0:3], v[64:67], a[128:131], v[0:3]
    s_add_u32 s57, s49, 24576
    ds_read_b128 v[88:91], v129 offset:52224
    v_mfma_f32_16x16x32_bf16 v[0:3], v[68:71], a[132:135], v[0:3]
    buffer_load_dwordx4 a[192:195], v224, s[32:35], s57 offen offset:0 sc1
    v_mfma_f32_16x16x32_bf16 v[4:7], v[64:67], a[136:139], v[4:7]
    ds_read_b128 v[92:95], v129 offset:56320
    v_mfma_f32_16x16x32_bf16 v[4:7], v[68:71], a[140:143], v[4:7]
    s_waitcnt lgkmcnt(4)
    v_mfma_f32_16x16x32_bf16 v[8:11], v[72:75], a[128:131], v[8:11]
    ds_read_b128 v[64:67], v129 offset:57344
    v_mfma_f32_16x16x32_bf16 v[8:11], v[76:79], a[132:135], v[8:11]
    buffer_load_dwordx4 a[196:199], v224, s[32:35], s57 offen offset:1024 sc1
    v_mfma_f32_16x16x32_bf16 v[12:15], v[72:75], a[136:139], v[12:15]
    ds_read_b128 v[68:71], v129 offset:61440
    v_mfma_f32_16x16x32_bf16 v[12:15], v[76:79], a[140:143], v[12:15]
    s_waitcnt lgkmcnt(4)
    v_mfma_f32_16x16x32_bf16 v[16:19], v[80:83], a[128:131], v[16:19]
    s_add_u32 s57, s49, 139264
    ds_read_b128 v[72:75], v129 offset:58368
    v_mfma_f32_16x16x32_bf16 v[16:19], v[84:87], a[132:135], v[16:19]
    buffer_load_dwordx4 a[200:203], v224, s[32:35], s57 offen offset:0 sc1
    v_mfma_f32_16x16x32_bf16 v[20:23], v[80:83], a[136:139], v[20:23]
    ds_read_b128 v[76:79], v129 offset:62464
    v_mfma_f32_16x16x32_bf16 v[20:23], v[84:87], a[140:143], v[20:23]
    s_waitcnt lgkmcnt(4)
    v_mfma_f32_16x16x32_bf16 v[24:27], v[88:91], a[128:131], v[24:27]
    ds_read_b128 v[80:83], v129 offset:59392
    v_mfma_f32_16x16x32_bf16 v[24:27], v[92:95], a[132:135], v[24:27]
    buffer_load_dwordx4 a[204:207], v224, s[32:35], s57 offen offset:1024 sc1
    v_mfma_f32_16x16x32_bf16 v[28:31], v[88:91], a[136:139], v[28:31]
    ds_read_b128 v[84:87], v129 offset:63488
    v_mfma_f32_16x16x32_bf16 v[28:31], v[92:95], a[140:143], v[28:31]
    s_waitcnt lgkmcnt(4)
    v_mfma_f32_16x16x32_bf16 v[32:35], v[64:67], a[128:131], v[32:35]
    s_add_u32 s56, s52, 106496
    ds_read_b128 v[88:91], v129 offset:60416
    s_add_u32 m0, s53, 8192
    v_mfma_f32_16x16x32_bf16 v[32:35], v[68:71], a[132:135], v[32:35]
    buffer_load_dwordx4 v224, s[24:27], s56 offen offset:0 sc1 lds
    v_mfma_f32_16x16x32_bf16 v[36:39], v[64:67], a[136:139], v[36:39]
    s_waitcnt vmcnt(29)
    ds_read_b128 v[92:95], v129 offset:64512
    v_mfma_f32_16x16x32_bf16 v[36:39], v[68:71], a[140:143], v[36:39]
    s_waitcnt lgkmcnt(4)
    s_barrier
    v_mfma_f32_16x16x32_bf16 v[40:43], v[72:75], a[128:131], v[40:43]
    ds_read_b128 v[64:67], v130 offset:0
    v_mfma_f32_16x16x32_bf16 v[40:43], v[76:79], a[132:135], v[40:43]
    buffer_load_dwordx4 v224, s[24:27], s56 offen offset:1024 sc1 lds
    v_mfma_f32_16x16x32_bf16 v[44:47], v[72:75], a[136:139], v[44:47]
    ds_read_b128 v[68:71], v130 offset:4096
    v_mfma_f32_16x16x32_bf16 v[44:47], v[76:79], a[140:143], v[44:47]
    s_waitcnt lgkmcnt(4)
    v_mfma_f32_16x16x32_bf16 v[48:51], v[80:83], a[128:131], v[48:51]
    s_add_u32 s56, s55, 106496
    ds_read_b128 v[72:75], v130 offset:1024
    s_add_u32 m0, s53, 16384
    v_mfma_f32_16x16x32_bf16 v[48:51], v[84:87], a[132:135], v[48:51]
    buffer_load_dwordx4 v224, s[24:27], s56 offen offset:0 sc1 lds
    v_mfma_f32_16x16x32_bf16 v[52:55], v[80:83], a[136:139], v[52:55]
    ds_read_b128 v[76:79], v130 offset:5120
    v_mfma_f32_16x16x32_bf16 v[52:55], v[84:87], a[140:143], v[52:55]
    s_waitcnt lgkmcnt(4)
    v_mfma_f32_16x16x32_bf16 v[56:59], v[88:91], a[128:131], v[56:59]
    ds_read_b128 v[80:83], v130 offset:2048
    v_mfma_f32_16x16x32_bf16 v[56:59], v[92:95], a[132:135], v[56:59]
    buffer_load_dwordx4 v224, s[24:27], s56 offen offset:1024 sc1 lds
    v_mfma_f32_16x16x32_bf16 v[60:63], v[88:91], a[136:139], v[60:63]
    s_waitcnt vmcnt(28)
    ds_read_b128 v[84:87], v130 offset:6144
    v_mfma_f32_16x16x32_bf16 v[60:63], v[92:95], a[140:143], v[60:63]
    s_waitcnt lgkmcnt(4)
    v_mfma_f32_16x16x32_bf16 v[0:3], v[64:67], a[144:147], v[0:3]
    s_add_u32 s57, s49, 26624
    ds_read_b128 v[88:91], v130 offset:3072
    v_mfma_f32_16x16x32_bf16 v[0:3], v[68:71], a[148:151], v[0:3]
    buffer_load_dwordx4 a[208:211], v224, s[32:35], s57 offen offset:0 sc1
    v_mfma_f32_16x16x32_bf16 v[4:7], v[64:67], a[152:155], v[4:7]
    ds_read_b128 v[92:95], v130 offset:7168
    v_mfma_f32_16x16x32_bf16 v[4:7], v[68:71], a[156:159], v[4:7]
    s_waitcnt lgkmcnt(4)
    v_mfma_f32_16x16x32_bf16 v[8:11], v[72:75], a[144:147], v[8:11]
    ds_read_b128 v[64:67], v130 offset:8192
    v_mfma_f32_16x16x32_bf16 v[8:11], v[76:79], a[148:151], v[8:11]
    buffer_load_dwordx4 a[212:215], v224, s[32:35], s57 offen offset:1024 sc1
    v_mfma_f32_16x16x32_bf16 v[12:15], v[72:75], a[152:155], v[12:15]
    ds_read_b128 v[68:71], v130 offset:12288
    v_mfma_f32_16x16x32_bf16 v[12:15], v[76:79], a[156:159], v[12:15]
    s_waitcnt lgkmcnt(4)
    v_mfma_f32_16x16x32_bf16 v[16:19], v[80:83], a[144:147], v[16:19]
    s_add_u32 s57, s49, 141312
    ds_read_b128 v[72:75], v130 offset:9216
    v_mfma_f32_16x16x32_bf16 v[16:19], v[84:87], a[148:151], v[16:19]
    buffer_load_dwordx4 a[216:219], v224, s[32:35], s57 offen offset:0 sc1
    v_mfma_f32_16x16x32_bf16 v[20:23], v[80:83], a[152:155], v[20:23]
    ds_read_b128 v[76:79], v130 offset:13312
    v_mfma_f32_16x16x32_bf16 v[20:23], v[84:87], a[156:159], v[20:23]
    s_waitcnt lgkmcnt(4)
    v_mfma_f32_16x16x32_bf16 v[24:27], v[88:91], a[144:147], v[24:27]
    ds_read_b128 v[80:83], v130 offset:10240
    v_mfma_f32_16x16x32_bf16 v[24:27], v[92:95], a[148:151], v[24:27]
    buffer_load_dwordx4 a[220:223], v224, s[32:35], s57 offen offset:1024 sc1
    v_mfma_f32_16x16x32_bf16 v[28:31], v[88:91], a[152:155], v[28:31]
    ds_read_b128 v[84:87], v130 offset:14336
    v_mfma_f32_16x16x32_bf16 v[28:31], v[92:95], a[156:159], v[28:31]
    s_waitcnt lgkmcnt(4)
    v_mfma_f32_16x16x32_bf16 v[32:35], v[64:67], a[144:147], v[32:35]
    s_add_u32 s56, s52, 114688
    ds_read_b128 v[88:91], v130 offset:11264
    s_add_u32 m0, s53, 24576
    v_mfma_f32_16x16x32_bf16 v[32:35], v[68:71], a[148:151], v[32:35]
    buffer_load_dwordx4 v224, s[24:27], s56 offen offset:0 sc1 lds
    v_mfma_f32_16x16x32_bf16 v[36:39], v[64:67], a[152:155], v[36:39]
    s_waitcnt vmcnt(29)
    ds_read_b128 v[92:95], v130 offset:15360
    v_mfma_f32_16x16x32_bf16 v[36:39], v[68:71], a[156:159], v[36:39]
    s_waitcnt lgkmcnt(4)
    s_barrier
    v_mfma_f32_16x16x32_bf16 v[40:43], v[72:75], a[144:147], v[40:43]
    ds_read_b128 v[64:67], v128 offset:32768
    v_mfma_f32_16x16x32_bf16 v[40:43], v[76:79], a[148:151], v[40:43]
    buffer_load_dwordx4 v224, s[24:27], s56 offen offset:1024 sc1 lds
    v_mfma_f32_16x16x32_bf16 v[44:47], v[72:75], a[152:155], v[44:47]
    ds_read_b128 v[68:71], v128 offset:36864
    v_mfma_f32_16x16x32_bf16 v[44:47], v[76:79], a[156:159], v[44:47]
    s_waitcnt lgkmcnt(4)
    v_mfma_f32_16x16x32_bf16 v[48:51], v[80:83], a[144:147], v[48:51]
    s_add_u32 s56, s55, 114688
    ds_read_b128 v[72:75], v128 offset:33792
    s_add_u32 m0, s53, 57344
    v_mfma_f32_16x16x32_bf16 v[48:51], v[84:87], a[148:151], v[48:51]
    buffer_load_dwordx4 v224, s[24:27], s56 offen offset:0 sc1 lds
    v_mfma_f32_16x16x32_bf16 v[52:55], v[80:83], a[152:155], v[52:55]
    ds_read_b128 v[76:79], v128 offset:37888
    v_mfma_f32_16x16x32_bf16 v[52:55], v[84:87], a[156:159], v[52:55]
    s_waitcnt lgkmcnt(4)
    v_mfma_f32_16x16x32_bf16 v[56:59], v[88:91], a[144:147], v[56:59]
    ds_read_b128 v[80:83], v128 offset:34816
    v_mfma_f32_16x16x32_bf16 v[56:59], v[92:95], a[148:151], v[56:59]
    buffer_load_dwordx4 v224, s[24:27], s56 offen offset:1024 sc1 lds
    v_mfma_f32_16x16x32_bf16 v[60:63], v[88:91], a[152:155], v[60:63]
    s_waitcnt vmcnt(28)
    ds_read_b128 v[84:87], v128 offset:38912
    v_mfma_f32_16x16x32_bf16 v[60:63], v[92:95], a[156:159], v[60:63]
    s_waitcnt lgkmcnt(4)
    v_mfma_f32_16x16x32_bf16 v[0:3], v[64:67], a[160:163], v[0:3]
    s_add_u32 s57, s49, 28672
    ds_read_b128 v[88:91], v128 offset:35840
    v_mfma_f32_16x16x32_bf16 v[0:3], v[68:71], a[164:167], v[0:3]
    buffer_load_dwordx4 a[224:227], v224, s[32:35], s57 offen offset:0 sc1
    v_mfma_f32_16x16x32_bf16 v[4:7], v[64:67], a[168:171], v[4:7]
    ds_read_b128 v[92:95], v128 offset:39936
    global_load_dword v252, v[250:251], off
    v_mfma_f32_16x16x32_bf16 v[4:7], v[68:71], a[172:175], v[4:7]
    s_waitcnt lgkmcnt(4)
    v_mfma_f32_16x16x32_bf16 v[8:11], v[72:75], a[160:163], v[8:11]
    ds_read_b128 v[64:67], v128 offset:40960
    v_mfma_f32_16x16x32_bf16 v[8:11], v[76:79], a[164:167], v[8:11]
    buffer_load_dwordx4 a[228:231], v224, s[32:35], s57 offen offset:1024 sc1
    v_mfma_f32_16x16x32_bf16 v[12:15], v[72:75], a[168:171], v[12:15]
    ds_read_b128 v[68:71], v128 offset:45056
    v_mfma_f32_16x16x32_bf16 v[12:15], v[76:79], a[172:175], v[12:15]
    s_waitcnt lgkmcnt(4)
    v_mfma_f32_16x16x32_bf16 v[16:19], v[80:83], a[160:163], v[16:19]
    s_add_u32 s57, s49, 143360
    ds_read_b128 v[72:75], v128 offset:41984
    v_mfma_f32_16x16x32_bf16 v[16:19], v[84:87], a[164:167], v[16:19]
    buffer_load_dwordx4 a[232:235], v224, s[32:35], s57 offen offset:0 sc1
    v_mfma_f32_16x16x32_bf16 v[20:23], v[80:83], a[168:171], v[20:23]
    ds_read_b128 v[76:79], v128 offset:46080
    v_mfma_f32_16x16x32_bf16 v[20:23], v[84:87], a[172:175], v[20:23]
    s_waitcnt lgkmcnt(4)
    v_mfma_f32_16x16x32_bf16 v[24:27], v[88:91], a[160:163], v[24:27]
    ds_read_b128 v[80:83], v128 offset:43008
    v_mfma_f32_16x16x32_bf16 v[24:27], v[92:95], a[164:167], v[24:27]
    buffer_load_dwordx4 a[236:239], v224, s[32:35], s57 offen offset:1024 sc1
    v_mfma_f32_16x16x32_bf16 v[28:31], v[88:91], a[168:171], v[28:31]
    ds_read_b128 v[84:87], v128 offset:47104
    v_mfma_f32_16x16x32_bf16 v[28:31], v[92:95], a[172:175], v[28:31]
    s_waitcnt lgkmcnt(4)
    v_mfma_f32_16x16x32_bf16 v[32:35], v[64:67], a[160:163], v[32:35]
    s_add_u32 s56, s52, 122880
    ds_read_b128 v[88:91], v128 offset:44032
    s_add_u32 m0, s53, 65536
    v_mfma_f32_16x16x32_bf16 v[32:35], v[68:71], a[164:167], v[32:35]
    buffer_load_dwordx4 v224, s[24:27], s56 offen offset:0 sc1 lds
    v_mfma_f32_16x16x32_bf16 v[36:39], v[64:67], a[168:171], v[36:39]
    s_waitcnt vmcnt(30)
    ds_read_b128 v[92:95], v128 offset:48128
    v_mfma_f32_16x16x32_bf16 v[36:39], v[68:71], a[172:175], v[36:39]
    s_waitcnt lgkmcnt(4)
    s_barrier
    v_mfma_f32_16x16x32_bf16 v[40:43], v[72:75], a[160:163], v[40:43]
    ds_read_b128 v[64:67], v128 offset:49152
    v_mfma_f32_16x16x32_bf16 v[40:43], v[76:79], a[164:167], v[40:43]
    buffer_load_dwordx4 v224, s[24:27], s56 offen offset:1024 sc1 lds
    v_mfma_f32_16x16x32_bf16 v[44:47], v[72:75], a[168:171], v[44:47]
    ds_read_b128 v[68:71], v128 offset:53248
    v_mfma_f32_16x16x32_bf16 v[44:47], v[76:79], a[172:175], v[44:47]
    s_waitcnt lgkmcnt(4)
    v_mfma_f32_16x16x32_bf16 v[48:51], v[80:83], a[160:163], v[48:51]
    s_add_u32 s56, s55, 122880
    ds_read_b128 v[72:75], v128 offset:50176
    s_add_u32 m0, s53, 73728
    v_mfma_f32_16x16x32_bf16 v[48:51], v[84:87], a[164:167], v[48:51]
    buffer_load_dwordx4 v224, s[24:27], s56 offen offset:0 sc1 lds
    v_mfma_f32_16x16x32_bf16 v[52:55], v[80:83], a[168:171], v[52:55]
    ds_read_b128 v[76:79], v128 offset:54272
    v_mfma_f32_16x16x32_bf16 v[52:55], v[84:87], a[172:175], v[52:55]
    s_waitcnt lgkmcnt(4)
    v_mfma_f32_16x16x32_bf16 v[56:59], v[88:91], a[160:163], v[56:59]
    ds_read_b128 v[80:83], v128 offset:51200
    v_mfma_f32_16x16x32_bf16 v[56:59], v[92:95], a[164:167], v[56:59]
    buffer_load_dwordx4 v224, s[24:27], s56 offen offset:1024 sc1 lds
    v_mfma_f32_16x16x32_bf16 v[60:63], v[88:91], a[168:171], v[60:63]
    s_waitcnt vmcnt(29)
    ds_read_b128 v[84:87], v128 offset:55296
    v_mfma_f32_16x16x32_bf16 v[60:63], v[92:95], a[172:175], v[60:63]
    s_waitcnt lgkmcnt(4)
    v_mfma_f32_16x16x32_bf16 v[0:3], v[64:67], a[176:179], v[0:3]
    s_add_u32 s57, s49, 30720
    ds_read_b128 v[88:91], v128 offset:52224
    v_mfma_f32_16x16x32_bf16 v[0:3], v[68:71], a[180:183], v[0:3]
    buffer_load_dwordx4 a[240:243], v224, s[32:35], s57 offen offset:0 sc1
    v_mfma_f32_16x16x32_bf16 v[4:7], v[64:67], a[184:187], v[4:7]
    ds_read_b128 v[92:95], v128 offset:56320
    v_mfma_f32_16x16x32_bf16 v[4:7], v[68:71], a[188:191], v[4:7]
    s_waitcnt lgkmcnt(4)
    v_mfma_f32_16x16x32_bf16 v[8:11], v[72:75], a[176:179], v[8:11]
    ds_read_b128 v[64:67], v130 offset:16384
    v_mfma_f32_16x16x32_bf16 v[8:11], v[76:79], a[180:183], v[8:11]
    buffer_load_dwordx4 a[244:247], v224, s[32:35], s57 offen offset:1024 sc1
    v_mfma_f32_16x16x32_bf16 v[12:15], v[72:75], a[184:187], v[12:15]
    ds_read_b128 v[68:71], v130 offset:20480
    v_mfma_f32_16x16x32_bf16 v[12:15], v[76:79], a[188:191], v[12:15]
    s_waitcnt lgkmcnt(4)
    v_mfma_f32_16x16x32_bf16 v[16:19], v[80:83], a[176:179], v[16:19]
    s_add_u32 s57, s49, 145408
    ds_read_b128 v[72:75], v130 offset:17408
    v_mfma_f32_16x16x32_bf16 v[16:19], v[84:87], a[180:183], v[16:19]
    buffer_load_dwordx4 a[248:251], v224, s[32:35], s57 offen offset:0 sc1
    v_mfma_f32_16x16x32_bf16 v[20:23], v[80:83], a[184:187], v[20:23]
    ds_read_b128 v[76:79], v130 offset:21504
    v_mfma_f32_16x16x32_bf16 v[20:23], v[84:87], a[188:191], v[20:23]
    s_waitcnt lgkmcnt(4)
    v_mfma_f32_16x16x32_bf16 v[24:27], v[88:91], a[176:179], v[24:27]
    ds_read_b128 v[80:83], v130 offset:18432
    v_mfma_f32_16x16x32_bf16 v[24:27], v[92:95], a[180:183], v[24:27]
    buffer_load_dwordx4 a[252:255], v224, s[32:35], s57 offen offset:1024 sc1
    v_mfma_f32_16x16x32_bf16 v[28:31], v[88:91], a[184:187], v[28:31]
    ds_read_b128 v[84:87], v130 offset:22528
    v_mfma_f32_16x16x32_bf16 v[28:31], v[92:95], a[188:191], v[28:31]
    s_waitcnt lgkmcnt(4)
    v_mfma_f32_16x16x32_bf16 v[32:35], v[64:67], a[176:179], v[32:35]
    s_add_u32 s56, s52, 131072
    ds_read_b128 v[88:91], v130 offset:19456
    s_add_u32 m0, s53, 81920
    v_mfma_f32_16x16x32_bf16 v[32:35], v[68:71], a[180:183], v[32:35]
    buffer_load_dwordx4 v224, s[24:27], s56 offen offset:0 sc1 lds
    v_mfma_f32_16x16x32_bf16 v[36:39], v[64:67], a[184:187], v[36:39]
    s_waitcnt vmcnt(30)
    ds_read_b128 v[92:95], v130 offset:23552
    v_mfma_f32_16x16x32_bf16 v[36:39], v[68:71], a[188:191], v[36:39]
    s_waitcnt lgkmcnt(4)
    s_barrier
    v_mfma_f32_16x16x32_bf16 v[40:43], v[72:75], a[176:179], v[40:43]
    ds_read_b128 v[64:67], v130 offset:24576
    v_mfma_f32_16x16x32_bf16 v[40:43], v[76:79], a[180:183], v[40:43]
    buffer_load_dwordx4 v224, s[24:27], s56 offen offset:1024 sc1 lds
    v_mfma_f32_16x16x32_bf16 v[44:47], v[72:75], a[184:187], v[44:47]
    ds_read_b128 v[68:71], v130 offset:28672
    v_mfma_f32_16x16x32_bf16 v[44:47], v[76:79], a[188:191], v[44:47]
    s_waitcnt lgkmcnt(4)
    v_mfma_f32_16x16x32_bf16 v[48:51], v[80:83], a[176:179], v[48:51]
    s_add_u32 s56, s55, 131072
    ds_read_b128 v[72:75], v130 offset:25600
    s_add_u32 m0, s53, 90112
    v_mfma_f32_16x16x32_bf16 v[48:51], v[84:87], a[180:183], v[48:51]
    buffer_load_dwordx4 v224, s[24:27], s56 offen offset:0 sc1 lds
    v_mfma_f32_16x16x32_bf16 v[52:55], v[80:83], a[184:187], v[52:55]
    ds_read_b128 v[76:79], v130 offset:29696
    v_mfma_f32_16x16x32_bf16 v[52:55], v[84:87], a[188:191], v[52:55]
    s_waitcnt lgkmcnt(4)
    v_mfma_f32_16x16x32_bf16 v[56:59], v[88:91], a[176:179], v[56:59]
    ds_read_b128 v[80:83], v130 offset:26624
    v_mfma_f32_16x16x32_bf16 v[56:59], v[92:95], a[180:183], v[56:59]
    buffer_load_dwordx4 v224, s[24:27], s56 offen offset:1024 sc1 lds
    v_mfma_f32_16x16x32_bf16 v[60:63], v[88:91], a[184:187], v[60:63]
    s_waitcnt vmcnt(29)
    ds_read_b128 v[84:87], v130 offset:30720
    v_mfma_f32_16x16x32_bf16 v[60:63], v[92:95], a[188:191], v[60:63]
    s_waitcnt lgkmcnt(4)
    v_mfma_f32_16x16x32_bf16 v[0:3], v[64:67], a[192:195], v[0:3]
    s_add_u32 s57, s49, 32768
    ds_read_b128 v[88:91], v130 offset:27648
    v_mfma_f32_16x16x32_bf16 v[0:3], v[68:71], a[196:199], v[0:3]
    buffer_load_dwordx4 a[0:3], v224, s[32:35], s57 offen offset:0 sc1
    v_mfma_f32_16x16x32_bf16 v[4:7], v[64:67], a[200:203], v[4:7]
    ds_read_b128 v[92:95], v130 offset:31744
    v_mfma_f32_16x16x32_bf16 v[4:7], v[68:71], a[204:207], v[4:7]
    s_waitcnt lgkmcnt(4)
    v_mfma_f32_16x16x32_bf16 v[8:11], v[72:75], a[192:195], v[8:11]
    ds_read_b128 v[64:67], v128 offset:0
    v_mfma_f32_16x16x32_bf16 v[8:11], v[76:79], a[196:199], v[8:11]
    buffer_load_dwordx4 a[4:7], v224, s[32:35], s57 offen offset:1024 sc1
    v_mfma_f32_16x16x32_bf16 v[12:15], v[72:75], a[200:203], v[12:15]
    ds_read_b128 v[68:71], v128 offset:4096
    v_mfma_f32_16x16x32_bf16 v[12:15], v[76:79], a[204:207], v[12:15]
    s_waitcnt lgkmcnt(4)
    v_mfma_f32_16x16x32_bf16 v[16:19], v[80:83], a[192:195], v[16:19]
    s_add_u32 s57, s49, 147456
    ds_read_b128 v[72:75], v128 offset:1024
    v_mfma_f32_16x16x32_bf16 v[16:19], v[84:87], a[196:199], v[16:19]
    buffer_load_dwordx4 a[8:11], v224, s[32:35], s57 offen offset:0 sc1
    v_mfma_f32_16x16x32_bf16 v[20:23], v[80:83], a[200:203], v[20:23]
    ds_read_b128 v[76:79], v128 offset:5120
    v_mfma_f32_16x16x32_bf16 v[20:23], v[84:87], a[204:207], v[20:23]
    s_waitcnt lgkmcnt(4)
    v_mfma_f32_16x16x32_bf16 v[24:27], v[88:91], a[192:195], v[24:27]
    ds_read_b128 v[80:83], v128 offset:2048
    v_mfma_f32_16x16x32_bf16 v[24:27], v[92:95], a[196:199], v[24:27]
    buffer_load_dwordx4 a[12:15], v224, s[32:35], s57 offen offset:1024 sc1
    v_mfma_f32_16x16x32_bf16 v[28:31], v[88:91], a[200:203], v[28:31]
    ds_read_b128 v[84:87], v128 offset:6144
    v_mfma_f32_16x16x32_bf16 v[28:31], v[92:95], a[204:207], v[28:31]
    s_waitcnt lgkmcnt(4)
    v_mfma_f32_16x16x32_bf16 v[32:35], v[64:67], a[192:195], v[32:35]
    s_add_u32 s56, s52, 139264
    ds_read_b128 v[88:91], v128 offset:3072
    s_add_u32 m0, s53, 98304
    v_mfma_f32_16x16x32_bf16 v[32:35], v[68:71], a[196:199], v[32:35]
    buffer_load_dwordx4 v224, s[24:27], s56 offen offset:0 sc1 lds
    v_mfma_f32_16x16x32_bf16 v[36:39], v[64:67], a[200:203], v[36:39]
    s_waitcnt vmcnt(30)
    ds_read_b128 v[92:95], v128 offset:7168
    v_mfma_f32_16x16x32_bf16 v[36:39], v[68:71], a[204:207], v[36:39]
    s_waitcnt lgkmcnt(4)
    s_barrier
    v_mfma_f32_16x16x32_bf16 v[40:43], v[72:75], a[192:195], v[40:43]
    ds_read_b128 v[64:67], v128 offset:8192
    v_mfma_f32_16x16x32_bf16 v[40:43], v[76:79], a[196:199], v[40:43]
    buffer_load_dwordx4 v224, s[24:27], s56 offen offset:1024 sc1 lds
    v_mfma_f32_16x16x32_bf16 v[44:47], v[72:75], a[200:203], v[44:47]
    ds_read_b128 v[68:71], v128 offset:12288
    v_mfma_f32_16x16x32_bf16 v[44:47], v[76:79], a[204:207], v[44:47]
    s_waitcnt lgkmcnt(4)
    v_mfma_f32_16x16x32_bf16 v[48:51], v[80:83], a[192:195], v[48:51]
    s_add_u32 s56, s55, 139264
    ds_read_b128 v[72:75], v128 offset:9216
    s_add_u32 m0, s53, 106496
    v_mfma_f32_16x16x32_bf16 v[48:51], v[84:87], a[196:199], v[48:51]
    buffer_load_dwordx4 v224, s[24:27], s56 offen offset:0 sc1 lds
    v_mfma_f32_16x16x32_bf16 v[52:55], v[80:83], a[200:203], v[52:55]
    ds_read_b128 v[76:79], v128 offset:13312
    v_mfma_f32_16x16x32_bf16 v[52:55], v[84:87], a[204:207], v[52:55]
    s_waitcnt lgkmcnt(4)
    v_mfma_f32_16x16x32_bf16 v[56:59], v[88:91], a[192:195], v[56:59]
    ds_read_b128 v[80:83], v128 offset:10240
    v_mfma_f32_16x16x32_bf16 v[56:59], v[92:95], a[196:199], v[56:59]
    buffer_load_dwordx4 v224, s[24:27], s56 offen offset:1024 sc1 lds
    v_mfma_f32_16x16x32_bf16 v[60:63], v[88:91], a[200:203], v[60:63]
    s_waitcnt vmcnt(29)
    ds_read_b128 v[84:87], v128 offset:14336
    v_mfma_f32_16x16x32_bf16 v[60:63], v[92:95], a[204:207], v[60:63]
    s_waitcnt lgkmcnt(4)
    v_mfma_f32_16x16x32_bf16 v[0:3], v[64:67], a[208:211], v[0:3]
    s_add_u32 s57, s49, 34816
    ds_read_b128 v[88:91], v128 offset:11264
    v_mfma_f32_16x16x32_bf16 v[0:3], v[68:71], a[212:215], v[0:3]
    buffer_load_dwordx4 a[16:19], v224, s[32:35], s57 offen offset:0 sc1
    v_mfma_f32_16x16x32_bf16 v[4:7], v[64:67], a[216:219], v[4:7]
    ds_read_b128 v[92:95], v128 offset:15360
    v_mfma_f32_16x16x32_bf16 v[4:7], v[68:71], a[220:223], v[4:7]
    s_waitcnt lgkmcnt(4)
    v_mfma_f32_16x16x32_bf16 v[8:11], v[72:75], a[208:211], v[8:11]
    ds_read_b128 v[64:67], v128 offset:16384
    v_mfma_f32_16x16x32_bf16 v[8:11], v[76:79], a[212:215], v[8:11]
    buffer_load_dwordx4 a[20:23], v224, s[32:35], s57 offen offset:1024 sc1
    v_mfma_f32_16x16x32_bf16 v[12:15], v[72:75], a[216:219], v[12:15]
    ds_read_b128 v[68:71], v128 offset:20480
    v_mfma_f32_16x16x32_bf16 v[12:15], v[76:79], a[220:223], v[12:15]
    s_waitcnt lgkmcnt(4)
    v_mfma_f32_16x16x32_bf16 v[16:19], v[80:83], a[208:211], v[16:19]
    s_add_u32 s57, s49, 149504
    ds_read_b128 v[72:75], v128 offset:17408
    v_mfma_f32_16x16x32_bf16 v[16:19], v[84:87], a[212:215], v[16:19]
    buffer_load_dwordx4 a[24:27], v224, s[32:35], s57 offen offset:0 sc1
    v_mfma_f32_16x16x32_bf16 v[20:23], v[80:83], a[216:219], v[20:23]
    ds_read_b128 v[76:79], v128 offset:21504
    v_mfma_f32_16x16x32_bf16 v[20:23], v[84:87], a[220:223], v[20:23]
    s_waitcnt lgkmcnt(4)
    v_mfma_f32_16x16x32_bf16 v[24:27], v[88:91], a[208:211], v[24:27]
    ds_read_b128 v[80:83], v128 offset:18432
    v_mfma_f32_16x16x32_bf16 v[24:27], v[92:95], a[212:215], v[24:27]
    buffer_load_dwordx4 a[28:31], v224, s[32:35], s57 offen offset:1024 sc1
    v_mfma_f32_16x16x32_bf16 v[28:31], v[88:91], a[216:219], v[28:31]
    ds_read_b128 v[84:87], v128 offset:22528
    v_mfma_f32_16x16x32_bf16 v[28:31], v[92:95], a[220:223], v[28:31]
    s_waitcnt lgkmcnt(4)
    v_mfma_f32_16x16x32_bf16 v[32:35], v[64:67], a[208:211], v[32:35]
    s_add_u32 s56, s52, 147456
    ds_read_b128 v[88:91], v128 offset:19456
    s_add_u32 m0, s53, 114688
    v_mfma_f32_16x16x32_bf16 v[32:35], v[68:71], a[212:215], v[32:35]
    buffer_load_dwordx4 v224, s[24:27], s56 offen offset:0 sc1 lds
    v_mfma_f32_16x16x32_bf16 v[36:39], v[64:67], a[216:219], v[36:39]
    s_waitcnt vmcnt(30)
    ds_read_b128 v[92:95], v128 offset:23552
    v_mfma_f32_16x16x32_bf16 v[36:39], v[68:71], a[220:223], v[36:39]
    s_waitcnt lgkmcnt(4)
    s_barrier
    v_mfma_f32_16x16x32_bf16 v[40:43], v[72:75], a[208:211], v[40:43]
    ds_read_b128 v[64:67], v128 offset:24576
    v_mfma_f32_16x16x32_bf16 v[40:43], v[76:79], a[212:215], v[40:43]
    buffer_load_dwordx4 v224, s[24:27], s56 offen offset:1024 sc1 lds
    v_mfma_f32_16x16x32_bf16 v[44:47], v[72:75], a[216:219], v[44:47]
    ds_read_b128 v[68:71], v128 offset:28672
    v_mfma_f32_16x16x32_bf16 v[44:47], v[76:79], a[220:223], v[44:47]
    s_waitcnt lgkmcnt(4)
    v_mfma_f32_16x16x32_bf16 v[48:51], v[80:83], a[208:211], v[48:51]
    s_add_u32 s56, s55, 147456
    ds_read_b128 v[72:75], v128 offset:25600
    s_add_u32 m0, s53, 122880
    v_mfma_f32_16x16x32_bf16 v[48:51], v[84:87], a[212:215], v[48:51]
    buffer_load_dwordx4 v224, s[24:27], s56 offen offset:0 sc1 lds
    v_mfma_f32_16x16x32_bf16 v[52:55], v[80:83], a[216:219], v[52:55]
    ds_read_b128 v[76:79], v128 offset:29696
    v_mfma_f32_16x16x32_bf16 v[52:55], v[84:87], a[220:223], v[52:55]
    s_waitcnt lgkmcnt(4)
    v_mfma_f32_16x16x32_bf16 v[56:59], v[88:91], a[208:211], v[56:59]
    ds_read_b128 v[80:83], v128 offset:26624
    v_mfma_f32_16x16x32_bf16 v[56:59], v[92:95], a[212:215], v[56:59]
    buffer_load_dwordx4 v224, s[24:27], s56 offen offset:1024 sc1 lds
    v_mfma_f32_16x16x32_bf16 v[60:63], v[88:91], a[216:219], v[60:63]
    s_waitcnt vmcnt(28)
    ds_read_b128 v[84:87], v128 offset:30720
    v_mfma_f32_16x16x32_bf16 v[60:63], v[92:95], a[220:223], v[60:63]
    s_waitcnt lgkmcnt(4)
    v_mfma_f32_16x16x32_bf16 v[0:3], v[64:67], a[224:227], v[0:3]
    s_add_u32 s57, s49, 36864
    ds_read_b128 v[88:91], v128 offset:27648
    v_mfma_f32_16x16x32_bf16 v[0:3], v[68:71], a[228:231], v[0:3]
L_stub_20:
    s_cbranch_execz L_warm_w28_ret
    buffer_load_dwordx4 a[32:35], v224, s[32:35], s57 offen offset:0 sc1
    v_mfma_f32_16x16x32_bf16 v[4:7], v[64:67], a[232:235], v[4:7]
    ds_read_b128 v[92:95], v128 offset:31744
    v_mfma_f32_16x16x32_bf16 v[4:7], v[68:71], a[236:239], v[4:7]
    s_waitcnt lgkmcnt(4)
    v_mfma_f32_16x16x32_bf16 v[8:11], v[72:75], a[224:227], v[8:11]
    ds_read_b128 v[64:67], v128 offset:57344
    v_mfma_f32_16x16x32_bf16 v[8:11], v[76:79], a[228:231], v[8:11]
    buffer_load_dwordx4 a[36:39], v224, s[32:35], s57 offen offset:1024 sc1
    v_mfma_f32_16x16x32_bf16 v[12:15], v[72:75], a[232:235], v[12:15]
    ds_read_b128 v[68:71], v128 offset:61440
    v_mfma_f32_16x16x32_bf16 v[12:15], v[76:79], a[236:239], v[12:15]
    s_waitcnt lgkmcnt(4)
    v_mfma_f32_16x16x32_bf16 v[16:19], v[80:83], a[224:227], v[16:19]
    s_add_u32 s57, s49, 151552
    ds_read_b128 v[72:75], v128 offset:58368
    v_mfma_f32_16x16x32_bf16 v[16:19], v[84:87], a[228:231], v[16:19]
    buffer_load_dwordx4 a[40:43], v224, s[32:35], s57 offen offset:0 sc1
    v_mfma_f32_16x16x32_bf16 v[20:23], v[80:83], a[232:235], v[20:23]
    ds_read_b128 v[76:79], v128 offset:62464
    v_mfma_f32_16x16x32_bf16 v[20:23], v[84:87], a[236:239], v[20:23]
    s_waitcnt lgkmcnt(4)
    v_mfma_f32_16x16x32_bf16 v[24:27], v[88:91], a[224:227], v[24:27]
    ds_read_b128 v[80:83], v128 offset:59392
    v_mfma_f32_16x16x32_bf16 v[24:27], v[92:95], a[228:231], v[24:27]
    buffer_load_dwordx4 a[44:47], v224, s[32:35], s57 offen offset:1024 sc1
    v_mfma_f32_16x16x32_bf16 v[28:31], v[88:91], a[232:235], v[28:31]
    ds_read_b128 v[84:87], v128 offset:63488
    v_mfma_f32_16x16x32_bf16 v[28:31], v[92:95], a[236:239], v[28:31]
    s_waitcnt lgkmcnt(4)
    v_mfma_f32_16x16x32_bf16 v[32:35], v[64:67], a[224:227], v[32:35]
    s_add_u32 s56, s52, 155648
    ds_read_b128 v[88:91], v128 offset:60416
    s_add_u32 m0, s53, 131072
    v_mfma_f32_16x16x32_bf16 v[32:35], v[68:71], a[228:231], v[32:35]
    buffer_load_dwordx4 v224, s[24:27], s56 offen offset:0 sc1 lds
    v_mfma_f32_16x16x32_bf16 v[36:39], v[64:67], a[232:235], v[36:39]
    s_waitcnt vmcnt(29)
    ds_read_b128 v[92:95], v128 offset:64512
    v_mfma_f32_16x16x32_bf16 v[36:39], v[68:71], a[236:239], v[36:39]
    s_waitcnt lgkmcnt(4)
    s_barrier
    v_mfma_f32_16x16x32_bf16 v[40:43], v[72:75], a[224:227], v[40:43]
    ds_read_b128 v[64:67], v129 offset:0
    v_mfma_f32_16x16x32_bf16 v[40:43], v[76:79], a[228:231], v[40:43]
    buffer_load_dwordx4 v224, s[24:27], s56 offen offset:1024 sc1 lds
    v_mfma_f32_16x16x32_bf16 v[44:47], v[72:75], a[232:235], v[44:47]
    ds_read_b128 v[68:71], v129 offset:4096
    v_mfma_f32_16x16x32_bf16 v[44:47], v[76:79], a[236:239], v[44:47]
    s_waitcnt lgkmcnt(4)
    v_mfma_f32_16x16x32_bf16 v[48:51], v[80:83], a[224:227], v[48:51]
    s_add_u32 s56, s55, 155648
    ds_read_b128 v[72:75], v129 offset:1024
    s_add_u32 m0, s53, 139264
    v_mfma_f32_16x16x32_bf16 v[48:51], v[84:87], a[228:231], v[48:51]
    buffer_load_dwordx4 v224, s[24:27], s56 offen offset:0 sc1 lds
    v_mfma_f32_16x16x32_bf16 v[52:55], v[80:83], a[232:235], v[52:55]
    ds_read_b128 v[76:79], v129 offset:5120
    v_mfma_f32_16x16x32_bf16 v[52:55], v[84:87], a[236:239], v[52:55]
    s_waitcnt lgkmcnt(4)
    v_mfma_f32_16x16x32_bf16 v[56:59], v[88:91], a[224:227], v[56:59]
    ds_read_b128 v[80:83], v129 offset:2048
    v_mfma_f32_16x16x32_bf16 v[56:59], v[92:95], a[228:231], v[56:59]
    buffer_load_dwordx4 v224, s[24:27], s56 offen offset:1024 sc1 lds
    v_mfma_f32_16x16x32_bf16 v[60:63], v[88:91], a[232:235], v[60:63]
    s_waitcnt vmcnt(28)
    ds_read_b128 v[84:87], v129 offset:6144
    v_mfma_f32_16x16x32_bf16 v[60:63], v[92:95], a[236:239], v[60:63]
    s_waitcnt lgkmcnt(4)
    v_mfma_f32_16x16x32_bf16 v[0:3], v[64:67], a[240:243], v[0:3]
    s_add_u32 s57, s49, 38912
    ds_read_b128 v[88:91], v129 offset:3072
    v_mfma_f32_16x16x32_bf16 v[0:3], v[68:71], a[244:247], v[0:3]
    buffer_load_dwordx4 a[48:51], v224, s[32:35], s57 offen offset:0 sc1
    v_mfma_f32_16x16x32_bf16 v[4:7], v[64:67], a[248:251], v[4:7]
    ds_read_b128 v[92:95], v129 offset:7168
    v_mfma_f32_16x16x32_bf16 v[4:7], v[68:71], a[252:255], v[4:7]
    s_waitcnt lgkmcnt(4)
    v_mfma_f32_16x16x32_bf16 v[8:11], v[72:75], a[240:243], v[8:11]
    ds_read_b128 v[64:67], v129 offset:8192
    v_mfma_f32_16x16x32_bf16 v[8:11], v[76:79], a[244:247], v[8:11]
    buffer_load_dwordx4 a[52:55], v224, s[32:35], s57 offen offset:1024 sc1
    v_mfma_f32_16x16x32_bf16 v[12:15], v[72:75], a[248:251], v[12:15]
    ds_read_b128 v[68:71], v129 offset:12288
    v_mfma_f32_16x16x32_bf16 v[12:15], v[76:79], a[252:255], v[12:15]
    s_waitcnt lgkmcnt(4)
    v_mfma_f32_16x16x32_bf16 v[16:19], v[80:83], a[240:243], v[16:19]
    s_add_u32 s57, s49, 153600
    ds_read_b128 v[72:75], v129 offset:9216
    v_mfma_f32_16x16x32_bf16 v[16:19], v[84:87], a[244:247], v[16:19]
    buffer_load_dwordx4 a[56:59], v224, s[32:35], s57 offen offset:0 sc1
    v_mfma_f32_16x16x32_bf16 v[20:23], v[80:83], a[248:251], v[20:23]
    ds_read_b128 v[76:79], v129 offset:13312
    v_mfma_f32_16x16x32_bf16 v[20:23], v[84:87], a[252:255], v[20:23]
    s_waitcnt lgkmcnt(4)
    v_mfma_f32_16x16x32_bf16 v[24:27], v[88:91], a[240:243], v[24:27]
    ds_read_b128 v[80:83], v129 offset:10240
    v_mfma_f32_16x16x32_bf16 v[24:27], v[92:95], a[244:247], v[24:27]
    buffer_load_dwordx4 a[60:63], v224, s[32:35], s57 offen offset:1024 sc1
    v_mfma_f32_16x16x32_bf16 v[28:31], v[88:91], a[248:251], v[28:31]
    ds_read_b128 v[84:87], v129 offset:14336
    v_mfma_f32_16x16x32_bf16 v[28:31], v[92:95], a[252:255], v[28:31]
    s_waitcnt lgkmcnt(4)
    v_mfma_f32_16x16x32_bf16 v[32:35], v[64:67], a[240:243], v[32:35]
    s_add_u32 s56, s55, 163840
    ds_read_b128 v[88:91], v129 offset:11264
    s_add_u32 m0, s53, 32768
    v_mfma_f32_16x16x32_bf16 v[32:35], v[68:71], a[244:247], v[32:35]
    buffer_load_dwordx4 v224, s[24:27], s56 offen offset:0 sc1 lds
    v_mfma_f32_16x16x32_bf16 v[36:39], v[64:67], a[248:251], v[36:39]
    s_waitcnt vmcnt(29)
    ds_read_b128 v[92:95], v129 offset:15360
    v_mfma_f32_16x16x32_bf16 v[36:39], v[68:71], a[252:255], v[36:39]
    s_waitcnt lgkmcnt(4)
    s_barrier
    v_mfma_f32_16x16x32_bf16 v[40:43], v[72:75], a[240:243], v[40:43]
    ds_read_b128 v[64:67], v129 offset:16384
    v_mfma_f32_16x16x32_bf16 v[40:43], v[76:79], a[244:247], v[40:43]
    buffer_load_dwordx4 v224, s[24:27], s56 offen offset:1024 sc1 lds
    v_mfma_f32_16x16x32_bf16 v[44:47], v[72:75], a[248:251], v[44:47]
    ds_read_b128 v[68:71], v129 offset:20480
    v_mfma_f32_16x16x32_bf16 v[44:47], v[76:79], a[252:255], v[44:47]
    s_waitcnt lgkmcnt(4)
    v_mfma_f32_16x16x32_bf16 v[48:51], v[80:83], a[240:243], v[48:51]
    s_add_u32 s56, s55, 172032
    ds_read_b128 v[72:75], v129 offset:17408
    s_add_u32 m0, s53, 40960
    v_mfma_f32_16x16x32_bf16 v[48:51], v[84:87], a[244:247], v[48:51]
    buffer_load_dwordx4 v224, s[24:27], s56 offen offset:0 sc1 lds
    v_mfma_f32_16x16x32_bf16 v[52:55], v[80:83], a[248:251], v[52:55]
    ds_read_b128 v[76:79], v129 offset:21504
    v_mfma_f32_16x16x32_bf16 v[52:55], v[84:87], a[252:255], v[52:55]
    s_waitcnt lgkmcnt(4)
    v_mfma_f32_16x16x32_bf16 v[56:59], v[88:91], a[240:243], v[56:59]
    ds_read_b128 v[80:83], v129 offset:18432
    v_mfma_f32_16x16x32_bf16 v[56:59], v[92:95], a[244:247], v[56:59]
    buffer_load_dwordx4 v224, s[24:27], s56 offen offset:1024 sc1 lds
    v_mfma_f32_16x16x32_bf16 v[60:63], v[88:91], a[248:251], v[60:63]
    s_waitcnt vmcnt(28)
    ds_read_b128 v[84:87], v129 offset:22528
    v_mfma_f32_16x16x32_bf16 v[60:63], v[92:95], a[252:255], v[60:63]
    s_waitcnt lgkmcnt(4)
    v_mfma_f32_16x16x32_bf16 v[0:3], v[64:67], a[0:3], v[0:3]
    s_add_u32 s57, s49, 40960
    ds_read_b128 v[88:91], v129 offset:19456
    v_mfma_f32_16x16x32_bf16 v[0:3], v[68:71], a[4:7], v[0:3]
    buffer_load_dwordx4 a[64:67], v224, s[32:35], s57 offen offset:0 sc1
    v_mfma_f32_16x16x32_bf16 v[4:7], v[64:67], a[8:11], v[4:7]
    ds_read_b128 v[92:95], v129 offset:23552
    v_mfma_f32_16x16x32_bf16 v[4:7], v[68:71], a[12:15], v[4:7]
    s_waitcnt lgkmcnt(4)
    v_mfma_f32_16x16x32_bf16 v[8:11], v[72:75], a[0:3], v[8:11]
    ds_read_b128 v[64:67], v129 offset:24576
    v_mfma_f32_16x16x32_bf16 v[8:11], v[76:79], a[4:7], v[8:11]
    buffer_load_dwordx4 a[68:71], v224, s[32:35], s57 offen offset:1024 sc1
    v_mfma_f32_16x16x32_bf16 v[12:15], v[72:75], a[8:11], v[12:15]
    ds_read_b128 v[68:71], v129 offset:28672
    v_mfma_f32_16x16x32_bf16 v[12:15], v[76:79], a[12:15], v[12:15]
    s_waitcnt lgkmcnt(4)
    v_mfma_f32_16x16x32_bf16 v[16:19], v[80:83], a[0:3], v[16:19]
    s_add_u32 s57, s49, 155648
    ds_read_b128 v[72:75], v129 offset:25600
    v_mfma_f32_16x16x32_bf16 v[16:19], v[84:87], a[4:7], v[16:19]
    buffer_load_dwordx4 a[72:75], v224, s[32:35], s57 offen offset:0 sc1
    v_mfma_f32_16x16x32_bf16 v[20:23], v[80:83], a[8:11], v[20:23]
    ds_read_b128 v[76:79], v129 offset:29696
    v_mfma_f32_16x16x32_bf16 v[20:23], v[84:87], a[12:15], v[20:23]
    s_waitcnt lgkmcnt(4)
    v_mfma_f32_16x16x32_bf16 v[24:27], v[88:91], a[0:3], v[24:27]
    ds_read_b128 v[80:83], v129 offset:26624
    v_mfma_f32_16x16x32_bf16 v[24:27], v[92:95], a[4:7], v[24:27]
    buffer_load_dwordx4 a[76:79], v224, s[32:35], s57 offen offset:1024 sc1
    v_mfma_f32_16x16x32_bf16 v[28:31], v[88:91], a[8:11], v[28:31]
    ds_read_b128 v[84:87], v129 offset:30720
    v_mfma_f32_16x16x32_bf16 v[28:31], v[92:95], a[12:15], v[28:31]
    s_waitcnt lgkmcnt(4)
    v_mfma_f32_16x16x32_bf16 v[32:35], v[64:67], a[0:3], v[32:35]
    s_add_u32 s57, s49, 43008
    ds_read_b128 v[88:91], v129 offset:27648
    v_mfma_f32_16x16x32_bf16 v[32:35], v[68:71], a[4:7], v[32:35]
    buffer_load_dwordx4 a[80:83], v224, s[32:35], s57 offen offset:0 sc1
    v_mfma_f32_16x16x32_bf16 v[36:39], v[64:67], a[8:11], v[36:39]
    s_waitcnt vmcnt(29)
    ds_read_b128 v[92:95], v129 offset:31744
    v_mfma_f32_16x16x32_bf16 v[36:39], v[68:71], a[12:15], v[36:39]
    s_waitcnt lgkmcnt(4)
    s_barrier
    v_mfma_f32_16x16x32_bf16 v[40:43], v[72:75], a[0:3], v[40:43]
    ds_read_b128 v[64:67], v129 offset:32768
    v_mfma_f32_16x16x32_bf16 v[40:43], v[76:79], a[4:7], v[40:43]
    buffer_load_dwordx4 a[84:87], v224, s[32:35], s57 offen offset:1024 sc1
    v_mfma_f32_16x16x32_bf16 v[44:47], v[72:75], a[8:11], v[44:47]
    ds_read_b128 v[68:71], v129 offset:36864
    v_mfma_f32_16x16x32_bf16 v[44:47], v[76:79], a[12:15], v[44:47]
    s_waitcnt lgkmcnt(4)
    v_mfma_f32_16x16x32_bf16 v[48:51], v[80:83], a[0:3], v[48:51]
    s_add_u32 s57, s49, 157696
    ds_read_b128 v[72:75], v129 offset:33792
    v_mfma_f32_16x16x32_bf16 v[48:51], v[84:87], a[4:7], v[48:51]
    buffer_load_dwordx4 a[88:91], v224, s[32:35], s57 offen offset:0 sc1
    v_mfma_f32_16x16x32_bf16 v[52:55], v[80:83], a[8:11], v[52:55]
    ds_read_b128 v[76:79], v129 offset:37888
    v_mfma_f32_16x16x32_bf16 v[52:55], v[84:87], a[12:15], v[52:55]
    s_waitcnt lgkmcnt(4)
    v_mfma_f32_16x16x32_bf16 v[56:59], v[88:91], a[0:3], v[56:59]
    ds_read_b128 v[80:83], v129 offset:34816
    v_mfma_f32_16x16x32_bf16 v[56:59], v[92:95], a[4:7], v[56:59]
    buffer_load_dwordx4 a[92:95], v224, s[32:35], s57 offen offset:1024 sc1
    v_mfma_f32_16x16x32_bf16 v[60:63], v[88:91], a[8:11], v[60:63]
    s_waitcnt vmcnt(28)
    ds_read_b128 v[84:87], v129 offset:38912
    v_mfma_f32_16x16x32_bf16 v[60:63], v[92:95], a[12:15], v[60:63]
    s_waitcnt lgkmcnt(4)
    v_mfma_f32_16x16x32_bf16 v[0:3], v[64:67], a[16:19], v[0:3]
    s_add_u32 s56, s55, 180224
    ds_read_b128 v[88:91], v129 offset:35840
    s_add_u32 m0, s53, 49152
    v_mfma_f32_16x16x32_bf16 v[0:3], v[68:71], a[20:23], v[0:3]
    buffer_load_dwordx4 v224, s[24:27], s56 offen offset:0 sc1 lds
    v_mfma_f32_16x16x32_bf16 v[4:7], v[64:67], a[24:27], v[4:7]
    ds_read_b128 v[92:95], v129 offset:39936
    v_mfma_f32_16x16x32_bf16 v[4:7], v[68:71], a[28:31], v[4:7]
    s_waitcnt lgkmcnt(4)
    v_mfma_f32_16x16x32_bf16 v[8:11], v[72:75], a[16:19], v[8:11]
    ds_read_b128 v[64:67], v129 offset:40960
    v_mfma_f32_16x16x32_bf16 v[8:11], v[76:79], a[20:23], v[8:11]
    buffer_load_dwordx4 v224, s[24:27], s56 offen offset:1024 sc1 lds
    v_mfma_f32_16x16x32_bf16 v[12:15], v[72:75], a[24:27], v[12:15]
    ds_read_b128 v[68:71], v129 offset:45056
    v_mfma_f32_16x16x32_bf16 v[12:15], v[76:79], a[28:31], v[12:15]
    s_waitcnt lgkmcnt(4)
    v_mfma_f32_16x16x32_bf16 v[16:19], v[80:83], a[16:19], v[16:19]
    s_add_u32 s56, s55, 188416
    ds_read_b128 v[72:75], v129 offset:41984
    s_add_u32 m0, s53, 147456
    v_mfma_f32_16x16x32_bf16 v[16:19], v[84:87], a[20:23], v[16:19]
    buffer_load_dwordx4 v224, s[24:27], s56 offen offset:0 sc1 lds
    v_mfma_f32_16x16x32_bf16 v[20:23], v[80:83], a[24:27], v[20:23]
    ds_read_b128 v[76:79], v129 offset:46080
    v_mfma_f32_16x16x32_bf16 v[20:23], v[84:87], a[28:31], v[20:23]
    s_waitcnt lgkmcnt(4)
    v_mfma_f32_16x16x32_bf16 v[24:27], v[88:91], a[16:19], v[24:27]
    ds_read_b128 v[80:83], v129 offset:43008
    v_mfma_f32_16x16x32_bf16 v[24:27], v[92:95], a[20:23], v[24:27]
    buffer_load_dwordx4 v224, s[24:27], s56 offen offset:1024 sc1 lds
    v_mfma_f32_16x16x32_bf16 v[28:31], v[88:91], a[24:27], v[28:31]
    ds_read_b128 v[84:87], v129 offset:47104
    v_mfma_f32_16x16x32_bf16 v[28:31], v[92:95], a[28:31], v[28:31]
    s_waitcnt lgkmcnt(4)
    v_mfma_f32_16x16x32_bf16 v[32:35], v[64:67], a[16:19], v[32:35]
    s_add_u32 s57, s49, 45056
    ds_read_b128 v[88:91], v129 offset:44032
    v_mfma_f32_16x16x32_bf16 v[32:35], v[68:71], a[20:23], v[32:35]
    buffer_load_dwordx4 a[96:99], v224, s[32:35], s57 offen offset:0 sc1
    v_mfma_f32_16x16x32_bf16 v[36:39], v[64:67], a[24:27], v[36:39]
    s_waitcnt vmcnt(29)
    ds_read_b128 v[92:95], v129 offset:48128
    v_mfma_f32_16x16x32_bf16 v[36:39], v[68:71], a[28:31], v[36:39]
    s_waitcnt lgkmcnt(4)
    s_barrier
    v_mfma_f32_16x16x32_bf16 v[40:43], v[72:75], a[16:19], v[40:43]
    ds_read_b128 v[64:67], v129 offset:49152
    v_mfma_f32_16x16x32_bf16 v[40:43], v[76:79], a[20:23], v[40:43]
    buffer_load_dwordx4 a[100:103], v224, s[32:35], s57 offen offset:1024 sc1
    v_mfma_f32_16x16x32_bf16 v[44:47], v[72:75], a[24:27], v[44:47]
    ds_read_b128 v[68:71], v129 offset:53248
    v_mfma_f32_16x16x32_bf16 v[44:47], v[76:79], a[28:31], v[44:47]
    s_waitcnt lgkmcnt(4)
    v_mfma_f32_16x16x32_bf16 v[48:51], v[80:83], a[16:19], v[48:51]
    s_add_u32 s57, s49, 159744
    ds_read_b128 v[72:75], v129 offset:50176
    v_mfma_f32_16x16x32_bf16 v[48:51], v[84:87], a[20:23], v[48:51]
    buffer_load_dwordx4 a[104:107], v224, s[32:35], s57 offen offset:0 sc1
    v_mfma_f32_16x16x32_bf16 v[52:55], v[80:83], a[24:27], v[52:55]
    ds_read_b128 v[76:79], v129 offset:54272
    v_mfma_f32_16x16x32_bf16 v[52:55], v[84:87], a[28:31], v[52:55]
    s_waitcnt lgkmcnt(4)
    v_mfma_f32_16x16x32_bf16 v[56:59], v[88:91], a[16:19], v[56:59]
    ds_read_b128 v[80:83], v129 offset:51200
    v_mfma_f32_16x16x32_bf16 v[56:59], v[92:95], a[20:23], v[56:59]
    buffer_load_dwordx4 a[108:111], v224, s[32:35], s57 offen offset:1024 sc1
    v_mfma_f32_16x16x32_bf16 v[60:63], v[88:91], a[24:27], v[60:63]
    s_waitcnt vmcnt(28)
    ds_read_b128 v[84:87], v129 offset:55296
    v_mfma_f32_16x16x32_bf16 v[60:63], v[92:95], a[28:31], v[60:63]
    s_waitcnt lgkmcnt(4)
    v_mfma_f32_16x16x32_bf16 v[0:3], v[64:67], a[32:35], v[0:3]
    s_add_u32 s57, s49, 47104
    ds_read_b128 v[88:91], v129 offset:52224
    v_mfma_f32_16x16x32_bf16 v[0:3], v[68:71], a[36:39], v[0:3]
    buffer_load_dwordx4 a[112:115], v224, s[32:35], s57 offen offset:0 sc1
    v_mfma_f32_16x16x32_bf16 v[4:7], v[64:67], a[40:43], v[4:7]
    ds_read_b128 v[92:95], v129 offset:56320
    v_mfma_f32_16x16x32_bf16 v[4:7], v[68:71], a[44:47], v[4:7]
    s_waitcnt lgkmcnt(4)
    v_mfma_f32_16x16x32_bf16 v[8:11], v[72:75], a[32:35], v[8:11]
    ds_read_b128 v[64:67], v129 offset:57344
    v_mfma_f32_16x16x32_bf16 v[8:11], v[76:79], a[36:39], v[8:11]
    buffer_load_dwordx4 a[116:119], v224, s[32:35], s57 offen offset:1024 sc1
    v_mfma_f32_16x16x32_bf16 v[12:15], v[72:75], a[40:43], v[12:15]
    ds_read_b128 v[68:71], v129 offset:61440
    v_mfma_f32_16x16x32_bf16 v[12:15], v[76:79], a[44:47], v[12:15]
    s_waitcnt lgkmcnt(4)
    v_mfma_f32_16x16x32_bf16 v[16:19], v[80:83], a[32:35], v[16:19]
    s_add_u32 s57, s49, 161792
    ds_read_b128 v[72:75], v129 offset:58368
    v_mfma_f32_16x16x32_bf16 v[16:19], v[84:87], a[36:39], v[16:19]
    buffer_load_dwordx4 a[120:123], v224, s[32:35], s57 offen offset:0 sc1
    v_mfma_f32_16x16x32_bf16 v[20:23], v[80:83], a[40:43], v[20:23]
    ds_read_b128 v[76:79], v129 offset:62464
    v_mfma_f32_16x16x32_bf16 v[20:23], v[84:87], a[44:47], v[20:23]
    s_waitcnt lgkmcnt(4)
    v_mfma_f32_16x16x32_bf16 v[24:27], v[88:91], a[32:35], v[24:27]
    ds_read_b128 v[80:83], v129 offset:59392
    v_mfma_f32_16x16x32_bf16 v[24:27], v[92:95], a[36:39], v[24:27]
    buffer_load_dwordx4 a[124:127], v224, s[32:35], s57 offen offset:1024 sc1
    v_mfma_f32_16x16x32_bf16 v[28:31], v[88:91], a[40:43], v[28:31]
    ds_read_b128 v[84:87], v129 offset:63488
    v_mfma_f32_16x16x32_bf16 v[28:31], v[92:95], a[44:47], v[28:31]
    s_waitcnt lgkmcnt(4)
    v_mfma_f32_16x16x32_bf16 v[32:35], v[64:67], a[32:35], v[32:35]
    s_add_u32 s56, s55, 196608
    ds_read_b128 v[88:91], v129 offset:60416
    s_add_u32 m0, s53, 155648
    v_mfma_f32_16x16x32_bf16 v[32:35], v[68:71], a[36:39], v[32:35]
    buffer_load_dwordx4 v224, s[24:27], s56 offen offset:0 sc1 lds
    v_mfma_f32_16x16x32_bf16 v[36:39], v[64:67], a[40:43], v[36:39]
    s_waitcnt vmcnt(29)
    ds_read_b128 v[92:95], v129 offset:64512
    v_mfma_f32_16x16x32_bf16 v[36:39], v[68:71], a[44:47], v[36:39]
    s_waitcnt lgkmcnt(4)
    s_barrier
    v_mfma_f32_16x16x32_bf16 v[40:43], v[72:75], a[32:35], v[40:43]
    ds_read_b128 v[64:67], v130 offset:0
    v_mfma_f32_16x16x32_bf16 v[40:43], v[76:79], a[36:39], v[40:43]
    buffer_load_dwordx4 v224, s[24:27], s56 offen offset:1024 sc1 lds
    v_mfma_f32_16x16x32_bf16 v[44:47], v[72:75], a[40:43], v[44:47]
    ds_read_b128 v[68:71], v130 offset:4096
    v_mfma_f32_16x16x32_bf16 v[44:47], v[76:79], a[44:47], v[44:47]
    s_waitcnt lgkmcnt(4)
    v_mfma_f32_16x16x32_bf16 v[48:51], v[80:83], a[32:35], v[48:51]
    s_add_u32 s56, s55, 204800
    ds_read_b128 v[72:75], v130 offset:1024
    s_add_u32 m0, s53, 0
    v_mfma_f32_16x16x32_bf16 v[48:51], v[84:87], a[36:39], v[48:51]
    buffer_load_dwordx4 v224, s[24:27], s56 offen offset:0 sc1 lds
    v_mfma_f32_16x16x32_bf16 v[52:55], v[80:83], a[40:43], v[52:55]
    ds_read_b128 v[76:79], v130 offset:5120
    v_mfma_f32_16x16x32_bf16 v[52:55], v[84:87], a[44:47], v[52:55]
    s_waitcnt lgkmcnt(4)
    v_mfma_f32_16x16x32_bf16 v[56:59], v[88:91], a[32:35], v[56:59]
    ds_read_b128 v[80:83], v130 offset:2048
    v_mfma_f32_16x16x32_bf16 v[56:59], v[92:95], a[36:39], v[56:59]
    buffer_load_dwordx4 v224, s[24:27], s56 offen offset:1024 sc1 lds
    v_mfma_f32_16x16x32_bf16 v[60:63], v[88:91], a[40:43], v[60:63]
    s_waitcnt vmcnt(28)
    ds_read_b128 v[84:87], v130 offset:6144
    v_mfma_f32_16x16x32_bf16 v[60:63], v[92:95], a[44:47], v[60:63]
    s_waitcnt lgkmcnt(4)
    v_mfma_f32_16x16x32_bf16 v[0:3], v[64:67], a[48:51], v[0:3]
    s_add_u32 s57, s49, 49152
    ds_read_b128 v[88:91], v130 offset:3072
    v_mfma_f32_16x16x32_bf16 v[0:3], v[68:71], a[52:55], v[0:3]
    buffer_load_dwordx4 a[128:131], v224, s[32:35], s57 offen offset:0 sc1
    v_mfma_f32_16x16x32_bf16 v[4:7], v[64:67], a[56:59], v[4:7]
    ds_read_b128 v[92:95], v130 offset:7168
    v_mfma_f32_16x16x32_bf16 v[4:7], v[68:71], a[60:63], v[4:7]
    s_waitcnt lgkmcnt(4)
    v_mfma_f32_16x16x32_bf16 v[8:11], v[72:75], a[48:51], v[8:11]
    ds_read_b128 v[64:67], v130 offset:8192
    v_mfma_f32_16x16x32_bf16 v[8:11], v[76:79], a[52:55], v[8:11]
    buffer_load_dwordx4 a[132:135], v224, s[32:35], s57 offen offset:1024 sc1
    v_mfma_f32_16x16x32_bf16 v[12:15], v[72:75], a[56:59], v[12:15]
    ds_read_b128 v[68:71], v130 offset:12288
    v_mfma_f32_16x16x32_bf16 v[12:15], v[76:79], a[60:63], v[12:15]
    s_waitcnt lgkmcnt(4)
    v_mfma_f32_16x16x32_bf16 v[16:19], v[80:83], a[48:51], v[16:19]
    s_add_u32 s57, s49, 163840
    ds_read_b128 v[72:75], v130 offset:9216
    v_mfma_f32_16x16x32_bf16 v[16:19], v[84:87], a[52:55], v[16:19]
    buffer_load_dwordx4 a[136:139], v224, s[32:35], s57 offen offset:0 sc1
    v_mfma_f32_16x16x32_bf16 v[20:23], v[80:83], a[56:59], v[20:23]
    ds_read_b128 v[76:79], v130 offset:13312
    v_mfma_f32_16x16x32_bf16 v[20:23], v[84:87], a[60:63], v[20:23]
    s_waitcnt lgkmcnt(4)
    v_mfma_f32_16x16x32_bf16 v[24:27], v[88:91], a[48:51], v[24:27]
    ds_read_b128 v[80:83], v130 offset:10240
    v_mfma_f32_16x16x32_bf16 v[24:27], v[92:95], a[52:55], v[24:27]
    buffer_load_dwordx4 a[140:143], v224, s[32:35], s57 offen offset:1024 sc1
    v_mfma_f32_16x16x32_bf16 v[28:31], v[88:91], a[56:59], v[28:31]
    ds_read_b128 v[84:87], v130 offset:14336
    v_mfma_f32_16x16x32_bf16 v[28:31], v[92:95], a[60:63], v[28:31]
    s_waitcnt lgkmcnt(4)
    v_mfma_f32_16x16x32_bf16 v[32:35], v[64:67], a[48:51], v[32:35]
    s_add_u32 s57, s49, 51200
    ds_read_b128 v[88:91], v130 offset:11264
    v_mfma_f32_16x16x32_bf16 v[32:35], v[68:71], a[52:55], v[32:35]
    buffer_load_dwordx4 a[144:147], v224, s[32:35], s57 offen offset:0 sc1
    v_mfma_f32_16x16x32_bf16 v[36:39], v[64:67], a[56:59], v[36:39]
    s_waitcnt vmcnt(29)
    ds_read_b128 v[92:95], v130 offset:15360
    v_mfma_f32_16x16x32_bf16 v[36:39], v[68:71], a[60:63], v[36:39]
    s_waitcnt lgkmcnt(4)
    s_barrier
    v_mfma_f32_16x16x32_bf16 v[40:43], v[72:75], a[48:51], v[40:43]
    ds_read_b128 v[64:67], v128 offset:32768
    v_mfma_f32_16x16x32_bf16 v[40:43], v[76:79], a[52:55], v[40:43]
    buffer_load_dwordx4 a[148:151], v224, s[32:35], s57 offen offset:1024 sc1
    v_mfma_f32_16x16x32_bf16 v[44:47], v[72:75], a[56:59], v[44:47]
    ds_read_b128 v[68:71], v128 offset:36864
    v_mfma_f32_16x16x32_bf16 v[44:47], v[76:79], a[60:63], v[44:47]
    s_waitcnt lgkmcnt(4)
    v_mfma_f32_16x16x32_bf16 v[48:51], v[80:83], a[48:51], v[48:51]
    s_add_u32 s57, s49, 165888
    ds_read_b128 v[72:75], v128 offset:33792
    v_mfma_f32_16x16x32_bf16 v[48:51], v[84:87], a[52:55], v[48:51]
    buffer_load_dwordx4 a[152:155], v224, s[32:35], s57 offen offset:0 sc1
    v_mfma_f32_16x16x32_bf16 v[52:55], v[80:83], a[56:59], v[52:55]
    ds_read_b128 v[76:79], v128 offset:37888
    v_mfma_f32_16x16x32_bf16 v[52:55], v[84:87], a[60:63], v[52:55]
    s_waitcnt lgkmcnt(4)
    v_mfma_f32_16x16x32_bf16 v[56:59], v[88:91], a[48:51], v[56:59]
    ds_read_b128 v[80:83], v128 offset:34816
    v_mfma_f32_16x16x32_bf16 v[56:59], v[92:95], a[52:55], v[56:59]
    buffer_load_dwordx4 a[156:159], v224, s[32:35], s57 offen offset:1024 sc1
    v_mfma_f32_16x16x32_bf16 v[60:63], v[88:91], a[56:59], v[60:63]
    s_waitcnt vmcnt(28)
    ds_read_b128 v[84:87], v128 offset:38912
    v_mfma_f32_16x16x32_bf16 v[60:63], v[92:95], a[60:63], v[60:63]
    s_waitcnt lgkmcnt(4)
    v_mfma_f32_16x16x32_bf16 v[32:35], v[64:67], a[64:67], v[32:35]
    s_add_u32 s56, s55, 212992
    ds_read_b128 v[88:91], v128 offset:35840
    s_add_u32 m0, s53, 8192
    v_mfma_f32_16x16x32_bf16 v[32:35], v[68:71], a[68:71], v[32:35]
    buffer_load_dwordx4 v224, s[24:27], s56 offen offset:0 sc1 lds
    v_mfma_f32_16x16x32_bf16 v[36:39], v[64:67], a[72:75], v[36:39]
    ds_read_b128 v[92:95], v128 offset:39936
    v_mfma_f32_16x16x32_bf16 v[36:39], v[68:71], a[76:79], v[36:39]
    s_waitcnt lgkmcnt(4)
    v_mfma_f32_16x16x32_bf16 v[40:43], v[72:75], a[64:67], v[40:43]
    ds_read_b128 v[64:67], v128 offset:40960
    v_mfma_f32_16x16x32_bf16 v[40:43], v[76:79], a[68:71], v[40:43]
    buffer_load_dwordx4 v224, s[24:27], s56 offen offset:1024 sc1 lds
    v_mfma_f32_16x16x32_bf16 v[44:47], v[72:75], a[72:75], v[44:47]
    ds_read_b128 v[68:71], v128 offset:45056
    v_mfma_f32_16x16x32_bf16 v[44:47], v[76:79], a[76:79], v[44:47]
    s_waitcnt lgkmcnt(4)
    v_mfma_f32_16x16x32_bf16 v[48:51], v[80:83], a[64:67], v[48:51]
    s_add_u32 s56, s55, 221184
    ds_read_b128 v[72:75], v128 offset:41984
    s_add_u32 m0, s53, 16384
    v_mfma_f32_16x16x32_bf16 v[48:51], v[84:87], a[68:71], v[48:51]
    buffer_load_dwordx4 v224, s[24:27], s56 offen offset:0 sc1 lds
    v_mfma_f32_16x16x32_bf16 v[52:55], v[80:83], a[72:75], v[52:55]
    ds_read_b128 v[76:79], v128 offset:46080
    v_mfma_f32_16x16x32_bf16 v[52:55], v[84:87], a[76:79], v[52:55]
    s_waitcnt lgkmcnt(4)
    v_mfma_f32_16x16x32_bf16 v[56:59], v[88:91], a[64:67], v[56:59]
    ds_read_b128 v[80:83], v128 offset:43008
    v_mfma_f32_16x16x32_bf16 v[56:59], v[92:95], a[68:71], v[56:59]
    buffer_load_dwordx4 v224, s[24:27], s56 offen offset:1024 sc1 lds
    v_mfma_f32_16x16x32_bf16 v[60:63], v[88:91], a[72:75], v[60:63]
    s_waitcnt vmcnt(28)
    ds_read_b128 v[84:87], v128 offset:47104
    v_mfma_f32_16x16x32_bf16 v[60:63], v[92:95], a[76:79], v[60:63]
    s_waitcnt lgkmcnt(4)
    v_mfma_f32_16x16x32_bf16 v[32:35], v[64:67], a[80:83], v[32:35]
    s_add_u32 s57, s49, 53248
    ds_read_b128 v[88:91], v128 offset:44032
    v_mfma_f32_16x16x32_bf16 v[32:35], v[68:71], a[84:87], v[32:35]
    buffer_load_dwordx4 a[160:163], v224, s[32:35], s57 offen offset:0 sc1
    v_mfma_f32_16x16x32_bf16 v[36:39], v[64:67], a[88:91], v[36:39]
    s_waitcnt vmcnt(25)
    ds_read_b128 v[92:95], v128 offset:48128
    v_mfma_f32_16x16x32_bf16 v[36:39], v[68:71], a[92:95], v[36:39]
    s_waitcnt lgkmcnt(4)
    s_barrier
    v_mfma_f32_16x16x32_bf16 v[40:43], v[72:75], a[80:83], v[40:43]
    ds_read_b128 v[64:67], v128 offset:49152
    v_mfma_f32_16x16x32_bf16 v[40:43], v[76:79], a[84:87], v[40:43]
    buffer_load_dwordx4 a[164:167], v224, s[32:35], s57 offen offset:1024 sc1
    v_mfma_f32_16x16x32_bf16 v[44:47], v[72:75], a[88:91], v[44:47]
    ds_read_b128 v[68:71], v128 offset:53248
    v_mfma_f32_16x16x32_bf16 v[44:47], v[76:79], a[92:95], v[44:47]
    s_waitcnt lgkmcnt(4)
    v_mfma_f32_16x16x32_bf16 v[48:51], v[80:83], a[80:83], v[48:51]
    s_add_u32 s57, s49, 167936
    ds_read_b128 v[72:75], v128 offset:50176
    v_mfma_f32_16x16x32_bf16 v[48:51], v[84:87], a[84:87], v[48:51]
    buffer_load_dwordx4 a[168:171], v224, s[32:35], s57 offen offset:0 sc1
    v_mfma_f32_16x16x32_bf16 v[52:55], v[80:83], a[88:91], v[52:55]
    ds_read_b128 v[76:79], v128 offset:54272
    v_mfma_f32_16x16x32_bf16 v[52:55], v[84:87], a[92:95], v[52:55]
    s_waitcnt lgkmcnt(4)
    v_mfma_f32_16x16x32_bf16 v[56:59], v[88:91], a[80:83], v[56:59]
    ds_read_b128 v[80:83], v128 offset:51200
    v_mfma_f32_16x16x32_bf16 v[56:59], v[92:95], a[84:87], v[56:59]
    buffer_load_dwordx4 a[172:175], v224, s[32:35], s57 offen offset:1024 sc1
    v_mfma_f32_16x16x32_bf16 v[60:63], v[88:91], a[88:91], v[60:63]
    s_waitcnt vmcnt(24)
    ds_read_b128 v[84:87], v128 offset:55296
    v_mfma_f32_16x16x32_bf16 v[60:63], v[92:95], a[92:95], v[60:63]
    s_waitcnt lgkmcnt(4)
    v_mfma_f32_16x16x32_bf16 v[32:35], v[64:67], a[96:99], v[32:35]
    s_add_u32 s57, s49, 55296
    ds_read_b128 v[88:91], v128 offset:52224
    v_mfma_f32_16x16x32_bf16 v[32:35], v[68:71], a[100:103], v[32:35]
    buffer_load_dwordx4 a[176:179], v224, s[32:35], s57 offen offset:0 sc1
    v_mfma_f32_16x16x32_bf16 v[36:39], v[64:67], a[104:107], v[36:39]
    ds_read_b128 v[92:95], v128 offset:56320
    v_mfma_f32_16x16x32_bf16 v[36:39], v[68:71], a[108:111], v[36:39]
    s_waitcnt lgkmcnt(4)
    v_mfma_f32_16x16x32_bf16 v[40:43], v[72:75], a[96:99], v[40:43]
    ds_read_b128 v[64:67], v130 offset:16384
    v_mfma_f32_16x16x32_bf16 v[40:43], v[76:79], a[100:103], v[40:43]
    buffer_load_dwordx4 a[180:183], v224, s[32:35], s57 offen offset:1024 sc1
    v_mfma_f32_16x16x32_bf16 v[44:47], v[72:75], a[104:107], v[44:47]
    ds_read_b128 v[68:71], v130 offset:20480
    v_mfma_f32_16x16x32_bf16 v[44:47], v[76:79], a[108:111], v[44:47]
    s_waitcnt lgkmcnt(4)
    v_mfma_f32_16x16x32_bf16 v[48:51], v[80:83], a[96:99], v[48:51]
    s_add_u32 s57, s49, 169984
    ds_read_b128 v[72:75], v130 offset:17408
    v_mfma_f32_16x16x32_bf16 v[48:51], v[84:87], a[100:103], v[48:51]
    buffer_load_dwordx4 a[184:187], v224, s[32:35], s57 offen offset:0 sc1
    v_mfma_f32_16x16x32_bf16 v[52:55], v[80:83], a[104:107], v[52:55]
    ds_read_b128 v[76:79], v130 offset:21504
    v_mfma_f32_16x16x32_bf16 v[52:55], v[84:87], a[108:111], v[52:55]
    s_waitcnt lgkmcnt(4)
    v_mfma_f32_16x16x32_bf16 v[56:59], v[88:91], a[96:99], v[56:59]
    ds_read_b128 v[80:83], v130 offset:18432
    v_mfma_f32_16x16x32_bf16 v[56:59], v[92:95], a[100:103], v[56:59]
    buffer_load_dwordx4 a[188:191], v224, s[32:35], s57 offen offset:1024 sc1
    v_mfma_f32_16x16x32_bf16 v[60:63], v[88:91], a[104:107], v[60:63]
    s_waitcnt vmcnt(24)
    ds_read_b128 v[84:87], v130 offset:22528
    v_mfma_f32_16x16x32_bf16 v[60:63], v[92:95], a[108:111], v[60:63]
    s_waitcnt lgkmcnt(4)
    v_mfma_f32_16x16x32_bf16 v[32:35], v[64:67], a[112:115], v[32:35]
    s_add_u32 s56, s52, 163840
    ds_read_b128 v[88:91], v130 offset:19456
    s_add_u32 m0, s53, 24576
    v_mfma_f32_16x16x32_bf16 v[32:35], v[68:71], a[116:119], v[32:35]
    buffer_load_dwordx4 v224, s[24:27], s56 offen offset:0 sc1 lds
    v_mfma_f32_16x16x32_bf16 v[36:39], v[64:67], a[120:123], v[36:39]
    s_waitcnt vmcnt(21)
    ds_read_b128 v[92:95], v130 offset:23552
    v_mfma_f32_16x16x32_bf16 v[36:39], v[68:71], a[124:127], v[36:39]
    s_waitcnt lgkmcnt(4)
    s_barrier
    v_mfma_f32_16x16x32_bf16 v[40:43], v[72:75], a[112:115], v[40:43]
    ds_read_b128 v[64:67], v130 offset:24576
    v_mfma_f32_16x16x32_bf16 v[40:43], v[76:79], a[116:119], v[40:43]
    buffer_load_dwordx4 v224, s[24:27], s56 offen offset:1024 sc1 lds
L_stub_21:
    s_cbranch_execz L_warm_w28_ret
    v_mfma_f32_16x16x32_bf16 v[44:47], v[72:75], a[120:123], v[44:47]
    ds_read_b128 v[68:71], v130 offset:28672
    v_mfma_f32_16x16x32_bf16 v[44:47], v[76:79], a[124:127], v[44:47]
    s_waitcnt lgkmcnt(4)
    v_mfma_f32_16x16x32_bf16 v[48:51], v[80:83], a[112:115], v[48:51]
    s_add_u32 s56, s52, 172032
    ds_read_b128 v[72:75], v130 offset:25600
    s_add_u32 m0, s53, 57344
    v_mfma_f32_16x16x32_bf16 v[48:51], v[84:87], a[116:119], v[48:51]
    buffer_load_dwordx4 v224, s[24:27], s56 offen offset:0 sc1 lds
    v_mfma_f32_16x16x32_bf16 v[52:55], v[80:83], a[120:123], v[52:55]
    ds_read_b128 v[76:79], v130 offset:29696
    v_mfma_f32_16x16x32_bf16 v[52:55], v[84:87], a[124:127], v[52:55]
    s_waitcnt lgkmcnt(4)
    v_mfma_f32_16x16x32_bf16 v[56:59], v[88:91], a[112:115], v[56:59]
    ds_read_b128 v[80:83], v130 offset:26624
    v_mfma_f32_16x16x32_bf16 v[56:59], v[92:95], a[116:119], v[56:59]
    buffer_load_dwordx4 v224, s[24:27], s56 offen offset:1024 sc1 lds
    v_mfma_f32_16x16x32_bf16 v[60:63], v[88:91], a[120:123], v[60:63]
    s_waitcnt vmcnt(20)
    ds_read_b128 v[84:87], v130 offset:30720
    v_mfma_f32_16x16x32_bf16 v[60:63], v[92:95], a[124:127], v[60:63]
    s_waitcnt lgkmcnt(4)
    v_mfma_f32_16x16x32_bf16 v[32:35], v[64:67], a[128:131], v[32:35]
    s_add_u32 s56, s52, 180224
    ds_read_b128 v[88:91], v130 offset:27648
    s_add_u32 m0, s53, 65536
    v_mfma_f32_16x16x32_bf16 v[32:35], v[68:71], a[132:135], v[32:35]
    buffer_load_dwordx4 v224, s[24:27], s56 offen offset:0 sc1 lds
    v_mfma_f32_16x16x32_bf16 v[36:39], v[64:67], a[136:139], v[36:39]
    ds_read_b128 v[92:95], v130 offset:31744
    v_mfma_f32_16x16x32_bf16 v[36:39], v[68:71], a[140:143], v[36:39]
    s_waitcnt lgkmcnt(4)
    v_mfma_f32_16x16x32_bf16 v[40:43], v[72:75], a[128:131], v[40:43]
    ds_read_b128 v[64:67], v128 offset:0
    v_mfma_f32_16x16x32_bf16 v[40:43], v[76:79], a[132:135], v[40:43]
    buffer_load_dwordx4 v224, s[24:27], s56 offen offset:1024 sc1 lds
    v_mfma_f32_16x16x32_bf16 v[44:47], v[72:75], a[136:139], v[44:47]
    ds_read_b128 v[68:71], v128 offset:4096
    v_mfma_f32_16x16x32_bf16 v[44:47], v[76:79], a[140:143], v[44:47]
    s_waitcnt lgkmcnt(4)
    v_mfma_f32_16x16x32_bf16 v[48:51], v[80:83], a[128:131], v[48:51]
    s_add_u32 s56, s52, 188416
    ds_read_b128 v[72:75], v128 offset:1024
    s_add_u32 m0, s53, 73728
    v_mfma_f32_16x16x32_bf16 v[48:51], v[84:87], a[132:135], v[48:51]
    buffer_load_dwordx4 v224, s[24:27], s56 offen offset:0 sc1 lds
    v_mfma_f32_16x16x32_bf16 v[52:55], v[80:83], a[136:139], v[52:55]
    ds_read_b128 v[76:79], v128 offset:5120
    v_mfma_f32_16x16x32_bf16 v[52:55], v[84:87], a[140:143], v[52:55]
    s_waitcnt lgkmcnt(4)
    v_mfma_f32_16x16x32_bf16 v[56:59], v[88:91], a[128:131], v[56:59]
    ds_read_b128 v[80:83], v128 offset:2048
    v_mfma_f32_16x16x32_bf16 v[56:59], v[92:95], a[132:135], v[56:59]
    buffer_load_dwordx4 v224, s[24:27], s56 offen offset:1024 sc1 lds
    v_mfma_f32_16x16x32_bf16 v[60:63], v[88:91], a[136:139], v[60:63]
    s_waitcnt vmcnt(20)
    ds_read_b128 v[84:87], v128 offset:6144
    v_mfma_f32_16x16x32_bf16 v[60:63], v[92:95], a[140:143], v[60:63]
    s_waitcnt lgkmcnt(4)
    v_mfma_f32_16x16x32_bf16 v[32:35], v[64:67], a[144:147], v[32:35]
    s_add_u32 s56, s52, 196608
    ds_read_b128 v[88:91], v128 offset:3072
    s_add_u32 m0, s53, 81920
    v_mfma_f32_16x16x32_bf16 v[32:35], v[68:71], a[148:151], v[32:35]
    buffer_load_dwordx4 v224, s[24:27], s56 offen offset:0 sc1 lds
    v_mfma_f32_16x16x32_bf16 v[36:39], v[64:67], a[152:155], v[36:39]
    s_waitcnt vmcnt(17)
    ds_read_b128 v[92:95], v128 offset:7168
    v_mfma_f32_16x16x32_bf16 v[36:39], v[68:71], a[156:159], v[36:39]
    s_waitcnt lgkmcnt(4)
    s_barrier
    v_mfma_f32_16x16x32_bf16 v[40:43], v[72:75], a[144:147], v[40:43]
    ds_read_b128 v[64:67], v128 offset:8192
    v_mfma_f32_16x16x32_bf16 v[40:43], v[76:79], a[148:151], v[40:43]
    buffer_load_dwordx4 v224, s[24:27], s56 offen offset:1024 sc1 lds
    v_mfma_f32_16x16x32_bf16 v[44:47], v[72:75], a[152:155], v[44:47]
    ds_read_b128 v[68:71], v128 offset:12288
    v_mfma_f32_16x16x32_bf16 v[44:47], v[76:79], a[156:159], v[44:47]
    s_waitcnt lgkmcnt(4)
    v_mfma_f32_16x16x32_bf16 v[48:51], v[80:83], a[144:147], v[48:51]
    s_add_u32 s56, s52, 204800
    ds_read_b128 v[72:75], v128 offset:9216
    s_add_u32 m0, s53, 90112
    v_mfma_f32_16x16x32_bf16 v[48:51], v[84:87], a[148:151], v[48:51]
    buffer_load_dwordx4 v224, s[24:27], s56 offen offset:0 sc1 lds
    v_mfma_f32_16x16x32_bf16 v[52:55], v[80:83], a[152:155], v[52:55]
    ds_read_b128 v[76:79], v128 offset:13312
    v_mfma_f32_16x16x32_bf16 v[52:55], v[84:87], a[156:159], v[52:55]
    s_waitcnt lgkmcnt(4)
    v_mfma_f32_16x16x32_bf16 v[56:59], v[88:91], a[144:147], v[56:59]
    ds_read_b128 v[80:83], v128 offset:10240
    v_mfma_f32_16x16x32_bf16 v[56:59], v[92:95], a[148:151], v[56:59]
    buffer_load_dwordx4 v224, s[24:27], s56 offen offset:1024 sc1 lds
    v_mfma_f32_16x16x32_bf16 v[60:63], v[88:91], a[152:155], v[60:63]
    s_waitcnt vmcnt(16)
    ds_read_b128 v[84:87], v128 offset:14336
    v_mfma_f32_16x16x32_bf16 v[60:63], v[92:95], a[156:159], v[60:63]
    s_waitcnt lgkmcnt(4)
    v_mfma_f32_16x16x32_bf16 v[32:35], v[64:67], a[160:163], v[32:35]
    s_add_u32 s56, s52, 212992
    ds_read_b128 v[88:91], v128 offset:11264
    s_add_u32 m0, s53, 98304
    v_mfma_f32_16x16x32_bf16 v[32:35], v[68:71], a[164:167], v[32:35]
    buffer_load_dwordx4 v224, s[24:27], s56 offen offset:0 sc1 lds
    v_mfma_f32_16x16x32_bf16 v[36:39], v[64:67], a[168:171], v[36:39]
    ds_read_b128 v[92:95], v128 offset:15360
    v_mfma_f32_16x16x32_bf16 v[36:39], v[68:71], a[172:175], v[36:39]
    s_waitcnt lgkmcnt(4)
    v_mfma_f32_16x16x32_bf16 v[40:43], v[72:75], a[160:163], v[40:43]
    ds_read_b128 v[64:67], v128 offset:16384
    v_mfma_f32_16x16x32_bf16 v[40:43], v[76:79], a[164:167], v[40:43]
    buffer_load_dwordx4 v224, s[24:27], s56 offen offset:1024 sc1 lds
    v_mfma_f32_16x16x32_bf16 v[44:47], v[72:75], a[168:171], v[44:47]
    ds_read_b128 v[68:71], v128 offset:20480
    v_mfma_f32_16x16x32_bf16 v[44:47], v[76:79], a[172:175], v[44:47]
    s_waitcnt lgkmcnt(4)
    v_mfma_f32_16x16x32_bf16 v[48:51], v[80:83], a[160:163], v[48:51]
    s_add_u32 s56, s52, 221184
    ds_read_b128 v[72:75], v128 offset:17408
    s_add_u32 m0, s53, 106496
    v_mfma_f32_16x16x32_bf16 v[48:51], v[84:87], a[164:167], v[48:51]
    buffer_load_dwordx4 v224, s[24:27], s56 offen offset:0 sc1 lds
    v_mfma_f32_16x16x32_bf16 v[52:55], v[80:83], a[168:171], v[52:55]
    ds_read_b128 v[76:79], v128 offset:21504
    v_mfma_f32_16x16x32_bf16 v[52:55], v[84:87], a[172:175], v[52:55]
    s_waitcnt lgkmcnt(4)
    v_mfma_f32_16x16x32_bf16 v[56:59], v[88:91], a[160:163], v[56:59]
    ds_read_b128 v[80:83], v128 offset:18432
    v_mfma_f32_16x16x32_bf16 v[56:59], v[92:95], a[164:167], v[56:59]
    buffer_load_dwordx4 v224, s[24:27], s56 offen offset:1024 sc1 lds
    v_mfma_f32_16x16x32_bf16 v[60:63], v[88:91], a[168:171], v[60:63]
    s_waitcnt vmcnt(16)
    ds_read_b128 v[84:87], v128 offset:22528
    v_mfma_f32_16x16x32_bf16 v[60:63], v[92:95], a[172:175], v[60:63]
    s_waitcnt lgkmcnt(4)
    v_mfma_f32_16x16x32_bf16 v[32:35], v[64:67], a[176:179], v[32:35]
    ds_read_b128 v[88:91], v128 offset:19456
    v_mfma_f32_16x16x32_bf16 v[32:35], v[68:71], a[180:183], v[32:35]
    v_mfma_f32_16x16x32_bf16 v[36:39], v[64:67], a[184:187], v[36:39]
    s_waitcnt vmcnt(12)
    ds_read_b128 v[92:95], v128 offset:23552
    v_mfma_f32_16x16x32_bf16 v[36:39], v[68:71], a[188:191], v[36:39]
    s_waitcnt lgkmcnt(4)
    s_barrier
    v_mfma_f32_16x16x32_bf16 v[40:43], v[72:75], a[176:179], v[40:43]
    ds_read_b128 v[64:67], v128 offset:24576
    v_mfma_f32_16x16x32_bf16 v[40:43], v[76:79], a[180:183], v[40:43]
    v_mfma_f32_16x16x32_bf16 v[44:47], v[72:75], a[184:187], v[44:47]
    ds_read_b128 v[68:71], v128 offset:28672
    v_mfma_f32_16x16x32_bf16 v[44:47], v[76:79], a[188:191], v[44:47]
    s_waitcnt lgkmcnt(4)
    v_mfma_f32_16x16x32_bf16 v[48:51], v[80:83], a[176:179], v[48:51]
    ds_read_b128 v[72:75], v128 offset:25600
    v_mfma_f32_16x16x32_bf16 v[48:51], v[84:87], a[180:183], v[48:51]
    v_mfma_f32_16x16x32_bf16 v[52:55], v[80:83], a[184:187], v[52:55]
    ds_read_b128 v[76:79], v128 offset:29696
    v_mfma_f32_16x16x32_bf16 v[52:55], v[84:87], a[188:191], v[52:55]
    s_waitcnt lgkmcnt(4)
    v_mfma_f32_16x16x32_bf16 v[56:59], v[88:91], a[176:179], v[56:59]
    ds_read_b128 v[80:83], v128 offset:26624
    v_mfma_f32_16x16x32_bf16 v[56:59], v[92:95], a[180:183], v[56:59]
    v_cvt_pk_bf16_f32 v32, v32, v33
    v_cvt_pk_bf16_f32 v33, v34, v35
    v_cvt_pk_bf16_f32 v34, v40, v41
    v_cvt_pk_bf16_f32 v35, v42, v43
    v_mfma_f32_16x16x32_bf16 v[60:63], v[88:91], a[184:187], v[60:63]
    ds_read_b128 v[84:87], v128 offset:30720
    v_min_u32 v32, -2, v32
    v_min_u32 v33, -2, v33
    v_mfma_f32_16x16x32_bf16 v[60:63], v[92:95], a[188:191], v[60:63]
    s_waitcnt lgkmcnt(4)
    v_min_u32 v34, -2, v34
    v_min_u32 v35, -2, v35
    buffer_store_dwordx4 v[32:35], v231, s[40:43], s66 offen offset:0 sc1
    v_cvt_pk_bf16_f32 v36, v36, v37
    v_mfma_f32_16x16x32_bf16 v[0:3], v[64:67], a[64:67], v[0:3]
    ds_read_b128 v[88:91], v128 offset:27648
    v_cvt_pk_bf16_f32 v37, v38, v39
    v_cvt_pk_bf16_f32 v38, v44, v45
    v_mfma_f32_16x16x32_bf16 v[0:3], v[68:71], a[68:71], v[0:3]
    v_cvt_pk_bf16_f32 v39, v46, v47
    v_min_u32 v36, -2, v36
    v_min_u32 v37, -2, v37
    v_min_u32 v38, -2, v38
    v_mfma_f32_16x16x32_bf16 v[4:7], v[64:67], a[72:75], v[4:7]
    ds_read_b128 v[92:95], v128 offset:31744
    v_min_u32 v39, -2, v39
    buffer_store_dwordx4 v[36:39], v231, s[40:43], s66 offen offset:2048 sc1
    v_mfma_f32_16x16x32_bf16 v[4:7], v[68:71], a[76:79], v[4:7]
    s_waitcnt lgkmcnt(4)
    v_cvt_pk_bf16_f32 v48, v48, v49
    v_cvt_pk_bf16_f32 v49, v50, v51
    v_cvt_pk_bf16_f32 v50, v56, v57
    v_cvt_pk_bf16_f32 v51, v58, v59
    v_mfma_f32_16x16x32_bf16 v[8:11], v[72:75], a[64:67], v[8:11]
    ds_read_b128 v[64:67], v128 offset:57344
    v_min_u32 v48, -2, v48
    v_min_u32 v49, -2, v49
    v_mfma_f32_16x16x32_bf16 v[8:11], v[76:79], a[68:71], v[8:11]
    v_min_u32 v50, -2, v50
    v_min_u32 v51, -2, v51
    buffer_store_dwordx4 v[48:51], v231, s[40:43], s66 offen offset:1024 sc1
    v_cvt_pk_bf16_f32 v52, v52, v53
    v_mfma_f32_16x16x32_bf16 v[12:15], v[72:75], a[72:75], v[12:15]
    ds_read_b128 v[68:71], v128 offset:61440
    v_cvt_pk_bf16_f32 v53, v54, v55
    v_cvt_pk_bf16_f32 v54, v60, v61
    v_mfma_f32_16x16x32_bf16 v[12:15], v[76:79], a[76:79], v[12:15]
    s_waitcnt lgkmcnt(4)
    v_cvt_pk_bf16_f32 v55, v62, v63
    v_min_u32 v52, -2, v52
    v_min_u32 v53, -2, v53
    v_min_u32 v54, -2, v54
    v_mfma_f32_16x16x32_bf16 v[16:19], v[80:83], a[64:67], v[16:19]
    ds_read_b128 v[72:75], v128 offset:58368
    v_min_u32 v55, -2, v55
    buffer_store_dwordx4 v[52:55], v231, s[40:43], s66 offen offset:3072 sc1
    v_mfma_f32_16x16x32_bf16 v[16:19], v[84:87], a[68:71], v[16:19]
    v_mfma_f32_16x16x32_bf16 v[20:23], v[80:83], a[72:75], v[20:23]
    ds_read_b128 v[76:79], v128 offset:62464
    v_mfma_f32_16x16x32_bf16 v[20:23], v[84:87], a[76:79], v[20:23]
    s_waitcnt lgkmcnt(4)
    v_mfma_f32_16x16x32_bf16 v[24:27], v[88:91], a[64:67], v[24:27]
    ds_read_b128 v[80:83], v128 offset:59392
    v_mfma_f32_16x16x32_bf16 v[24:27], v[92:95], a[68:71], v[24:27]
    v_mfma_f32_16x16x32_bf16 v[28:31], v[88:91], a[72:75], v[28:31]
    ds_read_b128 v[84:87], v128 offset:63488
    v_mfma_f32_16x16x32_bf16 v[28:31], v[92:95], a[76:79], v[28:31]
    s_waitcnt lgkmcnt(4)
    v_mfma_f32_16x16x32_bf16 v[0:3], v[64:67], a[80:83], v[0:3]
    ds_read_b128 v[88:91], v128 offset:60416
    v_mfma_f32_16x16x32_bf16 v[0:3], v[68:71], a[84:87], v[0:3]
    v_mfma_f32_16x16x32_bf16 v[4:7], v[64:67], a[88:91], v[4:7]
    s_waitcnt vmcnt(12)
    ds_read_b128 v[92:95], v128 offset:64512
    v_mfma_f32_16x16x32_bf16 v[4:7], v[68:71], a[92:95], v[4:7]
    s_waitcnt lgkmcnt(4)
    s_barrier
    v_mfma_f32_16x16x32_bf16 v[8:11], v[72:75], a[80:83], v[8:11]
    ds_read_b128 v[64:67], v129 offset:0
    v_mfma_f32_16x16x32_bf16 v[8:11], v[76:79], a[84:87], v[8:11]
    v_mfma_f32_16x16x32_bf16 v[12:15], v[72:75], a[88:91], v[12:15]
    ds_read_b128 v[68:71], v129 offset:4096
    v_mfma_f32_16x16x32_bf16 v[12:15], v[76:79], a[92:95], v[12:15]
    s_waitcnt lgkmcnt(4)
    v_mfma_f32_16x16x32_bf16 v[16:19], v[80:83], a[80:83], v[16:19]
    ds_read_b128 v[72:75], v129 offset:1024
    v_mfma_f32_16x16x32_bf16 v[16:19], v[84:87], a[84:87], v[16:19]
    v_mfma_f32_16x16x32_bf16 v[20:23], v[80:83], a[88:91], v[20:23]
    ds_read_b128 v[76:79], v129 offset:5120
    v_mfma_f32_16x16x32_bf16 v[20:23], v[84:87], a[92:95], v[20:23]
    s_waitcnt lgkmcnt(4)
    v_mfma_f32_16x16x32_bf16 v[24:27], v[88:91], a[80:83], v[24:27]
    ds_read_b128 v[80:83], v129 offset:2048
    v_mfma_f32_16x16x32_bf16 v[24:27], v[92:95], a[84:87], v[24:27]
    v_mfma_f32_16x16x32_bf16 v[28:31], v[88:91], a[88:91], v[28:31]
    ds_read_b128 v[84:87], v129 offset:6144
    v_mfma_f32_16x16x32_bf16 v[28:31], v[92:95], a[92:95], v[28:31]
    s_waitcnt lgkmcnt(4)
    v_mfma_f32_16x16x32_bf16 v[0:3], v[64:67], a[96:99], v[0:3]
    ds_read_b128 v[88:91], v129 offset:3072
    v_mfma_f32_16x16x32_bf16 v[0:3], v[68:71], a[100:103], v[0:3]
    v_mfma_f32_16x16x32_bf16 v[4:7], v[64:67], a[104:107], v[4:7]
    ds_read_b128 v[92:95], v129 offset:7168
    v_mfma_f32_16x16x32_bf16 v[4:7], v[68:71], a[108:111], v[4:7]
    s_waitcnt lgkmcnt(4)
    v_mfma_f32_16x16x32_bf16 v[8:11], v[72:75], a[96:99], v[8:11]
    ds_read_b128 v[64:67], v129 offset:8192
    v_mfma_f32_16x16x32_bf16 v[8:11], v[76:79], a[100:103], v[8:11]
    v_mfma_f32_16x16x32_bf16 v[12:15], v[72:75], a[104:107], v[12:15]
    ds_read_b128 v[68:71], v129 offset:12288
    v_mfma_f32_16x16x32_bf16 v[12:15], v[76:79], a[108:111], v[12:15]
    s_waitcnt lgkmcnt(4)
    v_mfma_f32_16x16x32_bf16 v[16:19], v[80:83], a[96:99], v[16:19]
    ds_read_b128 v[72:75], v129 offset:9216
    v_mfma_f32_16x16x32_bf16 v[16:19], v[84:87], a[100:103], v[16:19]
    v_mfma_f32_16x16x32_bf16 v[20:23], v[80:83], a[104:107], v[20:23]
    ds_read_b128 v[76:79], v129 offset:13312
    v_mfma_f32_16x16x32_bf16 v[20:23], v[84:87], a[108:111], v[20:23]
    s_waitcnt lgkmcnt(4)
    v_mfma_f32_16x16x32_bf16 v[24:27], v[88:91], a[96:99], v[24:27]
    ds_read_b128 v[80:83], v129 offset:10240
    v_mfma_f32_16x16x32_bf16 v[24:27], v[92:95], a[100:103], v[24:27]
    v_mfma_f32_16x16x32_bf16 v[28:31], v[88:91], a[104:107], v[28:31]
    ds_read_b128 v[84:87], v129 offset:14336
    v_mfma_f32_16x16x32_bf16 v[28:31], v[92:95], a[108:111], v[28:31]
    s_waitcnt lgkmcnt(4)
    v_mfma_f32_16x16x32_bf16 v[0:3], v[64:67], a[112:115], v[0:3]
    ds_read_b128 v[88:91], v129 offset:11264
    v_mfma_f32_16x16x32_bf16 v[0:3], v[68:71], a[116:119], v[0:3]
    v_mfma_f32_16x16x32_bf16 v[4:7], v[64:67], a[120:123], v[4:7]
    s_waitcnt vmcnt(8)
    ds_read_b128 v[92:95], v129 offset:15360
    v_mfma_f32_16x16x32_bf16 v[4:7], v[68:71], a[124:127], v[4:7]
    s_waitcnt lgkmcnt(4)
    s_barrier
    v_mfma_f32_16x16x32_bf16 v[8:11], v[72:75], a[112:115], v[8:11]
    ds_read_b128 v[64:67], v129 offset:16384
    v_mfma_f32_16x16x32_bf16 v[8:11], v[76:79], a[116:119], v[8:11]
    v_mfma_f32_16x16x32_bf16 v[12:15], v[72:75], a[120:123], v[12:15]
    ds_read_b128 v[68:71], v129 offset:20480
    v_mfma_f32_16x16x32_bf16 v[12:15], v[76:79], a[124:127], v[12:15]
    s_waitcnt lgkmcnt(4)
    v_mfma_f32_16x16x32_bf16 v[16:19], v[80:83], a[112:115], v[16:19]
    ds_read_b128 v[72:75], v129 offset:17408
    v_mfma_f32_16x16x32_bf16 v[16:19], v[84:87], a[116:119], v[16:19]
    v_mfma_f32_16x16x32_bf16 v[20:23], v[80:83], a[120:123], v[20:23]
    ds_read_b128 v[76:79], v129 offset:21504
    v_mfma_f32_16x16x32_bf16 v[20:23], v[84:87], a[124:127], v[20:23]
    s_waitcnt lgkmcnt(4)
    v_mfma_f32_16x16x32_bf16 v[24:27], v[88:91], a[112:115], v[24:27]
    ds_read_b128 v[80:83], v129 offset:18432
    v_mfma_f32_16x16x32_bf16 v[24:27], v[92:95], a[116:119], v[24:27]
    v_mfma_f32_16x16x32_bf16 v[28:31], v[88:91], a[120:123], v[28:31]
    ds_read_b128 v[84:87], v129 offset:22528
    v_mfma_f32_16x16x32_bf16 v[28:31], v[92:95], a[124:127], v[28:31]
    s_waitcnt lgkmcnt(4)
    v_mfma_f32_16x16x32_bf16 v[0:3], v[64:67], a[128:131], v[0:3]
    ds_read_b128 v[88:91], v129 offset:19456
    v_mfma_f32_16x16x32_bf16 v[0:3], v[68:71], a[132:135], v[0:3]
    v_mfma_f32_16x16x32_bf16 v[4:7], v[64:67], a[136:139], v[4:7]
    ds_read_b128 v[92:95], v129 offset:23552
    v_mfma_f32_16x16x32_bf16 v[4:7], v[68:71], a[140:143], v[4:7]
    s_waitcnt lgkmcnt(4)
    v_mfma_f32_16x16x32_bf16 v[8:11], v[72:75], a[128:131], v[8:11]
    ds_read_b128 v[64:67], v129 offset:24576
    v_mfma_f32_16x16x32_bf16 v[8:11], v[76:79], a[132:135], v[8:11]
    v_mfma_f32_16x16x32_bf16 v[12:15], v[72:75], a[136:139], v[12:15]
    ds_read_b128 v[68:71], v129 offset:28672
    v_mfma_f32_16x16x32_bf16 v[12:15], v[76:79], a[140:143], v[12:15]
    s_waitcnt lgkmcnt(4)
    buffer_load_dwordx4 v[160:163], v231, s[40:43], s67 offen offset:0 sc1
    v_mfma_f32_16x16x32_bf16 v[16:19], v[80:83], a[128:131], v[16:19]
    ds_read_b128 v[72:75], v129 offset:25600
    v_mfma_f32_16x16x32_bf16 v[16:19], v[84:87], a[132:135], v[16:19]
    buffer_load_dwordx4 v[164:167], v231, s[40:43], s67 offen offset:1024 sc1
    v_mfma_f32_16x16x32_bf16 v[20:23], v[80:83], a[136:139], v[20:23]
    ds_read_b128 v[76:79], v129 offset:29696
    v_mfma_f32_16x16x32_bf16 v[20:23], v[84:87], a[140:143], v[20:23]
    s_waitcnt lgkmcnt(4)
    v_mfma_f32_16x16x32_bf16 v[24:27], v[88:91], a[128:131], v[24:27]
    ds_read_b128 v[80:83], v129 offset:26624
    v_mfma_f32_16x16x32_bf16 v[24:27], v[92:95], a[132:135], v[24:27]
    buffer_load_dwordx4 v[168:171], v231, s[40:43], s67 offen offset:2048 sc1
    v_mfma_f32_16x16x32_bf16 v[28:31], v[88:91], a[136:139], v[28:31]
    ds_read_b128 v[84:87], v129 offset:30720
    v_mfma_f32_16x16x32_bf16 v[28:31], v[92:95], a[140:143], v[28:31]
    s_waitcnt lgkmcnt(4)
    buffer_load_dwordx4 v[172:175], v231, s[40:43], s67 offen offset:3072 sc1
    v_mfma_f32_16x16x32_bf16 v[0:3], v[64:67], a[144:147], v[0:3]
    ds_read_b128 v[88:91], v129 offset:27648
    v_mfma_f32_16x16x32_bf16 v[0:3], v[68:71], a[148:151], v[0:3]
    v_mfma_f32_16x16x32_bf16 v[4:7], v[64:67], a[152:155], v[4:7]
    s_waitcnt vmcnt(8)
    ds_read_b128 v[92:95], v129 offset:31744
    v_mfma_f32_16x16x32_bf16 v[4:7], v[68:71], a[156:159], v[4:7]
    s_waitcnt lgkmcnt(4)
    s_barrier
    v_mfma_f32_16x16x32_bf16 v[8:11], v[72:75], a[144:147], v[8:11]
    ds_read_b128 v[64:67], v129 offset:32768
    v_mfma_f32_16x16x32_bf16 v[8:11], v[76:79], a[148:151], v[8:11]
    v_mfma_f32_16x16x32_bf16 v[12:15], v[72:75], a[152:155], v[12:15]
    ds_read_b128 v[68:71], v129 offset:36864
    v_mfma_f32_16x16x32_bf16 v[12:15], v[76:79], a[156:159], v[12:15]
    s_waitcnt lgkmcnt(4)
    v_mfma_f32_16x16x32_bf16 v[16:19], v[80:83], a[144:147], v[16:19]
    ds_read_b128 v[72:75], v129 offset:33792
    v_mfma_f32_16x16x32_bf16 v[16:19], v[84:87], a[148:151], v[16:19]
    v_mfma_f32_16x16x32_bf16 v[20:23], v[80:83], a[152:155], v[20:23]
    ds_read_b128 v[76:79], v129 offset:37888
    v_mfma_f32_16x16x32_bf16 v[20:23], v[84:87], a[156:159], v[20:23]
    s_waitcnt lgkmcnt(4)
    v_mfma_f32_16x16x32_bf16 v[24:27], v[88:91], a[144:147], v[24:27]
    ds_read_b128 v[80:83], v129 offset:34816
    v_mfma_f32_16x16x32_bf16 v[24:27], v[92:95], a[148:151], v[24:27]
    v_mfma_f32_16x16x32_bf16 v[28:31], v[88:91], a[152:155], v[28:31]
    ds_read_b128 v[84:87], v129 offset:38912
    v_mfma_f32_16x16x32_bf16 v[28:31], v[92:95], a[156:159], v[28:31]
    s_waitcnt lgkmcnt(4)
    v_mfma_f32_16x16x32_bf16 v[0:3], v[64:67], a[160:163], v[0:3]
    ds_read_b128 v[88:91], v129 offset:35840
    v_mfma_f32_16x16x32_bf16 v[0:3], v[68:71], a[164:167], v[0:3]
    v_mfma_f32_16x16x32_bf16 v[4:7], v[64:67], a[168:171], v[4:7]
    ds_read_b128 v[92:95], v129 offset:39936
    v_mfma_f32_16x16x32_bf16 v[4:7], v[68:71], a[172:175], v[4:7]
    s_waitcnt lgkmcnt(4)
    v_mfma_f32_16x16x32_bf16 v[8:11], v[72:75], a[160:163], v[8:11]
    ds_read_b128 v[64:67], v129 offset:40960
    v_mfma_f32_16x16x32_bf16 v[8:11], v[76:79], a[164:167], v[8:11]
    v_mfma_f32_16x16x32_bf16 v[12:15], v[72:75], a[168:171], v[12:15]
    ds_read_b128 v[68:71], v129 offset:45056
    v_mfma_f32_16x16x32_bf16 v[12:15], v[76:79], a[172:175], v[12:15]
    s_waitcnt lgkmcnt(4)
    v_mfma_f32_16x16x32_bf16 v[16:19], v[80:83], a[160:163], v[16:19]
    ds_read_b128 v[72:75], v129 offset:41984
    v_mfma_f32_16x16x32_bf16 v[16:19], v[84:87], a[164:167], v[16:19]
    v_mfma_f32_16x16x32_bf16 v[20:23], v[80:83], a[168:171], v[20:23]
    ds_read_b128 v[76:79], v129 offset:46080
    v_mfma_f32_16x16x32_bf16 v[20:23], v[84:87], a[172:175], v[20:23]
    s_waitcnt lgkmcnt(4)
    v_mfma_f32_16x16x32_bf16 v[24:27], v[88:91], a[160:163], v[24:27]
    ds_read_b128 v[80:83], v129 offset:43008
    v_mfma_f32_16x16x32_bf16 v[24:27], v[92:95], a[164:167], v[24:27]
    v_mfma_f32_16x16x32_bf16 v[28:31], v[88:91], a[168:171], v[28:31]
    ds_read_b128 v[84:87], v129 offset:47104
    v_mfma_f32_16x16x32_bf16 v[28:31], v[92:95], a[172:175], v[28:31]
    s_waitcnt lgkmcnt(4)
    v_mfma_f32_16x16x32_bf16 v[0:3], v[64:67], a[176:179], v[0:3]
    ds_read_b128 v[88:91], v129 offset:44032
    v_mfma_f32_16x16x32_bf16 v[0:3], v[68:71], a[180:183], v[0:3]
    v_mfma_f32_16x16x32_bf16 v[4:7], v[64:67], a[184:187], v[4:7]
    ds_read_b128 v[92:95], v129 offset:48128
    v_mfma_f32_16x16x32_bf16 v[4:7], v[68:71], a[188:191], v[4:7]
    s_waitcnt lgkmcnt(4)
    v_mfma_f32_16x16x32_bf16 v[8:11], v[72:75], a[176:179], v[8:11]
    v_mfma_f32_16x16x32_bf16 v[8:11], v[76:79], a[180:183], v[8:11]
    v_mfma_f32_16x16x32_bf16 v[12:15], v[72:75], a[184:187], v[12:15]
    v_mfma_f32_16x16x32_bf16 v[12:15], v[76:79], a[188:191], v[12:15]
    s_waitcnt lgkmcnt(2)
    v_mfma_f32_16x16x32_bf16 v[16:19], v[80:83], a[176:179], v[16:19]
    v_mfma_f32_16x16x32_bf16 v[16:19], v[84:87], a[180:183], v[16:19]
    v_mfma_f32_16x16x32_bf16 v[20:23], v[80:83], a[184:187], v[20:23]
    v_mfma_f32_16x16x32_bf16 v[20:23], v[84:87], a[188:191], v[20:23]
    s_waitcnt lgkmcnt(0)
    v_mfma_f32_16x16x32_bf16 v[24:27], v[88:91], a[176:179], v[24:27]
    v_mfma_f32_16x16x32_bf16 v[24:27], v[92:95], a[180:183], v[24:27]
    v_mfma_f32_16x16x32_bf16 v[28:31], v[88:91], a[184:187], v[28:31]
    v_mfma_f32_16x16x32_bf16 v[28:31], v[92:95], a[188:191], v[28:31]
    s_waitcnt vmcnt(0)
    v_max3_u32 v152, v160, v161, v162
    v_max3_u32 v153, v163, v164, v165
    v_max3_u32 v152, v152, v166, v167
    v_max3_u32 v153, v153, v168, v169
    v_max3_u32 v152, v152, v170, v171
    v_max3_u32 v153, v153, v172, v173
    v_max3_u32 v152, v152, v174, v175
    v_max_u32 v152, v152, v153
    v_cmp_eq_u32 vcc, -1, v152
    s_nop 4
    s_cbranch_vccnz L_sequential_preLN__softmax_full_mha__glu_gated_swiglu__prompt_kernel_xpoll_29
L_sequential_preLN__softmax_full_mha__glu_gated_swiglu__prompt_kernel_xpoll_29_x:
    v_lshlrev_b32 v156, 16, v160
    v_and_b32 v157, 0xffff0000, v160
    v_lshlrev_b32 v158, 16, v161
    v_and_b32 v159, 0xffff0000, v161
    v_pk_add_f32 v[0:1], v[0:1], v[156:157] op_sel:[0,0] op_sel_hi:[1,1]
    v_pk_add_f32 v[2:3], v[2:3], v[158:159] op_sel:[0,0] op_sel_hi:[1,1]
    v_cvt_pk_bf16_f32 v160, v0, v1
    v_cvt_pk_bf16_f32 v161, v2, v3
    v_lshlrev_b32 v156, 16, v162
    v_and_b32 v157, 0xffff0000, v162
    v_lshlrev_b32 v158, 16, v163
    v_and_b32 v159, 0xffff0000, v163
    v_pk_add_f32 v[8:9], v[8:9], v[156:157] op_sel:[0,0] op_sel_hi:[1,1]
    v_pk_add_f32 v[10:11], v[10:11], v[158:159] op_sel:[0,0] op_sel_hi:[1,1]
    v_cvt_pk_bf16_f32 v162, v8, v9
    v_cvt_pk_bf16_f32 v163, v10, v11
    s_nop 1
    v_permlane16_swap_b32 v160, v162
    v_permlane16_swap_b32 v161, v163
    buffer_store_dwordx4 v[160:163], v154, s[36:39], s60 offen offset:0 sc1
    v_lshlrev_b32 v156, 16, v168
    v_and_b32 v157, 0xffff0000, v168
    v_lshlrev_b32 v158, 16, v169
    v_and_b32 v159, 0xffff0000, v169
    v_pk_add_f32 v[4:5], v[4:5], v[156:157] op_sel:[0,0] op_sel_hi:[1,1]
    v_pk_add_f32 v[6:7], v[6:7], v[158:159] op_sel:[0,0] op_sel_hi:[1,1]
    v_cvt_pk_bf16_f32 v168, v4, v5
    v_cvt_pk_bf16_f32 v169, v6, v7
    v_lshlrev_b32 v156, 16, v170
    v_and_b32 v157, 0xffff0000, v170
    v_lshlrev_b32 v158, 16, v171
    v_and_b32 v159, 0xffff0000, v171
    v_pk_add_f32 v[12:13], v[12:13], v[156:157] op_sel:[0,0] op_sel_hi:[1,1]
    v_pk_add_f32 v[14:15], v[14:15], v[158:159] op_sel:[0,0] op_sel_hi:[1,1]
    v_cvt_pk_bf16_f32 v170, v12, v13
    v_cvt_pk_bf16_f32 v171, v14, v15
    s_nop 1
    v_permlane16_swap_b32 v168, v170
    v_permlane16_swap_b32 v169, v171
    buffer_store_dwordx4 v[168:171], v154, s[36:39], s61 offen offset:0 sc1
    v_lshlrev_b32 v156, 16, v164
    v_and_b32 v157, 0xffff0000, v164
    v_lshlrev_b32 v158, 16, v165
    v_and_b32 v159, 0xffff0000, v165
    v_pk_add_f32 v[16:17], v[16:17], v[156:157] op_sel:[0,0] op_sel_hi:[1,1]
    v_pk_add_f32 v[18:19], v[18:19], v[158:159] op_sel:[0,0] op_sel_hi:[1,1]
    v_cvt_pk_bf16_f32 v164, v16, v17
    v_cvt_pk_bf16_f32 v165, v18, v19
    v_lshlrev_b32 v156, 16, v166
    v_and_b32 v157, 0xffff0000, v166
    v_lshlrev_b32 v158, 16, v167
    v_and_b32 v159, 0xffff0000, v167
    v_pk_add_f32 v[24:25], v[24:25], v[156:157] op_sel:[0,0] op_sel_hi:[1,1]
    v_pk_add_f32 v[26:27], v[26:27], v[158:159] op_sel:[0,0] op_sel_hi:[1,1]
    v_cvt_pk_bf16_f32 v166, v24, v25
    v_cvt_pk_bf16_f32 v167, v26, v27
    s_nop 1
    v_permlane16_swap_b32 v164, v166
    v_permlane16_swap_b32 v165, v167
    buffer_store_dwordx4 v[164:167], v154, s[36:39], s60 offen offset:64 sc1
    v_lshlrev_b32 v156, 16, v172
    v_and_b32 v157, 0xffff0000, v172
    v_lshlrev_b32 v158, 16, v173
    v_and_b32 v159, 0xffff0000, v173
    v_pk_add_f32 v[20:21], v[20:21], v[156:157] op_sel:[0,0] op_sel_hi:[1,1]
    v_pk_add_f32 v[22:23], v[22:23], v[158:159] op_sel:[0,0] op_sel_hi:[1,1]
    v_cvt_pk_bf16_f32 v172, v20, v21
    v_cvt_pk_bf16_f32 v173, v22, v23
    v_lshlrev_b32 v156, 16, v174
    v_and_b32 v157, 0xffff0000, v174
    v_lshlrev_b32 v158, 16, v175
    v_and_b32 v159, 0xffff0000, v175
    v_pk_add_f32 v[28:29], v[28:29], v[156:157] op_sel:[0,0] op_sel_hi:[1,1]
    v_pk_add_f32 v[30:31], v[30:31], v[158:159] op_sel:[0,0] op_sel_hi:[1,1]
    v_cvt_pk_bf16_f32 v174, v28, v29
    v_cvt_pk_bf16_f32 v175, v30, v31
    s_nop 1
    v_permlane16_swap_b32 v172, v174
    v_permlane16_swap_b32 v173, v175
    buffer_store_dwordx4 v[172:175], v154, s[36:39], s61 offen offset:64 sc1
    s_endpgm
L_sequential_preLN__softmax_full_mha__glu_gated_swiglu__prompt_kernel_xpoll_29:
    s_sub_u32 s69, s69, 1
    s_cbranch_scc1 L_sequential_preLN__softmax_full_mha__glu_gated_swiglu__prompt_kernel_xpoll_29_x
    buffer_load_dwordx4 v[160:163], v231, s[40:43], s67 offen offset:0 sc1
    buffer_load_dwordx4 v[164:167], v231, s[40:43], s67 offen offset:1024 sc1
    buffer_load_dwordx4 v[168:171], v231, s[40:43], s67 offen offset:2048 sc1
    buffer_load_dwordx4 v[172:175], v231, s[40:43], s67 offen offset:3072 sc1
    s_waitcnt vmcnt(0)
    v_max3_u32 v152, v160, v161, v162
    v_max3_u32 v153, v163, v164, v165
    v_max3_u32 v152, v152, v166, v167
    v_max3_u32 v153, v153, v168, v169
    v_max3_u32 v152, v152, v170, v171
    v_max3_u32 v153, v153, v172, v173
    v_max3_u32 v152, v152, v174, v175
    v_max_u32 v152, v152, v153
    v_cmp_eq_u32 vcc, -1, v152
    s_nop 4
    s_cbranch_vccnz L_sequential_preLN__softmax_full_mha__glu_gated_swiglu__prompt_kernel_xpoll_29
    s_branch L_sequential_preLN__softmax_full_mha__glu_gated_swiglu__prompt_kernel_xpoll_29_x
L_sequential_preLN__softmax_full_mha__glu_gated_swiglu__prompt_kernel_allspin_14:
    s_mov_b32 s94, 262144
L_sequential_preLN__softmax_full_mha__glu_gated_swiglu__prompt_kernel_allspin_14_l:
    s_sub_u32 s94, s94, 1
    s_cbranch_scc1 L_sequential_preLN__softmax_full_mha__glu_gated_swiglu__prompt_kernel_allspin_14_r
    s_sleep 8
    buffer_load_dword v249, v248, s[88:91], s51 offen sc1
    s_waitcnt vmcnt(0)
    v_cmp_gt_u32 vcc, s50, v249
    s_nop 4
    s_cbranch_vccnz L_sequential_preLN__softmax_full_mha__glu_gated_swiglu__prompt_kernel_allspin_14_l
    s_branch L_sequential_preLN__softmax_full_mha__glu_gated_swiglu__prompt_kernel_allspin_14_r
L_sequential_preLN__softmax_full_mha__glu_gated_swiglu__prompt_kernel_gspin_21:
    s_mov_b32 s50, 262144
L_sequential_preLN__softmax_full_mha__glu_gated_swiglu__prompt_kernel_gspin_21_l:
    s_sub_u32 s50, s50, 1
    s_cbranch_scc1 L_sequential_preLN__softmax_full_mha__glu_gated_swiglu__prompt_kernel_gspin_21_r
    s_sleep 16
    buffer_load_dword v245, v244, s[88:91], s73 offen sc1
    s_waitcnt vmcnt(0)
    v_cmp_gt_u32 vcc, 16, v245
    s_nop 4
    s_cbranch_vccnz L_sequential_preLN__softmax_full_mha__glu_gated_swiglu__prompt_kernel_gspin_21_l
    s_branch L_sequential_preLN__softmax_full_mha__glu_gated_swiglu__prompt_kernel_gspin_21_r
L_sequential_preLN__softmax_full_mha__glu_gated_swiglu__prompt_kernel_gspin_22:
    s_mov_b32 s50, 262144
L_sequential_preLN__softmax_full_mha__glu_gated_swiglu__prompt_kernel_gspin_22_l:
    s_sub_u32 s50, s50, 1
    s_cbranch_scc1 L_sequential_preLN__softmax_full_mha__glu_gated_swiglu__prompt_kernel_gspin_22_r
    s_sleep 16
    buffer_load_dword v227, v226, s[88:91], s73 offen sc1
    s_waitcnt vmcnt(0)
    v_cmp_gt_u32 vcc, 16, v227
    s_nop 4
    s_cbranch_vccnz L_sequential_preLN__softmax_full_mha__glu_gated_swiglu__prompt_kernel_gspin_22_l
    s_branch L_sequential_preLN__softmax_full_mha__glu_gated_swiglu__prompt_kernel_gspin_22_r
L_sequential_preLN__softmax_full_mha__glu_gated_swiglu__prompt_kernel_spin_2:
    s_mov_b32 s94, 262144
L_sequential_preLN__softmax_full_mha__glu_gated_swiglu__prompt_kernel_spin_2_l:
    s_sleep 8
    s_sub_u32 s94, s94, 1
    s_cbranch_scc1 L_sequential_preLN__softmax_full_mha__glu_gated_swiglu__prompt_kernel_ok_3
    buffer_load_dword v130, v131, s[32:35], 0 offen sc1
    s_waitcnt vmcnt(0)
    v_cmp_gt_u32 vcc, v129, v130
    s_nop 4
    s_cbranch_vccnz L_sequential_preLN__softmax_full_mha__glu_gated_swiglu__prompt_kernel_spin_2_l
    s_branch L_sequential_preLN__softmax_full_mha__glu_gated_swiglu__prompt_kernel_ok_3
L_sequential_preLN__softmax_full_mha__glu_gated_swiglu__prompt_kernel_fb_4:
    s_waitcnt vmcnt(0) lgkmcnt(0)
    s_lshl_b32 s51, s67, 18
    s_mov_b32 s50, 64
    v_mov_b32 v164, 0xff800000
    v_mov_b32 v165, 0xff800000
    v_mov_b32 v248, v228
L_sequential_preLN__softmax_full_mha__glu_gated_swiglu__prompt_kernel_maxloop_31:
    buffer_load_dwordx4 a[184:187], v233, s[24:27], s51 offen offset:0 sc1
    buffer_load_dwordx4 a[188:191], v233, s[24:27], s51 offen offset:1024 sc1
    s_waitcnt vmcnt(0)
    v_mfma_f32_32x32x16_bf16 v[16:31], a[184:187], v[0:3], 0
    v_mfma_f32_32x32x16_bf16 v[16:31], a[188:191], v[4:7], v[16:31]
    v_mfma_f32_32x32x16_bf16 v[32:47], a[184:187], v[8:11], 0
    v_mfma_f32_32x32x16_bf16 v[32:47], a[188:191], v[12:15], v[32:47]
    s_nop 15
    v_max3_f32 v164, v164, v16, v17
    v_max3_f32 v164, v164, v18, v19
    v_max3_f32 v164, v164, v20, v21
    v_max3_f32 v164, v164, v22, v23
    v_max3_f32 v164, v164, v24, v25
    v_max3_f32 v164, v164, v26, v27
    v_max3_f32 v164, v164, v28, v29
    v_max3_f32 v164, v164, v30, v31
    v_max3_f32 v165, v165, v32, v33
    v_max3_f32 v165, v165, v34, v35
    v_max3_f32 v165, v165, v36, v37
    v_max3_f32 v165, v165, v38, v39
    v_max3_f32 v165, v165, v40, v41
    v_max3_f32 v165, v165, v42, v43
    v_max3_f32 v165, v165, v44, v45
    v_max3_f32 v165, v165, v46, v47
    s_add_u32 s51, s51, 4096
    s_sub_u32 s50, s50, 1
    s_cmp_lg_u32 s50, 0
    s_cbranch_scc1 L_sequential_preLN__softmax_full_mha__glu_gated_swiglu__prompt_kernel_maxloop_31
    v_mov_b32 v226, v164
    v_mov_b32 v227, v165
    v_mov_b32 v228, -1.0
    v_permlane32_swap_b32 v164, v226
    v_permlane32_swap_b32 v165, v227
    v_max_f32 v164, v164, v226
    v_max_f32 v165, v165, v227
    v_pk_mul_f32 v[48:49], v[164:165], v[228:229] op_sel:[0,0] op_sel_hi:[0,0]
    v_pk_mul_f32 v[50:51], v[164:165], v[228:229] op_sel:[0,0] op_sel_hi:[0,0]
    v_pk_mul_f32 v[52:53], v[164:165], v[228:229] op_sel:[0,0] op_sel_hi:[0,0]
    v_pk_mul_f32 v[54:55], v[164:165], v[228:229] op_sel:[0,0] op_sel_hi:[0,0]
    v_pk_mul_f32 v[56:57], v[164:165], v[228:229] op_sel:[0,0] op_sel_hi:[0,0]
    v_pk_mul_f32 v[58:59], v[164:165], v[228:229] op_sel:[0,0] op_sel_hi:[0,0]
    v_pk_mul_f32 v[60:61], v[164:165], v[228:229] op_sel:[0,0] op_sel_hi:[0,0]
    v_pk_mul_f32 v[62:63], v[164:165], v[228:229] op_sel:[0,0] op_sel_hi:[0,0]
    v_pk_mul_f32 v[64:65], v[164:165], v[228:229] op_sel:[1,0] op_sel_hi:[1,0]
    v_pk_mul_f32 v[66:67], v[164:165], v[228:229] op_sel:[1,0] op_sel_hi:[1,0]
    v_pk_mul_f32 v[68:69], v[164:165], v[228:229] op_sel:[1,0] op_sel_hi:[1,0]
    v_pk_mul_f32 v[70:71], v[164:165], v[228:229] op_sel:[1,0] op_sel_hi:[1,0]
    v_pk_mul_f32 v[72:73], v[164:165], v[228:229] op_sel:[1,0] op_sel_hi:[1,0]
    v_pk_mul_f32 v[74:75], v[164:165], v[228:229] op_sel:[1,0] op_sel_hi:[1,0]
    v_pk_mul_f32 v[76:77], v[164:165], v[228:229] op_sel:[1,0] op_sel_hi:[1,0]
    v_pk_mul_f32 v[78:79], v[164:165], v[228:229] op_sel:[1,0] op_sel_hi:[1,0]
    v_mov_b32 v228, v248
    v_mov_b32 v192, 0
    v_mov_b32 v193, 0
    v_mov_b32 v194, 0
    v_mov_b32 v195, 0
    v_mov_b32 v196, 0
    v_mov_b32 v197, 0
    v_mov_b32 v198, 0
    v_mov_b32 v199, 0
    v_mov_b32 v200, 0
    v_mov_b32 v201, 0
    v_mov_b32 v202, 0
    v_mov_b32 v203, 0
    v_mov_b32 v204, 0
    v_mov_b32 v205, 0
    v_mov_b32 v206, 0
    v_mov_b32 v207, 0
    v_mov_b32 v208, 0
    v_mov_b32 v209, 0
    v_mov_b32 v210, 0
    v_mov_b32 v211, 0
    v_mov_b32 v212, 0
    v_mov_b32 v213, 0
    v_mov_b32 v214, 0
    v_mov_b32 v215, 0
    v_mov_b32 v216, 0
    v_mov_b32 v217, 0
    v_mov_b32 v218, 0
    v_mov_b32 v219, 0
    v_mov_b32 v220, 0
    v_mov_b32 v221, 0
    v_mov_b32 v222, 0
    v_mov_b32 v223, 0
    v_mov_b32 v176, 0
    v_mov_b32 v177, 0
    v_mov_b32 v178, 0
    v_mov_b32 v179, 0
    v_mov_b32 v180, 0
    v_mov_b32 v181, 0
    v_mov_b32 v182, 0
    v_mov_b32 v183, 0
    s_lshl_b32 s51, s67, 18
    s_mov_b32 s50, 64
L_sequential_preLN__softmax_full_mha__glu_gated_swiglu__prompt_kernel_pass2_32:
    buffer_load_dwordx4 a[184:187], v233, s[24:27], s51 offen offset:0 sc1
    buffer_load_dwordx4 a[188:191], v233, s[24:27], s51 offen offset:1024 sc1
    buffer_load_dwordx4 a[192:195], v233, s[24:27], s51 offen offset:2048 sc1
    buffer_load_dwordx4 a[196:199], v233, s[24:27], s51 offen offset:3072 sc1
    s_waitcnt vmcnt(0)
    v_mfma_f32_32x32x16_bf16 v[16:31], a[184:187], v[0:3], v[48:63]
    v_mfma_f32_32x32x16_bf16 v[16:31], a[188:191], v[4:7], v[16:31]
    v_mfma_f32_32x32x16_bf16 v[32:47], a[184:187], v[8:11], v[64:79]
    v_mfma_f32_32x32x16_bf16 v[32:47], a[188:191], v[12:15], v[32:47]
    s_nop 15
    v_exp_f32 v16, v16
    v_exp_f32 v17, v17
    v_exp_f32 v18, v18
    v_exp_f32 v19, v19
    v_exp_f32 v20, v20
    v_exp_f32 v21, v21
    v_exp_f32 v22, v22
    v_exp_f32 v23, v23
    v_exp_f32 v24, v24
    v_exp_f32 v25, v25
    v_exp_f32 v26, v26
    v_exp_f32 v27, v27
    v_exp_f32 v28, v28
    v_exp_f32 v29, v29
    v_exp_f32 v30, v30
    v_exp_f32 v31, v31
    v_cvt_pk_bf16_f32 v112, v16, v17
    v_cvt_pk_bf16_f32 v113, v18, v19
    v_cvt_pk_bf16_f32 v114, v20, v21
    v_cvt_pk_bf16_f32 v115, v22, v23
    v_cvt_pk_bf16_f32 v116, v24, v25
    v_cvt_pk_bf16_f32 v117, v26, v27
    v_cvt_pk_bf16_f32 v118, v28, v29
    v_cvt_pk_bf16_f32 v119, v30, v31
    v_exp_f32 v32, v32
    v_exp_f32 v33, v33
    v_exp_f32 v34, v34
    v_exp_f32 v35, v35
    v_exp_f32 v36, v36
    v_exp_f32 v37, v37
    v_exp_f32 v38, v38
    v_exp_f32 v39, v39
    v_exp_f32 v40, v40
    v_exp_f32 v41, v41
    v_exp_f32 v42, v42
    v_exp_f32 v43, v43
    v_exp_f32 v44, v44
    v_exp_f32 v45, v45
    v_exp_f32 v46, v46
    v_exp_f32 v47, v47
    v_cvt_pk_bf16_f32 v120, v32, v33
    v_cvt_pk_bf16_f32 v121, v34, v35
    v_cvt_pk_bf16_f32 v122, v36, v37
    v_cvt_pk_bf16_f32 v123, v38, v39
    v_cvt_pk_bf16_f32 v124, v40, v41
    v_cvt_pk_bf16_f32 v125, v42, v43
    v_cvt_pk_bf16_f32 v126, v44, v45
    v_cvt_pk_bf16_f32 v127, v46, v47
    s_nop 1
    v_mfma_f32_32x32x16_bf16 v[192:207], a[192:195], v[112:115], v[192:207]
    v_mfma_f32_32x32x16_bf16 v[192:207], a[196:199], v[116:119], v[192:207]
    v_smfmac_f32_16x16x64_bf16 v[176:179], v[152:155], v[112:119], v156
    v_mfma_f32_32x32x16_bf16 v[208:223], a[192:195], v[120:123], v[208:223]
    v_mfma_f32_32x32x16_bf16 v[208:223], a[196:199], v[124:127], v[208:223]
    v_smfmac_f32_16x16x64_bf16 v[180:183], v[152:155], v[120:127], v156
    s_nop 7
    s_add_u32 s51, s51, 4096
    s_sub_u32 s50, s50, 1
    s_cmp_lg_u32 s50, 0
    s_cbranch_scc1 L_sequential_preLN__softmax_full_mha__glu_gated_swiglu__prompt_kernel_pass2_32
    v_mov_b32 v80, 0
    v_mov_b32 v81, 0
    v_mov_b32 v82, 0
    v_mov_b32 v83, 0
    v_mov_b32 v84, 0
    v_mov_b32 v85, 0
    v_mov_b32 v86, 0
    v_mov_b32 v87, 0
    v_mov_b32 v88, 0
    v_mov_b32 v89, 0
    v_mov_b32 v90, 0
    v_mov_b32 v91, 0
    v_mov_b32 v92, 0
    v_mov_b32 v93, 0
    v_mov_b32 v94, 0
    v_mov_b32 v95, 0
    v_mov_b32 v96, 0
    v_mov_b32 v97, 0
    v_mov_b32 v98, 0
    v_mov_b32 v99, 0
    v_mov_b32 v100, 0
    v_mov_b32 v101, 0
    v_mov_b32 v102, 0
    v_mov_b32 v103, 0
    v_mov_b32 v104, 0
    v_mov_b32 v105, 0
    v_mov_b32 v106, 0
    v_mov_b32 v107, 0
    v_mov_b32 v108, 0
    v_mov_b32 v109, 0
    v_mov_b32 v110, 0
    v_mov_b32 v111, 0
    v_add_f32 v244, v176, v177
    v_add_f32 v245, v180, v181
    v_rcp_f32 v244, v244
    v_rcp_f32 v245, v245
    v_mov_b32 v246, 0
    v_mov_b32 v247, 0
    s_branch L_sequential_preLN__softmax_full_mha__glu_gated_swiglu__prompt_kernel_nofb_5
L_sequential_preLN__softmax_full_mha__glu_gated_swiglu__prompt_kernel_fin_30:
L_sequential_preLN__softmax_full_mha__glu_gated_swiglu__prompt_kernel_end:
    s_endpgm
.section .rodata,"a"
.p2align 6
.amdhsa_kernel sequential_preLN__softmax_full_mha__glu_gated_swiglu__prompt_kernel
  .amdhsa_next_free_vgpr 512
  .amdhsa_next_free_sgpr 102
  .amdhsa_accum_offset 256
  .amdhsa_group_segment_fixed_size 0
  .amdhsa_kernarg_size 80
  .amdhsa_user_sgpr_count 2
  .amdhsa_user_sgpr_kernarg_segment_ptr 1
  .amdhsa_system_sgpr_workgroup_id_x 1
.end_amdhsa_kernel
```
